```python
import torch

def _softmax(x, axis=-1):
    return torch.softmax(x, dim=axis)
def _gelu(x):
    return torch.nn.functional.gelu(x, approximate="tanh")
def _silu(x):
    return torch.nn.functional.silu(x)
def _sigmoid(x):
    return torch.sigmoid(x)
def _layernorm(x, axis=-1, eps=1e-5):
    m = x.mean(dim=axis, keepdim=True)
    v = x.var(dim=axis, keepdim=True, unbiased=False)
    return (x - m) / torch.sqrt(v + eps)
def _scatter_add(tgt, idx, src, axis=0):
    return tgt.clone().index_add_(axis, idx, src)
def _segment_sum(src, seg, n):
    out = torch.zeros((n,) + src.shape[1:], dtype=src.dtype)
    return out.index_add_(0, seg, src)
def _pad(x, pw):
    flat = tuple(v for pair in reversed(pw) for v in pair)
    return torch.nn.functional.pad(x, flat)

kernel_name = 'interleave_layers__linear_kernel_hedgehog__dense_activation_squared_relu__prompt'

def setup_inputs():

    _w = (lambda a: (lambda t: t.to(torch.bfloat16) if t.is_floating_point() else t)(torch.as_tensor(a)))
    def _A_setup():
        B, S, D, H = 1, 2048, 640, 32
        Dh = D // H
        return {
            "x": _w((lambda *s: torch.randn(*s, dtype=torch.bfloat16) * 0.05)(B, S, D)),
            "wqkv": _w((lambda *s: torch.randn(*s, dtype=torch.bfloat16) * 0.2)(D, 3 * D)),
            "w_phi": _w((lambda *s: torch.randn(*s, dtype=torch.bfloat16) * 0.2)(H, Dh, Dh) * (Dh ** -0.5)),
            "wo": _w((lambda *s: torch.randn(*s, dtype=torch.bfloat16) * 0.05)(D, D)),
        }
    _A_in = _A_setup()

    def _B_setup():
        B, S, D, F = 1, 2048, 640, 1728
        return {
            "x": _w((lambda *s: torch.randn(*s, dtype=torch.bfloat16) * 0.05)(B, S, D)),
            "w1": _w((lambda *s: torch.randn(*s, dtype=torch.bfloat16) * 0.05)(D, F)),
            "b1": _w((lambda *s: torch.randn(*s, dtype=torch.bfloat16) * 0.2)(F)),
            "w2": _w((lambda *s: torch.randn(*s, dtype=torch.bfloat16) * 0.05)(F, D)),
            "b2": _w((lambda *s: torch.randn(*s, dtype=torch.bfloat16) * 0.8)(D)),
        }
    _B_in = _B_setup()

    return {
        "A_x": _A_in["x"],
        "A_wqkv": _A_in["wqkv"],
        "A_w_phi": _A_in["w_phi"],
        "A_wo": _A_in["wo"],
        "B_x": _B_in["x"],
        "B_w1": _B_in["w1"],
        "B_b1": _B_in["b1"],
        "B_w2": _B_in["w2"],
        "B_b2": _B_in["b2"],
    }

def reference(A_x, A_wqkv, A_w_phi, A_wo, B_x, B_w1, B_b1, B_w2, B_b2):
    def _A_ref(x, wqkv, w_phi, wo):
        B, S, D = x.shape
        H = 32; Dh = D // H
        qkv = (lambda x, *d: x.permute(*d))((x @ wqkv).reshape(B, S, 3, H, Dh), 2, 0, 3, 1, 4)
        q, k, v = qkv[0], qkv[1], qkv[2]
        pq = torch.einsum("bhsd,hdf->bhsf", q, w_phi)
        pk = torch.einsum("bhsd,hdf->bhsf", k, w_phi)
        phi_q = torch.concatenate([_softmax(pq, axis=-1), _softmax(-pq, axis=-1)], axis=-1)
        phi_k = torch.concatenate([_softmax(pk, axis=-1), _softmax(-pk, axis=-1)], axis=-1)
        kv = torch.einsum("bhsf,bhsd->bhfd", phi_k, v)
        z  = torch.einsum("bhsf->bhf", phi_k)
        num = torch.einsum("bhqf,bhfd->bhqd", phi_q, kv)
        den = torch.einsum("bhqf,bhf->bhq", phi_q, z)[..., None] + 1e-6
        o = num / den
        return (lambda x, *d: x.permute(*d))(o, 0, 2, 1, 3).reshape(B, S, D) @ wo

    def _B_ref(x, w1, b1, w2, b2):
        h = torch.einsum("bsd,df->bsf", x, w1) + b1
        zero = torch.zeros_like(h)
        r = torch.where(h > zero, h, zero)
        h = r * r
        out = torch.einsum("bsf,fd->bsd", h, w2) + b2
        return out

    x = A_x
    x = x + _A_ref(_layernorm(x, axis=-1), A_wqkv, A_w_phi, A_wo)
    x = x + _B_ref(_layernorm(x, axis=-1), B_w1, B_b1, B_w2, B_b2)
    x = x + _A_ref(_layernorm(x, axis=-1), A_wqkv, A_w_phi, A_wo)
    x = x + _B_ref(_layernorm(x, axis=-1), B_w1, B_b1, B_w2, B_b2)
    return x
```

```asm
; @launch grid=(256,1,1) block=(256,1,1) lds=163840
.amdgcn_target "amdgcn-amd-amdhsa--gfx950"
.text
.globl interleave_layers__linear_kernel_hedgehog__dense_activation_squared_relu__prompt_kernel
.p2align 8
.type interleave_layers__linear_kernel_hedgehog__dense_activation_squared_relu__prompt_kernel,@function
interleave_layers__linear_kernel_hedgehog__dense_activation_squared_relu__prompt_kernel:
    s_cmp_ge_u32 s2, 256
    s_cbranch_scc1 L_end
    s_load_dwordx16 s[48:63], s[0:1], 0
    s_load_dwordx8 s[64:71], s[0:1], 64
    s_getpc_b64 s[100:101]
L_pc:
    s_mov_b64 s[26:27], s[100:101]
    s_lshr_b32 s3, s2, 3
    s_mul_i32 s3, s3, 18
    v_add_lshl_u32 v203, v0, s3, 7
    v_min_u32 v203, L_end-L_pc, v203
    v_mov_b32 v205, s101
    v_add_co_u32 v204, vcc, s100, v203
    s_nop 1
    v_addc_co_u32 v205, vcc, 0, v205, vcc
    v_cmp_gt_u32 vcc, 18, v0
    s_nop 0
    s_and_saveexec_b64 s[100:101], vcc
    s_cbranch_execz L_nopf
    global_load_dword a255, v[204:205], off
L_nopf:
    s_mov_b64 exec, -1
    v_lshrrev_b32 v203, 6, v0
    v_and_b32 v200, 63, v0
    v_readfirstlane_b32 s73, v203
    s_and_b32 s95, s2, 7
    s_lshr_b32 s96, s2, 7
    s_lshl_b32 s95, s95, 1
    s_add_u32 s78, s95, s96
    s_bfe_u32 s77, s2, 0x40003
    s_lshl2_add_u32 s99, s78, s73
    s_mul_i32 s100, s99, 96
    s_add_u32 s100, s100, 4096
    v_add_u32 v162, s100, v200
    v_bfe_u32 v206, v162, 4, 2
    v_and_b32 v203, 3, v200
    v_lshrrev_b32 v204, 1, v203
    v_add_u32 v204, v203, v204
    v_cmp_eq_u32 vcc, 3, v206
    v_lshrrev_b32 v207, 6, v162
    v_bfe_u32 v205, v200, 2, 2
    v_lshl_add_u32 v207, v207, 2, v205
    v_cndmask_b32 v204, v204, 2, vcc
    v_cndmask_b32 v203, v206, v203, vcc
    v_add_u32 v205, 1, v203
    v_cmp_gt_u32 vcc, 2, v203
    v_mul_u32_u24 v207, 3840, v207
    s_mul_i32 s96, s77, 80
    v_cndmask_b32 v205, 0, v205, vcc
    v_mul_u32_u24 v205, 1280, v205
    v_lshl_add_u32 v205, v204, 4, v205
    v_add3_u32 v207, v207, v205, s96
    v_cmp_eq_u32 vcc, 3, v203
    s_nop 1
    v_cndmask_b32 v207, v207, 2.0, vcc
    s_mov_b32 s100, 15360
    s_mov_b32 s101, 30720
    s_lshl2_add_u32 s95, s77, s73
    s_mul_i32 s95, s95, 2560
    s_mul_i32 s96, s78, 163840
    s_add_u32 s95, s95, s96
    v_min_u32 v203, 19, v200
    v_lshl_add_u32 v203, v203, 7, s95
    s_lshl2_add_u32 s95, s2, s73
    s_mul_i32 s95, s95, 8
    v_min_u32 v204, 7, v200
    v_add_lshl_u32 v204, v204, s95, 7
    s_mov_b32 s18, 0x280000
    s_mov_b32 s19, 0x20000
    s_mov_b32 s14, 0x258000
    s_mov_b32 s15, 0x20000
    s_waitcnt lgkmcnt(0)
    s_mov_b64 s[12:13], s[50:51]
    s_mov_b64 s[16:17], s[48:49]
    buffer_load_dwordx4 v[136:139], v207, s[12:15], 0 offen
    s_mov_b32 exec_hi, 0
    buffer_load_dwordx4 v[140:143], v207, s[12:15], s100 offen
    buffer_load_dword a255, v204, s[12:15], 0 offen
    s_mov_b64 exec, -1
    s_load_dword s72, s[70:71], 0
    s_lshl_b32 s74, s73, 10
    s_lshr_b32 s95, s2, 1
    s_mul_i32 s96, s95, 52
    s_lshr_b32 s96, s96, 8
    s_sub_u32 s100, s95, s96
    s_mul_i32 s100, s100, 40
    s_mul_i32 s96, s96, 5
    s_sub_u32 s95, s95, s96
    s_lshr_b32 s96, s73, 1
    s_add_u32 s96, s96, s73
    s_lshl_b32 s96, s96, 3
    s_mul_i32 s101, s73, 40
    s_sub_u32 s3, s101, 144
    s_cmp_eq_u32 s95, 4
    s_cselect_b32 s96, s3, s96
    s_add_u32 s100, s100, s96
    s_sub_u32 s95, s2, 148
    s_lshr_b32 s95, s95, 1
    s_lshl3_add_u32 s95, s95, s73
    s_lshl_b32 s95, s95, 2
    s_cmp_lt_u32 s2, 40
    s_cselect_b32 s100, s100, s95
    s_cselect_b32 s28, 0, 15360
    s_mov_b32 s22, 0x21c000
    s_cmov_b32 s22, 0xc8000
    s_and_b32 s95, s2, 1
    s_lshl1_add_u32 s100, s100, s95
    s_mul_i32 s100, s100, 640
    s_sub_u32 s95, s2, 40
    s_and_b32 s96, s95, 3
    s_mul_i32 s96, s96, 160
    s_add_u32 s96, s96, s101
    s_mul_i32 s96, s96, 27
    s_lshr_b32 s3, s95, 2
    s_add_u32 s96, s96, s3
    s_lshl_b32 s96, s96, 7
    s_movk_i32 s29, 1639
    s_movk_i32 s30, 640
    s_cmp_lt_u32 s95, 108
    s_cselect_b32 s93, 1, 0
    s_cmov_b32 s100, s96
    s_cmov_b32 s28, 0
    s_cmovk_i32 s29, 8192
    s_cmovk_i32 s30, 3328
    s_mov_b32 s23, 0x20000
    v_add_u32 v213, 0, v200
    v_mul_u32_u24 v214, s29, v213
    v_lshl_add_u32 v213, v213, 4, s100
    v_lshrrev_b32 v208, 16, v214
    v_lshrrev_b32 v214, 18, v214
    v_mad_u32_u24 v213, v208, s30, v213
    v_mad_u32_u24 v208, v214, s28, v213
    v_add_u32 v213, 64, v200
    v_mul_u32_u24 v214, s29, v213
    v_lshl_add_u32 v213, v213, 4, s100
    v_lshrrev_b32 v209, 16, v214
    v_lshrrev_b32 v214, 18, v214
    v_mad_u32_u24 v213, v209, s30, v213
    v_mad_u32_u24 v209, v214, s28, v213
    v_add_u32 v213, 128, v200
    v_mul_u32_u24 v214, s29, v213
    v_lshl_add_u32 v213, v213, 4, s100
    v_lshrrev_b32 v210, 16, v214
    v_lshrrev_b32 v214, 18, v214
    v_mad_u32_u24 v213, v210, s30, v213
    v_mad_u32_u24 v210, v214, s28, v213
    v_add_u32 v213, 192, v200
    v_mul_u32_u24 v214, s29, v213
    v_lshl_add_u32 v213, v213, 4, s100
    v_lshrrev_b32 v211, 16, v214
    v_lshrrev_b32 v214, 18, v214
    v_mad_u32_u24 v213, v211, s30, v213
    v_mad_u32_u24 v211, v214, s28, v213
    v_add_u32 v213, 256, v200
    v_mul_u32_u24 v214, s29, v213
    v_lshl_add_u32 v213, v213, 4, s100
    v_lshrrev_b32 v212, 16, v214
    v_lshrrev_b32 v214, 18, v214
    v_mad_u32_u24 v213, v212, s30, v213
    v_mad_u32_u24 v212, v214, s28, v213
    s_cmp_lt_u32 s2, 40
    s_cselect_b64 s[20:21], s[54:55], s[62:63]
    s_cmp_eq_u32 s93, 1
    s_cmov_b64 s[20:21], s[58:59]
    s_mul_i32 s95, s74, 5
    s_add_u32 m0, s95, 139264
    s_nop 0
    buffer_load_dwordx4 v208, s[20:23], 0 offen lds
    s_add_u32 m0, s95, 140288
    s_nop 0
    buffer_load_dwordx4 v209, s[20:23], 0 offen lds
    s_add_u32 m0, s95, 141312
    s_nop 0
    buffer_load_dwordx4 v210, s[20:23], 0 offen lds
    s_add_u32 m0, s95, 142336
    s_nop 0
    buffer_load_dwordx4 v211, s[20:23], 0 offen lds
    s_add_u32 m0, s95, 143360
    s_nop 0
    buffer_load_dwordx4 v212, s[20:23], 0 offen lds
    s_and_b32 s79, s77, 7
    s_lshr_b32 s97, s77, 3
    s_lshl1_add_u32 s97, s73, s97
    s_lshl_b32 s98, s78, 3
    s_add_u32 s98, s98, s97
    s_mul_i32 s95, s98, 20480
    s_mul_i32 s96, s79, 160
    s_add_u32 s95, s95, s96
    v_lshrrev_b32 v201, 4, v200
    v_and_b32 v202, 15, v200
    v_mul_u32_u24 v203, 1280, v202
    v_add_u32 v203, s95, v203
    v_lshl_add_u32 v25, v201, 4, v203
    v_lshl_add_u32 v26, v201, 3, v203
    v_readfirstlane_b32 s95, v25
    s_mul_i32 s96, s74, 3
    v_add_u32 v148, 0, v200
    v_mul_u32_u24 v149, 6554, v148
    v_lshrrev_b32 v149, 16, v149
    v_lshl_add_u32 v148, v148, 4, s95
    v_mul_u32_u24 v149, 1120, v149
    s_add_u32 m0, s96, 77824
    v_add_u32 v148, v148, v149
    buffer_load_dwordx4 v148, s[16:19], 0 offen lds
    v_add_u32 v148, 64, v200
    v_mul_u32_u24 v149, 6554, v148
    v_lshrrev_b32 v149, 16, v149
    v_lshl_add_u32 v148, v148, 4, s95
    v_mul_u32_u24 v149, 1120, v149
    s_add_u32 m0, s96, 78848
    v_add_u32 v148, v148, v149
    buffer_load_dwordx4 v148, s[16:19], 0 offen lds
    v_add_u32 v148, 128, v200
    v_mul_u32_u24 v149, 6554, v148
    v_lshrrev_b32 v149, 16, v149
    v_lshl_add_u32 v148, v148, 4, s95
    v_mul_u32_u24 v149, 1120, v149
    s_add_u32 m0, s96, 79872
    v_add_u32 v148, v148, v149
    s_mov_b32 exec_hi, 0
    buffer_load_dwordx4 v148, s[16:19], 0 offen lds
    s_mov_b64 exec, -1
    s_add_u32 s96, s96, 77824
    v_mul_u32_u24 v149, 160, v202
    v_add_u32 v149, s96, v149
    v_lshl_add_u32 v158, v201, 4, v149
    v_lshl_add_u32 v159, v201, 3, v149
    v_lshlrev_b32 v2, 4, v200
    s_mul_i32 s86, s77, 163840
    s_add_u32 s86, s86, 0xa00000
    v_lshl_add_u32 v162, v162, 4, s86
    s_mov_b64 s[4:5], s[70:71]
    s_mov_b32 s6, 0x1000000
    s_mov_b32 s7, 0x20000
    s_add_u32 s8, s70, 0x1000000
    s_addc_u32 s9, s71, 0
    s_mov_b32 s10, 0xa00000
    s_mov_b32 s11, 0x20000
    s_mul_i32 s95, s99, 40960
    v_lshrrev_b32 v203, 3, v200
    v_mul_u32_u24 v203, 1280, v203
    v_and_b32 v204, 7, v200
    v_xor_b32 v204, v204, v201
    v_lshlrev_b32 v204, 4, v204
    v_add3_u32 v164, v203, v204, s95
    v_xor_b32 v165, 64, v164
    v_add_u32 v165, 10240, v165
    v_add_u32 v166, 20480, v164
    v_add_u32 v167, 20480, v165
    s_mov_b64 s[70:71], s[26:27]
    s_mov_b64 s[24:25], s[52:53]
    s_mov_b32 s26, 25600
    s_mov_b32 s27, 0x20000
    s_mul_i32 s95, s77, 1600
    v_lshl_add_u32 v242, v0, 2, s95
    s_mul_i32 s95, s77, 96
    s_lshr_b32 s96, s77, 3
    s_mul_i32 s96, s96, 6
    s_add_u32 s96, s96, s79
    s_cmp_ge_u32 s79, 6
    s_cselect_b32 s96, 12, s96
    s_lshl_b32 s96, s96, 4
    s_add_u32 s96, s96, 1440
    v_add_u32 v240, s95, v0
    v_add_u32 v241, s96, v0
    v_cmp_gt_u32 vcc, 96, v0
    s_nop 1
    v_cndmask_b32 v240, v241, v240, vcc
    v_lshlrev_b32 v1, 4, v240
    v_cmp_gt_u32 vcc, 1728, v240
    s_nop 1
    v_cndmask_b32 v1, 2.0, v1, vcc
    v_lshlrev_b32 v245, 1, v240
    v_bfe_u32 v240, v0, 2, 2
    v_lshlrev_b32 v240, 3, v240
    v_bfe_u32 v241, v0, 4, 1
    v_lshl_add_u32 v240, v241, 2, v240
    v_and_b32 v241, 0x23, v0
    v_add_u32 v240, v240, v241
    v_cmp_gt_u32 vcc, 64, v0
    s_nop 1
    v_cndmask_b32 v240, v0, v240, vcc
    s_mul_i32 s95, s79, 80
    v_add_lshl_u32 v240, v240, s95, 1
    s_lshr_b32 s96, s74, 2
    s_add_u32 m0, s96, 161792
    s_mov_b64 s[20:21], s[60:61]
    s_mov_b32 s22, 3456
    buffer_load_dword v242, s[24:27], 0 offen lds
    buffer_load_dword v242, s[24:27], 0 offen offset:1024 lds
    buffer_load_ushort v243, v245, s[20:23], 0 offen
    s_mov_b64 s[24:25], s[64:65]
    s_mov_b32 s26, 1280
    buffer_load_ushort v244, v240, s[24:27], 0 offen
    s_and_b32 s96, s2, 1
    s_lshl2_add_u32 s96, s96, s73
    s_sub_u32 s95, s2, 148
    s_lshr_b32 s95, s95, 1
    s_cmp_ge_u32 s95, 48
    s_cselect_b32 s28, 51, 24
    s_cmp_ge_u32 s95, s28
    s_cselect_b32 s28, 1, 0
    s_lshl3_add_u32 s29, s28, s96
    s_mul_i32 s100, s29, 3
    s_sub_u32 s100, s95, s100
    s_cselect_b32 s101, 24, 0
    s_add_u32 s100, s100, s101
    s_mul_i32 s101, s28, 3
    s_sub_u32 s101, s95, s101
    s_sub_u32 s101, s101, 24
    s_cmp_ge_u32 s95, 48
    s_cselect_b32 s100, s101, s100
    s_mul_i32 s29, s29, 136
    s_mul_i32 s100, s100, 5
    s_add_u32 s29, s29, s100
    s_add_u32 s29, s29, 7168
    s_lshr_b32 s95, s2, 1
    s_mul_i32 s96, s96, 20
    s_add_u32 s96, s96, s95
    s_mul_i32 s96, s96, 5
    s_add_u32 s96, s96, 3072
    s_cmp_lt_u32 s2, 40
    s_cmov_b32 s29, s96
    s_sub_u32 s95, s2, 40
    s_and_b32 s96, s95, 3
    s_and_b32 s95, s95, -4
    s_add_u32 s95, s95, s73
    s_lshl_b32 s100, s95, 8
    s_lshl2_add_u32 s100, s96, s100
    s_add_u32 s30, s100, 0x8000
    s_mul_i32 s100, s95, 43
    s_lshr_b32 s100, s100, 8
    s_mul_i32 s101, s100, 6
    s_sub_u32 s101, s95, s101
    s_cmp_ge_u32 s95, 102
    s_cselect_b32 s3, 2, 0
    s_add_u32 s3, s3, s95
    s_sub_u32 s3, s3, 96
    s_cmp_ge_u32 s95, 96
    s_cselect_b32 s100, s3, s100
    s_cselect_b32 s101, 6, s101
    s_lshl2_add_u32 s100, s100, s96
    s_mul_i32 s100, s100, 35
    s_add_u32 s100, s100, s101
    s_add_u32 s100, s100, 4096
    s_cmp_eq_u32 s93, 1
    s_cmov_b32 s29, s100
    s_cselect_b32 s30, s30, 2.0
    s_cselect_b32 s95, 7, 1
    v_add_u32 v213, s30, v2
    v_cmp_gt_u32 vcc, 16, v200
    s_nop 1
    v_cndmask_b32 v161, 2.0, v213, vcc
    s_lshl_b32 s28, s29, 10
    s_lshl_b32 s95, s95, 10
    s_add_u32 s29, s28, s95
    s_add_u32 s30, s29, s95
    s_add_u32 s31, s30, s95
    s_add_u32 s94, s31, s95
    s_lshl_b32 s95, s77, 16
    s_add_u32 s95, s95, 0x100000
    v_lshl_add_u32 v203, v0, 4, s95
    v_mov_b32 v35, 0x40000000
    v_cmp_gt_u32 vcc, 210, v0
    s_nop 1
    v_cndmask_b32 v35, v35, v203, vcc
    s_nop 0
    s_mov_b32 s32, 4096
    s_mov_b32 s33, 8192
    s_mov_b32 s34, 12288
    s_mov_b32 s35, 16384
    s_mov_b32 s36, 20480
    s_mov_b32 s37, 24576
    s_mov_b32 s38, 28672
    s_mov_b32 s39, 32768
    s_mov_b32 s40, 36864
    s_mov_b32 s41, 40960
    s_mov_b32 s42, 45056
    s_mov_b32 s43, 49152
    s_mov_b32 s44, 53248
    s_mov_b32 s45, 57344
    s_mov_b32 s46, 61440
    s_mov_b32 s47, 55296
    s_mov_b64 s[48:49], s[8:9]
    s_mov_b32 s50, 0xa00000
    s_mov_b32 s51, 0x20000
    s_mov_b64 s[52:53], s[8:9]
    s_mov_b32 s54, 0xa00000
    s_mov_b32 s55, 0x20000
    s_mov_b32 s56, 0
    s_mov_b32 s75, 0
    s_mov_b32 s76, 0
    s_mov_b32 s80, 0x20000
    s_lshl_b32 s99, s78, 2
    s_add_u32 s99, s99, s73
    s_lshr_b32 s100, s98, 1
    s_and_b32 s101, s97, 1
    s_lshl_b32 s88, s78, 2
    s_mul_i32 s99, s99, 155648
    s_add_u32 s99, s99, 0x10000
    s_mul_i32 s100, s100, 155648
    s_add_u32 s100, s100, 0x10000
    v_add_u32 v11, s99, v2
    s_mul_i32 s95, s101, 20480
    s_add_u32 s95, s95, s100
    s_add_u32 s95, s95, 0xb000
    v_add_u32 v12, s95, v2
    s_mul_i32 s95, s101, 55296
    s_add_u32 s95, s95, s100
    s_add_u32 s95, s95, 0xb000
    v_add_u32 v13, s95, v2
    s_mov_b32 s95, s100
    s_mul_i32 s96, s79, 5120
    s_add_u32 s96, s96, s95
    s_lshl_b32 s3, s101, 8
    s_add_u32 s96, s96, s3
    v_lshl_add_u32 v203, v202, 4, s96
    v_lshl_add_u32 v14, v201, 9, v203
    v_lshrrev_b32 v204, 1, v201
    v_lshl_add_u32 v203, v204, 9, v203
    v_and_b32 v205, 1, v201
    v_lshl_add_u32 v203, v205, 3, v203
    v_add_u32 v15, 4096, v203
    s_lshr_b32 s96, s79, 1
    s_mul_i32 s96, s96, 10
    s_add_u32 s96, s96, s101
    s_lshl_b32 s96, s96, 10
    s_add_u32 s95, s95, s96
    s_and_b32 s96, s79, 1
    s_lshl_b32 s3, s96, 12
    s_add_u32 s3, s3, s95
    v_add_u32 v16, s3, v2
    s_lshl_b32 s3, s96, 3
    s_add_u32 s3, s3, s95
    s_add_u32 s3, s3, 8192
    v_add_u32 v17, s3, v2
    s_lshl_b32 s3, s96, 3
    s_add_u32 s95, s100, s3
    s_lshr_b32 s3, s79, 1
    s_lshl_b32 s3, s3, 9
    s_add_u32 s95, s95, s3
    s_lshl_b32 s3, s101, 8
    s_add_u32 s95, s95, s3
    s_add_u32 s95, s95, 0xa000
    v_lshl_add_u32 v203, v202, 4, s95
    v_lshl_add_u32 v18, v204, 2, v203
    s_add_u32 s95, s99, 0xa000
    v_add_u32_e64 v19, s95, v2
    v_lshl_add_u32 v203, v202, 4, s95
    v_lshl_add_u32 v20, v201, 9, v203
    s_add_u32 s82, s99, 0xa800
    s_add_u32 s83, s100, 0xa800
    s_lshl_b32 s3, s101, 3
    s_add_u32 s3, s3, s79
    s_lshl_b32 s3, s3, 2
    s_add_u32 s84, s83, s3
    s_lshl_b32 s3, s77, 2
    s_add_u32 s85, s82, s3
    v_lshlrev_b32 v27, 2, v202
    s_lshl_b32 s87, s77, 7
    s_add_u32 s87, s87, 0x3000
    s_add_u32 s88, s88, s87
    s_lshl_b32 s92, s2, 7
    s_add_u32 s92, s92, 0x10000
    s_waitcnt lgkmcnt(0)
    s_add_u32 s72, s72, 0x9e377900
    s_and_b32 s72, s72, 0xffffff00
    s_getreg_b32 s3, hwreg(HW_REG_XCC_ID)
    s_and_b32 s3, s3, 15
    s_or_b32 s3, s3, 16
    s_or_b32 s81, s72, s3
    v_mov_b32 v29, s72
    v_mov_b32 v28, s81
    v_mov_b32 v224, -1
    v_mov_b32 v225, -1
    v_mov_b32 v226, -1
    v_mov_b32 v227, -1
    s_mov_b64 exec, 0
    s_cmp_eq_u32 s73, 0
    s_cbranch_scc1 L_pad1
    s_cmp_eq_u32 s73, 1
    s_cbranch_scc1 L_pad2
    s_cmp_eq_u32 s73, 2
    s_cbranch_scc1 L_pad3
    s_branch L_pad4
    .p2align 12
L_pad15:
L_pad16:
L_pad17:
L_pad18:
    s_mov_b64 exec, -1
    s_waitcnt vmcnt(13)
    buffer_store_dwordx4 v[136:139], v162, s[4:7], 0 offen offset:0 sc1
    s_mov_b32 exec_hi, 0
    buffer_store_dwordx4 v[140:143], v162, s[4:7], 0 offen offset:1024 sc1
    s_mov_b64 exec, -1
    s_lshl_b32 s95, s78, 12
    buffer_store_dwordx4 v[224:227], v35, s[4:7], s95 offen sc1
    s_waitcnt vmcnt(10)
    s_barrier
    v_lshrrev_b32 v210, 8, v2
    v_bfe_u32 v211, v2, 6, 2
    v_mov_b32 v212, 0x3f803f80
    v_mov_b32 v213, 0x3f803f80
    v_mov_b32 v214, 0x3f803f80
    v_mov_b32 v215, 0x3f803f80
    s_cmp_eq_u32 s93, 1
    s_cbranch_scc1 L_p2_w1
    v_lshl_add_u32 v210, v210, 3, v211
    v_mul_u32_u24 v210, 640, v210
    s_mul_i32 s95, s73, 160
    s_add_u32 s95, s95, 139264
    v_add_u32 v210, s95, v210
    v_and_b32 v211, 48, v2
    v_add_u32 v208, v210, v211
    v_lshrrev_b32 v211, 1, v211
    v_add_u32_e64 v209, v210, v211
    ds_read_b64_tr_b16 v[176:177], v208 offset:0
    ds_read_b64_tr_b16 v[178:179], v208 offset:2560
    ds_read_b64_tr_b16 v[180:181], v208 offset:8
    ds_read_b64_tr_b16 v[182:183], v208 offset:2568
    ds_read_b64_tr_b16 v[184:185], v208 offset:64
    ds_read_b64_tr_b16 v[186:187], v208 offset:2624
    ds_read_b64_tr_b16 v[188:189], v208 offset:72
    ds_read_b64_tr_b16 v[190:191], v208 offset:2632
    ds_read_b64_tr_b16 v[192:193], v209 offset:128
    ds_read_b64_tr_b16 v[194:195], v209 offset:2688
    s_branch L_p2_go
L_p2_w1:
    v_lshl_add_u32 v208, v210, 3, v211
    v_lshl_add_u32 v209, v210, 2, v211
    v_and_b32 v211, 48, v2
    v_lshrrev_b32 v211, 1, v211
    s_lshl_b32 s95, s73, 5
    s_add_u32 s95, s95, 139264
    v_add_u32_e64 v211, s95, v211
    v_lshl_add_u32 v208, v208, 7, v211
    v_lshl_add_u32 v209, v209, 7, v211
    ds_read_b64_tr_b16 v[176:177], v208 offset:0
    ds_read_b64_tr_b16 v[178:179], v208 offset:512
    ds_read_b64_tr_b16 v[180:181], v208 offset:4096
    ds_read_b64_tr_b16 v[182:183], v208 offset:4608
    ds_read_b64_tr_b16 v[184:185], v208 offset:10240
    ds_read_b64_tr_b16 v[186:187], v208 offset:10752
    ds_read_b64_tr_b16 v[188:189], v208 offset:14336
    ds_read_b64_tr_b16 v[190:191], v208 offset:14848
    ds_read_b64_tr_b16 v[192:193], v209 offset:8192
    ds_read_b64_tr_b16 v[194:195], v209 offset:18432
L_p2_go:
    s_waitcnt lgkmcnt(0)
    v_mfma_f32_16x16x32_bf16 v[196:199], v[212:215], v[176:179], 0
    v_mfma_f32_16x16x32_bf16 v[196:199], v[212:215], v[180:183], v[196:199]
    v_mfma_f32_16x16x32_bf16 v[196:199], v[212:215], v[184:187], v[196:199]
    v_mfma_f32_16x16x32_bf16 v[196:199], v[212:215], v[188:191], v[196:199]
    v_mfma_f32_16x16x32_bf16 v[196:199], v[212:215], v[192:195], v[196:199]
    s_lshl_b32 s93, s78, 12
    s_add_u32 s93, s93, 0x100000
    buffer_store_dwordx4 v[176:179], v2, s[4:7], s28 offen sc1
    s_waitcnt vmcnt(8)
    ds_read_b128 v[148:151], v158
    ds_read_b128 v[152:155], v158 offset:64
    ds_read_b64 v[156:157], v159 offset:128
    s_waitcnt lgkmcnt(0)
    v_lshlrev_b32 v52, 16, v148
    v_and_b32 v53, 0xffff0000, v148
    v_lshlrev_b32 v54, 16, v149
    v_and_b32 v55, 0xffff0000, v149
    buffer_store_dwordx4 v[180:183], v2, s[4:7], s29 offen sc1
    v_lshlrev_b32 v56, 16, v150
    v_and_b32 v57, 0xffff0000, v150
    v_lshlrev_b32 v58, 16, v151
    v_and_b32 v59, 0xffff0000, v151
    v_lshlrev_b32 v60, 16, v152
    v_and_b32 v61, 0xffff0000, v152
    v_lshlrev_b32 v62, 16, v153
    v_and_b32 v63, 0xffff0000, v153
    v_lshlrev_b32 v64, 16, v154
    buffer_store_dwordx4 v[184:187], v2, s[4:7], s30 offen sc1
    v_and_b32 v65, 0xffff0000, v154
    v_lshlrev_b32 v66, 16, v155
    v_and_b32 v67, 0xffff0000, v155
    v_lshlrev_b32 v68, 16, v156
    v_and_b32 v69, 0xffff0000, v156
    v_lshlrev_b32 v70, 16, v157
    v_and_b32 v71, 0xffff0000, v157
    v_pk_add_f32 v[232:233], v[52:53], v[54:55]
    v_pk_mul_f32 v[234:235], v[52:53], v[52:53]
    buffer_store_dwordx4 v[188:191], v2, s[4:7], s31 offen sc1
    v_pk_fma_f32 v[234:235], v[54:55], v[54:55], v[234:235]
    v_pk_add_f32 v[232:233], v[232:233], v[56:57]
    v_pk_fma_f32 v[234:235], v[56:57], v[56:57], v[234:235]
    v_pk_add_f32 v[232:233], v[232:233], v[58:59]
    v_pk_fma_f32 v[234:235], v[58:59], v[58:59], v[234:235]
    v_pk_add_f32 v[232:233], v[232:233], v[60:61]
    v_pk_fma_f32 v[234:235], v[60:61], v[60:61], v[234:235]
    v_pk_add_f32 v[232:233], v[232:233], v[62:63]
    v_pk_fma_f32 v[234:235], v[62:63], v[62:63], v[234:235]
    buffer_store_dwordx4 v[192:195], v2, s[4:7], s94 offen sc1
    v_pk_add_f32 v[232:233], v[232:233], v[64:65]
    v_pk_fma_f32 v[234:235], v[64:65], v[64:65], v[234:235]
    v_pk_add_f32 v[232:233], v[232:233], v[66:67]
    v_pk_fma_f32 v[234:235], v[66:67], v[66:67], v[234:235]
    v_pk_add_f32 v[232:233], v[232:233], v[68:69]
    v_pk_fma_f32 v[234:235], v[68:69], v[68:69], v[234:235]
    v_pk_add_f32 v[232:233], v[232:233], v[70:71]
    v_pk_fma_f32 v[234:235], v[70:71], v[70:71], v[234:235]
    v_add_f32 v232, v232, v233
    buffer_store_dword v196, v161, s[4:7], 0 offen sc1
    v_add_f32 v234, v234, v235
    s_nop 1
    v_permlane32_swap_b32 v232, v234
    v_add_f32 v232, v232, v234
    v_mov_b32 v234, v232
    s_nop 1
    v_permlane16_swap_b32 v232, v234
    v_add_f32 v234, v232, v234
    buffer_store_dwordx4 v[224:227], v35, s[4:7], s93 offen sc1
    buffer_store_dword v234, v18, s[48:51], 0 offen sc1
    v_and_b32 v203, 3, v200
    v_lshrrev_b32 v204, 1, v203
    v_add_u32 v204, v203, v204
    v_cmp_eq_u32 vcc, 3, v201
    s_nop 1
    v_cndmask_b32 v204, v204, 2, vcc
    v_cndmask_b32 v203, v201, v203, vcc
    v_add_u32 v205, 1, v203
    v_cmp_gt_u32 vcc, 2, v203
    s_nop 1
    v_cndmask_b32 v205, 0, v205, vcc
    v_mul_u32_u24 v205, 1280, v205
    v_lshl_add_u32 v205, v204, 4, v205
    v_cmp_eq_u32 vcc, 3, v203
    s_nop 0
    s_nop 0
    v_cndmask_b32 v205, v205, 2.0, vcc
    v_bfe_u32 v203, v200, 2, 2
    v_mul_u32_u24 v203, 3840, v203
    s_mul_i32 s95, s73, 15360
    s_mul_i32 s96, s77, 80
    s_add_u32 s95, s95, s96
    v_add3_u32 v163, v203, v205, s95
    v_add_u32 v3, 0x10000, v2
    v_add_u32 v4, 0x20000, v2
    v_add_u32 v36, s74, v2
    v_add_u32 v37, s74, v3
    s_mov_b32 s58, 0
    s_lshl2_add_u32 m0, s74, 90112
    v_add_u32 v38, s74, v4
    buffer_load_dwordx4 v164, s[16:19], s58 offen lds
    v_lshrrev_b32 v203, 5, v200
    v_lshlrev_b32 v203, 11, v203
    v_bfe_u32 v204, v200, 2, 2
    v_lshl_add_u32 v203, v204, 6, v203
    v_and_b32 v204, 1, v200
    v_lshl_add_u32 v205, v204, 5, v203
    v_and_b32 v204, 16, v200
    v_add_u32 v205, v205, v204
    v_lshl_add_u32 v203, v204, 1, v203
    v_and_b32 v204, 2, v200
    v_lshl_add_u32 v5, v204, 2, v205
    v_and_b32 v204, 3, v200
    v_lshl_add_u32 v8, v204, 3, v203
    v_add_u32 v6, 0x10000, v5
    v_add_u32 v7, 0x20000, v5
    v_add_u32 v9, 0x10000, v8
    v_add_u32 v10, 0x20000, v8
    v_lshrrev_b32 v204, 1, v201
    v_and_b32 v205, 1, v201
    s_lshr_b32 s96, s77, 2
    s_mul_i32 s96, s96, 5120
    s_lshl2_add_u32 m0, s74, 91136
    s_add_u32 s95, s99, s96
    buffer_load_dwordx4 v165, s[16:19], s58 offen lds
    s_add_u32 s95, s95, 0xb000
    s_and_b32 s96, s77, 3
    v_mul_u32_u24 v203, 20480, v205
    v_lshl_add_u32 v203, v202, 4, v203
    s_lshl_b32 s3, s96, 10
    s_add_u32 s3, s3, s95
    v_add_u32 v206, s3, v203
    v_lshl_add_u32 v21, v204, 8, v206
    s_lshl_b32 s3, s96, 8
    s_add_u32 s3, s3, s95
    s_add_u32 s3, s3, 4096
    v_add_u32 v206, s3, v203
    v_mov_b32 v22, 0x7ffffff0
    v_cmp_gt_u32 vcc, 32, v200
    s_nop 1
    v_cndmask_b32 v22, v22, v206, vcc
    s_add_u32 s95, s99, 0xb000
    s_mul_i32 s3, s77, 3072
    s_add_u32 s3, s3, s95
    v_add_u32 v23, s3, v2
    s_lshr_b32 s96, s77, 3
    s_mul_i32 s96, s96, 6
    s_add_u32 s96, s96, s79
    s_lshl2_add_u32 m0, s74, 92160
    s_cmp_ge_u32 s79, 6
    s_cselect_b32 s96, 12, s96
    buffer_load_dwordx4 v166, s[16:19], s58 offen lds
    s_lshr_b32 s3, s96, 1
    s_add_u32 s3, s3, 48
    s_lshl_b32 s3, s3, 10
    s_add_u32 s95, s95, s3
    s_and_b32 s3, s77, 1
    s_lshl_b32 s3, s3, 3
    s_add_u32 s95, s95, s3
    s_cmp_ge_u32 s79, 6
    s_cselect_b32 s95, 0x40000000, s95
    v_add_u32_e64 v24, s95, v2
    s_mul_i32 s89, s79, 102400
    s_add_u32 s89, s89, 0x2ff000
    s_mul_i32 s90, s77, 143360
    s_add_u32 s90, s90, 0x3e6000
    s_mul_i32 s91, s77, 139264
    s_add_u32 s91, s91, 0x6ea000
    s_lshl_b32 s95, s77, 16
    s_add_u32 s95, s95, 0x100000
    s_lshl_b32 s3, s78, 12
    s_add_u32 s95, s95, s3
    s_lshr_b32 s100, s73, 1
    s_lshl2_add_u32 m0, s74, 93184
    s_and_b32 s101, s73, 1
    buffer_load_dwordx4 v167, s[16:19], s58 offen lds
    s_mul_i32 s3, s100, 1680
    s_add_u32 s95, s95, s3
    s_lshl_b32 s3, s101, 4
    v_add_u32 v203, s3, v202
    v_cmp_gt_u32 vcc, 21, v203
    v_lshl_add_u32 v203, v203, 4, s95
    v_mov_b32 v206, 0x40000000
    v_cndmask_b32 v203, v206, v203, vcc
    v_mul_u32_u24 v33, 336, v201
    v_add_u32 v33, v33, v203
    v_lshl_add_u32 v203, v201, 3, v203
    v_add_u32 v203, 1344, v203
    v_cmp_gt_u32 vcc, 32, v200
    s_nop 1
    v_cndmask_b32 v34, v206, v203, vcc
    v_lshlrev_b32 v47, 4, v0
    v_add_u32 v47, 0, v47
    v_and_b32 v203, 31, v200
    v_lshlrev_b32 v203, 7, v203
    v_lshl_add_u32 v203, v204, 14, v203
    v_and_b32 v206, 7, v200
    v_lshl_add_u32 v203, v206, 4, v203
    s_lshl_b32 s3, s73, 12
    s_mov_b32 s57, 0
    s_add_u32 m0, s74, 0
    s_add_u32 s3, s3, 126976
    v_add_u32 v39, s3, v203
    buffer_load_dwordx4 v163, s[12:15], s57 offen lds
    v_bfe_u32 v203, v200, 2, 3
    v_lshl_add_u32 v206, v204, 4, v203
    v_lshlrev_b32 v206, 7, v206
    s_lshl_b32 s3, s100, 14
    s_add_u32 s3, s3, 126976
    v_add_u32 v206, s3, v206
    v_and_b32 v205, 1, v200
    v_lshl_add_u32 v206, v205, 3, v206
    v_bfe_u32 v205, v200, 1, 1
    v_xor_b32 v40, v205, v203
    v_lshl_add_u32 v40, v40, 4, v206
    v_add_u32 v205, 5, v205
    s_cmp_eq_u32 s101, 1
    s_cselect_b64 vcc, -1, 0
    v_cndmask_b32 v205, v205, 7, vcc
    v_xor_b32 v205, v205, v203
    v_lshl_add_u32 v41, v205, 4, v206
    v_bfe_u32 v203, v200, 3, 2
    v_bfe_u32 v205, v200, 2, 1
    v_cmp_gt_u32 vcc, 2, v203
    s_nop 1
    v_cndmask_b32 v205, 1, v205, vcc
    v_lshlrev_b32_e64 v205, 3, v205
    s_mov_b32 s57, 61440
    s_add_u32 m0, s74, 4096
    v_lshl_add_u32 v205, v203, 2, v205
    buffer_load_dwordx4 v163, s[12:15], s57 offen lds
    v_and_b32 v203, 3, v200
    v_add_u32 v205, v205, v203
    v_mul_u32_u24 v203, 21, v204
    v_add_lshl_u32 v203, v203, v205, 4
    v_add_u32 v42, 0, v203
    v_cmp_gt_u32 vcc, 32, v200
    v_mov_b32 v206, 130
    s_nop 0
    v_cndmask_b32 v203, v206, v205, vcc
    v_cndmask_b32 v206, v205, 25, vcc
    v_lshlrev_b32 v203, 4, v203
    v_lshlrev_b32 v206, 4, v206
    v_add_u32 v43, 1344, v203
    v_add_u32 v44, 3024, v206
    v_lshlrev_b32 v203, 4, v204
    v_add_u32 v45, 159744, v203
    v_lshlrev_b32 v203, 4, v201
    v_add_u32 v46, 159744, v203
    s_and_b32 s95, s78, 1
    s_lshr_b32 s96, s77, 3
    s_lshl_b32 s3, s95, 1
    s_add_u32 s96, s96, s3
    s_mov_b32 s58, 128
    s_lshl2_add_u32 m0, s74, 106496
    s_lshl_b32 s3, s95, 3
    buffer_load_dwordx4 v164, s[16:19], s58 offen lds
    s_lshr_b32 s3, 0xa00, s3
    s_and_b32 s3, s3, 0xff
    s_mul_i32 s100, s3, 2
    s_sub_u32 s62, 40, s100
    s_lshl_b32 s65, s100, 10
    s_mul_i32 s3, s3, 7
    s_lshl_b32 s100, s3, 10
    s_sub_u32 s68, s90, s100
    s_add_u32 s68, s68, 0x2c000
    s_add_u32 s90, s90, s100
    s_add_u32 s3, s3, s73
    s_sub_u32 s3, 143, s3
    s_lshr_b32 s60, s3, 2
    s_lshl_b32 s3, s96, 3
    s_lshr_b32 s3, 0x0, s3
    s_and_b32 s3, s3, 0xff
    s_mul_i32 s100, s3, 1
    s_sub_u32 s63, 20, s100
    s_lshl_b32 s100, s3, 10
    v_add_u32 v12, s100, v12
    s_mul_i32 s3, s3, 5
    s_lshl2_add_u32 m0, s74, 107520
    s_lshl_b32 s100, s3, 10
    buffer_load_dwordx4 v165, s[16:19], s58 offen lds
    s_add_u32 s89, s89, s100
    s_add_u32 s3, s3, s73
    s_sub_u32 s3, 103, s3
    s_lshr_b32 s59, s3, 2
    s_lshl_b32 s3, s96, 3
    s_lshr_b32 s3, 0x0, s3
    s_and_b32 s3, s3, 0xff
    s_mul_i32 s100, s3, 1
    s_sub_u32 s64, 54, s100
    s_lshl_b32 s100, s3, 10
    v_add_u32 v13, s100, v13
    s_mul_i32 s3, s3, 5
    s_lshl_b32 s100, s3, 10
    s_add_u32 s91, s91, s100
    s_add_u32 s3, s3, s73
    s_sub_u32 s3, 273, s3
    s_lshr_b32 s61, s3, 2
    v_and_b32 v203, 31, v200
    v_bfe_u32 v204, v200, 1, 3
    v_lshrrev_b32 v205, 5, v200
    v_xor_b32 v204, v204, v205
    v_lshlrev_b32_e64 v204, 4, v204
    s_lshl2_add_u32 m0, s74, 108544
    v_lshl_add_u32 v203, v203, 7, v204
    buffer_load_dwordx4 v166, s[16:19], s58 offen lds
    s_lshl2_add_u32 s95, s74, 53248
    v_add_u32 v168, s95, v203
    v_xor_b32 v169, 32, v168
    v_xor_b32_e64 v170, 64, v168
    v_xor_b32 v171, 96, v168
    v_add_u32 v172, 0x10000, v168
    v_add_u32 v173, 0x10000, v169
    v_add_u32 v174, 0x10000, v170
    v_add_u32 v175, 0x10000, v171
    v_add_u32 v160, s86, v2
    s_lshl_b32 s97, s78, 7
    s_add_u32 s97, s97, 0x1000
    s_lshl2_add_u32 s98, s77, s97
    s_bfe_u32 s95, s2, 0x50003
    s_lshl2_add_u32 s95, s95, s73
    s_min_u32 s95, s95, 79
    s_lshl_b32 s95, s95, 7
    s_add_u32 s70, s70, s95
    s_addc_u32 s71, s71, 0
    s_waitcnt vmcnt(20)
    v_lshlrev_b32 v236, 16, v243
    v_lshlrev_b32 v237, 16, v244
    v_min_u32 v238, 127, v0
    v_lshlrev_b32 v238, 2, v238
    v_add_u32 v238, 159744, v238
    ds_write_b32 v238, v236 offset:1024
    ds_write_b32 v238, v237 offset:1536
    s_waitcnt lgkmcnt(0)
    v_add_u32 v30, s89, v2
    v_add_u32 v49, s68, v36
    v_bfe_u32 v236, v2, 8, 1
    s_lshl2_add_u32 m0, s74, 109568
    v_bfe_u32 v237, v2, 6, 1
    buffer_load_dwordx4 v167, s[16:19], s58 offen lds
    v_cmp_eq_u32 vcc, v236, v237
    v_mov_b32 v237, 0x3f803f80
    s_nop 0
    v_cndmask_b32 v236, 0, v237, vcc
    v_mov_b32 v237, v236
    v_mov_b32 v238, v236
    v_mov_b32 v239, v236
    s_cmp_eq_u32 s73, 3
    s_cselect_b64 vcc, -1, 0
    v_cndmask_b32 v252, v5, v8, vcc
    s_lshr_b32 s95, s74, 2
    v_add_u32 v252, s95, v252
    v_lshrrev_b32 v200, 4, v2
    v_min_u32 v200, 31, v200
    s_lshr_b32 s95, s79, 2
    v_lshl_add_u32 v201, v200, 1, s95
    s_mul_i32 s95, s77, 6
    s_and_b32 s95, s95, -4
    s_add_u32 s95, s95, 20
    v_add_u32 v202, s95, v200
    v_cmp_gt_u32 vcc, 20, v200
    s_nop 1
    v_cndmask_b32 v201, v202, v201, vcc
    s_lshr_b32 s95, s77, 3
    s_mul_i32 s95, s95, 6
    s_add_u32 s95, s95, s79
    s_cmp_ge_u32 s79, 6
    s_cselect_b32 s95, 12, s95
    s_min_u32 s95, s95, 11
    s_and_b32 s95, s95, -4
    s_add_u32 s95, s95, 108
    v_add_u32 v202, s95, v200
    s_mov_b32 s57, 122880
    s_add_u32 m0, s74, 8192
    v_cmp_gt_u32 vcc, 28, v200
    s_nop 1
    v_cndmask_b32 v201, v202, v201, vcc
    s_cmp_eq_u32 s73, 1
    s_nop 0
    s_cselect_b32 s96, 0x10000, 0x40000000
    v_lshl_add_u32 v204, v201, 7, s96
    buffer_load_dwordx4 v163, s[12:15], s57 offen lds
    s_mov_b32 s57, 184320
    s_add_u32 m0, s74, 12288
    s_nop 0
    buffer_load_dwordx4 v163, s[12:15], s57 offen lds
    s_mov_b32 s58, 256
    s_lshl2_add_u32 m0, s74, 122880
    s_nop 0
    buffer_load_dwordx4 v164, s[16:19], s58 offen lds
    s_lshl2_add_u32 m0, s74, 123904
    s_nop 0
    buffer_load_dwordx4 v165, s[16:19], s58 offen lds
    s_lshl2_add_u32 m0, s74, 124928
    s_nop 0
    buffer_load_dwordx4 v166, s[16:19], s58 offen lds
    s_lshl2_add_u32 m0, s74, 125952
    s_nop 0
    buffer_load_dwordx4 v167, s[16:19], s58 offen lds
    s_mov_b32 s57, 245760
    s_add_u32 m0, s74, 16384
    s_nop 0
    buffer_load_dwordx4 v163, s[12:15], s57 offen lds
    s_mov_b32 s57, 307200
    s_add_u32 m0, s74, 20480
    s_nop 0
    buffer_load_dwordx4 v163, s[12:15], s57 offen lds
    s_waitcnt vmcnt(14)
    ds_read_b128 a[0:3], v168 offset:36864
    ds_read_b128 a[4:7], v169 offset:36864
    ds_read_b128 a[8:11], v170 offset:36864
    ds_read_b128 a[12:15], v171 offset:36864
    s_waitcnt vmcnt(12)
    s_barrier
    ds_read_b64_tr_b16 v[136:137], v5 offset:0
    ds_read_b64_tr_b16 v[138:139], v5 offset:1024
    ds_read_b64_tr_b16 v[140:141], v5 offset:256
    ds_read_b64_tr_b16 v[142:143], v5 offset:1280
    ds_read_b64_tr_b16 v[144:145], v5 offset:512
    ds_read_b64_tr_b16 v[146:147], v5 offset:1536
    ds_read_b64_tr_b16 v[148:149], v8 offset:768
    ds_read_b64_tr_b16 v[150:151], v8 offset:1792
    ds_read_b64_tr_b16 v[152:153], v5 offset:4096
    ds_read_b64_tr_b16 v[154:155], v5 offset:5120
    s_mov_b32 s57, 368640
    s_add_u32 m0, s74, 24576
    s_waitcnt lgkmcnt(6)
    buffer_load_dwordx4 v163, s[12:15], s57 offen lds
    s_cmp_eq_u32 s73, 0
    s_cbranch_scc0 L_ow_4
    s_mov_b64 exec, 1
    buffer_store_dword v29, off, s[4:7], s88 sc1
    buffer_store_dword v29, off, s[4:7], s92 sc1
    buffer_store_dword v28, off, s[4:7], s98 sc1
    s_mov_b64 exec, -1
L_ow_4:
    v_mfma_f32_32x32x16_bf16 v[72:87], v[136:139], a[0:3], 0
    ds_read_b64_tr_b16 v[156:157], v5 offset:4352
    ds_read_b64_tr_b16 v[158:159], v5 offset:5376
    v_mfma_f32_32x32x16_bf16 v[88:103], v[140:143], a[0:3], 0
    s_nop 0
    ds_read_b64_tr_b16 v[136:137], v5 offset:4608
    ds_read_b64_tr_b16 v[138:139], v5 offset:5632
    ds_read_b64_tr_b16 v[228:229], v252 offset:0
    ds_read_b64_tr_b16 v[230:231], v252 offset:1024
    s_mov_b32 s58, 384
    s_lshl2_add_u32 m0, s74, 90112
    s_waitcnt lgkmcnt(8)
    v_mfma_f32_32x32x16_bf16 v[104:119], v[144:147], a[0:3], 0
    ds_read_b64_tr_b16 v[140:141], v8 offset:4864
    ds_read_b64_tr_b16 v[142:143], v8 offset:5888
    buffer_load_dwordx4 v164, s[16:19], s58 offen lds
    v_mfma_f32_32x32x16_bf16 v[120:135], v[148:151], a[0:3], 0
    s_waitcnt vmcnt(8)
    s_barrier
    s_nop 0
    ds_read_b64_tr_b16 v[144:145], v5 offset:8192
    ds_read_b64_tr_b16 v[146:147], v5 offset:9216
    s_mov_b32 s57, 430080
    s_add_u32 m0, s74, 28672
    s_waitcnt lgkmcnt(4)
    v_mfma_f32_16x16x32_bf16 v[240:243], v[236:239], v[228:231], 0
    ds_read_b128 a[0:3], v36 offset:0
    v_mfma_f32_32x32x16_bf16 v[72:87], v[152:155], a[4:7], v[72:87]
    s_nop 0
    ds_read_b64_tr_b16 v[148:149], v5 offset:8448
    ds_read_b64_tr_b16 v[150:151], v5 offset:9472
    buffer_load_dwordx4 v163, s[12:15], s57 offen lds
    v_bfe_u32 v208, v2, 4, 1
    v_bfe_u32 v209, v2, 6, 2
    v_mfma_f32_32x32x16_bf16 v[88:103], v[156:159], a[4:7], v[88:103]
    ds_read_b64_tr_b16 v[152:153], v5 offset:8704
    ds_read_b64_tr_b16 v[154:155], v5 offset:9728
    ds_read_b64_tr_b16 v[228:229], v252 offset:4096
    ds_read_b64_tr_b16 v[230:231], v252 offset:5120
    s_lshl2_add_u32 m0, s74, 91136
    s_waitcnt lgkmcnt(9)
    v_mfma_f32_32x32x16_bf16 v[104:119], v[136:139], a[4:7], v[104:119]
    ds_read_b64_tr_b16 v[156:157], v8 offset:8960
    ds_read_b64_tr_b16 v[158:159], v8 offset:9984
    buffer_load_dwordx4 v165, s[16:19], s58 offen lds
    v_mul_u32_u24 v209, 40, v209
    v_bfe_u32 v210, v2, 5, 1
    v_mfma_f32_32x32x16_bf16 v[120:135], v[140:143], a[4:7], v[120:135]
    ds_read_b64_tr_b16 v[136:137], v5 offset:12288
    ds_read_b64_tr_b16 v[138:139], v5 offset:13312
    s_mov_b32 s57, 491520
    s_add_u32 m0, s74, 32768
    v_lshl_add_u32 v209, v210, 3, v209
    s_waitcnt lgkmcnt(4)
    v_mfma_f32_16x16x32_bf16 v[240:243], v[236:239], v[228:231], v[240:243]
    ds_read_b128 a[4:7], v36 offset:4096
    v_mfma_f32_32x32x16_bf16 v[72:87], v[144:147], a[8:11], v[72:87]
    s_nop 0
    ds_read_b64_tr_b16 v[140:141], v5 offset:12544
    ds_read_b64_tr_b16 v[142:143], v5 offset:13568
    buffer_load_dwordx4 v163, s[12:15], s57 offen lds
    v_bfe_u32 v210, v2, 8, 1
    v_lshl_add_u32 v209, v210, 4, v209
    v_mfma_f32_32x32x16_bf16 v[88:103], v[148:151], a[8:11], v[88:103]
    ds_read_b64_tr_b16 v[144:145], v5 offset:12800
    ds_read_b64_tr_b16 v[146:147], v5 offset:13824
    ds_read_b64_tr_b16 v[228:229], v252 offset:8192
    ds_read_b64_tr_b16 v[230:231], v252 offset:9216
    s_lshl2_add_u32 m0, s74, 92160
    s_waitcnt lgkmcnt(9)
    v_mfma_f32_32x32x16_bf16 v[104:119], v[152:155], a[8:11], v[104:119]
    s_nop 0
    ds_read_b64_tr_b16 v[148:149], v8 offset:13056
    ds_read_b64_tr_b16 v[150:151], v8 offset:14080
    ds_read_b128 a[16:19], v168 offset:53248
    ds_read_b128 a[20:23], v169 offset:53248
    ds_read_b128 a[24:27], v170 offset:53248
    ds_read_b128 a[28:31], v171 offset:53248
    buffer_load_dwordx4 v166, s[16:19], s58 offen lds
    v_mfma_f32_32x32x16_bf16 v[120:135], v[156:159], a[8:11], v[120:135]
    s_waitcnt vmcnt(6)
    s_barrier
    ds_read_b64_tr_b16 v[152:153], v5 offset:16384
    ds_read_b64_tr_b16 v[154:155], v5 offset:17408
    s_mov_b32 s57, 552960
    s_add_u32 m0, s74, 36864
    s_waitcnt lgkmcnt(8)
    v_mfma_f32_16x16x32_bf16 v[240:243], v[236:239], v[228:231], v[240:243]
    ds_read_b128 a[8:11], v36 offset:8192
    v_mfma_f32_32x32x16_bf16 v[72:87], v[136:139], a[12:15], v[72:87]
    s_nop 0
    ds_read_b64_tr_b16 v[156:157], v5 offset:16640
    ds_read_b64_tr_b16 v[158:159], v5 offset:17664
    buffer_load_dwordx4 v163, s[12:15], s57 offen lds
    v_add_u32 v209, 161792, v209
    v_mul_u32_u24 v210, 960, v208
    v_mfma_f32_32x32x16_bf16 v[88:103], v[140:143], a[12:15], v[88:103]
    ds_read_b64_tr_b16 v[136:137], v5 offset:16896
    ds_read_b64_tr_b16 v[138:139], v5 offset:17920
    ds_read_b64_tr_b16 v[228:229], v252 offset:12288
    ds_read_b64_tr_b16 v[230:231], v252 offset:13312
    s_lshl2_add_u32 m0, s74, 93184
    s_waitcnt lgkmcnt(13)
    v_mfma_f32_32x32x16_bf16 v[104:119], v[144:147], a[12:15], v[104:119]
    ds_read_b64_tr_b16 v[140:141], v8 offset:17152
    ds_read_b64_tr_b16 v[142:143], v8 offset:18176
    buffer_load_dwordx4 v167, s[16:19], s58 offen lds
    v_add_u32 v211, v209, v210
    v_mul_u32_u24 v210, 160, v208
    v_mfma_f32_32x32x16_bf16 v[120:135], v[148:151], a[12:15], v[120:135]
    ds_read_b64_tr_b16 v[144:145], v5 offset:20480
    ds_read_b64_tr_b16 v[146:147], v5 offset:21504
    s_mov_b32 s57, 614400
    s_add_u32 m0, s74, 40960
    v_add_u32 v212, v209, v210
    s_waitcnt lgkmcnt(4)
    v_mfma_f32_16x16x32_bf16 v[240:243], v[236:239], v[228:231], v[240:243]
    ds_read_b128 a[12:15], v36 offset:12288
    v_mfma_f32_32x32x16_bf16 v[72:87], v[152:155], a[16:19], v[72:87]
    ds_read_b64_tr_b16 v[148:149], v5 offset:20736
    ds_read_b64_tr_b16 v[150:151], v5 offset:21760
    buffer_load_dwordx4 v163, s[12:15], s57 offen lds
    v_bfe_u32 v208, v2, 6, 1
    v_lshrrev_b32_e64 v210, 9, v2
    v_mfma_f32_32x32x16_bf16 v[88:103], v[156:159], a[16:19], v[88:103]
    ds_read_b64_tr_b16 v[152:153], v5 offset:20992
    ds_read_b64_tr_b16 v[154:155], v5 offset:22016
    ds_read_b64_tr_b16 v[228:229], v252 offset:16384
    ds_read_b64_tr_b16 v[230:231], v252 offset:17408
    s_mov_b32 s58, 512
    s_lshl2_add_u32 m0, s74, 106496
    s_waitcnt lgkmcnt(9)
    v_mfma_f32_32x32x16_bf16 v[104:119], v[136:139], a[16:19], v[104:119]
    ds_read_b64_tr_b16 v[156:157], v8 offset:21248
    ds_read_b64_tr_b16 v[158:159], v8 offset:22272
    buffer_load_dwordx4 v164, s[16:19], s58 offen lds
    v_xor_b32 v208, v208, v210
    v_add_u32 v213, -1, v208
    v_mfma_f32_32x32x16_bf16 v[120:135], v[140:143], a[16:19], v[120:135]
    s_waitcnt vmcnt(5)
    s_barrier
    s_nop 0
    ds_read_b64_tr_b16 v[136:137], v5 offset:24576
    ds_read_b64_tr_b16 v[138:139], v5 offset:25600
    s_mov_b32 s57, 675840
    s_add_u32 m0, s74, 45056
    s_waitcnt lgkmcnt(4)
    v_mfma_f32_16x16x32_bf16 v[240:243], v[236:239], v[228:231], v[240:243]
    ds_read_b128 a[16:19], v36 offset:16384
    v_mfma_f32_32x32x16_bf16 v[72:87], v[144:147], a[20:23], v[72:87]
    s_nop 0
    ds_read_b64_tr_b16 v[140:141], v5 offset:24832
    ds_read_b64_tr_b16 v[142:143], v5 offset:25856
    buffer_load_dwordx4 v163, s[12:15], s57 offen lds
    ds_read_b64_tr_b16 v[176:177], v211 offset:0
    ds_read_b64_tr_b16 v[178:179], v211 offset:160
    v_mfma_f32_32x32x16_bf16 v[88:103], v[148:151], a[20:23], v[88:103]
    ds_read_b64_tr_b16 v[144:145], v5 offset:25088
    ds_read_b64_tr_b16 v[146:147], v5 offset:26112
L_pad1:
    s_cbranch_execz L_pad5
    ds_read_b64_tr_b16 v[228:229], v252 offset:20480
    ds_read_b64_tr_b16 v[230:231], v252 offset:21504
    s_lshl2_add_u32 m0, s74, 107520
    s_waitcnt lgkmcnt(11)
    v_mfma_f32_32x32x16_bf16 v[104:119], v[152:155], a[20:23], v[104:119]
    ds_read_b64_tr_b16 v[148:149], v8 offset:25344
    ds_read_b64_tr_b16 v[150:151], v8 offset:26368
    ds_read_b128 a[32:35], v172 offset:4096
    ds_read_b128 a[36:39], v173 offset:4096
    ds_read_b128 a[40:43], v174 offset:4096
    ds_read_b128 a[44:47], v175 offset:4096
    buffer_load_dwordx4 v165, s[16:19], s58 offen lds
    v_mfma_f32_32x32x16_bf16 v[120:135], v[156:159], a[20:23], v[120:135]
    ds_read_b64_tr_b16 v[152:153], v5 offset:28672
    ds_read_b64_tr_b16 v[154:155], v5 offset:29696
    s_mov_b32 s57, 737280
    s_add_u32 m0, s74, 49152
    ds_read_b64_tr_b16 v[180:181], v211 offset:320
    s_waitcnt lgkmcnt(9)
    v_mfma_f32_16x16x32_bf16 v[240:243], v[236:239], v[228:231], v[240:243]
    ds_read_b128 a[20:23], v36 offset:20480
    v_mfma_f32_32x32x16_bf16 v[72:87], v[136:139], a[24:27], v[72:87]
    s_nop 0
    ds_read_b64_tr_b16 v[156:157], v5 offset:28928
    ds_read_b64_tr_b16 v[158:159], v5 offset:29952
    buffer_load_dwordx4 v163, s[12:15], s57 offen lds
    ds_read_b64_tr_b16 v[182:183], v211 offset:480
    ds_read_b64_tr_b16 v[184:185], v212 offset:640
    v_mfma_f32_32x32x16_bf16 v[88:103], v[140:143], a[24:27], v[88:103]
    ds_read_b64_tr_b16 v[136:137], v5 offset:29184
    ds_read_b64_tr_b16 v[138:139], v5 offset:30208
    ds_read_b64_tr_b16 v[228:229], v252 offset:24576
    ds_read_b64_tr_b16 v[230:231], v252 offset:25600
    s_lshl2_add_u32 m0, s74, 108544
    s_waitcnt lgkmcnt(14)
    v_mfma_f32_32x32x16_bf16 v[104:119], v[144:147], a[24:27], v[104:119]
    s_nop 0
    ds_read_b64_tr_b16 v[140:141], v8 offset:29440
    ds_read_b64_tr_b16 v[142:143], v8 offset:30464
    buffer_load_dwordx4 v166, s[16:19], s58 offen lds
    ds_read_b64_tr_b16 v[188:189], v211 offset:32
    ds_read_b64_tr_b16 v[190:191], v211 offset:192
    v_mfma_f32_32x32x16_bf16 v[120:135], v[148:151], a[24:27], v[120:135]
    ds_read_b64_tr_b16 v[144:145], v5 offset:32768
    ds_read_b64_tr_b16 v[146:147], v5 offset:33792
    s_mov_b32 s57, 798720
    s_add_u32 m0, s74, 53248
    ds_read_b64_tr_b16 v[192:193], v211 offset:352
    s_waitcnt lgkmcnt(7)
    v_mfma_f32_16x16x32_bf16 v[240:243], v[236:239], v[228:231], v[240:243]
    ds_read_b128 a[24:27], v36 offset:24576
    v_mfma_f32_32x32x16_bf16 v[72:87], v[152:155], a[28:31], v[72:87]
    s_nop 0
    ds_read_b64_tr_b16 v[148:149], v5 offset:33024
    ds_read_b64_tr_b16 v[150:151], v5 offset:34048
    buffer_load_dwordx4 v163, s[12:15], s57 offen lds
    ds_read_b64_tr_b16 v[194:195], v211 offset:512
    ds_read_b64_tr_b16 v[196:197], v212 offset:672
    v_mfma_f32_32x32x16_bf16 v[88:103], v[156:159], a[28:31], v[88:103]
    ds_read_b64_tr_b16 v[152:153], v5 offset:33280
    ds_read_b64_tr_b16 v[154:155], v5 offset:34304
    ds_read_b64_tr_b16 v[228:229], v252 offset:28672
    ds_read_b64_tr_b16 v[230:231], v252 offset:29696
    v_accvgpr_write_b32 a170, 0
    s_waitcnt lgkmcnt(14)
    v_mfma_f32_32x32x16_bf16 v[104:119], v[136:139], a[28:31], v[104:119]
    s_nop 0
    ds_read_b64_tr_b16 v[156:157], v8 offset:33536
    ds_read_b64_tr_b16 v[158:159], v8 offset:34560
    buffer_load_dword v206, v27, s[4:7], s87 offen sc1
    v_accvgpr_write_b32 a171, 0
    v_accvgpr_write_b32 a182, 0
    v_mfma_f32_32x32x16_bf16 v[120:135], v[140:143], a[28:31], v[120:135]
    s_waitcnt vmcnt(5)
    s_barrier
    ds_read_b64_tr_b16 v[136:137], v5 offset:36864
    ds_read_b64_tr_b16 v[138:139], v5 offset:37888
    s_lshl2_add_u32 m0, s74, 109568
    s_waitcnt lgkmcnt(4)
    v_mfma_f32_16x16x32_bf16 v[240:243], v[236:239], v[228:231], v[240:243]
    ds_read_b128 a[28:31], v36 offset:28672
    v_mfma_f32_32x32x16_bf16 v[72:87], v[144:147], a[32:35], v[72:87]
    s_nop 0
    ds_read_b64_tr_b16 v[140:141], v5 offset:37120
    ds_read_b64_tr_b16 v[142:143], v5 offset:38144
    buffer_load_dwordx4 v167, s[16:19], s58 offen lds
    v_accvgpr_write_b32 a183, 0
    v_and_b32_e64 v176, v213, v176
    v_mfma_f32_32x32x16_bf16 v[88:103], v[148:151], a[32:35], v[88:103]
    ds_read_b64_tr_b16 v[144:145], v5 offset:37376
    ds_read_b64_tr_b16 v[146:147], v5 offset:38400
    ds_read_b64_tr_b16 v[228:229], v252 offset:32768
    ds_read_b64_tr_b16 v[230:231], v252 offset:33792
    s_mov_b32 s57, 860160
    s_add_u32 m0, s74, 57344
    s_waitcnt lgkmcnt(9)
    v_mfma_f32_32x32x16_bf16 v[104:119], v[152:155], a[32:35], v[104:119]
    s_nop 0
    ds_read_b64_tr_b16 v[148:149], v8 offset:37632
    ds_read_b64_tr_b16 v[150:151], v8 offset:38656
    buffer_load_dwordx4 v163, s[12:15], s57 offen lds
    v_accvgpr_write_b32 a160, v176
    v_and_b32_e64 v177, v213, v177
    v_mfma_f32_32x32x16_bf16 v[120:135], v[156:159], a[32:35], v[120:135]
    ds_read_b64_tr_b16 v[152:153], v5 offset:40960
    ds_read_b64_tr_b16 v[154:155], v5 offset:41984
    s_mov_b32 s58, 640
    s_lshl2_add_u32 m0, s74, 122880
    v_accvgpr_write_b32 a161, v177
    s_waitcnt lgkmcnt(4)
    v_mfma_f32_16x16x32_bf16 v[240:243], v[236:239], v[228:231], v[240:243]
    ds_read_b128 a[32:35], v36 offset:32768
    v_mfma_f32_32x32x16_bf16 v[72:87], v[136:139], a[36:39], v[72:87]
    ds_read_b64_tr_b16 v[156:157], v5 offset:41216
    ds_read_b64_tr_b16 v[158:159], v5 offset:42240
    buffer_load_dwordx4 v164, s[16:19], s58 offen lds
    v_and_b32 v178, v213, v178
    v_accvgpr_write_b32 a162, v178
    v_mfma_f32_32x32x16_bf16 v[88:103], v[140:143], a[36:39], v[88:103]
    ds_read_b64_tr_b16 v[136:137], v5 offset:41472
    ds_read_b64_tr_b16 v[138:139], v5 offset:42496
    ds_read_b64_tr_b16 v[228:229], v252 offset:36864
    ds_read_b64_tr_b16 v[230:231], v252 offset:37888
    s_mov_b32 s57, 921600
    s_add_u32 m0, s74, 61440
    s_waitcnt lgkmcnt(9)
    v_mfma_f32_32x32x16_bf16 v[104:119], v[144:147], a[36:39], v[104:119]
    ds_read_b64_tr_b16 v[140:141], v8 offset:41728
    ds_read_b64_tr_b16 v[142:143], v8 offset:42752
    buffer_load_dwordx4 v163, s[12:15], s57 offen lds
    v_and_b32 v179, v213, v179
    v_accvgpr_write_b32 a163, v179
    v_mfma_f32_32x32x16_bf16 v[120:135], v[148:151], a[36:39], v[120:135]
    ds_read_b64_tr_b16 v[144:145], v5 offset:45056
    ds_read_b64_tr_b16 v[146:147], v5 offset:46080
    s_lshl2_add_u32 m0, s74, 123904
    v_and_b32 v180, v213, v180
    v_accvgpr_write_b32 a164, v180
    s_waitcnt lgkmcnt(4)
    buffer_load_dwordx4 v165, s[16:19], s58 offen lds
    s_waitcnt vmcnt(5)
L_p0_ck:
    v_cmp_ne_u32 vcc, s72, v206
    s_cbranch_vccnz L_p0_more
    v_mfma_f32_16x16x32_bf16 v[240:243], v[236:239], v[228:231], v[240:243]
    ds_read_b128 a[36:39], v36 offset:36864
    v_mfma_f32_32x32x16_bf16 v[72:87], v[152:155], a[40:43], v[72:87]
    ds_read_b64_tr_b16 v[148:149], v5 offset:45312
    ds_read_b64_tr_b16 v[150:151], v5 offset:46336
    v_and_b32 v181, v213, v181
    v_accvgpr_write_b32 a165, v181
    v_and_b32_e64 v182, v213, v182
    v_accvgpr_write_b32 a166, v182
    v_mfma_f32_32x32x16_bf16 v[88:103], v[156:159], a[40:43], v[88:103]
    ds_read_b64_tr_b16 v[152:153], v5 offset:45568
    ds_read_b64_tr_b16 v[154:155], v5 offset:46592
    ds_read_b64_tr_b16 v[228:229], v252 offset:40960
    ds_read_b64_tr_b16 v[230:231], v252 offset:41984
    s_add_u32 m0, s74, 65536
    s_waitcnt lgkmcnt(9)
    v_mfma_f32_32x32x16_bf16 v[104:119], v[136:139], a[40:43], v[104:119]
    s_nop 0
    ds_read_b64_tr_b16 v[156:157], v8 offset:45824
    ds_read_b64_tr_b16 v[158:159], v8 offset:46848
    ds_read_b128 a[48:51], v168 offset:36864
    ds_read_b128 a[52:55], v169 offset:36864
    ds_read_b128 a[56:59], v170 offset:36864
    ds_read_b128 a[60:63], v171 offset:36864
    buffer_load_dwordx4 v160, s[4:7], m0 offen sc1 lds
    v_mfma_f32_32x32x16_bf16 v[120:135], v[140:143], a[40:43], v[120:135]
    s_waitcnt vmcnt(4)
    s_barrier
    ds_read_b64_tr_b16 v[136:137], v5 offset:49152
    ds_read_b64_tr_b16 v[138:139], v5 offset:50176
    s_add_u32 m0, s74, 69632
    s_waitcnt lgkmcnt(8)
    v_mfma_f32_16x16x32_bf16 v[240:243], v[236:239], v[228:231], v[240:243]
    ds_read_b128 a[40:43], v36 offset:40960
    v_mfma_f32_32x32x16_bf16 v[72:87], v[144:147], a[44:47], v[72:87]
    s_nop 0
    ds_read_b64_tr_b16 v[140:141], v5 offset:49408
    ds_read_b64_tr_b16 v[142:143], v5 offset:50432
    buffer_load_dwordx4 v160, s[4:7], m0 offen sc1 lds
    s_lshl2_add_u32 m0, s74, 124928
    v_and_b32_e64 v183, v213, v183
    v_mfma_f32_32x32x16_bf16 v[88:103], v[148:151], a[44:47], v[88:103]
    ds_read_b64_tr_b16 v[144:145], v5 offset:49664
    ds_read_b64_tr_b16 v[146:147], v5 offset:50688
    ds_read_b64_tr_b16 v[228:229], v252 offset:45056
    ds_read_b64_tr_b16 v[230:231], v252 offset:46080
    buffer_load_dwordx4 v166, s[16:19], s58 offen lds
    s_waitcnt lgkmcnt(13)
    v_mfma_f32_32x32x16_bf16 v[104:119], v[152:155], a[44:47], v[104:119]
    s_nop 0
    ds_read_b64_tr_b16 v[148:149], v8 offset:49920
    ds_read_b64_tr_b16 v[150:151], v8 offset:50944
    s_add_u32 m0, s74, 73728
    v_accvgpr_write_b32 a167, v183
    v_and_b32 v184, v213, v184
    v_accvgpr_write_b32 a168, v184
    v_mfma_f32_32x32x16_bf16 v[120:135], v[156:159], a[44:47], v[120:135]
    ds_read_b64_tr_b16 v[152:153], v5 offset:53248
    ds_read_b64_tr_b16 v[154:155], v5 offset:54272
    buffer_load_dwordx4 v160, s[4:7], m0 offen sc1 lds
    v_and_b32 v185, v213, v185
    v_accvgpr_write_b32 a169, v185
    s_waitcnt lgkmcnt(4)
    v_mfma_f32_16x16x32_bf16 v[240:243], v[236:239], v[228:231], v[240:243]
    ds_read_b128 a[44:47], v36 offset:45056
    v_mfma_f32_32x32x16_bf16 v[72:87], v[136:139], a[48:51], v[72:87]
    ds_read_b64_tr_b16 v[156:157], v5 offset:53504
    ds_read_b64_tr_b16 v[158:159], v5 offset:54528
    s_lshl2_add_u32 m0, s74, 125952
    v_and_b32 v188, v213, v188
    v_accvgpr_write_b32 a172, v188
    v_and_b32_e64 v189, v213, v189
    v_mfma_f32_32x32x16_bf16 v[88:103], v[140:143], a[48:51], v[88:103]
    ds_read_b64_tr_b16 v[136:137], v5 offset:53760
    ds_read_b64_tr_b16 v[138:139], v5 offset:54784
    ds_read_b64_tr_b16 v[228:229], v252 offset:49152
    ds_read_b64_tr_b16 v[230:231], v252 offset:50176
    buffer_load_dwordx4 v167, s[16:19], s58 offen lds
    s_add_u32 m0, s74, 77824
    s_waitcnt lgkmcnt(9)
    v_mfma_f32_32x32x16_bf16 v[104:119], v[144:147], a[48:51], v[104:119]
    s_nop 0
    ds_read_b64_tr_b16 v[140:141], v8 offset:54016
    ds_read_b64_tr_b16 v[142:143], v8 offset:55040
    buffer_load_dwordx4 v160, s[4:7], m0 offen sc1 lds
    v_accvgpr_write_b32 a173, v189
    v_and_b32_e64 v190, v213, v190
    v_mfma_f32_32x32x16_bf16 v[120:135], v[148:151], a[48:51], v[120:135]
    ds_read_b64_tr_b16 v[144:145], v5 offset:57344
    ds_read_b64_tr_b16 v[146:147], v5 offset:58368
    s_mov_b32 s58, 768
    s_lshl2_add_u32 m0, s74, 139264
    v_accvgpr_write_b32 a174, v190
    s_waitcnt lgkmcnt(4)
    v_mfma_f32_16x16x32_bf16 v[240:243], v[236:239], v[228:231], v[240:243]
    ds_read_b128 a[48:51], v36 offset:49152
    v_mfma_f32_32x32x16_bf16 v[72:87], v[152:155], a[52:55], v[72:87]
    s_nop 0
    ds_read_b64_tr_b16 v[148:149], v5 offset:57600
    ds_read_b64_tr_b16 v[150:151], v5 offset:58624
    buffer_load_dwordx4 v164, s[16:19], s58 offen lds
    s_add_u32 m0, s74, 81920
    v_and_b32_e64 v191, v213, v191
    v_mfma_f32_32x32x16_bf16 v[88:103], v[156:159], a[52:55], v[88:103]
    ds_read_b64_tr_b16 v[152:153], v5 offset:57856
    ds_read_b64_tr_b16 v[154:155], v5 offset:58880
    ds_read_b64_tr_b16 v[228:229], v252 offset:53248
    ds_read_b64_tr_b16 v[230:231], v252 offset:54272
    buffer_load_dwordx4 v160, s[4:7], m0 offen sc1 lds
    s_waitcnt lgkmcnt(9)
    v_mfma_f32_32x32x16_bf16 v[104:119], v[136:139], a[52:55], v[104:119]
    s_nop 0
    ds_read_b64_tr_b16 v[156:157], v8 offset:58112
    ds_read_b64_tr_b16 v[158:159], v8 offset:59136
    s_lshl2_add_u32 m0, s74, 140288
    v_accvgpr_write_b32 a175, v191
    v_and_b32 v192, v213, v192
    v_accvgpr_write_b32 a176, v192
    v_mfma_f32_32x32x16_bf16 v[120:135], v[140:143], a[52:55], v[120:135]
    s_waitcnt vmcnt(6)
    s_barrier
    ds_read_b64_tr_b16 v[136:137], v5 offset:61440
    ds_read_b64_tr_b16 v[138:139], v5 offset:62464
    buffer_load_dwordx4 v165, s[16:19], s58 offen lds
    s_waitcnt lgkmcnt(4)
    v_mfma_f32_16x16x32_bf16 v[240:243], v[236:239], v[228:231], v[240:243]
    ds_read_b128 a[52:55], v36 offset:53248
    v_mfma_f32_32x32x16_bf16 v[72:87], v[144:147], a[56:59], v[72:87]
    ds_read_b64_tr_b16 v[140:141], v5 offset:61696
    ds_read_b64_tr_b16 v[142:143], v5 offset:62720
    s_add_u32 m0, s74, 86016
    v_and_b32 v193, v213, v193
    v_accvgpr_write_b32 a177, v193
    v_and_b32 v194, v213, v194
    v_mfma_f32_32x32x16_bf16 v[88:103], v[148:151], a[56:59], v[88:103]
    ds_read_b64_tr_b16 v[144:145], v5 offset:61952
    ds_read_b64_tr_b16 v[146:147], v5 offset:62976
    ds_read_b64_tr_b16 v[228:229], v252 offset:57344
    ds_read_b64_tr_b16 v[230:231], v252 offset:58368
    buffer_load_dwordx4 v160, s[4:7], m0 offen sc1 lds
    s_lshl2_add_u32 m0, s74, 141312
    s_waitcnt lgkmcnt(9)
    v_mfma_f32_32x32x16_bf16 v[104:119], v[152:155], a[56:59], v[104:119]
    s_nop 0
    ds_read_b64_tr_b16 v[148:149], v8 offset:62208
    ds_read_b64_tr_b16 v[150:151], v8 offset:63232
    ds_read_b128 a[64:67], v168 offset:53248
    ds_read_b128 a[68:71], v169 offset:53248
    ds_read_b128 a[72:75], v170 offset:53248
    ds_read_b128 a[76:79], v171 offset:53248
    buffer_load_dwordx4 v166, s[16:19], s58 offen lds
    v_mfma_f32_32x32x16_bf16 v[120:135], v[156:159], a[56:59], v[120:135]
    ds_read_b64_tr_b16 v[152:153], v6 offset:0
    ds_read_b64_tr_b16 v[154:155], v6 offset:1024
    s_add_u32 m0, s74, 90112
    v_accvgpr_write_b32 a178, v194
    v_and_b32 v195, v213, v195
    s_waitcnt lgkmcnt(8)
    v_mfma_f32_16x16x32_bf16 v[240:243], v[236:239], v[228:231], v[240:243]
    ds_read_b128 a[56:59], v36 offset:57344
    v_mfma_f32_32x32x16_bf16 v[72:87], v[136:139], a[60:63], v[72:87]
    ds_read_b64_tr_b16 v[156:157], v6 offset:256
    ds_read_b64_tr_b16 v[158:159], v6 offset:1280
    buffer_load_dwordx4 v160, s[4:7], m0 offen sc1 lds
    s_lshl2_add_u32 m0, s74, 142336
    v_accvgpr_write_b32 a179, v195
    v_mfma_f32_32x32x16_bf16 v[88:103], v[140:143], a[60:63], v[88:103]
    ds_read_b64_tr_b16 v[136:137], v6 offset:512
    ds_read_b64_tr_b16 v[138:139], v6 offset:1536
    ds_read_b64_tr_b16 v[228:229], v252 offset:61440
    ds_read_b64_tr_b16 v[230:231], v252 offset:62464
    buffer_load_dwordx4 v167, s[16:19], s58 offen lds
    s_waitcnt lgkmcnt(13)
    v_mfma_f32_32x32x16_bf16 v[104:119], v[144:147], a[60:63], v[104:119]
    ds_read_b64_tr_b16 v[140:141], v9 offset:768
    ds_read_b64_tr_b16 v[142:143], v9 offset:1792
    s_add_u32 m0, s74, 94208
    v_and_b32 v196, v213, v196
    v_accvgpr_write_b32 a180, v196
    v_and_b32_e64 v197, v213, v197
    v_mfma_f32_32x32x16_bf16 v[120:135], v[148:151], a[60:63], v[120:135]
    ds_read_b64_tr_b16 v[144:145], v6 offset:4096
    ds_read_b64_tr_b16 v[146:147], v6 offset:5120
    buffer_load_dwordx4 v160, s[4:7], m0 offen sc1 lds
    v_accvgpr_write_b32 a181, v197
    s_waitcnt lgkmcnt(4)
    v_mfma_f32_16x16x32_bf16 v[240:243], v[236:239], v[228:231], v[240:243]
    ds_read_b128 a[60:63], v36 offset:61440
    v_mfma_f32_32x32x16_bf16 v[72:87], v[152:155], a[64:67], v[72:87]
    ds_read_b64_tr_b16 v[148:149], v6 offset:4352
    ds_read_b64_tr_b16 v[150:151], v6 offset:5376
    s_add_u32 m0, s74, 98304
    v_mfma_f32_32x32x16_bf16 v[88:103], v[156:159], a[64:67], v[88:103]
    s_nop 0
    ds_read_b64_tr_b16 v[152:153], v6 offset:4608
    ds_read_b64_tr_b16 v[154:155], v6 offset:5632
    v_add_u32 v252, 0x10000, v252
    ds_read_b64_tr_b16 v[228:229], v252 offset:0
    ds_read_b64_tr_b16 v[230:231], v252 offset:1024
    buffer_load_dwordx4 v160, s[4:7], m0 offen sc1 lds
    s_add_u32 m0, s74, 102400
    s_waitcnt lgkmcnt(9)
    v_mfma_f32_32x32x16_bf16 v[104:119], v[136:139], a[64:67], v[104:119]
    ds_read_b64_tr_b16 v[156:157], v9 offset:4864
    ds_read_b64_tr_b16 v[158:159], v9 offset:5888
    buffer_load_dwordx4 v160, s[4:7], m0 offen sc1 lds
    v_mfma_f32_32x32x16_bf16 v[120:135], v[140:143], a[64:67], v[120:135]
    s_waitcnt vmcnt(8)
    s_barrier
    ds_read_b64_tr_b16 v[136:137], v6 offset:8192
    ds_read_b64_tr_b16 v[138:139], v6 offset:9216
    s_add_u32 m0, s74, 106496
    s_waitcnt lgkmcnt(4)
    v_mfma_f32_16x16x32_bf16 v[240:243], v[236:239], v[228:231], v[240:243]
    ds_read_b128 a[64:67], v37 offset:0
    v_mfma_f32_32x32x16_bf16 v[72:87], v[144:147], a[68:71], v[72:87]
    ds_read_b64_tr_b16 v[140:141], v6 offset:8448
    ds_read_b64_tr_b16 v[142:143], v6 offset:9472
    buffer_load_dwordx4 v160, s[4:7], m0 offen sc1 lds
    s_add_u32 m0, s74, 110592
    v_mfma_f32_32x32x16_bf16 v[88:103], v[148:151], a[68:71], v[88:103]
    ds_read_b64_tr_b16 v[144:145], v6 offset:8704
    ds_read_b64_tr_b16 v[146:147], v6 offset:9728
    ds_read_b64_tr_b16 v[228:229], v252 offset:4096
    ds_read_b64_tr_b16 v[230:231], v252 offset:5120
    buffer_load_dwordx4 v160, s[4:7], m0 offen sc1 lds
    s_waitcnt lgkmcnt(9)
    v_mfma_f32_32x32x16_bf16 v[104:119], v[152:155], a[68:71], v[104:119]
    s_nop 0
    ds_read_b64_tr_b16 v[148:149], v9 offset:8960
    ds_read_b64_tr_b16 v[150:151], v9 offset:9984
    ds_read_b128 a[80:83], v172 offset:4096
    ds_read_b128 a[84:87], v173 offset:4096
    ds_read_b128 a[88:91], v174 offset:4096
    ds_read_b128 a[92:95], v175 offset:4096
    s_add_u32 m0, s74, 114688
    v_mfma_f32_32x32x16_bf16 v[120:135], v[156:159], a[68:71], v[120:135]
    ds_read_b64_tr_b16 v[152:153], v6 offset:12288
    ds_read_b64_tr_b16 v[154:155], v6 offset:13312
    buffer_load_dwordx4 v160, s[4:7], m0 offen sc1 lds
    s_waitcnt lgkmcnt(8)
    v_mfma_f32_16x16x32_bf16 v[240:243], v[236:239], v[228:231], v[240:243]
    ds_read_b128 a[68:71], v37 offset:4096
    v_mfma_f32_32x32x16_bf16 v[72:87], v[136:139], a[72:75], v[72:87]
    ds_read_b64_tr_b16 v[156:157], v6 offset:12544
    ds_read_b64_tr_b16 v[158:159], v6 offset:13568
    v_mfma_f32_32x32x16_bf16 v[88:103], v[140:143], a[72:75], v[88:103]
    s_nop 0
    ds_read_b64_tr_b16 v[136:137], v6 offset:12800
    ds_read_b64_tr_b16 v[138:139], v6 offset:13824
    ds_read_b64_tr_b16 v[228:229], v252 offset:8192
    ds_read_b64_tr_b16 v[230:231], v252 offset:9216
    buffer_load_dword v205, v27, s[4:7], s97 offen sc1
    s_waitcnt lgkmcnt(13)
    v_mfma_f32_32x32x16_bf16 v[104:119], v[144:147], a[72:75], v[104:119]
    ds_read_b64_tr_b16 v[140:141], v9 offset:13056
    ds_read_b64_tr_b16 v[142:143], v9 offset:14080
    buffer_load_dword v200, v204, s[4:7], 0 offen sc1
    v_mfma_f32_32x32x16_bf16 v[120:135], v[148:151], a[72:75], v[120:135]
    ds_read_b64_tr_b16 v[144:145], v6 offset:16384
    ds_read_b64_tr_b16 v[146:147], v6 offset:17408
    s_add_u32 m0, s74, 118784
    s_waitcnt lgkmcnt(4)
    v_mfma_f32_16x16x32_bf16 v[240:243], v[236:239], v[228:231], v[240:243]
    ds_read_b128 a[72:75], v37 offset:8192
    v_mfma_f32_32x32x16_bf16 v[72:87], v[152:155], a[76:79], v[72:87]
    ds_read_b64_tr_b16 v[148:149], v6 offset:16640
    ds_read_b64_tr_b16 v[150:151], v6 offset:17664
    buffer_load_dwordx4 v160, s[4:7], m0 offen sc1 lds
    v_mfma_f32_32x32x16_bf16 v[88:103], v[156:159], a[76:79], v[88:103]
    ds_read_b64_tr_b16 v[152:153], v6 offset:16896
    ds_read_b64_tr_b16 v[154:155], v6 offset:17920
    ds_read_b64_tr_b16 v[228:229], v252 offset:12288
    ds_read_b64_tr_b16 v[230:231], v252 offset:13312
    s_waitcnt lgkmcnt(9)
    v_mfma_f32_32x32x16_bf16 v[104:119], v[136:139], a[76:79], v[104:119]
    ds_read_b64_tr_b16 v[156:157], v9 offset:17152
    ds_read_b64_tr_b16 v[158:159], v9 offset:18176
    v_mfma_f32_32x32x16_bf16 v[120:135], v[140:143], a[76:79], v[120:135]
    s_waitcnt vmcnt(7)
    s_barrier
    ds_read_b64_tr_b16 v[136:137], v6 offset:20480
    ds_read_b64_tr_b16 v[138:139], v6 offset:21504
    s_waitcnt lgkmcnt(4)
    v_mfma_f32_16x16x32_bf16 v[240:243], v[236:239], v[228:231], v[240:243]
    ds_read_b128 a[76:79], v37 offset:12288
    v_mfma_f32_32x32x16_bf16 v[72:87], v[144:147], a[80:83], v[72:87]
    ds_read_b64_tr_b16 v[140:141], v6 offset:20736
    ds_read_b64_tr_b16 v[142:143], v6 offset:21760
    s_mov_b32 s58, 896
    s_lshl2_add_u32 m0, s74, 53248
    v_mfma_f32_32x32x16_bf16 v[88:103], v[148:151], a[80:83], v[88:103]
    ds_read_b64_tr_b16 v[144:145], v6 offset:20992
    ds_read_b64_tr_b16 v[146:147], v6 offset:22016
    ds_read_b64_tr_b16 v[228:229], v252 offset:16384
    ds_read_b64_tr_b16 v[230:231], v252 offset:17408
    buffer_load_dwordx4 v164, s[16:19], s58 offen lds
    s_lshl2_add_u32 m0, s74, 54272
    s_waitcnt lgkmcnt(9)
    v_mfma_f32_32x32x16_bf16 v[104:119], v[152:155], a[80:83], v[104:119]
    s_nop 0
    ds_read_b64_tr_b16 v[148:149], v9 offset:21248
    ds_read_b64_tr_b16 v[150:151], v9 offset:22272
    ds_read_b128 a[96:99], v172 offset:20480
    ds_read_b128 a[100:103], v173 offset:20480
    ds_read_b128 a[104:107], v174 offset:20480
    ds_read_b128 a[108:111], v175 offset:20480
    buffer_load_dwordx4 v165, s[16:19], s58 offen lds
    v_mfma_f32_32x32x16_bf16 v[120:135], v[156:159], a[80:83], v[120:135]
    ds_read_b64_tr_b16 v[152:153], v6 offset:24576
    ds_read_b64_tr_b16 v[154:155], v6 offset:25600
    s_lshl2_add_u32 m0, s74, 55296
    s_waitcnt lgkmcnt(8)
    v_mfma_f32_16x16x32_bf16 v[240:243], v[236:239], v[228:231], v[240:243]
    ds_read_b128 a[80:83], v37 offset:16384
    v_mfma_f32_32x32x16_bf16 v[72:87], v[136:139], a[84:87], v[72:87]
    s_nop 0
    ds_read_b64_tr_b16 v[156:157], v6 offset:24832
    ds_read_b64_tr_b16 v[158:159], v6 offset:25856
    buffer_load_dwordx4 v166, s[16:19], s58 offen lds
    s_lshl2_add_u32 m0, s74, 56320
    v_mfma_f32_32x32x16_bf16 v[88:103], v[140:143], a[84:87], v[88:103]
    ds_read_b64_tr_b16 v[136:137], v6 offset:25088
    ds_read_b64_tr_b16 v[138:139], v6 offset:26112
    ds_read_b64_tr_b16 v[228:229], v252 offset:20480
    ds_read_b64_tr_b16 v[230:231], v252 offset:21504
    buffer_load_dwordx4 v167, s[16:19], s58 offen lds
    s_waitcnt lgkmcnt(13)
    v_mfma_f32_32x32x16_bf16 v[104:119], v[144:147], a[84:87], v[104:119]
    ds_read_b64_tr_b16 v[140:141], v9 offset:25344
    ds_read_b64_tr_b16 v[142:143], v9 offset:26368
    s_add_u32 m0, s74, 122880
    v_mfma_f32_32x32x16_bf16 v[120:135], v[148:151], a[84:87], v[120:135]
    ds_read_b64_tr_b16 v[144:145], v6 offset:28672
    ds_read_b64_tr_b16 v[146:147], v6 offset:29696
    buffer_load_dwordx4 v160, s[4:7], m0 offen sc1 lds
    s_waitcnt lgkmcnt(4)
    s_waitcnt vmcnt(6)
L_xf_ck:
    v_xor_b32 v205, s81, v205
    v_cmp_ne_u32 vcc, 0, v205
    s_cbranch_vccnz L_xf_more
L_xf_ok:
    s_cmp_eq_u32 s73, 1
    s_cbranch_scc0 L_pre_ok
L_pre_ck:
    v_cmp_ne_u32 vcc, s72, v200
    s_cbranch_vccnz L_pre_more
L_pre_ok:
    s_barrier
    s_mov_b32 s96, 0x8000
    v_mfma_f32_16x16x32_bf16 v[240:243], v[236:239], v[228:231], v[240:243]
    ds_read_b128 a[84:87], v37 offset:20480
    v_mfma_f32_32x32x16_bf16 v[72:87], v[152:155], a[88:91], v[72:87]
    ds_read_b64_tr_b16 v[148:149], v6 offset:28928
    ds_read_b64_tr_b16 v[150:151], v6 offset:29952
    v_mfma_f32_32x32x16_bf16 v[88:103], v[156:159], a[88:91], v[88:103]
    s_nop 0
    ds_read_b64_tr_b16 v[152:153], v6 offset:29184
    ds_read_b64_tr_b16 v[154:155], v6 offset:30208
    ds_read_b64_tr_b16 v[228:229], v252 offset:24576
    ds_read_b64_tr_b16 v[230:231], v252 offset:25600
    buffer_load_dwordx4 v[220:223], v1, s[4:7], s96 offen sc1
    s_waitcnt lgkmcnt(9)
    v_mfma_f32_32x32x16_bf16 v[104:119], v[136:139], a[88:91], v[104:119]
    ds_read_b64_tr_b16 v[156:157], v9 offset:29440
    ds_read_b64_tr_b16 v[158:159], v9 offset:30464
    buffer_load_dwordx4 v[244:247], v19, s[8:11], 0 offen offset:0 sc1
    v_mfma_f32_32x32x16_bf16 v[120:135], v[140:143], a[88:91], v[120:135]
    ds_read_b64_tr_b16 v[136:137], v6 offset:32768
    ds_read_b64_tr_b16 v[138:139], v6 offset:33792
    s_waitcnt lgkmcnt(4)
    v_mfma_f32_16x16x32_bf16 v[240:243], v[236:239], v[228:231], v[240:243]
    ds_read_b128 a[88:91], v37 offset:24576
    v_mfma_f32_32x32x16_bf16 v[72:87], v[144:147], a[92:95], v[72:87]
    ds_read_b64_tr_b16 v[140:141], v6 offset:33024
    ds_read_b64_tr_b16 v[142:143], v6 offset:34048
    buffer_load_dwordx4 v[248:251], v19, s[8:11], 0 offen offset:1024 sc1
    s_mov_b32 s58, 1024
    s_lshl2_add_u32 m0, s74, 69632
    v_mfma_f32_32x32x16_bf16 v[88:103], v[148:151], a[92:95], v[88:103]
    ds_read_b64_tr_b16 v[144:145], v6 offset:33280
    ds_read_b64_tr_b16 v[146:147], v6 offset:34304
    ds_read_b64_tr_b16 v[228:229], v252 offset:28672
    ds_read_b64_tr_b16 v[230:231], v252 offset:29696
    buffer_load_dwordx4 v164, s[16:19], s58 offen lds
    s_waitcnt lgkmcnt(9)
    v_mfma_f32_32x32x16_bf16 v[104:119], v[152:155], a[92:95], v[104:119]
    ds_read_b64_tr_b16 v[148:149], v9 offset:33536
    ds_read_b64_tr_b16 v[150:151], v9 offset:34560
    s_lshl2_add_u32 m0, s74, 70656
    v_mfma_f32_32x32x16_bf16 v[120:135], v[156:159], a[92:95], v[120:135]
    s_barrier
    ds_read_b64_tr_b16 v[152:153], v6 offset:36864
    ds_read_b64_tr_b16 v[154:155], v6 offset:37888
    buffer_load_dwordx4 v165, s[16:19], s58 offen lds
    s_waitcnt lgkmcnt(4)
    v_mfma_f32_16x16x32_bf16 v[240:243], v[236:239], v[228:231], v[240:243]
    ds_read_b128 a[92:95], v37 offset:28672
    v_mfma_f32_32x32x16_bf16 v[72:87], v[136:139], a[96:99], v[72:87]
    ds_read_b64_tr_b16 v[156:157], v6 offset:37120
    ds_read_b64_tr_b16 v[158:159], v6 offset:38144
    s_lshl2_add_u32 m0, s74, 71680
    v_mfma_f32_32x32x16_bf16 v[88:103], v[140:143], a[96:99], v[88:103]
    s_nop 0
    ds_read_b64_tr_b16 v[136:137], v6 offset:37376
    ds_read_b64_tr_b16 v[138:139], v6 offset:38400
    ds_read_b64_tr_b16 v[228:229], v252 offset:32768
    ds_read_b64_tr_b16 v[230:231], v252 offset:33792
    buffer_load_dwordx4 v166, s[16:19], s58 offen lds
    s_lshl2_add_u32 m0, s74, 72704
    s_waitcnt lgkmcnt(9)
    v_mfma_f32_32x32x16_bf16 v[104:119], v[144:147], a[96:99], v[104:119]
    ds_read_b64_tr_b16 v[140:141], v9 offset:37632
    ds_read_b64_tr_b16 v[142:143], v9 offset:38656
    buffer_load_dwordx4 v167, s[16:19], s58 offen lds
    v_mfma_f32_32x32x16_bf16 v[120:135], v[148:151], a[96:99], v[120:135]
    ds_read_b64_tr_b16 v[144:145], v6 offset:40960
    ds_read_b64_tr_b16 v[146:147], v6 offset:41984
    s_add_u32 m0, s74, 126976
L_pad2:
    s_cbranch_execz L_pad6
    s_waitcnt lgkmcnt(4)
    v_mfma_f32_16x16x32_bf16 v[240:243], v[236:239], v[228:231], v[240:243]
    ds_read_b128 a[96:99], v37 offset:32768
    v_mfma_f32_32x32x16_bf16 v[72:87], v[152:155], a[100:103], v[72:87]
    s_nop 0
    ds_read_b64_tr_b16 v[148:149], v6 offset:41216
    ds_read_b64_tr_b16 v[150:151], v6 offset:42240
    buffer_load_dwordx4 v160, s[4:7], m0 offen sc1 lds
    s_add_u32 m0, s74, 131072
    v_mfma_f32_32x32x16_bf16 v[88:103], v[156:159], a[100:103], v[88:103]
    ds_read_b64_tr_b16 v[152:153], v6 offset:41472
    ds_read_b64_tr_b16 v[154:155], v6 offset:42496
    ds_read_b64_tr_b16 v[228:229], v252 offset:36864
    ds_read_b64_tr_b16 v[230:231], v252 offset:37888
    buffer_load_dwordx4 v160, s[4:7], m0 offen sc1 lds
    s_waitcnt lgkmcnt(9)
    v_mfma_f32_32x32x16_bf16 v[104:119], v[136:139], a[100:103], v[104:119]
    ds_read_b64_tr_b16 v[156:157], v9 offset:41728
    ds_read_b64_tr_b16 v[158:159], v9 offset:42752
    s_add_u32 m0, s74, 135168
    v_mfma_f32_32x32x16_bf16 v[120:135], v[140:143], a[100:103], v[120:135]
    ds_read_b64_tr_b16 v[136:137], v6 offset:45056
    ds_read_b64_tr_b16 v[138:139], v6 offset:46080
    buffer_load_dwordx4 v160, s[4:7], m0 offen sc1 lds
    s_waitcnt lgkmcnt(4)
    v_mfma_f32_16x16x32_bf16 v[240:243], v[236:239], v[228:231], v[240:243]
    ds_read_b128 a[100:103], v37 offset:36864
    v_mfma_f32_32x32x16_bf16 v[72:87], v[144:147], a[104:107], v[72:87]
    ds_read_b64_tr_b16 v[140:141], v6 offset:45312
    ds_read_b64_tr_b16 v[142:143], v6 offset:46336
    s_add_u32 m0, s74, 139264
    s_waitcnt vmcnt(7)
    v_add_f32 v244, v244, v246
    v_add_f32_e64 v248, v248, v250
    v_mfma_f32_32x32x16_bf16 v[88:103], v[148:151], a[104:107], v[88:103]
    ds_read_b64_tr_b16 v[144:145], v6 offset:45568
    ds_read_b64_tr_b16 v[146:147], v6 offset:46592
    ds_read_b64_tr_b16 v[228:229], v252 offset:40960
    ds_read_b64_tr_b16 v[230:231], v252 offset:41984
    buffer_load_dwordx4 v160, s[4:7], m0 offen sc1 lds
    s_add_u32 m0, s74, 143360
    s_waitcnt lgkmcnt(9)
    v_mfma_f32_32x32x16_bf16 v[104:119], v[152:155], a[104:107], v[104:119]
    s_nop 0
    ds_read_b64_tr_b16 v[148:149], v9 offset:45824
    ds_read_b64_tr_b16 v[150:151], v9 offset:46848
    ds_read_b128 a[112:115], v168 offset:0
    ds_read_b128 a[116:119], v169 offset:0
    ds_read_b128 a[120:123], v170 offset:0
    ds_read_b128 a[124:127], v171 offset:0
    buffer_load_dwordx4 v160, s[4:7], m0 offen sc1 lds
    v_mfma_f32_32x32x16_bf16 v[120:135], v[156:159], a[104:107], v[120:135]
    ds_read_b64_tr_b16 v[152:153], v6 offset:49152
    ds_read_b64_tr_b16 v[154:155], v6 offset:50176
    s_add_u32 m0, s74, 147456
    v_add_f32 v245, v245, v247
    v_add_f32 v249, v249, v251
    s_waitcnt lgkmcnt(8)
    v_mfma_f32_16x16x32_bf16 v[240:243], v[236:239], v[228:231], v[240:243]
    ds_read_b128 a[104:107], v37 offset:40960
    v_mfma_f32_32x32x16_bf16 v[72:87], v[136:139], a[108:111], v[72:87]
    s_nop 0
    ds_read_b64_tr_b16 v[156:157], v6 offset:49408
    ds_read_b64_tr_b16 v[158:159], v6 offset:50432
    buffer_load_dwordx4 v160, s[4:7], m0 offen sc1 lds
    s_add_u32 m0, s74, 151552
    v_add_f32_e64 v244, v244, v248
    v_mfma_f32_32x32x16_bf16 v[88:103], v[140:143], a[108:111], v[88:103]
    ds_read_b64_tr_b16 v[136:137], v6 offset:49664
    ds_read_b64_tr_b16 v[138:139], v6 offset:50688
    ds_read_b64_tr_b16 v[228:229], v252 offset:45056
    ds_read_b64_tr_b16 v[230:231], v252 offset:46080
    buffer_load_dwordx4 v160, s[4:7], m0 offen sc1 lds
    s_waitcnt lgkmcnt(13)
    v_mfma_f32_32x32x16_bf16 v[104:119], v[144:147], a[108:111], v[104:119]
    ds_read_b64_tr_b16 v[140:141], v9 offset:49920
    ds_read_b64_tr_b16 v[142:143], v9 offset:50944
    s_add_u32 m0, s74, 155648
    v_add_f32 v245, v245, v249
    v_mov_b32 v246, v244
    v_mov_b32 v247, v245
    v_mfma_f32_32x32x16_bf16 v[120:135], v[148:151], a[108:111], v[120:135]
    s_waitcnt vmcnt(5)
    s_barrier
    ds_read_b64_tr_b16 v[144:145], v6 offset:53248
    ds_read_b64_tr_b16 v[146:147], v6 offset:54272
    buffer_load_dwordx4 v160, s[4:7], m0 offen sc1 lds
    s_waitcnt lgkmcnt(4)
    v_mfma_f32_16x16x32_bf16 v[240:243], v[236:239], v[228:231], v[240:243]
    ds_read_b128 a[108:111], v37 offset:45056
    v_mfma_f32_32x32x16_bf16 v[72:87], v[152:155], a[112:115], v[72:87]
    s_nop 0
    ds_read_b64_tr_b16 v[148:149], v6 offset:53504
    ds_read_b64_tr_b16 v[150:151], v6 offset:54528
    s_mov_b32 s58, 1152
    s_lshl2_add_u32 m0, s74, 86016
    v_permlane32_swap_b32 v244, v246
    v_mfma_f32_32x32x16_bf16 v[88:103], v[156:159], a[112:115], v[88:103]
    s_nop 0
    ds_read_b64_tr_b16 v[152:153], v6 offset:53760
    ds_read_b64_tr_b16 v[154:155], v6 offset:54784
    ds_read_b64_tr_b16 v[228:229], v252 offset:49152
    ds_read_b64_tr_b16 v[230:231], v252 offset:50176
    buffer_load_dwordx4 v164, s[16:19], s58 offen lds
    s_lshl2_add_u32 m0, s74, 87040
    s_waitcnt lgkmcnt(9)
    v_mfma_f32_32x32x16_bf16 v[104:119], v[136:139], a[112:115], v[104:119]
    ds_read_b64_tr_b16 v[156:157], v9 offset:54016
    ds_read_b64_tr_b16 v[158:159], v9 offset:55040
    buffer_load_dwordx4 v165, s[16:19], s58 offen lds
    v_permlane32_swap_b32 v245, v247
    v_mfma_f32_32x32x16_bf16 v[120:135], v[140:143], a[112:115], v[120:135]
    ds_read_b64_tr_b16 v[136:137], v6 offset:57344
    ds_read_b64_tr_b16 v[138:139], v6 offset:58368
    s_lshl2_add_u32 m0, s74, 88064
    v_add_f32 v244, v244, v246
    v_add_f32 v245, v245, v247
    s_waitcnt lgkmcnt(4)
    v_mfma_f32_16x16x32_bf16 v[240:243], v[236:239], v[228:231], v[240:243]
    ds_read_b128 a[112:115], v37 offset:49152
    v_mfma_f32_32x32x16_bf16 v[72:87], v[144:147], a[116:119], v[72:87]
    s_nop 0
    ds_read_b64_tr_b16 v[140:141], v6 offset:57600
    ds_read_b64_tr_b16 v[142:143], v6 offset:58624
    buffer_load_dwordx4 v166, s[16:19], s58 offen lds
    s_lshl2_add_u32 m0, s74, 89088
    v_mul_f32 v244, 0xbacccccd, v244
    v_mfma_f32_32x32x16_bf16 v[88:103], v[148:151], a[116:119], v[88:103]
    ds_read_b64_tr_b16 v[144:145], v6 offset:57856
    ds_read_b64_tr_b16 v[146:147], v6 offset:58880
    ds_read_b64_tr_b16 v[228:229], v252 offset:53248
    ds_read_b64_tr_b16 v[230:231], v252 offset:54272
    buffer_load_dwordx4 v167, s[16:19], s58 offen lds
    s_waitcnt lgkmcnt(9)
    v_mfma_f32_32x32x16_bf16 v[104:119], v[152:155], a[116:119], v[104:119]
    ds_read_b64_tr_b16 v[148:149], v9 offset:58112
    ds_read_b64_tr_b16 v[150:151], v9 offset:59136
    v_add_u32 v160, 0x27000, v160
    s_add_u32 m0, s74, 0
    v_mul_f32 v246, v244, v244
    v_mul_f32 v245, 0x3acccccd, v245
    v_mfma_f32_32x32x16_bf16 v[120:135], v[156:159], a[116:119], v[120:135]
    ds_read_b64_tr_b16 v[152:153], v6 offset:61440
    ds_read_b64_tr_b16 v[154:155], v6 offset:62464
    buffer_load_dwordx4 v160, s[4:7], m0 offen sc1 lds
    v_sub_f32 v246, v245, v246
    v_max_f32 v246, 0, v246
    s_waitcnt lgkmcnt(4)
    v_mfma_f32_16x16x32_bf16 v[240:243], v[236:239], v[228:231], v[240:243]
    ds_read_b128 a[116:119], v37 offset:53248
    v_mfma_f32_32x32x16_bf16 v[72:87], v[136:139], a[120:123], v[72:87]
    ds_read_b64_tr_b16 v[156:157], v6 offset:61696
    ds_read_b64_tr_b16 v[158:159], v6 offset:62720
    v_add_f32 v246, 0x3727c5ac, v246
    v_rsq_f32 v246, v246
    s_nop 0
    v_mul_f32_e64 v245, v246, v244
    v_mfma_f32_32x32x16_bf16 v[88:103], v[140:143], a[120:123], v[88:103]
    ds_read_b64_tr_b16 v[136:137], v6 offset:61952
    ds_read_b64_tr_b16 v[138:139], v6 offset:62976
    ds_read_b64_tr_b16 v[228:229], v252 offset:57344
    ds_read_b64_tr_b16 v[230:231], v252 offset:58368
    buffer_load_dwordx4 a[184:187], v49, s[4:7], 0 offen sc1
    s_add_u32 m0, s74, 4096
    s_waitcnt lgkmcnt(9)
    v_mfma_f32_32x32x16_bf16 v[104:119], v[144:147], a[120:123], v[104:119]
    s_nop 0
    ds_read_b64_tr_b16 v[140:141], v9 offset:62208
    ds_read_b64_tr_b16 v[142:143], v9 offset:63232
    ds_read_b128 a[128:131], v168 offset:16384
    ds_read_b128 a[132:135], v169 offset:16384
    ds_read_b128 a[136:139], v170 offset:16384
    ds_read_b128 a[140:143], v171 offset:16384
    buffer_load_dwordx4 v30, s[4:7], m0 offen sc1 lds
    v_mfma_f32_32x32x16_bf16 v[120:135], v[148:151], a[120:123], v[120:135]
    ds_read_b64_tr_b16 v[144:145], v7 offset:0
    ds_read_b64_tr_b16 v[146:147], v7 offset:1024
    v_mov_b32 v244, v246
    v_add_f32 v220, v220, v221
    v_add_f32 v222, v222, v223
    s_waitcnt lgkmcnt(8)
    v_mfma_f32_16x16x32_bf16 v[240:243], v[236:239], v[228:231], v[240:243]
    ds_read_b128 a[120:123], v37 offset:57344
    v_mfma_f32_32x32x16_bf16 v[72:87], v[152:155], a[124:127], v[72:87]
    ds_read_b64_tr_b16 v[148:149], v7 offset:256
    ds_read_b64_tr_b16 v[150:151], v7 offset:1280
    buffer_load_dwordx4 a[188:191], v49, s[4:7], s32 offen sc1
    s_add_u32 m0, s74, 8192
    v_min_u32 v221, 127, v0
    v_mfma_f32_32x32x16_bf16 v[88:103], v[156:159], a[124:127], v[88:103]
    ds_read_b64_tr_b16 v[152:153], v7 offset:512
    ds_read_b64_tr_b16 v[154:155], v7 offset:1536
    ds_read_b64_tr_b16 v[228:229], v252 offset:61440
    ds_read_b64_tr_b16 v[230:231], v252 offset:62464
    buffer_load_dwordx4 v30, s[4:7], m0 offen sc1 lds
    s_waitcnt lgkmcnt(13)
    v_mfma_f32_32x32x16_bf16 v[104:119], v[136:139], a[124:127], v[104:119]
    ds_read_b64_tr_b16 v[156:157], v10 offset:768
    ds_read_b64_tr_b16 v[158:159], v10 offset:1792
    v_add_f32 v220, v220, v222
    v_lshlrev_b32 v221, 2, v221
    v_add_u32 v221, 160256, v221
    ds_write_b32 v221, v220
    v_mfma_f32_32x32x16_bf16 v[120:135], v[140:143], a[124:127], v[120:135]
    s_waitcnt vmcnt(4)
    s_barrier
    s_nop 0
    ds_read_b64_tr_b16 v[136:137], v7 offset:4096
    ds_read_b64_tr_b16 v[138:139], v7 offset:5120
    v_add_u32 v252, 0x10000, v252
    ds_read_b64_tr_b16 v[232:233], v252 offset:0
    ds_read_b64_tr_b16 v[234:235], v252 offset:1024
    buffer_load_dwordx4 a[192:195], v49, s[4:7], s33 offen sc1
    s_waitcnt lgkmcnt(7)
    v_mfma_f32_16x16x32_bf16 v[240:243], v[236:239], v[228:231], v[240:243]
    ds_read_b128 a[124:127], v37 offset:61440
    v_mfma_f32_32x32x16_bf16 v[72:87], v[144:147], a[128:131], v[72:87]
    ds_read_b64_tr_b16 v[140:141], v7 offset:4352
    ds_read_b64_tr_b16 v[142:143], v7 offset:5376
    s_add_u32 m0, s74, 12288
    v_mfma_f32_32x32x16_bf16 v[88:103], v[148:151], a[128:131], v[88:103]
    s_nop 0
    ds_read_b64_tr_b16 v[144:145], v7 offset:4608
    ds_read_b64_tr_b16 v[146:147], v7 offset:5632
    ds_read_b64_tr_b16 v[228:229], v252 offset:4096
    ds_read_b64_tr_b16 v[230:231], v252 offset:5120
    s_waitcnt lgkmcnt(7)
    v_mfma_f32_16x16x32_bf16 v[240:243], v[236:239], v[232:235], v[240:243]
    buffer_load_dwordx4 v30, s[4:7], m0 offen sc1 lds
    v_mfma_f32_32x32x16_bf16 v[104:119], v[152:155], a[128:131], v[104:119]
    ds_read_b64_tr_b16 v[148:149], v10 offset:4864
    ds_read_b64_tr_b16 v[150:151], v10 offset:5888
    buffer_load_dwordx4 a[196:199], v49, s[4:7], s34 offen sc1
    v_mfma_f32_32x32x16_bf16 v[120:135], v[156:159], a[128:131], v[120:135]
    s_nop 0
    ds_read_b64_tr_b16 v[152:153], v7 offset:8192
    ds_read_b64_tr_b16 v[154:155], v7 offset:9216
    ds_read_b64_tr_b16 v[232:233], v252 offset:8192
    ds_read_b64_tr_b16 v[234:235], v252 offset:9216
    s_add_u32 m0, s74, 16384
    s_waitcnt lgkmcnt(6)
    v_mfma_f32_16x16x32_bf16 v[240:243], v[236:239], v[228:231], v[240:243]
    ds_read_b128 a[128:131], v38 offset:0
    v_mfma_f32_32x32x16_bf16 v[72:87], v[136:139], a[132:135], v[72:87]
    ds_read_b64_tr_b16 v[156:157], v7 offset:8448
    ds_read_b64_tr_b16 v[158:159], v7 offset:9472
    buffer_load_dwordx4 v30, s[4:7], m0 offen sc1 lds
    v_mfma_f32_32x32x16_bf16 v[88:103], v[140:143], a[132:135], v[88:103]
    s_nop 0
    ds_read_b64_tr_b16 v[136:137], v7 offset:8704
    ds_read_b64_tr_b16 v[138:139], v7 offset:9728
    ds_read_b64_tr_b16 v[228:229], v252 offset:12288
    ds_read_b64_tr_b16 v[230:231], v252 offset:13312
    s_waitcnt lgkmcnt(7)
    v_mfma_f32_16x16x32_bf16 v[240:243], v[236:239], v[232:235], v[240:243]
    buffer_load_dwordx4 a[200:203], v49, s[4:7], s35 offen sc1
    v_mfma_f32_32x32x16_bf16 v[104:119], v[144:147], a[132:135], v[104:119]
    ds_read_b64_tr_b16 v[140:141], v10 offset:8960
    ds_read_b64_tr_b16 v[142:143], v10 offset:9984
    s_add_u32 m0, s74, 20480
    v_mfma_f32_32x32x16_bf16 v[120:135], v[148:151], a[132:135], v[120:135]
    s_nop 0
    ds_read_b64_tr_b16 v[144:145], v7 offset:12288
    ds_read_b64_tr_b16 v[146:147], v7 offset:13312
    ds_read_b64_tr_b16 v[232:233], v252 offset:16384
    ds_read_b64_tr_b16 v[234:235], v252 offset:17408
    buffer_load_dwordx4 v30, s[4:7], m0 offen sc1 lds
    s_waitcnt lgkmcnt(6)
    v_mfma_f32_16x16x32_bf16 v[240:243], v[236:239], v[228:231], v[240:243]
    ds_read_b128 a[132:135], v38 offset:4096
    v_mfma_f32_32x32x16_bf16 v[72:87], v[152:155], a[136:139], v[72:87]
    ds_read_b64_tr_b16 v[148:149], v7 offset:12544
    ds_read_b64_tr_b16 v[150:151], v7 offset:13568
    v_mfma_f32_32x32x16_bf16 v[88:103], v[156:159], a[136:139], v[88:103]
    s_nop 0
    ds_read_b64_tr_b16 v[152:153], v7 offset:12800
    ds_read_b64_tr_b16 v[154:155], v7 offset:13824
    ds_read_b64_tr_b16 v[228:229], v252 offset:20480
    ds_read_b64_tr_b16 v[230:231], v252 offset:21504
    s_waitcnt lgkmcnt(7)
    v_mfma_f32_16x16x32_bf16 v[240:243], v[236:239], v[232:235], v[240:243]
    buffer_load_dwordx4 a[204:207], v49, s[4:7], s36 offen sc1
    s_add_u32 m0, s74, 24576
    v_mfma_f32_32x32x16_bf16 v[104:119], v[136:139], a[136:139], v[104:119]
    s_nop 0
    ds_read_b64_tr_b16 v[156:157], v10 offset:13056
    ds_read_b64_tr_b16 v[158:159], v10 offset:14080
    ds_read_b128 a[144:147], v168 offset:32768
    ds_read_b128 a[148:151], v169 offset:32768
    ds_read_b128 a[152:155], v170 offset:32768
    ds_read_b128 a[156:159], v171 offset:32768
    buffer_load_dwordx4 v30, s[4:7], m0 offen sc1 lds
    v_mfma_f32_32x32x16_bf16 v[120:135], v[140:143], a[136:139], v[120:135]
    ds_read_b64_tr_b16 v[136:137], v7 offset:16384
    ds_read_b64_tr_b16 v[138:139], v7 offset:17408
    ds_read_b64_tr_b16 v[232:233], v252 offset:24576
    ds_read_b64_tr_b16 v[234:235], v252 offset:25600
    s_waitcnt lgkmcnt(10)
    v_mfma_f32_16x16x32_bf16 v[240:243], v[236:239], v[228:231], v[240:243]
    ds_read_b128 a[136:139], v38 offset:8192
    v_mfma_f32_32x32x16_bf16 v[72:87], v[144:147], a[140:143], v[72:87]
    s_nop 0
    ds_read_b64_tr_b16 v[140:141], v7 offset:16640
    ds_read_b64_tr_b16 v[142:143], v7 offset:17664
    buffer_load_dwordx4 a[208:211], v49, s[4:7], s37 offen sc1
    s_add_u32 m0, s74, 28672
    v_mfma_f32_32x32x16_bf16 v[88:103], v[148:151], a[140:143], v[88:103]
    ds_read_b64_tr_b16 v[144:145], v7 offset:16896
    ds_read_b64_tr_b16 v[146:147], v7 offset:17920
    v_add_u32 v252, 0xfffe0000, v252
    ds_read_b64_tr_b16 v[228:229], v252 offset:0
    ds_read_b64_tr_b16 v[230:231], v252 offset:1024
    s_waitcnt lgkmcnt(7)
    v_mfma_f32_16x16x32_bf16 v[240:243], v[236:239], v[232:235], v[240:243]
    buffer_load_dwordx4 v30, s[4:7], m0 offen sc1 lds
    v_mfma_f32_32x32x16_bf16 v[104:119], v[152:155], a[140:143], v[104:119]
    ds_read_b64_tr_b16 v[148:149], v10 offset:17152
    ds_read_b64_tr_b16 v[150:151], v10 offset:18176
    s_add_u32 m0, s74, 32768
    v_mfma_f32_32x32x16_bf16 v[120:135], v[156:159], a[140:143], v[120:135]
    ds_read_b64_tr_b16 v[152:153], v7 offset:20480
    ds_read_b64_tr_b16 v[154:155], v7 offset:21504
    buffer_load_dwordx4 v30, s[4:7], m0 offen sc1 lds
    s_waitcnt lgkmcnt(4)
    v_mfma_f32_16x16x32_bf16 v[240:243], v[236:239], v[228:231], v[240:243]
    ds_read_b128 a[140:143], v38 offset:12288
    v_mfma_f32_32x32x16_bf16 v[72:87], v[136:139], a[144:147], v[72:87]
    ds_read_b64_tr_b16 v[156:157], v7 offset:20736
    ds_read_b64_tr_b16 v[158:159], v7 offset:21760
    s_add_u32 m0, s74, 36864
    v_mfma_f32_32x32x16_bf16 v[88:103], v[140:143], a[144:147], v[88:103]
    ds_read_b64_tr_b16 v[136:137], v7 offset:20992
    ds_read_b64_tr_b16 v[138:139], v7 offset:22016
    buffer_load_dwordx4 v30, s[4:7], m0 offen sc1 lds
    s_add_u32 m0, s74, 40960
    s_waitcnt lgkmcnt(7)
    v_mfma_f32_32x32x16_bf16 v[104:119], v[144:147], a[144:147], v[104:119]
    ds_read_b64_tr_b16 v[140:141], v10 offset:21248
    ds_read_b64_tr_b16 v[142:143], v10 offset:22272
    buffer_load_dwordx4 v30, s[4:7], m0 offen sc1 lds
    v_mfma_f32_32x32x16_bf16 v[120:135], v[148:151], a[144:147], v[120:135]
    ds_read_b64_tr_b16 v[144:145], v7 offset:24576
    ds_read_b64_tr_b16 v[146:147], v7 offset:25600
    v_bfe_u32 v228, v2, 2, 7
    s_lshr_b32 s95, s74, 3
    s_add_u32 s95, s95, 159744
    v_add_u32 v228, s95, v228
    ds_write_b32 v228, v240
    s_add_u32 m0, s74, 45056
    s_waitcnt lgkmcnt(7)
    ds_read_b128 a[144:147], v38 offset:16384
    v_mfma_f32_32x32x16_bf16 v[72:87], v[152:155], a[148:151], v[72:87]
    ds_read_b64_tr_b16 v[148:149], v7 offset:24832
    ds_read_b64_tr_b16 v[150:151], v7 offset:25856
    buffer_load_dwordx4 v30, s[4:7], m0 offen sc1 lds
    s_add_u32 m0, s74, 49152
    v_mfma_f32_32x32x16_bf16 v[88:103], v[156:159], a[148:151], v[88:103]
    ds_read_b64_tr_b16 v[152:153], v7 offset:25088
    ds_read_b64_tr_b16 v[154:155], v7 offset:26112
    buffer_load_dwordx4 v30, s[4:7], m0 offen sc1 lds
    s_waitcnt lgkmcnt(8)
    v_mfma_f32_32x32x16_bf16 v[104:119], v[136:139], a[148:151], v[104:119]
    ds_read_b64_tr_b16 v[156:157], v10 offset:25344
    ds_read_b64_tr_b16 v[158:159], v10 offset:26368
    s_add_u32 m0, s74, 53248
    v_mfma_f32_32x32x16_bf16 v[120:135], v[140:143], a[148:151], v[120:135]
    ds_read_b64_tr_b16 v[136:137], v5 offset:0
    ds_read_b64_tr_b16 v[138:139], v5 offset:1024
    s_waitcnt lgkmcnt(9)
    s_barrier
    buffer_load_dwordx4 v30, s[4:7], m0 offen sc1 lds
    s_waitcnt lgkmcnt(6)
    ds_read_b128 a[148:151], v38 offset:20480
    v_mfma_f32_32x32x16_bf16 v[72:87], v[144:147], a[152:155], v[72:87]
    ds_read_b64_tr_b16 v[140:141], v5 offset:256
    ds_read_b64_tr_b16 v[142:143], v5 offset:1280
    s_add_u32 m0, s74, 57344
    ds_read_b128 v[160:163], v45 offset:0
    ds_read_b128 v[164:167], v45 offset:32
    ds_read_b128 v[168:171], v45 offset:64
    v_mfma_f32_32x32x16_bf16 v[88:103], v[148:151], a[152:155], v[88:103]
    ds_read_b64_tr_b16 v[144:145], v5 offset:512
    ds_read_b64_tr_b16 v[146:147], v5 offset:1536
    buffer_load_dwordx4 v30, s[4:7], m0 offen sc1 lds
    s_add_u32 m0, s74, 61440
    ds_read_b128 v[172:175], v45 offset:96
    s_waitcnt lgkmcnt(11)
    v_mfma_f32_32x32x16_bf16 v[104:119], v[152:155], a[152:155], v[104:119]
    s_nop 0
    ds_read_b64_tr_b16 v[148:149], v8 offset:768
    ds_read_b64_tr_b16 v[150:151], v8 offset:1792
    buffer_load_dwordx4 v30, s[4:7], m0 offen sc1 lds
    ds_read_b128 v[176:179], v45 offset:384
    ds_read_b128 v[180:183], v45 offset:128
    v_mfma_f32_32x32x16_bf16 v[120:135], v[156:159], a[152:155], v[120:135]
    s_add_u32 m0, s74, 65536
    ds_read_b128 v[184:187], v45 offset:160
    ds_read_b128 v[188:191], v45 offset:192
    ds_read_b128 v[192:195], v45 offset:224
    ds_read_b128 v[196:199], v45 offset:416
    s_waitcnt lgkmcnt(14)
    ds_read_b128 a[152:155], v38 offset:24576
    v_mfma_f32_32x32x16_bf16 v[72:87], v[136:139], a[156:159], v[72:87]
    s_nop 0
    buffer_load_dwordx4 v30, s[4:7], m0 offen sc1 lds
    s_add_u32 m0, s74, 69632
    ds_read_b128 v[200:203], v45 offset:256
    ds_read_b128 v[204:207], v45 offset:288
    ds_read_b128 v[208:211], v45 offset:320
    v_mfma_f32_32x32x16_bf16 v[88:103], v[140:143], a[156:159], v[88:103]
    buffer_load_dwordx4 v30, s[4:7], m0 offen sc1 lds
    ds_read_b128 v[212:215], v45 offset:352
    ds_read_b128 v[216:219], v45 offset:448
    v_add_u32 v31, s90, v2
    v_add_u32 v32, s91, v2
    s_waitcnt lgkmcnt(12)
    v_mfma_f32_32x32x16_bf16 v[104:119], v[144:147], a[156:159], v[104:119]
    s_add_u32 m0, s74, 73728
    s_and_b32 s61, s78, 1
    s_mul_i32 s61, s61, 61440
    s_mul_i32 s64, s61, -2
    v_mov_b32 v230, 0
    v_mov_b32 v231, 0
    v_mfma_f32_32x32x16_bf16 v[120:135], v[148:151], a[156:159], v[120:135]
    buffer_load_dwordx4 v30, s[4:7], m0 offen sc1 lds
    v_xor_b32 v232, 0, v39
    v_xor_b32 v233, 16, v39
    v_xor_b32 v234, 32, v39
    v_xor_b32 v235, 48, v39
    v_xor_b32 v236, 64, v39
    v_xor_b32 v237, 80, v39
    v_xor_b32 v238, 96, v39
    v_xor_b32 v239, 112, v39
    v_xor_b32 v240, 32, v40
    v_xor_b32 v241, 64, v40
    buffer_load_dword a255, v2, s[52:55], s82 offen sc1
    ds_read_b128 a[156:159], v36 offset:0
    s_mov_b64 s[16:17], s[66:67]
L_body:
L_at0:
    s_waitcnt lgkmcnt(0)
    v_pk_mul_f32 v[160:161], v[160:161], v[244:245] op_sel:[0,1] op_sel_hi:[1,1]
    v_pk_mul_f32 v[162:163], v[162:163], v[244:245] op_sel:[0,1] op_sel_hi:[1,1]
    v_pk_mul_f32 v[164:165], v[164:165], v[244:245] op_sel:[0,1] op_sel_hi:[1,1]
    v_pk_mul_f32 v[166:167], v[166:167], v[244:245] op_sel:[0,1] op_sel_hi:[1,1]
    v_pk_mul_f32 v[168:169], v[168:169], v[244:245] op_sel:[0,1] op_sel_hi:[1,1]
    v_pk_mul_f32 v[170:171], v[170:171], v[244:245] op_sel:[0,1] op_sel_hi:[1,1]
    v_pk_mul_f32 v[172:173], v[172:173], v[244:245] op_sel:[0,1] op_sel_hi:[1,1]
    v_pk_mul_f32 v[174:175], v[174:175], v[244:245] op_sel:[0,1] op_sel_hi:[1,1]
    v_pk_mul_f32 v[176:177], v[176:177], v[244:245] op_sel:[0,1] op_sel_hi:[1,1]
    v_pk_mul_f32 v[178:179], v[178:179], v[244:245] op_sel:[0,1] op_sel_hi:[1,1]
    v_pk_mul_f32 v[180:181], v[180:181], v[244:245] op_sel:[0,1] op_sel_hi:[1,1]
    v_pk_mul_f32 v[182:183], v[182:183], v[244:245] op_sel:[0,1] op_sel_hi:[1,1]
    v_pk_mul_f32 v[184:185], v[184:185], v[244:245] op_sel:[0,1] op_sel_hi:[1,1]
    v_pk_mul_f32 v[186:187], v[186:187], v[244:245] op_sel:[0,1] op_sel_hi:[1,1]
    v_pk_mul_f32 v[188:189], v[188:189], v[244:245] op_sel:[0,1] op_sel_hi:[1,1]
    v_pk_mul_f32 v[190:191], v[190:191], v[244:245] op_sel:[0,1] op_sel_hi:[1,1]
    v_pk_mul_f32 v[192:193], v[192:193], v[244:245] op_sel:[0,1] op_sel_hi:[1,1]
    v_pk_mul_f32 v[194:195], v[194:195], v[244:245] op_sel:[0,1] op_sel_hi:[1,1]
    v_pk_mul_f32 v[196:197], v[196:197], v[244:245] op_sel:[0,1] op_sel_hi:[1,1]
    v_pk_mul_f32 v[198:199], v[198:199], v[244:245] op_sel:[0,1] op_sel_hi:[1,1]
    v_pk_fma_f32 v[72:73], v[72:73], v[244:245], v[160:161] op_sel_hi:[1,0,1]
    v_pk_fma_f32 v[74:75], v[74:75], v[244:245], v[162:163] op_sel_hi:[1,0,1]
    v_pk_fma_f32 v[76:77], v[76:77], v[244:245], v[164:165] op_sel_hi:[1,0,1]
    v_pk_fma_f32 v[78:79], v[78:79], v[244:245], v[166:167] op_sel_hi:[1,0,1]
    v_pk_fma_f32 v[80:81], v[80:81], v[244:245], v[168:169] op_sel_hi:[1,0,1]
    v_pk_fma_f32 v[82:83], v[82:83], v[244:245], v[170:171] op_sel_hi:[1,0,1]
    v_pk_fma_f32 v[84:85], v[84:85], v[244:245], v[172:173] op_sel_hi:[1,0,1]
    v_pk_fma_f32 v[86:87], v[86:87], v[244:245], v[174:175] op_sel_hi:[1,0,1]
    v_pk_fma_f32 v[120:121], v[120:121], v[244:245], v[176:177] op_sel_hi:[1,0,1]
    v_pk_fma_f32 v[122:123], v[122:123], v[244:245], v[178:179] op_sel_hi:[1,0,1]
    v_cvt_pk_bf16_f32 v220, v72, v73
    v_cvt_pk_bf16_f32 v221, v74, v75
    v_cvt_pk_bf16_f32 v222, v76, v77
    v_cvt_pk_bf16_f32 v223, v78, v79
    v_cvt_pk_bf16_f32 v224, v80, v81
    v_cvt_pk_bf16_f32 v225, v82, v83
    v_cvt_pk_bf16_f32 v226, v84, v85
    v_cvt_pk_bf16_f32 v227, v86, v87
    v_cvt_pk_bf16_f32 v228, v120, v121
    v_cvt_pk_bf16_f32 v229, v122, v123
    v_mfma_f32_32x32x16_bf16 v[136:151], a[160:163], v[220:223], 0
    s_barrier
    s_nop 0
    v_fma_f32 v88, v88, v244, v180
    buffer_load_dwordx4 a[212:215], v49, s[4:7], s38 offen sc1
    v_fma_f32 v89, v89, v244, v181
    s_add_u32 m0, s74, 77824
    v_fma_f32 v90, v90, v244, v182
    buffer_load_dwordx4 v30, s[4:7], m0 offen sc1 lds
    v_fma_f32 v91, v91, v244, v183
    v_fma_f32 v92, v92, v244, v184
    v_mfma_f32_32x32x16_bf16 v[152:167], a[172:175], v[220:223], 0
    v_fma_f32 v93, v93, v244, v185
    v_fma_f32 v94, v94, v244, v186
    v_fma_f32 v95, v95, v244, v187
    v_fma_f32 v96, v96, v244, v188
    v_fma_f32 v97, v97, v244, v189
    v_fma_f32 v98, v98, v244, v190
    s_add_u32 m0, s74, 81920
    v_mfma_f32_32x32x16_bf16 v[136:151], a[164:167], v[224:227], v[136:151]
    buffer_load_dwordx4 v30, s[4:7], m0 offen sc1 lds
    v_fma_f32 v99, v99, v244, v191
    v_fma_f32 v100, v100, v244, v192
    v_fma_f32 v101, v101, v244, v193
    v_fma_f32 v102, v102, v244, v194
    v_fma_f32 v103, v103, v244, v195
    v_fma_f32 v124, v124, v244, v196
    v_mfma_f32_32x32x16_bf16 v[152:167], a[176:179], v[224:227], v[152:167]
    v_fma_f32 v125, v125, v244, v197
    v_fma_f32 v126, v126, v244, v198
    v_fma_f32 v127, v127, v244, v199
    v_mov_b32 v82, 0x3f80
    v_mov_b32_e64 v83, 0
    buffer_load_dwordx4 a[216:219], v49, s[4:7], s39 offen sc1
    v_cvt_pk_bf16_f32 v72, v88, v89
    v_mfma_f32_32x32x16_bf16 v[136:151], a[168:171], v[228:231], v[136:151]
    v_cvt_pk_bf16_f32 v73, v90, v91
    v_cvt_pk_bf16_f32 v74, v92, v93
    v_cvt_pk_bf16_f32 v75, v94, v95
    v_cvt_pk_bf16_f32 v76, v96, v97
    s_add_u32 m0, s74, 86016
    v_cvt_pk_bf16_f32 v77, v98, v99
    buffer_load_dwordx4 v30, s[4:7], m0 offen sc1 lds
    v_cvt_pk_bf16_f32 v78, v100, v101
    v_mfma_f32_32x32x16_bf16 v[152:167], a[180:183], v[228:231], v[152:167]
    v_cvt_pk_bf16_f32 v79, v102, v103
    v_cvt_pk_bf16_f32 v80, v124, v125
    v_cvt_pk_bf16_f32 v81, v126, v127
    ds_write_b128 v237, v[72:75]
    s_mov_b32 s100, 0x3fb8aa3b
    s_mov_b32 s101, 0x3fb8aa3b
    v_max3_f32 v254, v136, v137, v138
    v_min3_f32 v255, v136, v137, v138
    v_max3_f32 v254, v254, v139, v140
    v_min3_f32 v255, v255, v139, v140
    v_max3_f32 v254, v254, v141, v142
    v_min3_f32 v255, v255, v141, v142
    s_add_u32 m0, s74, 90112
    v_max3_f32 v254, v254, v143, v144
    buffer_load_dwordx4 v30, s[4:7], m0 offen sc1 lds
    v_min3_f32 v255, v255, v143, v144
    v_max3_f32 v254, v254, v145, v146
    v_min3_f32 v255, v255, v145, v146
    v_max3_f32 v254, v254, v147, v148
    v_min3_f32 v255, v255, v147, v148
    v_max3_f32 v254, v254, v149, v150
    v_min3_f32 v255, v255, v149, v150
    v_max3_f32 v254, v254, v151, v152
    v_min3_f32 v255, v255, v151, v152
    v_max3_f32 v254, v254, v153, v154
    v_min3_f32 v255, v255, v153, v154
    v_max_f32 v254, v254, v155
    v_min_f32 v255, v255, v155
    v_pk_mul_f32 v[254:255], v[254:255], s[100:101] neg_lo:[1,0]
    v_pk_fma_f32 v[160:161], v[136:137], s[100:101], v[254:255] op_sel_hi:[1,1,0]
    v_pk_fma_f32 v[180:181], v[136:137], s[100:101], v[254:255] op_sel:[0,0,1] op_sel_hi:[1,1,1] neg_lo:[1,0,0] neg_hi:[1,0,0]
    v_pk_fma_f32 v[162:163], v[138:139], s[100:101], v[254:255] op_sel_hi:[1,1,0]
    v_pk_fma_f32 v[182:183], v[138:139], s[100:101], v[254:255] op_sel:[0,0,1] op_sel_hi:[1,1,1] neg_lo:[1,0,0] neg_hi:[1,0,0]
    v_pk_fma_f32 v[164:165], v[140:141], s[100:101], v[254:255] op_sel_hi:[1,1,0]
    v_pk_fma_f32 v[184:185], v[140:141], s[100:101], v[254:255] op_sel:[0,0,1] op_sel_hi:[1,1,1] neg_lo:[1,0,0] neg_hi:[1,0,0]
L_pad3:
    s_cbranch_execz L_pad7
    s_nop 0
    v_pk_fma_f32 v[166:167], v[142:143], s[100:101], v[254:255] op_sel_hi:[1,1,0]
    v_pk_fma_f32 v[186:187], v[142:143], s[100:101], v[254:255] op_sel:[0,0,1] op_sel_hi:[1,1,1] neg_lo:[1,0,0] neg_hi:[1,0,0]
    s_add_u32 m0, s74, 94208
    v_pk_fma_f32 v[168:169], v[144:145], s[100:101], v[254:255] op_sel_hi:[1,1,0]
    buffer_load_dwordx4 v30, s[4:7], m0 offen sc1 lds
    v_pk_fma_f32 v[188:189], v[144:145], s[100:101], v[254:255] op_sel:[0,0,1] op_sel_hi:[1,1,1] neg_lo:[1,0,0] neg_hi:[1,0,0]
    v_pk_fma_f32 v[170:171], v[146:147], s[100:101], v[254:255] op_sel_hi:[1,1,0]
    buffer_load_dwordx4 a[220:223], v49, s[4:7], s40 offen sc1
    v_pk_fma_f32 v[190:191], v[146:147], s[100:101], v[254:255] op_sel:[0,0,1] op_sel_hi:[1,1,1] neg_lo:[1,0,0] neg_hi:[1,0,0]
    v_pk_fma_f32 v[172:173], v[148:149], s[100:101], v[254:255] op_sel_hi:[1,1,0]
    v_pk_fma_f32 v[192:193], v[148:149], s[100:101], v[254:255] op_sel:[0,0,1] op_sel_hi:[1,1,1] neg_lo:[1,0,0] neg_hi:[1,0,0]
    v_pk_fma_f32 v[174:175], v[150:151], s[100:101], v[254:255] op_sel_hi:[1,1,0]
    v_pk_fma_f32 v[194:195], v[150:151], s[100:101], v[254:255] op_sel:[0,0,1] op_sel_hi:[1,1,1] neg_lo:[1,0,0] neg_hi:[1,0,0]
    v_pk_fma_f32 v[176:177], v[152:153], s[100:101], v[254:255] op_sel_hi:[1,1,0]
    v_pk_fma_f32 v[196:197], v[152:153], s[100:101], v[254:255] op_sel:[0,0,1] op_sel_hi:[1,1,1] neg_lo:[1,0,0] neg_hi:[1,0,0]
    v_pk_fma_f32 v[178:179], v[154:155], s[100:101], v[254:255] op_sel_hi:[1,1,0]
    v_pk_fma_f32 v[198:199], v[154:155], s[100:101], v[254:255] op_sel:[0,0,1] op_sel_hi:[1,1,1] neg_lo:[1,0,0] neg_hi:[1,0,0]
    v_exp_f32 v160, v160
    v_exp_f32 v161, v161
    v_exp_f32 v162, v162
    ds_write_b128 v238, v[76:79]
    v_exp_f32 v163, v163
    s_add_u32 m0, s74, 98304
    v_exp_f32 v164, v164
    buffer_load_dwordx4 v30, s[4:7], m0 offen sc1 lds
    v_exp_f32 v165, v165
    v_exp_f32 v166, v166
    v_exp_f32 v167, v167
    v_exp_f32 v168, v168
    v_exp_f32 v169, v169
    v_exp_f32 v170, v170
    ds_write_b128 v239, v[80:83]
    v_exp_f32 v171, v171
    s_add_u32 m0, s74, 102400
    v_exp_f32 v172, v172
    buffer_load_dwordx4 v30, s[4:7], m0 offen sc1 lds
    v_exp_f32 v173, v173
    v_exp_f32 v174, v174
    v_exp_f32 v175, v175
    v_exp_f32 v176, v176
    buffer_load_dwordx4 a[224:227], v49, s[4:7], s41 offen sc1
    v_exp_f32 v177, v177
    v_exp_f32 v178, v178
    v_exp_f32 v179, v179
    v_pk_add_f32 v[136:137], v[160:161], v[162:163]
    v_pk_add_f32 v[138:139], v[164:165], v[166:167]
    v_pk_add_f32 v[136:137], v[136:137], v[168:169]
    v_pk_add_f32 v[138:139], v[138:139], v[170:171]
    v_pk_add_f32 v[136:137], v[136:137], v[172:173]
    v_pk_add_f32 v[138:139], v[138:139], v[174:175]
    v_pk_add_f32 v[136:137], v[136:137], v[176:177]
    v_pk_add_f32 v[138:139], v[138:139], v[178:179]
    v_pk_add_f32 v[136:137], v[136:137], v[138:139]
    v_add_f32 v254, v136, v137
    v_rcp_f32 v254, v254
    s_nop 0
    s_nop 0
    v_pk_mul_f32 v[160:161], v[160:161], v[254:255] op_sel_hi:[1,0]
    v_pk_mul_f32 v[162:163], v[162:163], v[254:255] op_sel_hi:[1,0]
    v_pk_mul_f32 v[164:165], v[164:165], v[254:255] op_sel_hi:[1,0]
    v_pk_mul_f32 v[166:167], v[166:167], v[254:255] op_sel_hi:[1,0]
    v_pk_mul_f32 v[168:169], v[168:169], v[254:255] op_sel_hi:[1,0]
    v_pk_mul_f32 v[170:171], v[170:171], v[254:255] op_sel_hi:[1,0]
    v_pk_mul_f32 v[172:173], v[172:173], v[254:255] op_sel_hi:[1,0]
    v_pk_mul_f32 v[174:175], v[174:175], v[254:255] op_sel_hi:[1,0]
    v_pk_mul_f32 v[176:177], v[176:177], v[254:255] op_sel_hi:[1,0]
    v_pk_mul_f32 v[178:179], v[178:179], v[254:255] op_sel_hi:[1,0]
    v_cvt_pk_bf16_f32 v84, v160, v161
    v_cvt_pk_bf16_f32 v85, v162, v163
    v_cvt_pk_bf16_f32 v86, v164, v165
    v_cvt_pk_bf16_f32 v87, v166, v167
    v_cvt_pk_bf16_f32 v88, v168, v169
    v_cvt_pk_bf16_f32 v89, v170, v171
    v_cvt_pk_bf16_f32 v90, v172, v173
    v_cvt_pk_bf16_f32 v91, v174, v175
    v_cvt_pk_bf16_f32 v92, v176, v177
    v_cvt_pk_bf16_f32 v93, v178, v179
    v_exp_f32 v180, v180
    v_exp_f32 v181, v181
    v_exp_f32 v182, v182
    ds_write_b128 v232, v[84:87]
    v_exp_f32 v183, v183
    v_exp_f32 v184, v184
    v_exp_f32 v185, v185
    v_exp_f32 v186, v186
    v_exp_f32 v187, v187
    buffer_load_dwordx4 a[228:231], v49, s[4:7], s42 offen sc1
    v_exp_f32 v188, v188
    v_exp_f32 v189, v189
    v_exp_f32 v190, v190
    v_exp_f32 v191, v191
    ds_write_b128 v233, v[88:91]
    v_exp_f32 v192, v192
    v_exp_f32 v193, v193
    v_exp_f32 v194, v194
    v_exp_f32 v195, v195
    v_exp_f32 v196, v196
    v_exp_f32 v197, v197
    v_exp_f32 v198, v198
    v_exp_f32 v199, v199
    v_pk_add_f32 v[140:141], v[180:181], v[182:183]
    v_pk_add_f32 v[142:143], v[184:185], v[186:187]
    v_pk_add_f32 v[140:141], v[140:141], v[188:189]
    v_pk_add_f32 v[142:143], v[142:143], v[190:191]
    v_pk_add_f32 v[140:141], v[140:141], v[192:193]
    v_pk_add_f32 v[142:143], v[142:143], v[194:195]
    v_pk_add_f32 v[140:141], v[140:141], v[196:197]
    v_pk_add_f32 v[142:143], v[142:143], v[198:199]
    v_pk_add_f32 v[140:141], v[140:141], v[142:143]
    v_add_f32 v255, v140, v141
    v_rcp_f32 v255, v255
    s_nop 0
    s_nop 0
    v_pk_mul_f32 v[180:181], v[180:181], v[254:255] op_sel:[0,1] op_sel_hi:[1,1]
    v_pk_mul_f32 v[182:183], v[182:183], v[254:255] op_sel:[0,1] op_sel_hi:[1,1]
    v_cvt_pk_bf16_f32 v94, v180, v181
    v_cvt_pk_bf16_f32 v95, v182, v183
    ds_write_b128 v234, v[92:95]
    v_pk_mul_f32 v[184:185], v[184:185], v[254:255] op_sel:[0,1] op_sel_hi:[1,1]
    v_pk_mul_f32 v[186:187], v[186:187], v[254:255] op_sel:[0,1] op_sel_hi:[1,1]
    v_pk_mul_f32 v[188:189], v[188:189], v[254:255] op_sel:[0,1] op_sel_hi:[1,1]
    v_pk_mul_f32 v[190:191], v[190:191], v[254:255] op_sel:[0,1] op_sel_hi:[1,1]
    v_cvt_pk_bf16_f32 v96, v184, v185
    v_cvt_pk_bf16_f32 v97, v186, v187
    buffer_load_dwordx4 a[232:235], v49, s[4:7], s43 offen sc1
    v_cvt_pk_bf16_f32 v98, v188, v189
    v_cvt_pk_bf16_f32 v99, v190, v191
    ds_write_b128 v235, v[96:99]
    v_pk_mul_f32 v[192:193], v[192:193], v[254:255] op_sel:[0,1] op_sel_hi:[1,1]
    v_pk_mul_f32 v[194:195], v[194:195], v[254:255] op_sel:[0,1] op_sel_hi:[1,1]
    v_pk_mul_f32 v[196:197], v[196:197], v[254:255] op_sel:[0,1] op_sel_hi:[1,1]
    v_pk_mul_f32 v[198:199], v[198:199], v[254:255] op_sel:[0,1] op_sel_hi:[1,1]
    v_cvt_pk_bf16_f32 v100, v192, v193
    v_cvt_pk_bf16_f32 v101, v194, v195
    v_cvt_pk_bf16_f32 v102, v196, v197
    v_cvt_pk_bf16_f32 v103, v198, v199
    ds_write_b128 v236, v[100:103]
    s_waitcnt lgkmcnt(0)
    s_barrier
    ds_read_b64_tr_b16 v[136:137], v41 offset:0
    ds_read_b64_tr_b16 v[138:139], v41 offset:1024
    ds_read_b64_tr_b16 v[140:141], v40 offset:0
    ds_read_b64_tr_b16 v[142:143], v40 offset:1024
    ds_read_b64_tr_b16 v[144:145], v240 offset:0
    ds_read_b64_tr_b16 v[146:147], v240 offset:1024
    ds_read_b64_tr_b16 v[148:149], v241 offset:0
    ds_read_b64_tr_b16 v[150:151], v241 offset:1024
    ds_read_b64_tr_b16 v[152:153], v41 offset:4096
    ds_read_b64_tr_b16 v[154:155], v41 offset:5120
    ds_read_b64_tr_b16 v[156:157], v40 offset:4096
    ds_read_b64_tr_b16 v[158:159], v40 offset:5120
    s_waitcnt lgkmcnt(8)
    v_mfma_f32_16x16x32_bf16 v[72:75], v[140:143], v[136:139], 0
    ds_read_b64_tr_b16 v[160:161], v240 offset:4096
    ds_read_b64_tr_b16 v[162:163], v240 offset:5120
    s_waitcnt lgkmcnt(8)
    v_mfma_f32_16x16x32_bf16 v[76:79], v[144:147], v[136:139], 0
    ds_read_b64_tr_b16 v[164:165], v241 offset:4096
    ds_read_b64_tr_b16 v[166:167], v241 offset:5120
    s_waitcnt lgkmcnt(8)
    v_mfma_f32_16x16x32_bf16 v[80:83], v[148:151], v[136:139], 0
    s_nop 0
    ds_read_b64_tr_b16 v[168:169], v41 offset:8192
    ds_read_b64_tr_b16 v[170:171], v41 offset:9216
    ds_read_b64_tr_b16 v[172:173], v40 offset:8192
    ds_read_b64_tr_b16 v[174:175], v40 offset:9216
    s_waitcnt lgkmcnt(8)
    v_mfma_f32_16x16x32_bf16 v[72:75], v[156:159], v[152:155], v[72:75]
    ds_read_b64_tr_b16 v[176:177], v240 offset:8192
    ds_read_b64_tr_b16 v[178:179], v240 offset:9216
    s_waitcnt lgkmcnt(8)
    v_mfma_f32_16x16x32_bf16 v[76:79], v[160:163], v[152:155], v[76:79]
    ds_read_b64_tr_b16 v[180:181], v241 offset:8192
    ds_read_b64_tr_b16 v[182:183], v241 offset:9216
    s_waitcnt lgkmcnt(8)
    v_mfma_f32_16x16x32_bf16 v[80:83], v[164:167], v[152:155], v[80:83]
    s_nop 0
    ds_read_b64_tr_b16 v[184:185], v41 offset:12288
    ds_read_b64_tr_b16 v[186:187], v41 offset:13312
    ds_read_b64_tr_b16 v[188:189], v40 offset:12288
    ds_read_b64_tr_b16 v[190:191], v40 offset:13312
    s_waitcnt lgkmcnt(8)
    v_mfma_f32_16x16x32_bf16 v[72:75], v[172:175], v[168:171], v[72:75]
    ds_read_b64_tr_b16 v[192:193], v240 offset:12288
    ds_read_b64_tr_b16 v[194:195], v240 offset:13312
    s_waitcnt lgkmcnt(8)
    v_mfma_f32_16x16x32_bf16 v[76:79], v[176:179], v[168:171], v[76:79]
    ds_read_b64_tr_b16 v[196:197], v241 offset:12288
    ds_read_b64_tr_b16 v[198:199], v241 offset:13312
    s_waitcnt lgkmcnt(8)
    v_mfma_f32_16x16x32_bf16 v[80:83], v[180:183], v[168:171], v[80:83]
    s_waitcnt lgkmcnt(4)
    v_mfma_f32_16x16x32_bf16 v[72:75], v[188:191], v[184:187], v[72:75]
    s_waitcnt lgkmcnt(2)
    v_mfma_f32_16x16x32_bf16 v[76:79], v[192:195], v[184:187], v[76:79]
    s_waitcnt lgkmcnt(0)
    v_mfma_f32_16x16x32_bf16 v[80:83], v[196:199], v[184:187], v[80:83]
    s_nop 3
    v_cvt_pk_bf16_f32 v84, v72, v73
    v_min_u32 v84, -2, v84
    v_cvt_pk_bf16_f32 v85, v74, v75
    v_min_u32 v85, -2, v85
    v_cvt_pk_bf16_f32 v86, v76, v77
    v_min_u32 v86, -2, v86
    v_cvt_pk_bf16_f32 v87, v78, v79
    v_min_u32 v87, -2, v87
    buffer_store_dwordx4 v[84:87], v33, s[4:7], 0 offen sc1
    v_cvt_pk_bf16_f32 v88, v80, v81
    v_min_u32 v88, -2, v88
    v_cvt_pk_bf16_f32 v89, v82, v83
    v_min_u32 v89, -2, v89
    buffer_store_dwordx2 v[88:89], v34, s[4:7], 0 offen sc1
    s_xor_b32 s96, s78, 15
    s_lshl_b32 s96, s96, 12
    s_mov_b32 s97, 0
    s_barrier
    s_nop 0
    v_pk_mul_f32 v[200:201], v[200:201], v[244:245] op_sel:[0,1] op_sel_hi:[1,1]
    buffer_load_dwordx4 a[236:239], v49, s[4:7], s44 offen sc1
    v_pk_mul_f32 v[202:203], v[202:203], v[244:245] op_sel:[0,1] op_sel_hi:[1,1]
    v_pk_mul_f32 v[204:205], v[204:205], v[244:245] op_sel:[0,1] op_sel_hi:[1,1]
    v_pk_mul_f32 v[206:207], v[206:207], v[244:245] op_sel:[0,1] op_sel_hi:[1,1]
    v_pk_mul_f32 v[208:209], v[208:209], v[244:245] op_sel:[0,1] op_sel_hi:[1,1]
    v_pk_mul_f32 v[210:211], v[210:211], v[244:245] op_sel:[0,1] op_sel_hi:[1,1]
    v_pk_mul_f32 v[212:213], v[212:213], v[244:245] op_sel:[0,1] op_sel_hi:[1,1]
    v_pk_mul_f32 v[214:215], v[214:215], v[244:245] op_sel:[0,1] op_sel_hi:[1,1]
    v_pk_mul_f32 v[216:217], v[216:217], v[244:245] op_sel:[0,1] op_sel_hi:[1,1]
    v_pk_mul_f32 v[218:219], v[218:219], v[244:245] op_sel:[0,1] op_sel_hi:[1,1]
    v_pk_fma_f32 v[104:105], v[104:105], v[244:245], v[200:201] op_sel_hi:[1,0,1]
    v_pk_fma_f32 v[106:107], v[106:107], v[244:245], v[202:203] op_sel_hi:[1,0,1]
    v_pk_fma_f32 v[108:109], v[108:109], v[244:245], v[204:205] op_sel_hi:[1,0,1]
    v_pk_fma_f32 v[110:111], v[110:111], v[244:245], v[206:207] op_sel_hi:[1,0,1]
    v_pk_fma_f32 v[112:113], v[112:113], v[244:245], v[208:209] op_sel_hi:[1,0,1]
    v_pk_fma_f32 v[114:115], v[114:115], v[244:245], v[210:211] op_sel_hi:[1,0,1]
    buffer_load_dword a255, v21, s[52:55], 0 offen offset:0 sc1
    v_pk_fma_f32 v[116:117], v[116:117], v[244:245], v[212:213] op_sel_hi:[1,0,1]
    v_pk_fma_f32 v[118:119], v[118:119], v[244:245], v[214:215] op_sel_hi:[1,0,1]
    v_pk_fma_f32 v[128:129], v[128:129], v[244:245], v[216:217] op_sel_hi:[1,0,1]
    v_pk_fma_f32 v[130:131], v[130:131], v[244:245], v[218:219] op_sel_hi:[1,0,1]
    v_cvt_pk_bf16_f32 v220, v104, v105
    v_cvt_pk_bf16_f32 v221, v106, v107
    v_cvt_pk_bf16_f32 v222, v108, v109
    v_cvt_pk_bf16_f32 v223, v110, v111
    v_cvt_pk_bf16_f32 v224, v112, v113
    v_cvt_pk_bf16_f32 v225, v114, v115
    v_cvt_pk_bf16_f32 v226, v116, v117
    v_cvt_pk_bf16_f32 v227, v118, v119
    v_cvt_pk_bf16_f32 v228, v128, v129
    v_cvt_pk_bf16_f32 v229, v130, v131
    v_mfma_f32_32x32x16_bf16 v[136:151], a[160:163], v[220:223], 0
    buffer_load_dwordx4 a[240:243], v49, s[4:7], s45 offen sc1
    v_bfe_u32 v246, v2, 6, 1
    v_lshrrev_b32 v247, 9, v2
    v_xor_b32 v246, v246, v247
    v_bfe_u32 v247, v2, 7, 2
    v_lshl_add_u32 v246, v246, 2, v247
    v_mfma_f32_32x32x16_bf16 v[152:167], a[172:175], v[220:223], 0
    v_bfe_u32 v247, v2, 5, 1
    v_lshl_add_u32 v246, v246, 1, v247
    v_and_b32 v247, 16, v2
    v_mov_b32 v248, 0x3f80
    v_lshlrev_b32 v247, v247, v248
    v_mfma_f32_32x32x16_bf16 v[136:151], a[164:167], v[224:227], v[136:151]
    buffer_load_dword a255, v21, s[52:55], 0 offen offset:512 sc1
    v_cmp_eq_u32 vcc, 0, v246
    s_nop 1
    v_cndmask_b32 v248, 0, v247, vcc
    v_mfma_f32_32x32x16_bf16 v[152:167], a[176:179], v[224:227], v[152:167]
    v_cmp_eq_u32 vcc, 1, v246
    s_nop 1
    v_cndmask_b32 v249, 0, v247, vcc
    v_mfma_f32_32x32x16_bf16 v[136:151], a[168:171], v[228:231], v[136:151]
    buffer_load_dword a255, v22, s[52:55], 0 offen offset:0 sc1
    v_cmp_eq_u32 vcc, 2, v246
    s_nop 1
    v_cndmask_b32 v250, 0, v247, vcc
    v_mfma_f32_32x32x16_bf16 v[152:167], a[180:183], v[228:231], v[152:167]
    v_cmp_eq_u32 vcc, 3, v246
    s_nop 1
    v_cndmask_b32 v251, 0, v247, vcc
    s_mov_b32 s100, 0x3fb8aa3b
    s_mov_b32 s101, 0x3fb8aa3b
    v_max3_f32 v254, v136, v137, v138
    v_min3_f32 v255, v136, v137, v138
    v_max3_f32 v254, v254, v139, v140
    s_add_u32 m0, s74, 106496
    v_min3_f32 v255, v255, v139, v140
    buffer_load_dwordx4 v31, s[4:7], m0 offen sc1 lds
    v_max3_f32 v254, v254, v141, v142
    v_min3_f32 v255, v255, v141, v142
    v_max3_f32 v254, v254, v143, v144
    v_min3_f32 v255, v255, v143, v144
    v_max3_f32 v254, v254, v145, v146
    v_min3_f32 v255, v255, v145, v146
    v_max3_f32 v254, v254, v147, v148
    v_min3_f32 v255, v255, v147, v148
    v_max3_f32 v254, v254, v149, v150
    v_min3_f32 v255, v255, v149, v150
    v_max3_f32 v254, v254, v151, v152
    v_min3_f32 v255, v255, v151, v152
    v_max3_f32 v254, v254, v153, v154
    buffer_load_dwordx4 a[244:247], v49, s[4:7], s46 offen sc1
    v_min3_f32 v255, v255, v153, v154
    v_max_f32 v254, v254, v155
    v_min_f32 v255, v255, v155
    v_pk_mul_f32 v[254:255], v[254:255], s[100:101] neg_lo:[1,0]
    v_pk_fma_f32 v[160:161], v[136:137], s[100:101], v[254:255] op_sel_hi:[1,1,0]
    v_pk_fma_f32 v[180:181], v[136:137], s[100:101], v[254:255] op_sel:[0,0,1] op_sel_hi:[1,1,1] neg_lo:[1,0,0] neg_hi:[1,0,0]
    v_pk_fma_f32 v[162:163], v[138:139], s[100:101], v[254:255] op_sel_hi:[1,1,0]
    v_pk_fma_f32 v[182:183], v[138:139], s[100:101], v[254:255] op_sel:[0,0,1] op_sel_hi:[1,1,1] neg_lo:[1,0,0] neg_hi:[1,0,0]
    v_pk_fma_f32 v[164:165], v[140:141], s[100:101], v[254:255] op_sel_hi:[1,1,0]
    v_pk_fma_f32 v[184:185], v[140:141], s[100:101], v[254:255] op_sel:[0,0,1] op_sel_hi:[1,1,1] neg_lo:[1,0,0] neg_hi:[1,0,0]
    v_pk_fma_f32 v[166:167], v[142:143], s[100:101], v[254:255] op_sel_hi:[1,1,0]
    v_pk_fma_f32 v[186:187], v[142:143], s[100:101], v[254:255] op_sel:[0,0,1] op_sel_hi:[1,1,1] neg_lo:[1,0,0] neg_hi:[1,0,0]
    v_pk_fma_f32 v[168:169], v[144:145], s[100:101], v[254:255] op_sel_hi:[1,1,0]
    v_pk_fma_f32 v[188:189], v[144:145], s[100:101], v[254:255] op_sel:[0,0,1] op_sel_hi:[1,1,1] neg_lo:[1,0,0] neg_hi:[1,0,0]
    v_pk_fma_f32 v[170:171], v[146:147], s[100:101], v[254:255] op_sel_hi:[1,1,0]
    s_add_u32 m0, s74, 110592
    v_pk_fma_f32 v[190:191], v[146:147], s[100:101], v[254:255] op_sel:[0,0,1] op_sel_hi:[1,1,1] neg_lo:[1,0,0] neg_hi:[1,0,0]
    buffer_load_dwordx4 v31, s[4:7], m0 offen sc1 lds
    v_pk_fma_f32 v[172:173], v[148:149], s[100:101], v[254:255] op_sel_hi:[1,1,0]
    v_pk_fma_f32 v[192:193], v[148:149], s[100:101], v[254:255] op_sel:[0,0,1] op_sel_hi:[1,1,1] neg_lo:[1,0,0] neg_hi:[1,0,0]
    v_pk_fma_f32 v[174:175], v[150:151], s[100:101], v[254:255] op_sel_hi:[1,1,0]
    v_pk_fma_f32 v[194:195], v[150:151], s[100:101], v[254:255] op_sel:[0,0,1] op_sel_hi:[1,1,1] neg_lo:[1,0,0] neg_hi:[1,0,0]
    v_pk_fma_f32 v[176:177], v[152:153], s[100:101], v[254:255] op_sel_hi:[1,1,0]
    v_pk_fma_f32 v[196:197], v[152:153], s[100:101], v[254:255] op_sel:[0,0,1] op_sel_hi:[1,1,1] neg_lo:[1,0,0] neg_hi:[1,0,0]
    v_pk_fma_f32 v[178:179], v[154:155], s[100:101], v[254:255] op_sel_hi:[1,1,0]
    v_pk_fma_f32 v[198:199], v[154:155], s[100:101], v[254:255] op_sel:[0,0,1] op_sel_hi:[1,1,1] neg_lo:[1,0,0] neg_hi:[1,0,0]
    v_exp_f32 v160, v160
    v_exp_f32 v161, v161
    v_exp_f32 v162, v162
    s_add_u32 m0, s74, 114688
    v_exp_f32 v163, v163
    buffer_load_dwordx4 v31, s[4:7], m0 offen sc1 lds
    v_exp_f32 v164, v164
    v_exp_f32 v165, v165
    v_exp_f32 v166, v166
    v_exp_f32 v167, v167
    v_exp_f32 v168, v168
    v_exp_f32 v169, v169
    s_add_u32 m0, s74, 118784
    v_exp_f32 v170, v170
    buffer_load_dwordx4 v31, s[4:7], m0 offen sc1 lds
    v_exp_f32 v171, v171
    v_exp_f32 v172, v172
    v_exp_f32 v173, v173
    v_exp_f32 v174, v174
    v_exp_f32 v175, v175
    v_exp_f32 v176, v176
    v_add_u32 v49, 0x10000, v49
    v_exp_f32 v177, v177
    buffer_load_dwordx4 a[248:251], v49, s[4:7], 0 offen sc1
    v_exp_f32 v178, v178
    v_exp_f32 v179, v179
    v_pk_add_f32 v[136:137], v[160:161], v[162:163]
    v_pk_add_f32 v[138:139], v[164:165], v[166:167]
    v_pk_add_f32 v[136:137], v[136:137], v[168:169]
    v_pk_add_f32 v[138:139], v[138:139], v[170:171]
    v_pk_add_f32 v[136:137], v[136:137], v[172:173]
    v_pk_add_f32 v[138:139], v[138:139], v[174:175]
    v_pk_add_f32 v[136:137], v[136:137], v[176:177]
    v_pk_add_f32 v[138:139], v[138:139], v[178:179]
    s_add_u32 m0, s74, 122880
    v_pk_add_f32 v[136:137], v[136:137], v[138:139]
    buffer_load_dwordx4 v31, s[4:7], m0 offen sc1 lds
    v_add_f32 v254, v136, v137
    v_rcp_f32 v254, v254
    s_nop 0
    s_nop 0
    v_pk_mul_f32 v[160:161], v[160:161], v[254:255] op_sel_hi:[1,0]
    v_pk_mul_f32 v[162:163], v[162:163], v[254:255] op_sel_hi:[1,0]
    v_pk_mul_f32 v[164:165], v[164:165], v[254:255] op_sel_hi:[1,0]
    v_pk_mul_f32 v[166:167], v[166:167], v[254:255] op_sel_hi:[1,0]
    v_pk_mul_f32 v[168:169], v[168:169], v[254:255] op_sel_hi:[1,0]
    v_pk_mul_f32 v[170:171], v[170:171], v[254:255] op_sel_hi:[1,0]
    v_pk_mul_f32 v[172:173], v[172:173], v[254:255] op_sel_hi:[1,0]
    v_pk_mul_f32 v[174:175], v[174:175], v[254:255] op_sel_hi:[1,0]
    v_pk_mul_f32 v[176:177], v[176:177], v[254:255] op_sel_hi:[1,0]
    v_pk_mul_f32 v[178:179], v[178:179], v[254:255] op_sel_hi:[1,0]
    s_xor_b32 s95, s96, 0x0
    s_nop 0
    v_cvt_pk_bf16_f32 v72, v160, v161
    buffer_load_dwordx4 v[232:235], v35, s[4:7], s95 offen sc1
    v_cvt_pk_bf16_f32 v73, v162, v163
    v_cvt_pk_bf16_f32 v76, v164, v165
    v_cvt_pk_bf16_f32 v77, v166, v167
    v_cvt_pk_bf16_f32 v80, v168, v169
    v_cvt_pk_bf16_f32 v81, v170, v171
    v_cvt_pk_bf16_f32 v84, v172, v173
    v_cvt_pk_bf16_f32 v85, v174, v175
    v_cvt_pk_bf16_f32 v74, v176, v177
    v_cvt_pk_bf16_f32 v75, v178, v179
    v_exp_f32 v180, v180
    v_exp_f32 v181, v181
    s_xor_b32 s95, s96, 0x1000
    v_exp_f32 v182, v182
    buffer_load_dwordx4 v[236:239], v35, s[4:7], s95 offen sc1
    v_exp_f32 v183, v183
    v_exp_f32 v184, v184
    v_exp_f32 v185, v185
    v_exp_f32 v186, v186
    v_exp_f32 v187, v187
    v_exp_f32 v188, v188
    s_xor_b32 s95, s96, 0x2000
    v_exp_f32 v189, v189
    buffer_load_dwordx4 v[240:243], v35, s[4:7], s95 offen sc1
    v_exp_f32 v190, v190
    v_exp_f32 v191, v191
    v_exp_f32 v192, v192
    v_exp_f32 v193, v193
    v_exp_f32 v194, v194
    v_exp_f32 v195, v195
    s_xor_b32 s95, s96, 0x3000
    v_exp_f32 v196, v196
    buffer_load_dwordx4 v[92:95], v35, s[4:7], s95 offen sc1
    v_exp_f32 v197, v197
    v_exp_f32 v198, v198
    v_exp_f32 v199, v199
    v_pk_add_f32 v[140:141], v[180:181], v[182:183]
    v_pk_add_f32 v[142:143], v[184:185], v[186:187]
    v_pk_add_f32 v[140:141], v[140:141], v[188:189]
    v_pk_add_f32 v[142:143], v[142:143], v[190:191]
    v_pk_add_f32 v[140:141], v[140:141], v[192:193]
    v_pk_add_f32 v[142:143], v[142:143], v[194:195]
    s_xor_b32 s95, s96, 0x4000
    v_pk_add_f32 v[140:141], v[140:141], v[196:197]
    buffer_load_dwordx4 v[96:99], v35, s[4:7], s95 offen sc1
    v_pk_add_f32 v[142:143], v[142:143], v[198:199]
    v_pk_add_f32 v[140:141], v[140:141], v[142:143]
    v_add_f32 v255, v140, v141
    v_rcp_f32 v255, v255
    s_nop 0
    s_nop 0
    v_pk_mul_f32 v[180:181], v[180:181], v[254:255] op_sel:[0,1] op_sel_hi:[1,1]
    v_pk_mul_f32 v[182:183], v[182:183], v[254:255] op_sel:[0,1] op_sel_hi:[1,1]
    v_cvt_pk_bf16_f32 v78, v180, v181
    v_cvt_pk_bf16_f32 v79, v182, v183
    v_pk_mul_f32 v[184:185], v[184:185], v[254:255] op_sel:[0,1] op_sel_hi:[1,1]
    v_pk_mul_f32 v[186:187], v[186:187], v[254:255] op_sel:[0,1] op_sel_hi:[1,1]
    v_pk_mul_f32 v[188:189], v[188:189], v[254:255] op_sel:[0,1] op_sel_hi:[1,1]
    v_pk_mul_f32 v[190:191], v[190:191], v[254:255] op_sel:[0,1] op_sel_hi:[1,1]
    s_xor_b32 s95, s96, 0x5000
    v_cvt_pk_bf16_f32 v82, v184, v185
    buffer_load_dwordx4 v[100:103], v35, s[4:7], s95 offen sc1
    v_cvt_pk_bf16_f32 v83, v186, v187
    v_cvt_pk_bf16_f32 v86, v188, v189
    v_cvt_pk_bf16_f32 v87, v190, v191
    v_pk_mul_f32 v[192:193], v[192:193], v[254:255] op_sel:[0,1] op_sel_hi:[1,1]
    v_pk_mul_f32 v[194:195], v[194:195], v[254:255] op_sel:[0,1] op_sel_hi:[1,1]
    v_pk_mul_f32 v[196:197], v[196:197], v[254:255] op_sel:[0,1] op_sel_hi:[1,1]
    v_pk_mul_f32 v[198:199], v[198:199], v[254:255] op_sel:[0,1] op_sel_hi:[1,1]
    v_cvt_pk_bf16_f32 v88, v192, v193
    v_cvt_pk_bf16_f32 v89, v194, v195
    v_cvt_pk_bf16_f32 v90, v196, v197
    v_cvt_pk_bf16_f32 v91, v198, v199
    v_permlane32_swap_b32 v72, v76
    v_permlane32_swap_b32 v73, v77
    s_xor_b32 s95, s96, 0x6000
    v_permlane32_swap_b32 v74, v78
    buffer_load_dwordx4 v[120:123], v35, s[4:7], s95 offen sc1
    v_permlane32_swap_b32 v75, v79
    v_permlane32_swap_b32 v80, v84
    v_permlane32_swap_b32 v81, v85
    v_permlane32_swap_b32 v82, v86
    v_permlane32_swap_b32 v83, v87
    v_mov_b32 v136, 0
    v_mov_b32 v137, 0
    s_xor_b32 s95, s96, 0x7000
    v_mov_b32 v138, 0
    buffer_load_dwordx4 v[124:127], v35, s[4:7], s95 offen sc1
    v_mov_b32 v139, 0
    v_mov_b32 v140, 0
    v_mov_b32 v141, 0
    v_mov_b32 v142, 0
    v_mov_b32 v143, 0
    s_mov_b32 s100, 0x00003f80
    s_mov_b32 s101, 0x3f800000
    s_waitcnt vmcnt(7)
    v_max3_u32 v220, v232, v233, v234
    v_max_u32 v220, v220, v235
    v_cmp_eq_u32 vcc, -1, v220
    s_cbranch_vccnz L_kv_10_r
    v_mfma_f32_32x32x16_bf16 v[136:151], v[248:251], v[232:235], v[136:151]
L_kv_10:
    s_waitcnt vmcnt(6)
    v_max3_u32 v220, v236, v237, v238
    v_max_u32 v220, v220, v239
    v_cmp_eq_u32 vcc, -1, v220
    s_cbranch_vccnz L_kv_11_r
    v_mfma_f32_32x32x16_bf16 v[136:151], v[248:251], v[236:239], v[136:151]
L_kv_11:
    s_xor_b32 s95, s96, 0x8000
    buffer_load_dwordx4 v[132:135], v35, s[4:7], s95 offen sc1
    s_waitcnt vmcnt(6)
    v_max3_u32 v220, v240, v241, v242
    v_max_u32 v220, v220, v243
    v_cmp_eq_u32 vcc, -1, v220
    s_cbranch_vccnz L_kv_12_r
    v_mfma_f32_32x32x16_bf16 v[136:151], v[248:251], v[240:243], v[136:151]
L_kv_12:
    s_xor_b32 s95, s96, 0x9000
    buffer_load_dwordx4 v[104:107], v35, s[4:7], s95 offen sc1
    s_waitcnt vmcnt(6)
    v_max3_u32 v220, v92, v93, v94
    v_max_u32 v220, v220, v95
    v_cmp_eq_u32 vcc, -1, v220
    s_cbranch_vccnz L_kv_13_r
    v_mfma_f32_32x32x16_bf16 v[136:151], v[248:251], v[92:95], v[136:151]
L_kv_13:
    s_xor_b32 s95, s96, 0xa000
    buffer_load_dwordx4 v[108:111], v35, s[4:7], s95 offen sc1
    s_waitcnt vmcnt(6)
    v_max3_u32 v220, v96, v97, v98
    v_max_u32 v220, v220, v99
    v_cmp_eq_u32 vcc, -1, v220
    s_cbranch_vccnz L_kv_14_r
    v_mfma_f32_32x32x16_bf16 v[136:151], v[248:251], v[96:99], v[136:151]
L_kv_14:
    s_xor_b32 s95, s96, 0xb000
    buffer_load_dwordx4 v[112:115], v35, s[4:7], s95 offen sc1
    s_waitcnt vmcnt(6)
    v_max3_u32 v220, v100, v101, v102
    v_max_u32 v220, v220, v103
    v_cmp_eq_u32 vcc, -1, v220
    s_cbranch_vccnz L_kv_15_r
    v_mfma_f32_32x32x16_bf16 v[136:151], v[248:251], v[100:103], v[136:151]
L_kv_15:
    s_xor_b32 s95, s96, 0xc000
    buffer_load_dwordx4 v[116:119], v35, s[4:7], s95 offen sc1
    s_waitcnt vmcnt(6)
    v_max3_u32 v220, v120, v121, v122
    v_max_u32 v220, v220, v123
    v_cmp_eq_u32 vcc, -1, v220
    s_cbranch_vccnz L_kv_16_r
    v_mfma_f32_32x32x16_bf16 v[136:151], v[248:251], v[120:123], v[136:151]
L_kv_16:
    s_xor_b32 s95, s96, 0xd000
    buffer_load_dwordx4 v[128:131], v35, s[4:7], s95 offen sc1
    s_waitcnt vmcnt(6)
    v_max3_u32 v220, v124, v125, v126
    v_max_u32 v220, v220, v127
    v_cmp_eq_u32 vcc, -1, v220
    s_cbranch_vccnz L_kv_17_r
    v_mfma_f32_32x32x16_bf16 v[136:151], v[248:251], v[124:127], v[136:151]
L_kv_17:
    s_xor_b32 s95, s96, 0xe000
    buffer_load_dwordx4 v[224:227], v35, s[4:7], s95 offen sc1
    s_waitcnt vmcnt(6)
    v_max3_u32 v220, v132, v133, v134
    v_max_u32 v220, v220, v135
    v_cmp_eq_u32 vcc, -1, v220
    s_cbranch_vccnz L_kv_18_r
    v_mfma_f32_32x32x16_bf16 v[136:151], v[248:251], v[132:135], v[136:151]
L_kv_18:
    s_xor_b32 s95, s96, 0xf000
    buffer_load_dwordx4 v[228:231], v35, s[4:7], s95 offen sc1
    s_waitcnt vmcnt(6)
    v_max3_u32 v220, v104, v105, v106
    v_max_u32 v220, v220, v107
    v_cmp_eq_u32 vcc, -1, v220
    s_cbranch_vccnz L_kv_19_r
    v_mfma_f32_32x32x16_bf16 v[136:151], v[248:251], v[104:107], v[136:151]
L_kv_19:
    s_add_u32 m0, s74, 126976
    s_nop 0
    buffer_load_dwordx4 v31, s[4:7], m0 offen sc1 lds
    s_waitcnt vmcnt(6)
    v_max3_u32 v220, v108, v109, v110
    v_max_u32 v220, v220, v111
    v_cmp_eq_u32 vcc, -1, v220
    s_cbranch_vccnz L_kv_20_r
    v_mfma_f32_32x32x16_bf16 v[136:151], v[248:251], v[108:111], v[136:151]
L_kv_20:
    s_add_u32 m0, s74, 131072
    s_nop 0
    buffer_load_dwordx4 v31, s[4:7], m0 offen sc1 lds
    s_waitcnt vmcnt(6)
    v_max3_u32 v220, v112, v113, v114
    v_max_u32 v220, v220, v115
    v_cmp_eq_u32 vcc, -1, v220
    s_cbranch_vccnz L_kv_21_r
    v_mfma_f32_32x32x16_bf16 v[136:151], v[248:251], v[112:115], v[136:151]
L_kv_21:
    s_add_u32 m0, s74, 135168
    s_nop 0
    buffer_load_dwordx4 v31, s[4:7], m0 offen sc1 lds
    s_waitcnt vmcnt(6)
    v_max3_u32 v220, v116, v117, v118
    v_max_u32 v220, v220, v119
    v_cmp_eq_u32 vcc, -1, v220
    s_cbranch_vccnz L_kv_22_r
    v_mfma_f32_32x32x16_bf16 v[136:151], v[248:251], v[116:119], v[136:151]
L_kv_22:
    s_waitcnt vmcnt(5)
    v_max3_u32 v220, v128, v129, v130
    v_max_u32 v220, v220, v131
    v_cmp_eq_u32 vcc, -1, v220
    s_cbranch_vccnz L_kv_23_r
    v_mfma_f32_32x32x16_bf16 v[136:151], v[248:251], v[128:131], v[136:151]
L_kv_23:
    s_waitcnt vmcnt(4)
    v_max3_u32 v220, v224, v225, v226
    v_max_u32 v220, v220, v227
    v_cmp_eq_u32 vcc, -1, v220
    s_cbranch_vccnz L_kv_24_r
    v_mfma_f32_32x32x16_bf16 v[136:151], v[248:251], v[224:227], v[136:151]
L_kv_24:
    s_waitcnt vmcnt(3)
    v_max3_u32 v220, v228, v229, v230
    v_max_u32 v220, v220, v231
    v_cmp_eq_u32 vcc, -1, v220
    s_cbranch_vccnz L_kv_25_r
    v_mfma_f32_32x32x16_bf16 v[136:151], v[248:251], v[228:231], v[136:151]
L_kv_25:
    s_cmp_lg_u32 s97, 0
    s_cbranch_scc1 L_kv_late0
L_kv_done0:
    s_nop 0
    s_nop 8
    v_cvt_pk_bf16_f32 v216, v136, v137
    v_cvt_pk_bf16_f32 v217, v138, v139
    v_cvt_pk_bf16_f32 v218, v140, v141
    v_cvt_pk_bf16_f32 v219, v142, v143
    ds_write_b128 v47, v[216:219]
    s_waitcnt lgkmcnt(0)
    s_barrier
    ds_read_b128 v[136:139], v42 offset:0
    ds_read_b128 v[144:147], v42 offset:672
    ds_read_b128 v[152:155], v43 offset:0
    ds_read_b128 v[140:143], v42 offset:1680
    ds_read_b128 v[148:151], v42 offset:2352
    ds_read_b128 v[156:159], v44 offset:0
    s_add_u32 m0, s74, 139264
    s_nop 0
    buffer_load_dwordx4 v31, s[4:7], m0 offen sc1 lds
    s_add_u32 m0, s74, 143360
    s_nop 0
    buffer_load_dwordx4 v31, s[4:7], m0 offen sc1 lds
    s_add_u32 m0, s74, 147456
    s_nop 0
    buffer_load_dwordx4 v31, s[4:7], m0 offen sc1 lds
    s_add_u32 m0, s74, 151552
    s_nop 0
    buffer_load_dwordx4 v31, s[4:7], m0 offen sc1 lds
    s_waitcnt lgkmcnt(5)
    v_mfma_f32_32x32x16_bf16 v[200:215], v[136:139], v[72:75], 0
    s_waitcnt lgkmcnt(4)
    v_mfma_f32_32x32x16_bf16 v[200:215], v[144:147], v[80:83], v[200:215]
L_pad4:
    s_cbranch_execz L_pad8
    s_waitcnt lgkmcnt(3)
    v_mfma_f32_32x32x16_bf16 v[200:215], v[152:155], v[88:91], v[200:215]
    s_waitcnt lgkmcnt(2)
    v_mfma_f32_32x32x16_bf16 v[216:231], v[140:143], v[76:79], 0
    s_waitcnt lgkmcnt(1)
    v_mfma_f32_32x32x16_bf16 v[216:231], v[148:151], v[84:87], v[216:231]
    s_waitcnt lgkmcnt(0)
    v_mfma_f32_32x32x16_bf16 v[216:231], v[156:159], v[88:91], v[216:231]
    v_add_u32 v33, 0x100000, v33
    v_add_u32 v34, 0x100000, v34
    v_add_u32 v35, 0x100000, v35
    s_cmp_eq_u32 s76, 0
    s_cbranch_scc0 L_sec_26_s
    s_nop 0
    v_add_f32 v212, 0x358637bd, v212
    v_rcp_f32 v212, v212
    s_nop 0
    v_pk_mul_f32 v[200:201], v[200:201], v[212:213] op_sel_hi:[1,0]
    v_pk_mul_f32 v[202:203], v[202:203], v[212:213] op_sel_hi:[1,0]
    v_pk_mul_f32 v[204:205], v[204:205], v[212:213] op_sel_hi:[1,0]
    v_pk_mul_f32 v[206:207], v[206:207], v[212:213] op_sel_hi:[1,0]
    v_pk_mul_f32 v[208:209], v[208:209], v[212:213] op_sel_hi:[1,0]
    v_pk_mul_f32 v[210:211], v[210:211], v[212:213] op_sel_hi:[1,0]
    v_cvt_pk_bf16_f32 v96, v200, v201
    v_cvt_pk_bf16_f32 v97, v202, v203
    v_cvt_pk_bf16_f32 v98, v204, v205
    v_cvt_pk_bf16_f32 v99, v206, v207
    buffer_store_dwordx4 v[96:99], v21, s[48:51], 0 offen offset:0
    v_cvt_pk_bf16_f32 v104, v208, v209
    v_cvt_pk_bf16_f32 v105, v210, v211
    v_add_f32 v228, 0x358637bd, v228
    v_rcp_f32 v228, v228
    s_nop 0
    v_pk_mul_f32 v[216:217], v[216:217], v[228:229] op_sel_hi:[1,0]
    v_pk_mul_f32 v[218:219], v[218:219], v[228:229] op_sel_hi:[1,0]
    v_pk_mul_f32 v[220:221], v[220:221], v[228:229] op_sel_hi:[1,0]
    v_pk_mul_f32 v[222:223], v[222:223], v[228:229] op_sel_hi:[1,0]
    v_pk_mul_f32 v[224:225], v[224:225], v[228:229] op_sel_hi:[1,0]
    v_pk_mul_f32 v[226:227], v[226:227], v[228:229] op_sel_hi:[1,0]
    v_cvt_pk_bf16_f32 v100, v216, v217
    v_cvt_pk_bf16_f32 v101, v218, v219
    v_cvt_pk_bf16_f32 v102, v220, v221
    v_cvt_pk_bf16_f32 v103, v222, v223
    buffer_store_dwordx4 v[100:103], v21, s[48:51], 0 offen offset:512
    v_cvt_pk_bf16_f32 v106, v224, v225
    v_cvt_pk_bf16_f32 v107, v226, v227
    buffer_store_dwordx4 v[104:107], v22, s[48:51], 0 offen
    s_add_u32 m0, s74, 155648
    s_nop 0
    buffer_load_dwordx4 v31, s[4:7], m0 offen sc1 lds
    s_waitcnt vmcnt(1)
    s_mov_b64 exec, 1
    buffer_store_dword v28, off, s[48:51], s85 offset:64
    s_mov_b64 exec, -1
    s_mov_b64 s[8:9], s[48:49]
    s_add_u32 s48, s48, s56
    s_addc_u32 s49, s49, 0
L_sec_26_e:
L_p20:
    s_barrier
    ds_read_b128 v[136:139], v2 offset:4096
    ds_read_b128 v[140:143], v2 offset:5120
    ds_read_b128 v[144:147], v2 offset:6144
    ds_read_b128 v[148:151], v2 offset:7168
    ds_read_b128 v[152:155], v2 offset:8192
    ds_read_b128 v[156:159], v2 offset:9216
    ds_read_b128 v[160:163], v2 offset:10240
    ds_read_b128 v[164:167], v2 offset:11264
    ds_read_b128 v[168:171], v2 offset:12288
    ds_read_b128 v[172:175], v2 offset:13312
L_poll_29:
    buffer_load_dword v252, v27, s[8:11], s83 offen offset:64 sc1
    s_sub_u32 s80, s80, 1
    s_cbranch_scc1 L_end
    s_waitcnt vmcnt(0)
    v_cmp_ne_u32 vcc, s81, v252
    s_cbranch_vccnz L_poll_29
    s_nop 0
    buffer_load_dwordx4 v[72:75], v12, s[8:11], 0 offen offset:0 sc1
    buffer_load_dwordx4 v[76:79], v12, s[8:11], 0 offen offset:1024 sc1
    buffer_load_dwordx4 v[80:83], v12, s[8:11], 0 offen offset:2048 sc1
    buffer_load_dwordx4 v[84:87], v12, s[8:11], 0 offen offset:3072 sc1
    buffer_load_dwordx4 v[88:91], v12, s[8:11], s32 offen offset:0 sc1
    buffer_load_dwordx4 v[92:95], v12, s[8:11], s32 offen offset:1024 sc1
    buffer_load_dwordx4 v[96:99], v12, s[8:11], s32 offen offset:2048 sc1
    s_add_u32 s81, s81, 32
    v_mov_b32 v28, s81
    s_waitcnt vmcnt(6) lgkmcnt(5)
    v_mfma_f32_16x16x32_bf16 v[52:55], v[136:139], v[72:75], v[52:55]
    ds_read_b128 v[176:179], v2 offset:14336
    buffer_load_dwordx4 v[100:103], v12, s[8:11], s32 offen offset:3072 sc1
    v_mfma_f32_16x16x32_bf16 v[56:59], v[140:143], v[72:75], v[56:59]
    ds_read_b128 v[136:139], v2 offset:15360
    v_mfma_f32_16x16x32_bf16 v[60:63], v[144:147], v[72:75], v[60:63]
    ds_read_b128 v[140:143], v2 offset:16384
    v_mfma_f32_16x16x32_bf16 v[64:67], v[148:151], v[72:75], v[64:67]
    ds_read_b128 v[144:147], v2 offset:17408
    buffer_load_dwordx4 v[104:107], v12, s[8:11], s33 offen offset:0 sc1
    v_mfma_f32_16x16x32_bf16 v[68:71], v[152:155], v[72:75], v[68:71]
    ds_read_b128 v[148:151], v2 offset:18432
    s_waitcnt vmcnt(7) lgkmcnt(5)
    v_mfma_f32_16x16x32_bf16 v[52:55], v[156:159], v[76:79], v[52:55]
    ds_read_b128 v[152:155], v2 offset:19456
    v_mfma_f32_16x16x32_bf16 v[56:59], v[160:163], v[76:79], v[56:59]
    ds_read_b128 v[156:159], v2 offset:20480
    v_mfma_f32_16x16x32_bf16 v[60:63], v[164:167], v[76:79], v[60:63]
    ds_read_b128 v[160:163], v2 offset:21504
    buffer_load_dwordx4 v[108:111], v12, s[8:11], s33 offen offset:1024 sc1
    v_mfma_f32_16x16x32_bf16 v[64:67], v[168:171], v[76:79], v[64:67]
    ds_read_b128 v[164:167], v2 offset:22528
    v_mfma_f32_16x16x32_bf16 v[68:71], v[172:175], v[76:79], v[68:71]
    ds_read_b128 v[168:171], v2 offset:23552
    s_waitcnt vmcnt(7) lgkmcnt(5)
    v_mfma_f32_16x16x32_bf16 v[52:55], v[176:179], v[80:83], v[52:55]
    ds_read_b128 v[172:175], v2 offset:24576
    buffer_load_dwordx4 v[112:115], v12, s[8:11], s33 offen offset:2048 sc1
    v_mfma_f32_16x16x32_bf16 v[56:59], v[136:139], v[80:83], v[56:59]
    ds_read_b128 v[176:179], v2 offset:25600
    v_mfma_f32_16x16x32_bf16 v[60:63], v[140:143], v[80:83], v[60:63]
    ds_read_b128 v[136:139], v2 offset:26624
    v_mfma_f32_16x16x32_bf16 v[64:67], v[144:147], v[80:83], v[64:67]
    ds_read_b128 v[140:143], v2 offset:27648
    v_mfma_f32_16x16x32_bf16 v[68:71], v[148:151], v[80:83], v[68:71]
    ds_read_b128 v[144:147], v2 offset:28672
    s_waitcnt vmcnt(7) lgkmcnt(5)
    v_mfma_f32_16x16x32_bf16 v[52:55], v[152:155], v[84:87], v[52:55]
    ds_read_b128 v[148:151], v2 offset:29696
    buffer_load_dwordx4 v[116:119], v12, s[8:11], s33 offen offset:3072 sc1
    v_mfma_f32_16x16x32_bf16 v[56:59], v[156:159], v[84:87], v[56:59]
    ds_read_b128 v[152:155], v2 offset:30720
    v_mfma_f32_16x16x32_bf16 v[60:63], v[160:163], v[84:87], v[60:63]
    ds_read_b128 v[156:159], v2 offset:31744
    v_mfma_f32_16x16x32_bf16 v[64:67], v[164:167], v[84:87], v[64:67]
    ds_read_b128 v[160:163], v2 offset:32768
    buffer_load_dwordx4 v[120:123], v12, s[8:11], s34 offen offset:0 sc1
    v_mfma_f32_16x16x32_bf16 v[68:71], v[168:171], v[84:87], v[68:71]
    ds_read_b128 v[164:167], v2 offset:33792
    s_waitcnt vmcnt(8) lgkmcnt(5)
    v_mfma_f32_16x16x32_bf16 v[52:55], v[172:175], v[88:91], v[52:55]
    ds_read_b128 v[168:171], v2 offset:34816
    v_mfma_f32_16x16x32_bf16 v[56:59], v[176:179], v[88:91], v[56:59]
    ds_read_b128 v[172:175], v2 offset:35840
    buffer_load_dword a255, v16, s[52:55], 0 offen offset:0 sc1
    v_mfma_f32_16x16x32_bf16 v[60:63], v[136:139], v[88:91], v[60:63]
    ds_read_b128 v[176:179], v2 offset:36864
    v_mfma_f32_16x16x32_bf16 v[64:67], v[140:143], v[88:91], v[64:67]
    ds_read_b128 v[136:139], v2 offset:37888
    v_mfma_f32_16x16x32_bf16 v[68:71], v[144:147], v[88:91], v[68:71]
    ds_read_b128 v[140:143], v2 offset:38912
    s_waitcnt vmcnt(8) lgkmcnt(5)
    v_mfma_f32_16x16x32_bf16 v[52:55], v[148:151], v[92:95], v[52:55]
    ds_read_b128 v[144:147], v2 offset:39936
    buffer_load_dword a255, v16, s[52:55], 0 offen offset:2048 sc1
    v_mfma_f32_16x16x32_bf16 v[56:59], v[152:155], v[92:95], v[56:59]
    ds_read_b128 v[148:151], v2 offset:40960
    v_mfma_f32_16x16x32_bf16 v[60:63], v[156:159], v[92:95], v[60:63]
    ds_read_b128 v[152:155], v2 offset:41984
    v_mfma_f32_16x16x32_bf16 v[64:67], v[160:163], v[92:95], v[64:67]
    ds_read_b128 v[156:159], v2 offset:43008
    buffer_load_dword a255, v17, s[52:55], 0 offen offset:0 sc1
    v_mfma_f32_16x16x32_bf16 v[68:71], v[164:167], v[92:95], v[68:71]
    ds_read_b128 v[160:163], v2 offset:44032
    s_waitcnt vmcnt(9) lgkmcnt(5)
    v_mfma_f32_16x16x32_bf16 v[52:55], v[168:171], v[96:99], v[52:55]
    s_barrier
    ds_read_b128 v[164:167], v2 offset:45056
    v_mfma_f32_16x16x32_bf16 v[56:59], v[172:175], v[96:99], v[56:59]
    ds_read_b128 v[168:171], v2 offset:46080
    v_mfma_f32_16x16x32_bf16 v[60:63], v[176:179], v[96:99], v[60:63]
    ds_read_b128 v[172:175], v2 offset:47104
    buffer_load_dwordx4 v[124:127], v12, s[8:11], s34 offen offset:1024 sc1
    v_mfma_f32_16x16x32_bf16 v[64:67], v[136:139], v[96:99], v[64:67]
    ds_read_b128 v[176:179], v2 offset:48128
    v_mfma_f32_16x16x32_bf16 v[68:71], v[140:143], v[96:99], v[68:71]
    ds_read_b128 v[136:139], v2 offset:49152
    s_waitcnt vmcnt(9) lgkmcnt(5)
    v_mfma_f32_16x16x32_bf16 v[52:55], v[144:147], v[100:103], v[52:55]
    ds_read_b128 v[140:143], v2 offset:50176
    v_mfma_f32_16x16x32_bf16 v[56:59], v[148:151], v[100:103], v[56:59]
    ds_read_b128 v[144:147], v2 offset:51200
    buffer_load_dwordx4 v[128:131], v12, s[8:11], s34 offen offset:2048 sc1
    v_mfma_f32_16x16x32_bf16 v[60:63], v[152:155], v[100:103], v[60:63]
    ds_read_b128 v[148:151], v2 offset:52224
    v_mfma_f32_16x16x32_bf16 v[64:67], v[156:159], v[100:103], v[64:67]
    ds_read_b128 v[152:155], v2 offset:53248
    v_mfma_f32_16x16x32_bf16 v[68:71], v[160:163], v[100:103], v[68:71]
    ds_read_b128 v[156:159], v2 offset:54272
    s_waitcnt vmcnt(9) lgkmcnt(5)
    v_mfma_f32_16x16x32_bf16 v[52:55], v[164:167], v[104:107], v[52:55]
    ds_read_b128 v[160:163], v2 offset:55296
    buffer_load_dword a255, v18, s[52:55], 0 offen offset:0 sc1
    v_mfma_f32_16x16x32_bf16 v[56:59], v[168:171], v[104:107], v[56:59]
    ds_read_b128 v[164:167], v2 offset:56320
    v_mfma_f32_16x16x32_bf16 v[60:63], v[172:175], v[104:107], v[60:63]
    ds_read_b128 v[168:171], v2 offset:57344
    v_mfma_f32_16x16x32_bf16 v[64:67], v[176:179], v[104:107], v[64:67]
    ds_read_b128 v[172:175], v2 offset:58368
    buffer_load_dwordx4 v[132:135], v12, s[8:11], s34 offen offset:3072 sc1
    v_mfma_f32_16x16x32_bf16 v[68:71], v[136:139], v[104:107], v[68:71]
    ds_read_b128 v[176:179], v2 offset:59392
    s_waitcnt vmcnt(10) lgkmcnt(5)
    v_mfma_f32_16x16x32_bf16 v[52:55], v[140:143], v[108:111], v[52:55]
    ds_read_b128 v[136:139], v2 offset:60416
    v_mfma_f32_16x16x32_bf16 v[56:59], v[144:147], v[108:111], v[56:59]
    ds_read_b128 v[140:143], v2 offset:61440
    buffer_load_dwordx4 v[72:75], v12, s[8:11], s35 offen offset:0 sc1
    v_mfma_f32_16x16x32_bf16 v[60:63], v[148:151], v[108:111], v[60:63]
    ds_read_b128 v[144:147], v2 offset:62464
    v_mfma_f32_16x16x32_bf16 v[64:67], v[152:155], v[108:111], v[64:67]
    ds_read_b128 v[148:151], v2 offset:63488
    v_mfma_f32_16x16x32_bf16 v[68:71], v[156:159], v[108:111], v[68:71]
    ds_read_b128 v[152:155], v2 offset:64512
    v_add_u32 v31, 0x27000, v31
    s_add_u32 m0, s74, 0
    s_waitcnt vmcnt(10) lgkmcnt(5)
    v_mfma_f32_16x16x32_bf16 v[52:55], v[160:163], v[112:115], v[52:55]
    ds_read_b128 v[156:159], v3 offset:0
    buffer_load_dwordx4 v31, s[4:7], m0 offen sc1 lds
    v_mfma_f32_16x16x32_bf16 v[56:59], v[164:167], v[112:115], v[56:59]
    ds_read_b128 v[160:163], v3 offset:1024
    v_mfma_f32_16x16x32_bf16 v[60:63], v[168:171], v[112:115], v[60:63]
    ds_read_b128 v[164:167], v3 offset:2048
    v_mfma_f32_16x16x32_bf16 v[64:67], v[172:175], v[112:115], v[64:67]
    ds_read_b128 v[168:171], v3 offset:3072
    v_mfma_f32_16x16x32_bf16 v[68:71], v[176:179], v[112:115], v[68:71]
    ds_read_b128 v[172:175], v3 offset:4096
    s_waitcnt vmcnt(10) lgkmcnt(5)
    v_mfma_f32_16x16x32_bf16 v[52:55], v[136:139], v[116:119], v[52:55]
    ds_read_b128 v[176:179], v3 offset:5120
    buffer_load_dwordx4 v[76:79], v12, s[8:11], s35 offen offset:1024 sc1
    v_mfma_f32_16x16x32_bf16 v[56:59], v[140:143], v[116:119], v[56:59]
    ds_read_b128 v[136:139], v3 offset:6144
    v_mfma_f32_16x16x32_bf16 v[60:63], v[144:147], v[116:119], v[60:63]
    ds_read_b128 v[140:143], v3 offset:7168
    buffer_load_dwordx4 v[80:83], v12, s[8:11], s35 offen offset:2048 sc1
    v_mfma_f32_16x16x32_bf16 v[64:67], v[148:151], v[116:119], v[64:67]
    ds_read_b128 v[144:147], v3 offset:8192
    v_mfma_f32_16x16x32_bf16 v[68:71], v[152:155], v[116:119], v[68:71]
    ds_read_b128 v[148:151], v3 offset:9216
    s_waitcnt vmcnt(11) lgkmcnt(5)
    v_mfma_f32_16x16x32_bf16 v[52:55], v[156:159], v[120:123], v[52:55]
    ds_read_b128 v[152:155], v3 offset:10240
    v_mfma_f32_16x16x32_bf16 v[56:59], v[160:163], v[120:123], v[56:59]
    ds_read_b128 v[156:159], v3 offset:11264
    buffer_load_dwordx4 v[84:87], v12, s[8:11], s35 offen offset:3072 sc1
    v_mfma_f32_16x16x32_bf16 v[60:63], v[164:167], v[120:123], v[60:63]
    ds_read_b128 v[160:163], v3 offset:12288
    v_mfma_f32_16x16x32_bf16 v[64:67], v[168:171], v[120:123], v[64:67]
    ds_read_b128 v[164:167], v3 offset:13312
    v_mfma_f32_16x16x32_bf16 v[68:71], v[172:175], v[120:123], v[68:71]
    ds_read_b128 v[168:171], v3 offset:14336
    s_add_u32 m0, s74, 4096
    s_waitcnt vmcnt(8) lgkmcnt(5)
    v_mfma_f32_16x16x32_bf16 v[52:55], v[176:179], v[124:127], v[52:55]
    ds_read_b128 v[172:175], v3 offset:15360
    buffer_load_dwordx4 v31, s[4:7], m0 offen sc1 lds
    v_mfma_f32_16x16x32_bf16 v[56:59], v[136:139], v[124:127], v[56:59]
    ds_read_b128 v[176:179], v3 offset:16384
    v_mfma_f32_16x16x32_bf16 v[60:63], v[140:143], v[124:127], v[60:63]
    ds_read_b128 v[136:139], v3 offset:17408
    s_add_u32 m0, s74, 8192
    v_mfma_f32_16x16x32_bf16 v[64:67], v[144:147], v[124:127], v[64:67]
    ds_read_b128 v[140:143], v3 offset:18432
    buffer_load_dwordx4 v31, s[4:7], m0 offen sc1 lds
    v_mfma_f32_16x16x32_bf16 v[68:71], v[148:151], v[124:127], v[68:71]
    ds_read_b128 v[144:147], v3 offset:19456
    s_waitcnt vmcnt(9) lgkmcnt(5)
    v_mfma_f32_16x16x32_bf16 v[52:55], v[152:155], v[128:131], v[52:55]
    ds_read_b128 v[148:151], v3 offset:20480
    v_mfma_f32_16x16x32_bf16 v[56:59], v[156:159], v[128:131], v[56:59]
    ds_read_b128 v[152:155], v3 offset:21504
    s_add_u32 m0, s74, 12288
    v_mfma_f32_16x16x32_bf16 v[60:63], v[160:163], v[128:131], v[60:63]
    ds_read_b128 v[156:159], v3 offset:22528
    buffer_load_dwordx4 v31, s[4:7], m0 offen sc1 lds
    v_mfma_f32_16x16x32_bf16 v[64:67], v[164:167], v[128:131], v[64:67]
    ds_read_b128 v[160:163], v3 offset:23552
    v_mfma_f32_16x16x32_bf16 v[68:71], v[168:171], v[128:131], v[68:71]
    ds_read_b128 v[164:167], v3 offset:24576
    s_cmp_eq_u32 s60, 17
    s_cselect_b32 s3, 0xfffdd000, 0
    v_add_u32 v31, s3, v31
    s_add_u32 m0, s74, 16384
    s_waitcnt vmcnt(8) lgkmcnt(5)
    v_mfma_f32_16x16x32_bf16 v[52:55], v[172:175], v[132:135], v[52:55]
    ds_read_b128 v[168:171], v3 offset:25600
    buffer_load_dwordx4 v31, s[4:7], m0 offen sc1 lds
    v_mfma_f32_16x16x32_bf16 v[56:59], v[176:179], v[132:135], v[56:59]
    ds_read_b128 v[172:175], v3 offset:26624
    v_mfma_f32_16x16x32_bf16 v[60:63], v[136:139], v[132:135], v[60:63]
    ds_read_b128 v[176:179], v3 offset:27648
    v_mfma_f32_16x16x32_bf16 v[64:67], v[140:143], v[132:135], v[64:67]
    ds_read_b128 v[136:139], v3 offset:28672
    v_mfma_f32_16x16x32_bf16 v[68:71], v[144:147], v[132:135], v[68:71]
    ds_read_b128 v[140:143], v3 offset:29696
    s_waitcnt vmcnt(8) lgkmcnt(5)
    v_mfma_f32_16x16x32_bf16 v[52:55], v[148:151], v[72:75], v[52:55]
    ds_read_b128 v[144:147], v3 offset:30720
    v_mfma_f32_16x16x32_bf16 v[56:59], v[152:155], v[72:75], v[56:59]
    ds_read_b128 v[148:151], v3 offset:31744
    v_mfma_f32_16x16x32_bf16 v[60:63], v[156:159], v[72:75], v[60:63]
    ds_read_b128 v[152:155], v3 offset:32768
    v_mfma_f32_16x16x32_bf16 v[64:67], v[160:163], v[72:75], v[64:67]
    ds_read_b128 v[156:159], v3 offset:33792
    v_mfma_f32_16x16x32_bf16 v[68:71], v[164:167], v[72:75], v[68:71]
    ds_read_b128 v[160:163], v3 offset:34816
    s_waitcnt vmcnt(6) lgkmcnt(5)
    v_mfma_f32_16x16x32_bf16 v[52:55], v[168:171], v[76:79], v[52:55]
    ds_read_b128 v[164:167], v3 offset:35840
    v_mfma_f32_16x16x32_bf16 v[56:59], v[172:175], v[76:79], v[56:59]
    ds_read_b128 v[168:171], v3 offset:36864
    v_mfma_f32_16x16x32_bf16 v[60:63], v[176:179], v[76:79], v[60:63]
    ds_read_b128 v[172:175], v3 offset:37888
    v_mfma_f32_16x16x32_bf16 v[64:67], v[136:139], v[76:79], v[64:67]
    ds_read_b128 v[176:179], v3 offset:38912
    v_mfma_f32_16x16x32_bf16 v[68:71], v[140:143], v[76:79], v[68:71]
    ds_read_b128 v[136:139], v3 offset:39936
    s_waitcnt vmcnt(5) lgkmcnt(5)
    v_mfma_f32_16x16x32_bf16 v[52:55], v[144:147], v[80:83], v[52:55]
    v_mfma_f32_16x16x32_bf16 v[56:59], v[148:151], v[80:83], v[56:59]
    v_mfma_f32_16x16x32_bf16 v[60:63], v[152:155], v[80:83], v[60:63]
    v_mfma_f32_16x16x32_bf16 v[64:67], v[156:159], v[80:83], v[64:67]
    v_mfma_f32_16x16x32_bf16 v[68:71], v[160:163], v[80:83], v[68:71]
    s_waitcnt vmcnt(4) lgkmcnt(0)
    v_mfma_f32_16x16x32_bf16 v[52:55], v[164:167], v[84:87], v[52:55]
    v_mfma_f32_16x16x32_bf16 v[56:59], v[168:171], v[84:87], v[56:59]
    v_mfma_f32_16x16x32_bf16 v[60:63], v[172:175], v[84:87], v[60:63]
    v_mfma_f32_16x16x32_bf16 v[64:67], v[176:179], v[84:87], v[64:67]
    v_mfma_f32_16x16x32_bf16 v[68:71], v[136:139], v[84:87], v[68:71]
    s_cmp_eq_u32 s76, 0
    s_cbranch_scc0 L_sec_34_s
    s_nop 0
    s_nop 0
    v_cvt_pk_bf16_f32 v208, v52, v53
    v_cvt_pk_bf16_f32 v209, v54, v55
    v_cvt_pk_bf16_f32 v210, v56, v57
    v_cvt_pk_bf16_f32 v211, v58, v59
    buffer_store_dwordx4 v[208:211], v16, s[48:51], 0 offen
    v_cvt_pk_bf16_f32 v212, v60, v61
    v_cvt_pk_bf16_f32 v213, v62, v63
    v_cvt_pk_bf16_f32 v214, v64, v65
    v_cvt_pk_bf16_f32 v215, v66, v67
    v_cvt_pk_bf16_f32 v216, v68, v69
    v_cvt_pk_bf16_f32 v217, v70, v71
    v_pk_add_f32 v[228:229], v[52:53], v[54:55]
    v_pk_mul_f32 v[230:231], v[52:53], v[52:53]
    v_pk_fma_f32 v[230:231], v[54:55], v[54:55], v[230:231]
    v_pk_add_f32 v[228:229], v[228:229], v[56:57]
    v_pk_fma_f32 v[230:231], v[56:57], v[56:57], v[230:231]
    v_pk_add_f32 v[228:229], v[228:229], v[58:59]
    buffer_store_dwordx4 v[212:215], v16, s[48:51], 0 offen offset:2048
    v_pk_fma_f32 v[230:231], v[58:59], v[58:59], v[230:231]
    v_pk_add_f32 v[228:229], v[228:229], v[60:61]
    v_pk_fma_f32 v[230:231], v[60:61], v[60:61], v[230:231]
    v_pk_add_f32 v[228:229], v[228:229], v[62:63]
    v_pk_fma_f32 v[230:231], v[62:63], v[62:63], v[230:231]
    v_pk_add_f32 v[228:229], v[228:229], v[64:65]
    v_pk_fma_f32 v[230:231], v[64:65], v[64:65], v[230:231]
    v_pk_add_f32 v[228:229], v[228:229], v[66:67]
    v_pk_fma_f32 v[230:231], v[66:67], v[66:67], v[230:231]
    v_pk_add_f32 v[228:229], v[228:229], v[68:69]
    v_pk_fma_f32 v[230:231], v[68:69], v[68:69], v[230:231]
    v_pk_add_f32 v[228:229], v[228:229], v[70:71]
    v_pk_fma_f32 v[230:231], v[70:71], v[70:71], v[230:231]
    v_add_f32 v228, v228, v229
    v_add_f32 v230, v230, v231
    buffer_store_dwordx2 v[216:217], v17, s[48:51], 0 offen
    s_nop 0
    v_permlane32_swap_b32 v228, v230
    v_add_f32 v228, v228, v230
    v_mov_b32 v230, v228
    s_nop 1
    v_permlane16_swap_b32 v228, v230
    v_add_f32 v230, v228, v230
    buffer_store_dword v230, v18, s[48:51], 0 offen
    s_barrier
    ds_write_b128 v36, a[184:187] offset:20480
    ds_write_b128 v36, a[188:191] offset:24576
    ds_write_b128 v36, a[192:195] offset:28672
    ds_write_b128 v36, a[196:199] offset:32768
    s_waitcnt vmcnt(0)
    s_mov_b64 exec, 1
    buffer_store_dword v28, off, s[48:51], s84 offset:0
    s_mov_b64 exec, -1
    s_mov_b64 s[8:9], s[48:49]
    s_add_u32 s48, s48, s56
    s_addc_u32 s49, s49, 0
L_sec_34_e:
    ds_write_b128 v36, a[200:203] offset:36864
    ds_write_b128 v36, a[204:207] offset:40960
    ds_write_b128 v36, a[208:211] offset:45056
    ds_write_b128 v36, a[212:215] offset:49152
    ds_write_b128 v36, a[216:219] offset:53248
    ds_write_b128 v36, a[220:223] offset:57344
L_p30:
    s_lshr_b32 s95, s77, 3
    s_mul_i32 s26, s95, s47
    s_sub_u32 s27, s47, s26
    s_lshl_b32 s96, s95, 8
    v_add_u32 v132, s96, v20
    v_xor_b32 v133, 0x100, v132
    s_lshl2_add_u32 s96, s96, s65
    v_add_u32 v48, s96, v11
    v_xor_b32 v131, 0x400, v48
    s_mul_i32 s57, s65, -2
    s_lshl_b32 s96, s95, 5
    v_and_or_b32 v255, v27, 28, s96
    s_cmp_ge_u32 s79, 6
    s_cselect_b32 s95, 0x40000, 0
    v_add_u32 v128, s95, v2
    v_add_u32 v129, s95, v3
    v_add_u32 v130, s95, v4
    s_barrier
    ds_read_b128 v[136:139], v3 offset:40960
    ds_read_b128 v[140:143], v3 offset:41984
    ds_read_b128 v[144:147], v3 offset:43008
    ds_read_b128 v[148:151], v3 offset:44032
    ds_read_b128 v[152:155], v3 offset:45056
L_poll_37:
    buffer_load_dword v252, v27, s[8:11], s82 offen offset:0 sc1
    s_sub_u32 s80, s80, 1
    s_cbranch_scc1 L_end
    s_waitcnt vmcnt(0)
    v_cmp_ne_u32 vcc, s81, v252
    s_cbranch_vccnz L_poll_37
    s_waitcnt lgkmcnt(9)
    buffer_load_dwordx4 a[184:187], v48, s[8:11], 0 offen offset:0 sc1
    buffer_load_dwordx4 a[188:191], v131, s[8:11], 0 offen offset:0 sc1
    buffer_load_dwordx4 a[192:195], v48, s[8:11], 0 offen offset:2048 sc1
    buffer_load_dwordx4 a[196:199], v131, s[8:11], 0 offen offset:2048 sc1
    buffer_load_dwordx4 a[200:203], v48, s[8:11], s32 offen offset:0 sc1
    buffer_load_dwordx4 a[204:207], v131, s[8:11], s32 offen offset:0 sc1
    s_add_u32 m0, s74, 90112
    s_waitcnt vmcnt(4) lgkmcnt(3)
    v_mfma_f32_16x16x32_bf16 v[72:75], v[136:139], a[184:187], 0
    ds_read_b128 v[156:159], v3 offset:46080
    v_mfma_f32_16x16x32_bf16 v[100:103], v[136:139], a[188:191], 0
    buffer_load_dwordx4 v32, s[4:7], m0 offen sc1 lds
    v_mfma_f32_16x16x32_bf16 v[76:79], v[140:143], a[184:187], 0
    ds_write_b128 v36, a[224:227] offset:61440
    v_mfma_f32_16x16x32_bf16 v[104:107], v[140:143], a[188:191], 0
    s_waitcnt lgkmcnt(3)
    v_mfma_f32_16x16x32_bf16 v[80:83], v[144:147], a[184:187], 0
    ds_read_b128 v[136:139], v129 offset:47104
    ds_read_b128 v[140:143], v3 offset:48128
    v_mfma_f32_16x16x32_bf16 v[108:111], v[144:147], a[188:191], 0
    buffer_load_dwordx4 a[208:211], v48, s[8:11], s32 offen offset:2048 sc1
    v_mfma_f32_16x16x32_bf16 v[84:87], v[148:151], a[184:187], 0
    ds_read_b128 v[144:147], v3 offset:49152
    v_mfma_f32_16x16x32_bf16 v[112:115], v[148:151], a[188:191], 0
    s_waitcnt lgkmcnt(4)
    v_mfma_f32_16x16x32_bf16 v[88:91], v[152:155], a[184:187], 0
    ds_read_b128 v[148:151], v3 offset:50176
    v_mfma_f32_16x16x32_bf16 v[116:119], v[152:155], a[188:191], 0
    buffer_load_dwordx4 a[212:215], v131, s[8:11], s32 offen offset:2048 sc1
    v_mfma_f32_16x16x32_bf16 v[92:95], v[156:159], a[184:187], 0
    ds_write_b128 v37, a[228:231] offset:0
    v_mfma_f32_16x16x32_bf16 v[120:123], v[156:159], a[188:191], 0
    s_waitcnt vmcnt(5) lgkmcnt(3)
    v_mfma_f32_16x16x32_bf16 v[96:99], v[136:139], a[184:187], 0
    ds_read_b128 v[152:155], v3 offset:51200
    ds_read_b128 v[156:159], v3 offset:52224
    v_mfma_f32_16x16x32_bf16 v[124:127], v[136:139], a[188:191], 0
    buffer_load_dwordx4 a[216:219], v48, s[8:11], s33 offen offset:0 sc1
    v_mfma_f32_16x16x32_bf16 v[72:75], v[140:143], a[192:195], v[72:75]
    ds_read_b128 v[136:139], v3 offset:53248
    ds_read_b128 v[160:163], v46 offset:512
    v_mfma_f32_16x16x32_bf16 v[100:103], v[140:143], a[196:199], v[100:103]
    ds_read_b128 v[188:191], v46 offset:1024
    s_waitcnt lgkmcnt(6)
    v_mfma_f32_16x16x32_bf16 v[76:79], v[144:147], a[192:195], v[76:79]
    ds_read_b128 v[140:143], v129 offset:54272
    ds_read_b128 v[164:167], v46 offset:576
    v_mfma_f32_16x16x32_bf16 v[104:107], v[144:147], a[196:199], v[104:107]
    buffer_load_dwordx4 a[220:223], v131, s[8:11], s33 offen offset:0 sc1
    v_mfma_f32_16x16x32_bf16 v[80:83], v[148:151], a[192:195], v[80:83]
    ds_write_b128 v37, a[232:235] offset:4096
    v_mfma_f32_16x16x32_bf16 v[108:111], v[148:151], a[196:199], v[108:111]
    s_waitcnt lgkmcnt(6)
    v_mfma_f32_16x16x32_bf16 v[84:87], v[152:155], a[192:195], v[84:87]
    ds_read_b128 v[144:147], v3 offset:55296
    ds_read_b128 v[148:151], v3 offset:56320
    v_mfma_f32_16x16x32_bf16 v[112:115], v[152:155], a[196:199], v[112:115]
    buffer_load_dwordx4 v[244:247], v132, s[8:11], 0 offen offset:0 sc1
    v_mfma_f32_16x16x32_bf16 v[88:91], v[156:159], a[192:195], v[88:91]
    ds_read_b128 v[152:155], v3 offset:57344
    ds_read_b128 v[192:195], v46 offset:1088
    v_mfma_f32_16x16x32_bf16 v[116:119], v[156:159], a[196:199], v[116:119]
    ds_read_b128 v[168:171], v46 offset:640
    s_waitcnt lgkmcnt(7)
    v_mfma_f32_16x16x32_bf16 v[92:95], v[136:139], a[192:195], v[92:95]
    ds_read_b128 v[156:159], v3 offset:58368
    ds_read_b128 v[196:199], v46 offset:1152
    v_mfma_f32_16x16x32_bf16 v[120:123], v[136:139], a[196:199], v[120:123]
    buffer_load_dwordx4 a[224:227], v48, s[8:11], s33 offen offset:2048 sc1
    v_mfma_f32_16x16x32_bf16 v[96:99], v[140:143], a[192:195], v[96:99]
    ds_write_b128 v37, a[236:239] offset:8192
    v_mfma_f32_16x16x32_bf16 v[124:127], v[140:143], a[196:199], v[124:127]
    s_waitcnt vmcnt(7) lgkmcnt(6)
    v_mfma_f32_16x16x32_bf16 v[72:75], v[144:147], a[200:203], v[72:75]
    ds_read_b128 v[136:139], v3 offset:59392
    ds_read_b128 v[140:143], v3 offset:60416
    v_mfma_f32_16x16x32_bf16 v[100:103], v[144:147], a[204:207], v[100:103]
    buffer_load_dwordx4 v[248:251], v133, s[8:11], 0 offen offset:0 sc1
    v_mfma_f32_16x16x32_bf16 v[76:79], v[148:151], a[200:203], v[76:79]
    ds_read_b128 v[144:147], v129 offset:61440
    ds_read_b128 v[172:175], v46 offset:704
    v_mfma_f32_16x16x32_bf16 v[104:107], v[148:151], a[204:207], v[104:107]
    ds_read_b128 v[200:203], v46 offset:1216
    s_waitcnt lgkmcnt(7)
    v_mfma_f32_16x16x32_bf16 v[80:83], v[152:155], a[200:203], v[80:83]
    ds_read_b128 v[148:151], v3 offset:62464
    ds_read_b128 v[176:179], v46 offset:768
    v_mfma_f32_16x16x32_bf16 v[108:111], v[152:155], a[204:207], v[108:111]
    buffer_load_dwordx4 a[228:231], v131, s[8:11], s33 offen offset:2048 sc1
    v_mfma_f32_16x16x32_bf16 v[84:87], v[156:159], a[200:203], v[84:87]
    ds_write_b128 v37, a[240:243] offset:12288
    v_mfma_f32_16x16x32_bf16 v[112:115], v[156:159], a[204:207], v[112:115]
    s_waitcnt lgkmcnt(6)
    v_mfma_f32_16x16x32_bf16 v[88:91], v[136:139], a[200:203], v[88:91]
    ds_read_b128 v[152:155], v3 offset:63488
    ds_read_b128 v[156:159], v3 offset:64512
    v_mfma_f32_16x16x32_bf16 v[116:119], v[136:139], a[204:207], v[116:119]
    buffer_load_dwordx4 a[184:187], v48, s[8:11], s34 offen offset:0 sc1
    v_mfma_f32_16x16x32_bf16 v[92:95], v[140:143], a[200:203], v[92:95]
    ds_read_b128 v[136:139], v4 offset:0
    ds_read_b128 v[204:207], v46 offset:1280
    v_mfma_f32_16x16x32_bf16 v[120:123], v[140:143], a[204:207], v[120:123]
    s_add_u32 m0, s74, 94208
    s_waitcnt vmcnt(7) lgkmcnt(6)
    v_mfma_f32_16x16x32_bf16 v[96:99], v[144:147], a[200:203], v[96:99]
    ds_read_b128 v[140:143], v4 offset:1024
    ds_read_b128 v[180:183], v46 offset:832
    v_mfma_f32_16x16x32_bf16 v[124:127], v[144:147], a[204:207], v[124:127]
    buffer_load_dwordx4 v32, s[4:7], m0 offen sc1 lds
    v_mfma_f32_16x16x32_bf16 v[72:75], v[148:151], a[208:211], v[72:75]
    ds_write_b128 v37, a[244:247] offset:16384
    v_mfma_f32_16x16x32_bf16 v[100:103], v[148:151], a[212:215], v[100:103]
    s_waitcnt lgkmcnt(5)
    v_mfma_f32_16x16x32_bf16 v[76:79], v[152:155], a[208:211], v[76:79]
    ds_read_b128 v[144:147], v4 offset:2048
    ds_read_b128 v[148:151], v130 offset:3072
    v_mfma_f32_16x16x32_bf16 v[104:107], v[152:155], a[212:215], v[104:107]
    buffer_load_dwordx4 a[188:191], v131, s[8:11], s34 offen offset:0 sc1
    v_mfma_f32_16x16x32_bf16 v[80:83], v[156:159], a[208:211], v[80:83]
    s_barrier
    ds_read_b128 v[152:155], v4 offset:4096
    v_mfma_f32_16x16x32_bf16 v[108:111], v[156:159], a[212:215], v[108:111]
    s_add_u32 m0, s74, 98304
    s_waitcnt lgkmcnt(5)
    v_mfma_f32_16x16x32_bf16 v[84:87], v[136:139], a[208:211], v[84:87]
    ds_read_b128 v[156:159], v4 offset:5120
    ds_read_b128 v[208:211], v46 offset:1344
    v_mfma_f32_16x16x32_bf16 v[112:115], v[136:139], a[212:215], v[112:115]
    buffer_load_dwordx4 v32, s[4:7], m0 offen sc1 lds
    v_mfma_f32_16x16x32_bf16 v[88:91], v[140:143], a[208:211], v[88:91]
    ds_write_b128 v37, a[248:251] offset:20480
    v_mfma_f32_16x16x32_bf16 v[116:119], v[140:143], a[212:215], v[116:119]
    s_waitcnt lgkmcnt(4)
    v_mfma_f32_16x16x32_bf16 v[92:95], v[144:147], a[208:211], v[92:95]
    ds_read_b128 v[136:139], v4 offset:6144
    ds_read_b128 v[140:143], v4 offset:7168
    v_mfma_f32_16x16x32_bf16 v[120:123], v[144:147], a[212:215], v[120:123]
    buffer_load_dwordx4 a[192:195], v48, s[8:11], s34 offen offset:2048 sc1
    v_mfma_f32_16x16x32_bf16 v[96:99], v[148:151], a[208:211], v[96:99]
    ds_read_b128 v[144:147], v4 offset:8192
    ds_read_b128 v[184:187], v46 offset:896
    v_mfma_f32_16x16x32_bf16 v[124:127], v[148:151], a[212:215], v[124:127]
    s_cmp_ge_u32 s73, 3
    s_cselect_b32 s3, s61, 0
    v_add_u32 v32, s3, v32
    s_add_u32 m0, s74, 102400
L_pad5:
    s_cbranch_execz L_pad9
    s_waitcnt vmcnt(9) lgkmcnt(6)
    v_mfma_f32_16x16x32_bf16 v[72:75], v[152:155], a[216:219], v[72:75]
    ds_read_b128 v[148:151], v4 offset:9216
    ds_read_b128 v[212:215], v46 offset:1408
    v_mfma_f32_16x16x32_bf16 v[100:103], v[152:155], a[220:223], v[100:103]
    buffer_load_dwordx4 v32, s[4:7], m0 offen sc1 lds
    v_mfma_f32_16x16x32_bf16 v[76:79], v[156:159], a[216:219], v[76:79]
    ds_read_b128 v[152:155], v130 offset:10240
    v_mfma_f32_16x16x32_bf16 v[104:107], v[156:159], a[220:223], v[104:107]
    s_waitcnt lgkmcnt(5)
    v_mfma_f32_16x16x32_bf16 v[80:83], v[136:139], a[216:219], v[80:83]
    ds_read_b128 v[156:159], v4 offset:11264
    v_mfma_f32_16x16x32_bf16 v[108:111], v[136:139], a[220:223], v[108:111]
    buffer_load_dwordx4 a[196:199], v131, s[8:11], s34 offen offset:2048 sc1
    v_mfma_f32_16x16x32_bf16 v[84:87], v[140:143], a[216:219], v[84:87]
    ds_read_b128 v[136:139], v4 offset:12288
    v_mfma_f32_16x16x32_bf16 v[112:115], v[140:143], a[220:223], v[112:115]
    s_waitcnt lgkmcnt(4)
    v_mfma_f32_16x16x32_bf16 v[88:91], v[144:147], a[216:219], v[88:91]
    ds_read_b128 v[140:143], v4 offset:13312
    v_mfma_f32_16x16x32_bf16 v[116:119], v[144:147], a[220:223], v[116:119]
    buffer_load_dwordx4 a[200:203], v48, s[8:11], s35 offen offset:0 sc1
    v_mfma_f32_16x16x32_bf16 v[92:95], v[148:151], a[216:219], v[92:95]
    ds_read_b128 v[144:147], v4 offset:14336
    v_mfma_f32_16x16x32_bf16 v[120:123], v[148:151], a[220:223], v[120:123]
    s_cmp_le_u32 s73, 2
    s_cselect_b32 s3, s61, 0
    v_add_u32 v32, s3, v32
    s_add_u32 m0, s74, 106496
    s_waitcnt vmcnt(8) lgkmcnt(3)
    v_mfma_f32_16x16x32_bf16 v[96:99], v[152:155], a[216:219], v[96:99]
    ds_read_b128 v[148:151], v4 offset:15360
    v_mfma_f32_16x16x32_bf16 v[124:127], v[152:155], a[220:223], v[124:127]
    buffer_load_dwordx4 v32, s[4:7], m0 offen sc1 lds
    v_mfma_f32_16x16x32_bf16 v[72:75], v[156:159], a[224:227], v[72:75]
    ds_read_b128 v[152:155], v4 offset:16384
    v_mfma_f32_16x16x32_bf16 v[100:103], v[156:159], a[228:231], v[100:103]
    s_waitcnt lgkmcnt(3)
    v_mfma_f32_16x16x32_bf16 v[76:79], v[136:139], a[224:227], v[76:79]
    ds_read_b128 v[156:159], v130 offset:17408
    v_mfma_f32_16x16x32_bf16 v[104:107], v[136:139], a[228:231], v[104:107]
    buffer_load_dwordx4 a[204:207], v131, s[8:11], s35 offen offset:0 sc1
    v_mfma_f32_16x16x32_bf16 v[80:83], v[140:143], a[224:227], v[80:83]
    ds_read_b128 v[136:139], v4 offset:18432
    v_mfma_f32_16x16x32_bf16 v[108:111], v[140:143], a[228:231], v[108:111]
    s_waitcnt lgkmcnt(3)
    v_mfma_f32_16x16x32_bf16 v[84:87], v[144:147], a[224:227], v[84:87]
    ds_read_b128 v[140:143], v4 offset:19456
    v_mfma_f32_16x16x32_bf16 v[112:115], v[144:147], a[228:231], v[112:115]
    buffer_load_dwordx4 a[208:211], v48, s[8:11], s35 offen offset:2048 sc1
    v_mfma_f32_16x16x32_bf16 v[88:91], v[148:151], a[224:227], v[88:91]
    ds_read_b128 v[144:147], v4 offset:20480
    v_mfma_f32_16x16x32_bf16 v[116:119], v[148:151], a[228:231], v[116:119]
    s_add_u32 m0, s74, 110592
    s_waitcnt lgkmcnt(3)
    v_mfma_f32_16x16x32_bf16 v[92:95], v[152:155], a[224:227], v[92:95]
    ds_read_b128 v[148:151], v4 offset:21504
    v_mfma_f32_16x16x32_bf16 v[120:123], v[152:155], a[228:231], v[120:123]
    buffer_load_dwordx4 v32, s[4:7], m0 offen sc1 lds
    v_mfma_f32_16x16x32_bf16 v[96:99], v[156:159], a[224:227], v[96:99]
    ds_read_b128 v[152:155], v4 offset:22528
    v_mfma_f32_16x16x32_bf16 v[124:127], v[156:159], a[228:231], v[124:127]
    s_waitcnt vmcnt(9) lgkmcnt(3)
    v_mfma_f32_16x16x32_bf16 v[72:75], v[136:139], a[184:187], v[72:75]
    ds_read_b128 v[156:159], v4 offset:23552
    v_add_f32 v248, v248, v250
    v_mfma_f32_16x16x32_bf16 v[100:103], v[136:139], a[188:191], v[100:103]
    buffer_load_dwordx4 a[212:215], v131, s[8:11], s35 offen offset:2048 sc1
    v_mfma_f32_16x16x32_bf16 v[76:79], v[140:143], a[184:187], v[76:79]
    ds_read_b128 v[136:139], v130 offset:24576
    v_add_f32 v249, v249, v251
    v_mfma_f32_16x16x32_bf16 v[104:107], v[140:143], a[188:191], v[104:107]
    v_add_u32 v48, s57, v48
    s_waitcnt lgkmcnt(3)
    v_mfma_f32_16x16x32_bf16 v[80:83], v[144:147], a[184:187], v[80:83]
    ds_read_b128 v[140:143], v4 offset:25600
    v_mov_b32 v250, v248
    v_mfma_f32_16x16x32_bf16 v[108:111], v[144:147], a[188:191], v[108:111]
    buffer_load_dwordx4 a[216:219], v48, s[8:11], s36 offen offset:0 sc1
    v_mfma_f32_16x16x32_bf16 v[84:87], v[148:151], a[184:187], v[84:87]
    ds_read_b128 v[144:147], v4 offset:26624
    v_mov_b32 v251, v249
    v_mfma_f32_16x16x32_bf16 v[112:115], v[148:151], a[188:191], v[112:115]
    s_add_u32 m0, s74, 114688
    s_waitcnt lgkmcnt(3)
    v_mfma_f32_16x16x32_bf16 v[88:91], v[152:155], a[184:187], v[88:91]
    ds_read_b128 v[148:151], v4 offset:27648
    v_permlane32_swap_b32 v248, v250
    v_mfma_f32_16x16x32_bf16 v[116:119], v[152:155], a[188:191], v[116:119]
    buffer_load_dwordx4 v32, s[4:7], m0 offen sc1 lds
    v_mfma_f32_16x16x32_bf16 v[92:95], v[156:159], a[184:187], v[92:95]
    ds_read_b128 v[152:155], v2 offset:0
    v_permlane32_swap_b32 v249, v251
    v_mfma_f32_16x16x32_bf16 v[120:123], v[156:159], a[188:191], v[120:123]
    v_add_u32 v131, s57, v131
    s_waitcnt vmcnt(8) lgkmcnt(3)
    v_mfma_f32_16x16x32_bf16 v[96:99], v[136:139], a[184:187], v[96:99]
    ds_read_b128 v[156:159], v2 offset:1024
    v_add_f32 v248, v248, v250
    v_mfma_f32_16x16x32_bf16 v[124:127], v[136:139], a[188:191], v[124:127]
    buffer_load_dwordx4 a[220:223], v131, s[8:11], s36 offen offset:0 sc1
    v_mfma_f32_16x16x32_bf16 v[72:75], v[140:143], a[192:195], v[72:75]
    ds_read_b128 v[136:139], v2 offset:2048
    v_add_f32 v249, v249, v251
    v_mfma_f32_16x16x32_bf16 v[100:103], v[140:143], a[196:199], v[100:103]
    v_mov_b32 v250, v248
    s_waitcnt lgkmcnt(3)
    v_mfma_f32_16x16x32_bf16 v[76:79], v[144:147], a[192:195], v[76:79]
    ds_read_b128 v[140:143], v128 offset:3072
    v_mov_b32 v251, v249
    v_mfma_f32_16x16x32_bf16 v[104:107], v[144:147], a[196:199], v[104:107]
    buffer_load_dwordx4 a[224:227], v48, s[8:11], s36 offen offset:2048 sc1
    v_mfma_f32_16x16x32_bf16 v[80:83], v[148:151], a[192:195], v[80:83]
    s_barrier
    ds_read_b128 v[144:147], v2 offset:4096
    v_mfma_f32_16x16x32_bf16 v[108:111], v[148:151], a[196:199], v[108:111]
    v_permlane16_swap_b32 v248, v250
    s_waitcnt lgkmcnt(3)
    v_mfma_f32_16x16x32_bf16 v[84:87], v[152:155], a[192:195], v[84:87]
    ds_read_b128 v[148:151], v2 offset:5120
    v_permlane16_swap_b32 v249, v251
    v_mfma_f32_16x16x32_bf16 v[112:115], v[152:155], a[196:199], v[112:115]
    buffer_load_dwordx4 a[228:231], v131, s[8:11], s36 offen offset:2048 sc1
    v_mfma_f32_16x16x32_bf16 v[88:91], v[156:159], a[192:195], v[88:91]
    ds_read_b128 v[152:155], v2 offset:6144
    v_add_f32 v248, v248, v250
    v_mfma_f32_16x16x32_bf16 v[116:119], v[156:159], a[196:199], v[116:119]
    s_add_u32 m0, s74, 118784
    s_waitcnt lgkmcnt(3)
    v_mfma_f32_16x16x32_bf16 v[92:95], v[136:139], a[192:195], v[92:95]
    ds_read_b128 v[156:159], v2 offset:7168
    v_add_f32 v249, v249, v251
    v_mfma_f32_16x16x32_bf16 v[120:123], v[136:139], a[196:199], v[120:123]
    buffer_load_dwordx4 v32, s[4:7], m0 offen sc1 lds
    v_mfma_f32_16x16x32_bf16 v[96:99], v[140:143], a[192:195], v[96:99]
    ds_read_b128 v[136:139], v2 offset:8192
    v_mul_f32 v248, 0xbacccccd, v248
    v_mfma_f32_16x16x32_bf16 v[124:127], v[140:143], a[196:199], v[124:127]
    v_mul_f32 v250, v248, v248
    s_waitcnt vmcnt(9) lgkmcnt(3)
    v_mfma_f32_16x16x32_bf16 v[72:75], v[144:147], a[200:203], v[72:75]
    ds_read_b128 v[140:143], v2 offset:9216
    v_mul_f32 v249, 0x3acccccd, v249
    v_mfma_f32_16x16x32_bf16 v[100:103], v[144:147], a[204:207], v[100:103]
    buffer_load_dwordx4 a[184:187], v131, s[8:11], s37 offen offset:0 sc1
    v_mfma_f32_16x16x32_bf16 v[76:79], v[148:151], a[200:203], v[76:79]
    ds_read_b128 v[144:147], v128 offset:10240
    v_sub_f32 v250, v249, v250
    v_mfma_f32_16x16x32_bf16 v[104:107], v[148:151], a[204:207], v[104:107]
    v_max_f32 v250, 0, v250
    s_waitcnt lgkmcnt(3)
    v_mfma_f32_16x16x32_bf16 v[80:83], v[152:155], a[200:203], v[80:83]
    ds_read_b128 v[148:151], v2 offset:11264
    v_add_f32 v250, 0x3727c5ac, v250
    v_mfma_f32_16x16x32_bf16 v[108:111], v[152:155], a[204:207], v[108:111]
    buffer_load_dwordx4 a[188:191], v131, s[8:11], s37 offen offset:2048 sc1
    v_mfma_f32_16x16x32_bf16 v[84:87], v[156:159], a[200:203], v[84:87]
    ds_read_b128 v[152:155], v2 offset:12288
    v_rsq_f32 v250, v250
    v_mfma_f32_16x16x32_bf16 v[112:115], v[156:159], a[204:207], v[112:115]
    s_add_u32 m0, s74, 122880
    s_waitcnt lgkmcnt(3)
    v_mfma_f32_16x16x32_bf16 v[88:91], v[136:139], a[200:203], v[88:91]
    ds_read_b128 v[156:159], v2 offset:13312
    v_mul_f32 v249, v250, v248
    v_mfma_f32_16x16x32_bf16 v[116:119], v[136:139], a[204:207], v[116:119]
    buffer_load_dwordx4 v32, s[4:7], m0 offen sc1 lds
    v_mfma_f32_16x16x32_bf16 v[92:95], v[140:143], a[200:203], v[92:95]
    ds_read_b128 v[136:139], v2 offset:14336
    v_mov_b32 v248, v250
    v_mfma_f32_16x16x32_bf16 v[120:123], v[140:143], a[204:207], v[120:123]
    v_fma_f32 v216, v160, v249, v188
    s_waitcnt vmcnt(9) lgkmcnt(3)
    v_mfma_f32_16x16x32_bf16 v[96:99], v[144:147], a[200:203], v[96:99]
    ds_read_b128 v[140:143], v2 offset:15360
    v_fma_f32 v217, v161, v249, v189
    v_mfma_f32_16x16x32_bf16 v[124:127], v[144:147], a[204:207], v[124:127]
    buffer_load_dwordx4 a[192:195], v131, s[8:11], s38 offen offset:0 sc1
    v_mfma_f32_16x16x32_bf16 v[72:75], v[148:151], a[208:211], v[72:75]
    ds_read_b128 v[144:147], v2 offset:16384
    v_fma_f32 v218, v162, v249, v190
    v_mfma_f32_16x16x32_bf16 v[100:103], v[148:151], a[212:215], v[100:103]
    v_fma_f32 v219, v163, v249, v191
    s_waitcnt lgkmcnt(3)
    v_mfma_f32_16x16x32_bf16 v[76:79], v[152:155], a[208:211], v[76:79]
    ds_read_b128 v[148:151], v128 offset:17408
    v_fma_f32 v220, v164, v249, v192
    v_mfma_f32_16x16x32_bf16 v[104:107], v[152:155], a[212:215], v[104:107]
    buffer_load_dwordx4 a[196:199], v131, s[8:11], s38 offen offset:2048 sc1
    v_mfma_f32_16x16x32_bf16 v[80:83], v[156:159], a[208:211], v[80:83]
    ds_read_b128 v[152:155], v2 offset:18432
    v_fma_f32 v221, v165, v249, v193
    v_mfma_f32_16x16x32_bf16 v[108:111], v[156:159], a[212:215], v[108:111]
    s_add_u32 m0, s74, 126976
    s_waitcnt lgkmcnt(3)
    v_mfma_f32_16x16x32_bf16 v[84:87], v[136:139], a[208:211], v[84:87]
    ds_read_b128 v[156:159], v2 offset:19456
    v_fma_f32 v222, v166, v249, v194
    v_mfma_f32_16x16x32_bf16 v[112:115], v[136:139], a[212:215], v[112:115]
    buffer_load_dwordx4 v32, s[4:7], m0 offen sc1 lds
    v_mfma_f32_16x16x32_bf16 v[88:91], v[140:143], a[208:211], v[88:91]
    ds_read_b128 v[136:139], v2 offset:20480
    v_fma_f32 v223, v167, v249, v195
    v_mfma_f32_16x16x32_bf16 v[116:119], v[140:143], a[212:215], v[116:119]
    v_fma_f32 v224, v168, v249, v196
    s_waitcnt lgkmcnt(3)
    v_mfma_f32_16x16x32_bf16 v[92:95], v[144:147], a[208:211], v[92:95]
    ds_read_b128 v[140:143], v2 offset:21504
    v_fma_f32 v225, v169, v249, v197
    v_mfma_f32_16x16x32_bf16 v[120:123], v[144:147], a[212:215], v[120:123]
    buffer_load_dwordx4 a[200:203], v131, s[8:11], s39 offen offset:0 sc1
    v_mfma_f32_16x16x32_bf16 v[96:99], v[148:151], a[208:211], v[96:99]
    ds_read_b128 v[144:147], v2 offset:22528
    v_fma_f32 v226, v170, v249, v198
    v_mfma_f32_16x16x32_bf16 v[124:127], v[148:151], a[212:215], v[124:127]
    v_fma_f32 v227, v171, v249, v199
    s_waitcnt vmcnt(10) lgkmcnt(3)
    v_mfma_f32_16x16x32_bf16 v[72:75], v[152:155], a[216:219], v[72:75]
    ds_read_b128 v[148:151], v2 offset:23552
    v_fma_f32 v228, v172, v249, v200
    v_mfma_f32_16x16x32_bf16 v[100:103], v[152:155], a[220:223], v[100:103]
    buffer_load_dwordx4 a[204:207], v131, s[8:11], s39 offen offset:2048 sc1
    v_mfma_f32_16x16x32_bf16 v[76:79], v[156:159], a[216:219], v[76:79]
    ds_read_b128 v[152:155], v128 offset:24576
    v_fma_f32 v229, v173, v249, v201
    v_mfma_f32_16x16x32_bf16 v[104:107], v[156:159], a[220:223], v[104:107]
    s_add_u32 m0, s74, 131072
    s_waitcnt lgkmcnt(3)
    v_mfma_f32_16x16x32_bf16 v[80:83], v[136:139], a[216:219], v[80:83]
    ds_read_b128 v[156:159], v2 offset:25600
    v_fma_f32 v230, v174, v249, v202
    v_mfma_f32_16x16x32_bf16 v[108:111], v[136:139], a[220:223], v[108:111]
    buffer_load_dwordx4 v32, s[4:7], m0 offen sc1 lds
    v_mfma_f32_16x16x32_bf16 v[84:87], v[140:143], a[216:219], v[84:87]
    ds_read_b128 v[136:139], v2 offset:26624
    v_fma_f32 v231, v175, v249, v203
    v_mfma_f32_16x16x32_bf16 v[112:115], v[140:143], a[220:223], v[112:115]
    v_fma_f32 v232, v176, v249, v204
    s_waitcnt lgkmcnt(3)
    v_mfma_f32_16x16x32_bf16 v[88:91], v[144:147], a[216:219], v[88:91]
    ds_read_b128 v[140:143], v2 offset:27648
    v_fma_f32 v233, v177, v249, v205
    v_mfma_f32_16x16x32_bf16 v[116:119], v[144:147], a[220:223], v[116:119]
    buffer_load_dwordx4 a[208:211], v131, s[8:11], s40 offen offset:0 sc1
    v_mfma_f32_16x16x32_bf16 v[92:95], v[148:151], a[216:219], v[92:95]
    ds_read_b128 v[144:147], v2 offset:28672
    v_fma_f32 v234, v178, v249, v206
    v_mfma_f32_16x16x32_bf16 v[120:123], v[148:151], a[220:223], v[120:123]
    v_fma_f32 v235, v179, v249, v207
    s_waitcnt vmcnt(11) lgkmcnt(3)
    v_mfma_f32_16x16x32_bf16 v[96:99], v[152:155], a[216:219], v[96:99]
    ds_read_b128 v[148:151], v2 offset:29696
    v_fma_f32 v236, v180, v249, v208
    v_mfma_f32_16x16x32_bf16 v[124:127], v[152:155], a[220:223], v[124:127]
    buffer_load_dwordx4 a[212:215], v131, s[8:11], s40 offen offset:2048 sc1
    v_mfma_f32_16x16x32_bf16 v[72:75], v[156:159], a[224:227], v[72:75]
    ds_read_b128 v[152:155], v2 offset:30720
    v_fma_f32 v237, v181, v249, v209
    v_mfma_f32_16x16x32_bf16 v[100:103], v[156:159], a[228:231], v[100:103]
    v_fma_f32 v238, v182, v249, v210
    s_waitcnt lgkmcnt(3)
    v_mfma_f32_16x16x32_bf16 v[76:79], v[136:139], a[224:227], v[76:79]
    ds_read_b128 v[156:159], v128 offset:31744
    v_fma_f32 v239, v183, v249, v211
    v_mfma_f32_16x16x32_bf16 v[104:107], v[136:139], a[228:231], v[104:107]
    buffer_load_dwordx4 a[216:219], v48, s[8:11], s37 offen offset:0 sc1
    v_mfma_f32_16x16x32_bf16 v[80:83], v[140:143], a[224:227], v[80:83]
    ds_read_b128 a[232:235], v2 offset:32768
    ds_read_b128 a[236:239], v2 offset:33792
    v_mfma_f32_16x16x32_bf16 v[108:111], v[140:143], a[228:231], v[108:111]
    s_add_u32 m0, s74, 135168
    s_waitcnt lgkmcnt(4)
    v_mfma_f32_16x16x32_bf16 v[84:87], v[144:147], a[224:227], v[84:87]
    ds_read_b128 a[240:243], v2 offset:34816
    ds_read_b128 a[244:247], v2 offset:35840
    v_mfma_f32_16x16x32_bf16 v[112:115], v[144:147], a[228:231], v[112:115]
    buffer_load_dwordx4 v32, s[4:7], m0 offen sc1 lds
    v_mfma_f32_16x16x32_bf16 v[88:91], v[148:151], a[224:227], v[88:91]
    ds_read_b128 a[248:251], v2 offset:36864
    ds_read_b128 v[136:139], v2 offset:37888
    v_mfma_f32_16x16x32_bf16 v[116:119], v[148:151], a[228:231], v[116:119]
    v_fma_f32 v240, v184, v249, v212
    s_waitcnt lgkmcnt(6)
    v_mfma_f32_16x16x32_bf16 v[92:95], v[152:155], a[224:227], v[92:95]
    ds_read_b128 v[140:143], v128 offset:38912
    ds_read_b128 v[144:147], v2 offset:39936
    v_mfma_f32_16x16x32_bf16 v[120:123], v[152:155], a[228:231], v[120:123]
    buffer_load_dwordx4 a[220:223], v48, s[8:11], s37 offen offset:2048 sc1
    v_mfma_f32_16x16x32_bf16 v[96:99], v[156:159], a[224:227], v[96:99]
    ds_read_b128 v[148:151], v2 offset:40960
    ds_read_b128 v[152:155], v2 offset:41984
    v_mfma_f32_16x16x32_bf16 v[124:127], v[156:159], a[228:231], v[124:127]
    v_fma_f32 v241, v185, v249, v213
    s_waitcnt vmcnt(13) lgkmcnt(5)
    v_mfma_f32_16x16x32_bf16 v[100:103], a[232:235], a[184:187], v[100:103]
    ds_read_b128 v[156:159], v2 offset:43008
    v_fma_f32 v242, v186, v249, v214
    v_mfma_f32_16x16x32_bf16 v[104:107], a[236:239], a[184:187], v[104:107]
    ds_read_b128 a[232:235], v2 offset:44032
    v_fma_f32 v243, v187, v249, v215
    v_mfma_f32_16x16x32_bf16 v[108:111], a[240:243], a[184:187], v[108:111]
    ds_read_b128 a[236:239], v2 offset:45056
    v_add_f32 v244, v244, v246
    v_mfma_f32_16x16x32_bf16 v[112:115], a[244:247], a[184:187], v[112:115]
    ds_read_b128 a[240:243], v128 offset:46080
    v_add_f32 v245, v245, v247
    v_mfma_f32_16x16x32_bf16 v[116:119], a[248:251], a[184:187], v[116:119]
    s_barrier
    ds_read_b128 a[244:247], v2 offset:47104
    s_add_u32 m0, s74, 139264
    s_waitcnt vmcnt(12) lgkmcnt(5)
    v_mfma_f32_16x16x32_bf16 v[120:123], v[136:139], a[184:187], v[120:123]
    ds_read_b128 a[248:251], v2 offset:48128
    buffer_load_dwordx4 v32, s[4:7], m0 offen sc1 lds
    v_mfma_f32_16x16x32_bf16 v[124:127], v[140:143], a[184:187], v[124:127]
    ds_read_b128 v[136:139], v2 offset:49152
    v_mov_b32 v246, v244
    v_mfma_f32_16x16x32_bf16 v[100:103], v[144:147], a[188:191], v[100:103]
    ds_read_b128 v[140:143], v2 offset:50176
    v_mov_b32 v247, v245
    v_mfma_f32_16x16x32_bf16 v[104:107], v[148:151], a[188:191], v[104:107]
    ds_read_b128 v[144:147], v2 offset:51200
    buffer_load_dwordx4 a[224:227], v48, s[8:11], s38 offen offset:0 sc1
    v_mfma_f32_16x16x32_bf16 v[108:111], v[152:155], a[188:191], v[108:111]
    ds_read_b128 v[148:151], v2 offset:52224
    s_waitcnt vmcnt(12) lgkmcnt(5)
    v_mfma_f32_16x16x32_bf16 v[112:115], v[156:159], a[188:191], v[112:115]
    ds_read_b128 v[152:155], v128 offset:53248
    v_permlane32_swap_b32 v244, v246
    v_mfma_f32_16x16x32_bf16 v[116:119], a[232:235], a[188:191], v[116:119]
    ds_read_b128 v[156:159], v2 offset:54272
    v_permlane32_swap_b32 v245, v247
    v_mfma_f32_16x16x32_bf16 v[120:123], a[236:239], a[188:191], v[120:123]
    ds_read_b128 a[232:235], v2 offset:55296
    buffer_load_dwordx4 a[228:231], v48, s[8:11], s38 offen offset:2048 sc1
    v_mfma_f32_16x16x32_bf16 v[124:127], a[240:243], a[188:191], v[124:127]
    ds_read_b128 a[236:239], v2 offset:56320
    v_add_f32 v244, v244, v246
    v_mfma_f32_16x16x32_bf16 v[100:103], a[244:247], a[192:195], v[100:103]
    ds_read_b128 a[240:243], v2 offset:57344
    s_waitcnt lgkmcnt(5)
    v_mfma_f32_16x16x32_bf16 v[104:107], a[248:251], a[192:195], v[104:107]
    ds_read_b128 a[244:247], v2 offset:58368
    s_add_u32 m0, s74, 143360
    v_mfma_f32_16x16x32_bf16 v[108:111], v[136:139], a[192:195], v[108:111]
    ds_read_b128 a[248:251], v2 offset:59392
    buffer_load_dwordx4 v32, s[4:7], m0 offen sc1 lds
    v_mfma_f32_16x16x32_bf16 v[112:115], v[140:143], a[192:195], v[112:115]
    ds_read_b128 v[136:139], v128 offset:60416
    v_add_f32 v245, v245, v247
    v_mfma_f32_16x16x32_bf16 v[116:119], v[144:147], a[192:195], v[116:119]
    ds_read_b128 v[140:143], v2 offset:61440
    v_mov_b32 v246, v244
    v_mfma_f32_16x16x32_bf16 v[120:123], v[148:151], a[192:195], v[120:123]
    ds_read_b128 v[144:147], v2 offset:62464
    s_waitcnt vmcnt(13) lgkmcnt(5)
    v_mfma_f32_16x16x32_bf16 v[124:127], v[152:155], a[192:195], v[124:127]
    ds_read_b128 v[148:151], v2 offset:63488
    buffer_load_dwordx4 a[184:187], v48, s[8:11], s39 offen offset:0 sc1
    v_mfma_f32_16x16x32_bf16 v[100:103], v[156:159], a[196:199], v[100:103]
    ds_read_b128 v[152:155], v2 offset:64512
    v_mov_b32 v247, v245
    v_mfma_f32_16x16x32_bf16 v[104:107], a[232:235], a[196:199], v[104:107]
    ds_read_b128 v[156:159], v3 offset:0
    v_permlane16_swap_b32 v244, v246
    v_mfma_f32_16x16x32_bf16 v[108:111], a[236:239], a[196:199], v[108:111]
    ds_read_b128 a[232:235], v3 offset:1024
    v_permlane16_swap_b32 v245, v247
    v_mfma_f32_16x16x32_bf16 v[112:115], a[240:243], a[196:199], v[112:115]
    ds_read_b128 a[236:239], v129 offset:2048
    s_waitcnt vmcnt(12) lgkmcnt(5)
    v_mfma_f32_16x16x32_bf16 v[116:119], a[244:247], a[196:199], v[116:119]
    ds_read_b128 a[240:243], v3 offset:3072
    buffer_load_dwordx4 a[188:191], v48, s[8:11], s39 offen offset:2048 sc1
    v_mfma_f32_16x16x32_bf16 v[120:123], a[248:251], a[196:199], v[120:123]
    ds_read_b128 a[244:247], v3 offset:4096
    v_add_f32 v244, v244, v246
    v_mfma_f32_16x16x32_bf16 v[124:127], v[136:139], a[196:199], v[124:127]
    ds_read_b128 a[248:251], v3 offset:5120
    s_add_u32 m0, s74, 147456
    v_mfma_f32_16x16x32_bf16 v[100:103], v[140:143], a[200:203], v[100:103]
    ds_read_b128 v[136:139], v3 offset:6144
    buffer_load_dwordx4 v32, s[4:7], m0 offen sc1 lds
    v_mfma_f32_16x16x32_bf16 v[104:107], v[144:147], a[200:203], v[104:107]
    ds_read_b128 v[140:143], v3 offset:7168
    s_waitcnt lgkmcnt(5)
    v_mfma_f32_16x16x32_bf16 v[108:111], v[148:151], a[200:203], v[108:111]
    ds_read_b128 v[144:147], v3 offset:8192
    v_add_f32 v245, v245, v247
    v_mfma_f32_16x16x32_bf16 v[112:115], v[152:155], a[200:203], v[112:115]
    ds_read_b128 v[148:151], v129 offset:9216
    v_mul_f32 v244, 0xbacccccd, v244
    v_mfma_f32_16x16x32_bf16 v[116:119], v[156:159], a[200:203], v[116:119]
    ds_read_b128 v[152:155], v3 offset:10240
    buffer_load_dwordx4 a[192:195], v48, s[8:11], s40 offen offset:0 sc1
    v_mfma_f32_16x16x32_bf16 v[120:123], a[232:235], a[200:203], v[120:123]
    ds_read_b128 v[156:159], v3 offset:11264
    v_mul_f32 v246, v244, v244
    v_mfma_f32_16x16x32_bf16 v[124:127], a[236:239], a[200:203], v[124:127]
    ds_read_b128 a[232:235], v3 offset:12288
    s_waitcnt vmcnt(14) lgkmcnt(5)
    v_mfma_f32_16x16x32_bf16 v[100:103], a[240:243], a[204:207], v[100:103]
    ds_read_b128 a[236:239], v3 offset:13312
    v_mul_f32 v245, 0x3acccccd, v245
    v_mfma_f32_16x16x32_bf16 v[104:107], a[244:247], a[204:207], v[104:107]
    ds_read_b128 a[240:243], v3 offset:14336
    buffer_load_dwordx4 a[196:199], v48, s[8:11], s40 offen offset:2048 sc1
    v_mfma_f32_16x16x32_bf16 v[108:111], a[248:251], a[204:207], v[108:111]
    ds_read_b128 a[244:247], v3 offset:15360
    v_sub_f32 v246, v245, v246
    v_mfma_f32_16x16x32_bf16 v[112:115], v[136:139], a[204:207], v[112:115]
    ds_read_b128 a[248:251], v129 offset:16384
    v_max_f32 v246, 0, v246
    v_mfma_f32_16x16x32_bf16 v[116:119], v[140:143], a[204:207], v[116:119]
    ds_read_b128 v[136:139], v3 offset:17408
    s_add_u32 m0, s74, 151552
    s_waitcnt vmcnt(13) lgkmcnt(5)
    v_mfma_f32_16x16x32_bf16 v[120:123], v[144:147], a[204:207], v[120:123]
    ds_read_b128 v[140:143], v3 offset:18432
    buffer_load_dwordx4 v32, s[4:7], m0 offen sc1 lds
    v_mfma_f32_16x16x32_bf16 v[124:127], v[148:151], a[204:207], v[124:127]
    ds_read_b128 v[144:147], v3 offset:19456
    v_add_f32 v246, 0x3727c5ac, v246
    v_mfma_f32_16x16x32_bf16 v[100:103], v[152:155], a[208:211], v[100:103]
    ds_read_b128 v[148:151], v3 offset:20480
    v_rsq_f32 v246, v246
    v_mfma_f32_16x16x32_bf16 v[104:107], v[156:159], a[208:211], v[104:107]
    ds_read_b128 v[152:155], v3 offset:21504
    v_mul_f32 v245, v246, v244
    v_mfma_f32_16x16x32_bf16 v[108:111], a[232:235], a[208:211], v[108:111]
    ds_read_b128 v[156:159], v3 offset:22528
    s_waitcnt vmcnt(13) lgkmcnt(5)
    v_mfma_f32_16x16x32_bf16 v[112:115], a[236:239], a[208:211], v[112:115]
    ds_read_b128 a[232:235], v129 offset:23552
    v_mov_b32 v244, v246
    v_mfma_f32_16x16x32_bf16 v[116:119], a[240:243], a[208:211], v[116:119]
    ds_read_b128 a[236:239], v2 offset:32768
    v_fmac_f32 v188, v160, v245
    v_mfma_f32_16x16x32_bf16 v[120:123], a[244:247], a[208:211], v[120:123]
    ds_read_b128 a[240:243], v2 offset:33792
    v_fmac_f32 v189, v161, v245
    v_mfma_f32_16x16x32_bf16 v[124:127], a[248:251], a[208:211], v[124:127]
    ds_read_b128 a[244:247], v2 offset:34816
    v_fmac_f32 v190, v162, v245
    v_mfma_f32_16x16x32_bf16 v[100:103], v[136:139], a[212:215], v[100:103]
    ds_read_b128 a[248:251], v2 offset:35840
    s_waitcnt lgkmcnt(5)
    v_mfma_f32_16x16x32_bf16 v[104:107], v[140:143], a[212:215], v[104:107]
    ds_read_b128 v[136:139], v2 offset:36864
    v_fmac_f32 v191, v163, v245
    v_mfma_f32_16x16x32_bf16 v[108:111], v[144:147], a[212:215], v[108:111]
    ds_read_b128 v[140:143], v2 offset:37888
    s_add_u32 m0, s74, 155648
    v_mfma_f32_16x16x32_bf16 v[112:115], v[148:151], a[212:215], v[112:115]
    ds_read_b128 v[144:147], v128 offset:38912
    buffer_load_dwordx4 v32, s[4:7], m0 offen sc1 lds
    v_mfma_f32_16x16x32_bf16 v[116:119], v[152:155], a[212:215], v[116:119]
    ds_read_b128 v[148:151], v2 offset:39936
    v_fmac_f32 v192, v164, v245
    v_mfma_f32_16x16x32_bf16 v[120:123], v[156:159], a[212:215], v[120:123]
    ds_read_b128 v[152:155], v2 offset:40960
    s_waitcnt vmcnt(13) lgkmcnt(5)
    v_mfma_f32_16x16x32_bf16 v[124:127], a[232:235], a[212:215], v[124:127]
    ds_read_b128 v[156:159], v2 offset:41984
    v_fmac_f32 v193, v165, v245
    s_cmp_eq_u32 s76, 0
    s_cbranch_scc0 L_sec_38_s
    v_pk_fma_f32 v[100:101], v[100:101], v[248:249], v[216:217] op_sel_hi:[1,0,1]
    v_max_f32 v100, 0, v100
    v_max_f32 v101, 0, v101
    v_pk_mul_f32 v[100:101], v[100:101], v[100:101]
    v_cvt_pk_bf16_f32 v216, v100, v101
    v_pk_fma_f32 v[102:103], v[102:103], v[248:249], v[218:219] op_sel_hi:[1,0,1]
    v_max_f32 v102, 0, v102
    v_max_f32 v103, 0, v103
    v_pk_mul_f32 v[102:103], v[102:103], v[102:103]
    v_cvt_pk_bf16_f32 v217, v102, v103
    v_pk_fma_f32 v[104:105], v[104:105], v[248:249], v[220:221] op_sel_hi:[1,0,1]
    v_max_f32 v104, 0, v104
    v_max_f32 v105, 0, v105
    v_pk_mul_f32 v[104:105], v[104:105], v[104:105]
    v_cvt_pk_bf16_f32 v218, v104, v105
    v_pk_fma_f32 v[106:107], v[106:107], v[248:249], v[222:223] op_sel_hi:[1,0,1]
    v_max_f32 v106, 0, v106
    v_max_f32 v107, 0, v107
    v_pk_mul_f32 v[106:107], v[106:107], v[106:107]
    v_cvt_pk_bf16_f32 v219, v106, v107
    buffer_store_dwordx4 v[216:219], v23, s[48:51], s27 offen offset:0
    v_pk_fma_f32 v[108:109], v[108:109], v[248:249], v[224:225] op_sel_hi:[1,0,1]
    v_max_f32 v108, 0, v108
    v_max_f32 v109, 0, v109
    v_pk_mul_f32 v[108:109], v[108:109], v[108:109]
    v_cvt_pk_bf16_f32 v220, v108, v109
    v_pk_fma_f32 v[110:111], v[110:111], v[248:249], v[226:227] op_sel_hi:[1,0,1]
    v_max_f32 v110, 0, v110
    v_max_f32 v111, 0, v111
    v_pk_mul_f32 v[110:111], v[110:111], v[110:111]
    v_cvt_pk_bf16_f32 v221, v110, v111
    v_pk_fma_f32 v[112:113], v[112:113], v[248:249], v[228:229] op_sel_hi:[1,0,1]
    v_max_f32 v112, 0, v112
    v_max_f32 v113, 0, v113
    v_pk_mul_f32 v[112:113], v[112:113], v[112:113]
    v_cvt_pk_bf16_f32 v222, v112, v113
    v_pk_fma_f32 v[114:115], v[114:115], v[248:249], v[230:231] op_sel_hi:[1,0,1]
    v_max_f32 v114, 0, v114
    v_max_f32 v115, 0, v115
    v_pk_mul_f32 v[114:115], v[114:115], v[114:115]
    v_cvt_pk_bf16_f32 v223, v114, v115
    buffer_store_dwordx4 v[220:223], v23, s[48:51], s27 offen offset:1024
    v_pk_fma_f32 v[116:117], v[116:117], v[248:249], v[232:233] op_sel_hi:[1,0,1]
    v_max_f32 v116, 0, v116
    v_max_f32 v117, 0, v117
    v_pk_mul_f32 v[116:117], v[116:117], v[116:117]
    v_cvt_pk_bf16_f32 v224, v116, v117
    v_pk_fma_f32 v[118:119], v[118:119], v[248:249], v[234:235] op_sel_hi:[1,0,1]
    v_max_f32 v118, 0, v118
    v_max_f32 v119, 0, v119
    v_pk_mul_f32 v[118:119], v[118:119], v[118:119]
    v_cvt_pk_bf16_f32 v225, v118, v119
    v_pk_fma_f32 v[120:121], v[120:121], v[248:249], v[236:237] op_sel_hi:[1,0,1]
    v_max_f32 v120, 0, v120
    v_max_f32 v121, 0, v121
    v_pk_mul_f32 v[120:121], v[120:121], v[120:121]
    v_cvt_pk_bf16_f32 v226, v120, v121
    v_pk_fma_f32 v[122:123], v[122:123], v[248:249], v[238:239] op_sel_hi:[1,0,1]
    v_max_f32 v122, 0, v122
    v_max_f32 v123, 0, v123
    v_pk_mul_f32 v[122:123], v[122:123], v[122:123]
    v_cvt_pk_bf16_f32 v227, v122, v123
    buffer_store_dwordx4 v[224:227], v23, s[48:51], s27 offen offset:2048
    v_pk_fma_f32 v[124:125], v[124:125], v[248:249], v[240:241] op_sel_hi:[1,0,1]
    v_max_f32 v124, 0, v124
    v_max_f32 v125, 0, v125
    v_pk_mul_f32 v[124:125], v[124:125], v[124:125]
    v_cvt_pk_bf16_f32 v228, v124, v125
    v_pk_fma_f32 v[126:127], v[126:127], v[248:249], v[242:243] op_sel_hi:[1,0,1]
    v_max_f32 v126, 0, v126
    v_max_f32 v127, 0, v127
    v_pk_mul_f32 v[126:127], v[126:127], v[126:127]
    v_cvt_pk_bf16_f32 v229, v126, v127
    buffer_store_dwordx2 v[228:229], v24, s[48:51], s27 offen
L_sec_38_e:
    v_mfma_f32_16x16x32_bf16 v[72:75], a[236:239], a[216:219], v[72:75]
    ds_read_b128 a[232:235], v2 offset:43008
    v_fmac_f32 v194, v166, v245
    v_mfma_f32_16x16x32_bf16 v[76:79], a[240:243], a[216:219], v[76:79]
    ds_read_b128 a[236:239], v2 offset:44032
    v_fmac_f32 v195, v167, v245
    v_mfma_f32_16x16x32_bf16 v[80:83], a[244:247], a[216:219], v[80:83]
    ds_read_b128 a[240:243], v2 offset:45056
    v_fmac_f32 v196, v168, v245
    v_mfma_f32_16x16x32_bf16 v[84:87], a[248:251], a[216:219], v[84:87]
    ds_read_b128 a[244:247], v128 offset:46080
    v_add_u32 v32, 0x27000, v32
    s_add_u32 m0, s74, 0
    s_waitcnt vmcnt(15) lgkmcnt(5)
    v_mfma_f32_16x16x32_bf16 v[88:91], v[136:139], a[216:219], v[88:91]
    ds_read_b128 a[248:251], v2 offset:47104
    buffer_load_dwordx4 v32, s[4:7], m0 offen sc1 lds
    v_mfma_f32_16x16x32_bf16 v[92:95], v[140:143], a[216:219], v[92:95]
    ds_read_b128 v[136:139], v2 offset:48128
    v_fmac_f32 v197, v169, v245
    v_mfma_f32_16x16x32_bf16 v[96:99], v[144:147], a[216:219], v[96:99]
    ds_read_b128 v[140:143], v2 offset:49152
    v_fmac_f32 v198, v170, v245
    v_mfma_f32_16x16x32_bf16 v[72:75], v[148:151], a[220:223], v[72:75]
    ds_read_b128 v[144:147], v2 offset:50176
    v_fmac_f32 v199, v171, v245
    v_mfma_f32_16x16x32_bf16 v[76:79], v[152:155], a[220:223], v[76:79]
    ds_read_b128 v[148:151], v2 offset:51200
    s_waitcnt lgkmcnt(5)
    v_mfma_f32_16x16x32_bf16 v[80:83], v[156:159], a[220:223], v[80:83]
    ds_read_b128 v[152:155], v2 offset:52224
    v_fmac_f32 v200, v172, v245
    v_mfma_f32_16x16x32_bf16 v[84:87], a[232:235], a[220:223], v[84:87]
    ds_read_b128 v[156:159], v128 offset:53248
    v_fmac_f32 v201, v173, v245
    v_mfma_f32_16x16x32_bf16 v[88:91], a[236:239], a[220:223], v[88:91]
    s_barrier
    ds_read_b128 a[232:235], v2 offset:54272
L_pad6:
    s_cbranch_execz L_pad10
    s_cmp_ge_u32 s73, 3
    s_cselect_b32 s3, s64, 0
    v_add_u32 v32, s3, v32
    s_add_u32 m0, s74, 4096
    v_mfma_f32_16x16x32_bf16 v[92:95], a[240:243], a[220:223], v[92:95]
    ds_read_b128 a[236:239], v2 offset:55296
    buffer_load_dwordx4 v32, s[4:7], m0 offen sc1 lds
    v_mfma_f32_16x16x32_bf16 v[96:99], a[244:247], a[220:223], v[96:99]
    ds_read_b128 a[240:243], v2 offset:56320
    s_waitcnt vmcnt(15) lgkmcnt(5)
    v_mfma_f32_16x16x32_bf16 v[72:75], a[248:251], a[224:227], v[72:75]
    ds_read_b128 a[244:247], v2 offset:57344
    v_fmac_f32 v202, v174, v245
    v_mfma_f32_16x16x32_bf16 v[76:79], v[136:139], a[224:227], v[76:79]
    ds_read_b128 a[248:251], v2 offset:58368
    s_cmp_le_u32 s73, 2
    s_cselect_b32 s3, s64, 0
    v_add_u32 v32, s3, v32
    s_add_u32 m0, s74, 8192
    v_mfma_f32_16x16x32_bf16 v[80:83], v[140:143], a[224:227], v[80:83]
    ds_read_b128 v[136:139], v2 offset:59392
    buffer_load_dwordx4 v32, s[4:7], m0 offen sc1 lds
    v_mfma_f32_16x16x32_bf16 v[84:87], v[144:147], a[224:227], v[84:87]
    ds_read_b128 v[140:143], v128 offset:60416
    v_fmac_f32 v203, v175, v245
    v_mfma_f32_16x16x32_bf16 v[88:91], v[148:151], a[224:227], v[88:91]
    ds_read_b128 v[144:147], v2 offset:61440
    s_waitcnt vmcnt(15) lgkmcnt(5)
    v_mfma_f32_16x16x32_bf16 v[92:95], v[152:155], a[224:227], v[92:95]
    ds_read_b128 v[148:151], v2 offset:62464
    s_add_u32 m0, s74, 12288
    v_mfma_f32_16x16x32_bf16 v[96:99], v[156:159], a[224:227], v[96:99]
    ds_read_b128 v[152:155], v2 offset:63488
    buffer_load_dwordx4 v32, s[4:7], m0 offen sc1 lds
    v_mfma_f32_16x16x32_bf16 v[72:75], a[232:235], a[228:231], v[72:75]
    ds_read_b128 v[156:159], v2 offset:64512
    v_fmac_f32 v204, v176, v245
    v_mfma_f32_16x16x32_bf16 v[76:79], a[236:239], a[228:231], v[76:79]
    ds_read_b128 a[232:235], v3 offset:0
    v_fmac_f32 v205, v177, v245
    v_mfma_f32_16x16x32_bf16 v[80:83], a[240:243], a[228:231], v[80:83]
    ds_read_b128 a[236:239], v3 offset:1024
    s_add_u32 m0, s74, 16384
    s_waitcnt vmcnt(14) lgkmcnt(5)
    v_mfma_f32_16x16x32_bf16 v[84:87], a[244:247], a[228:231], v[84:87]
    ds_read_b128 a[240:243], v129 offset:2048
    buffer_load_dwordx4 v32, s[4:7], m0 offen sc1 lds
    v_mfma_f32_16x16x32_bf16 v[88:91], a[248:251], a[228:231], v[88:91]
    ds_read_b128 a[244:247], v3 offset:3072
    v_fmac_f32 v206, v178, v245
    v_mfma_f32_16x16x32_bf16 v[92:95], v[136:139], a[228:231], v[92:95]
    ds_read_b128 a[248:251], v3 offset:4096
    v_fmac_f32 v207, v179, v245
    v_mfma_f32_16x16x32_bf16 v[96:99], v[140:143], a[228:231], v[96:99]
    ds_read_b128 v[136:139], v3 offset:5120
    v_fmac_f32 v208, v180, v245
    s_waitcnt vmcnt(5)
    s_mov_b64 exec, 1
    s_cmp_eq_u32 s76, 0
    s_cbranch_scc0 L_st_39_s
    buffer_store_dword v28, off, s[48:51], s85 offset:192
L_st_39_e:
    s_mov_b64 exec, -1
    v_mfma_f32_16x16x32_bf16 v[72:75], v[144:147], a[184:187], v[72:75]
    ds_read_b128 v[140:143], v3 offset:6144
    s_add_u32 m0, s74, 20480
    s_waitcnt lgkmcnt(5)
    v_mfma_f32_16x16x32_bf16 v[76:79], v[148:151], a[184:187], v[76:79]
    ds_read_b128 v[144:147], v3 offset:7168
    buffer_load_dwordx4 v32, s[4:7], m0 offen sc1 lds
    v_mfma_f32_16x16x32_bf16 v[80:83], v[152:155], a[184:187], v[80:83]
    ds_read_b128 v[148:151], v3 offset:8192
    v_fmac_f32 v209, v181, v245
    v_mfma_f32_16x16x32_bf16 v[84:87], v[156:159], a[184:187], v[84:87]
    ds_read_b128 v[152:155], v129 offset:9216
    s_add_u32 m0, s74, 24576
    v_mfma_f32_16x16x32_bf16 v[88:91], a[232:235], a[184:187], v[88:91]
    ds_read_b128 v[156:159], v3 offset:10240
    buffer_load_dwordx4 v32, s[4:7], m0 offen sc1 lds
    v_mfma_f32_16x16x32_bf16 v[92:95], a[236:239], a[184:187], v[92:95]
    ds_read_b128 a[232:235], v3 offset:11264
    s_waitcnt lgkmcnt(5)
    v_mfma_f32_16x16x32_bf16 v[96:99], a[240:243], a[184:187], v[96:99]
    ds_read_b128 a[236:239], v3 offset:12288
    v_fmac_f32 v210, v182, v245
    v_mfma_f32_16x16x32_bf16 v[72:75], a[244:247], a[188:191], v[72:75]
    ds_read_b128 a[240:243], v3 offset:13312
    s_add_u32 m0, s74, 28672
    v_mfma_f32_16x16x32_bf16 v[76:79], a[248:251], a[188:191], v[76:79]
    ds_read_b128 a[244:247], v3 offset:14336
    buffer_load_dwordx4 v32, s[4:7], m0 offen sc1 lds
    v_mfma_f32_16x16x32_bf16 v[80:83], v[136:139], a[188:191], v[80:83]
    ds_read_b128 a[248:251], v3 offset:15360
    v_fmac_f32 v211, v183, v245
    v_mfma_f32_16x16x32_bf16 v[84:87], v[140:143], a[188:191], v[84:87]
    ds_read_b128 v[136:139], v129 offset:16384
    s_waitcnt lgkmcnt(5)
    v_mfma_f32_16x16x32_bf16 v[88:91], v[144:147], a[188:191], v[88:91]
    s_barrier
    ds_read_b128 v[140:143], v3 offset:17408
    s_add_u32 m0, s74, 32768
    v_mfma_f32_16x16x32_bf16 v[92:95], v[148:151], a[188:191], v[92:95]
    ds_read_b128 v[144:147], v3 offset:18432
    buffer_load_dwordx4 v32, s[4:7], m0 offen sc1 lds
    v_mfma_f32_16x16x32_bf16 v[96:99], v[152:155], a[188:191], v[96:99]
    ds_read_b128 v[148:151], v3 offset:19456
    v_fmac_f32 v212, v184, v245
    v_mfma_f32_16x16x32_bf16 v[72:75], v[156:159], a[192:195], v[72:75]
    ds_read_b128 v[152:155], v3 offset:20480
    v_fmac_f32 v213, v185, v245
    v_mfma_f32_16x16x32_bf16 v[76:79], a[232:235], a[192:195], v[76:79]
    ds_read_b128 v[156:159], v3 offset:21504
    s_add_u32 m0, s74, 36864
    s_waitcnt lgkmcnt(5)
    v_mfma_f32_16x16x32_bf16 v[80:83], a[236:239], a[192:195], v[80:83]
    ds_read_b128 a[232:235], v3 offset:22528
    buffer_load_dwordx4 v32, s[4:7], m0 offen sc1 lds
    v_mfma_f32_16x16x32_bf16 v[84:87], a[240:243], a[192:195], v[84:87]
    ds_read_b128 a[236:239], v129 offset:23552
    v_fmac_f32 v214, v186, v245
    v_mfma_f32_16x16x32_bf16 v[88:91], a[244:247], a[192:195], v[88:91]
    v_fmac_f32 v215, v187, v245
    v_mfma_f32_16x16x32_bf16 v[92:95], a[248:251], a[192:195], v[92:95]
    v_mfma_f32_16x16x32_bf16 v[96:99], v[136:139], a[192:195], v[96:99]
    s_add_u32 m0, s74, 40960
    s_waitcnt lgkmcnt(2)
    v_mfma_f32_16x16x32_bf16 v[72:75], v[140:143], a[196:199], v[72:75]
    buffer_load_dwordx4 v32, s[4:7], m0 offen sc1 lds
    v_mfma_f32_16x16x32_bf16 v[76:79], v[144:147], a[196:199], v[76:79]
    v_mfma_f32_16x16x32_bf16 v[80:83], v[148:151], a[196:199], v[80:83]
    s_add_u32 m0, s74, 45056
    v_mfma_f32_16x16x32_bf16 v[84:87], v[152:155], a[196:199], v[84:87]
    buffer_load_dwordx4 v32, s[4:7], m0 offen sc1 lds
    v_mfma_f32_16x16x32_bf16 v[88:91], v[156:159], a[196:199], v[88:91]
    s_waitcnt lgkmcnt(0)
    v_mfma_f32_16x16x32_bf16 v[92:95], a[232:235], a[196:199], v[92:95]
    v_mfma_f32_16x16x32_bf16 v[96:99], a[236:239], a[196:199], v[96:99]
    ds_read_b128 v[136:139], v46 offset:1536
    ds_read_b128 v[140:143], v46 offset:1600
    ds_read_b128 v[144:147], v46 offset:1664
    ds_read_b128 v[148:151], v46 offset:1728
    ds_read_b128 v[152:155], v46 offset:1792
    buffer_load_dword v252, v255, s[48:51], s82 offen offset:192 sc1
    s_cmp_eq_u32 s76, 0
    s_cbranch_scc0 L_sec_41_s
    v_pk_fma_f32 v[72:73], v[72:73], v[244:245], v[188:189] op_sel_hi:[1,0,1]
    s_add_u32 m0, s74, 49152
    v_max_f32 v72, 0, v72
    buffer_load_dwordx4 v32, s[4:7], m0 offen sc1 lds
    v_max_f32 v73, 0, v73
    v_pk_mul_f32 v[72:73], v[72:73], v[72:73]
    v_cvt_pk_bf16_f32 v156, v72, v73
    v_pk_fma_f32 v[74:75], v[74:75], v[244:245], v[190:191] op_sel_hi:[1,0,1]
    v_max_f32 v74, 0, v74
    v_max_f32 v75, 0, v75
    v_pk_mul_f32 v[74:75], v[74:75], v[74:75]
    v_cvt_pk_bf16_f32 v157, v74, v75
    v_pk_fma_f32 v[76:77], v[76:77], v[244:245], v[192:193] op_sel_hi:[1,0,1]
    v_max_f32 v76, 0, v76
    v_max_f32 v77, 0, v77
    v_pk_mul_f32 v[76:77], v[76:77], v[76:77]
    v_cvt_pk_bf16_f32 v158, v76, v77
    v_pk_fma_f32 v[78:79], v[78:79], v[244:245], v[194:195] op_sel_hi:[1,0,1]
    v_max_f32 v78, 0, v78
    v_max_f32 v79, 0, v79
    v_pk_mul_f32 v[78:79], v[78:79], v[78:79]
    v_cvt_pk_bf16_f32 v159, v78, v79
    buffer_store_dwordx4 v[156:159], v23, s[48:51], s26 offen offset:0
    v_pk_fma_f32 v[80:81], v[80:81], v[244:245], v[196:197] op_sel_hi:[1,0,1]
    v_max_f32 v80, 0, v80
    v_max_f32 v81, 0, v81
    s_add_u32 m0, s74, 53248
    v_pk_mul_f32 v[80:81], v[80:81], v[80:81]
    buffer_load_dwordx4 v32, s[4:7], m0 offen sc1 lds
    v_cvt_pk_bf16_f32 v160, v80, v81
    v_pk_fma_f32 v[82:83], v[82:83], v[244:245], v[198:199] op_sel_hi:[1,0,1]
    v_max_f32 v82, 0, v82
    v_max_f32 v83, 0, v83
    v_pk_mul_f32 v[82:83], v[82:83], v[82:83]
    v_cvt_pk_bf16_f32 v161, v82, v83
    v_pk_fma_f32 v[84:85], v[84:85], v[244:245], v[200:201] op_sel_hi:[1,0,1]
    v_max_f32 v84, 0, v84
    v_max_f32 v85, 0, v85
    v_pk_mul_f32 v[84:85], v[84:85], v[84:85]
    v_cvt_pk_bf16_f32 v162, v84, v85
    v_pk_fma_f32 v[86:87], v[86:87], v[244:245], v[202:203] op_sel_hi:[1,0,1]
    v_max_f32 v86, 0, v86
    v_max_f32 v87, 0, v87
    v_pk_mul_f32 v[86:87], v[86:87], v[86:87]
    v_cvt_pk_bf16_f32 v163, v86, v87
    buffer_store_dwordx4 v[160:163], v23, s[48:51], s26 offen offset:1024
    v_pk_fma_f32 v[88:89], v[88:89], v[244:245], v[204:205] op_sel_hi:[1,0,1]
    v_max_f32 v88, 0, v88
    v_max_f32 v89, 0, v89
    v_pk_mul_f32 v[88:89], v[88:89], v[88:89]
    v_cvt_pk_bf16_f32 v164, v88, v89
    s_add_u32 m0, s74, 57344
    v_pk_fma_f32 v[90:91], v[90:91], v[244:245], v[206:207] op_sel_hi:[1,0,1]
    buffer_load_dwordx4 v32, s[4:7], m0 offen sc1 lds
    v_max_f32 v90, 0, v90
    v_max_f32 v91, 0, v91
    v_pk_mul_f32 v[90:91], v[90:91], v[90:91]
    v_cvt_pk_bf16_f32 v165, v90, v91
    v_pk_fma_f32 v[92:93], v[92:93], v[244:245], v[208:209] op_sel_hi:[1,0,1]
    v_max_f32 v92, 0, v92
    v_max_f32 v93, 0, v93
    v_pk_mul_f32 v[92:93], v[92:93], v[92:93]
    v_cvt_pk_bf16_f32 v166, v92, v93
    v_pk_fma_f32 v[94:95], v[94:95], v[244:245], v[210:211] op_sel_hi:[1,0,1]
    v_max_f32 v94, 0, v94
    v_max_f32 v95, 0, v95
    v_pk_mul_f32 v[94:95], v[94:95], v[94:95]
    v_cvt_pk_bf16_f32 v167, v94, v95
    buffer_store_dwordx4 v[164:167], v23, s[48:51], s26 offen offset:2048
    v_pk_fma_f32 v[96:97], v[96:97], v[244:245], v[212:213] op_sel_hi:[1,0,1]
    v_max_f32 v96, 0, v96
    v_max_f32 v97, 0, v97
    v_pk_mul_f32 v[96:97], v[96:97], v[96:97]
    v_cvt_pk_bf16_f32 v168, v96, v97
    v_pk_fma_f32 v[98:99], v[98:99], v[244:245], v[214:215] op_sel_hi:[1,0,1]
    v_max_f32 v98, 0, v98
    s_add_u32 m0, s74, 61440
    v_max_f32 v99, 0, v99
    buffer_load_dwordx4 v32, s[4:7], m0 offen sc1 lds
    v_pk_mul_f32 v[98:99], v[98:99], v[98:99]
    v_cvt_pk_bf16_f32 v169, v98, v99
    buffer_store_dwordx2 v[168:169], v24, s[48:51], s26 offen
    s_waitcnt lgkmcnt(0)
    s_nop 0
    v_pk_add_f32 v[52:53], v[52:53], v[136:137]
    v_pk_add_f32 v[54:55], v[54:55], v[138:139]
    v_pk_add_f32 v[56:57], v[56:57], v[140:141]
    v_pk_add_f32 v[58:59], v[58:59], v[142:143]
    v_pk_add_f32 v[60:61], v[60:61], v[144:145]
    v_pk_add_f32 v[62:63], v[62:63], v[146:147]
    v_pk_add_f32 v[64:65], v[64:65], v[148:149]
    v_pk_add_f32 v[66:67], v[66:67], v[150:151]
    v_pk_add_f32 v[68:69], v[68:69], v[152:153]
    v_pk_add_f32 v[70:71], v[70:71], v[154:155]
    s_mov_b64 s[8:9], s[48:49]
    s_add_u32 s48, s48, s56
    s_addc_u32 s49, s49, 0
L_sec_41_e:
L_p40:
    s_lshr_b32 s95, s77, 3
    s_mul_i32 s96, s95, 24576
    s_add_u32 s3, s79, 1
    s_and_b32 s3, s3, 7
    s_mul_i32 s3, s3, 3072
    s_add_u32 s20, s3, s96
    s_add_u32 s3, s79, 2
    s_and_b32 s3, s3, 7
    s_mul_i32 s3, s3, 3072
    s_add_u32 s21, s3, s96
    s_add_u32 s3, s79, 3
    s_and_b32 s3, s3, 7
    s_mul_i32 s3, s3, 3072
    s_add_u32 s22, s3, s96
    s_add_u32 s3, s79, 4
    s_and_b32 s3, s3, 7
    s_mul_i32 s3, s3, 3072
    s_add_u32 s23, s3, s96
    s_add_u32 s3, s79, 5
    s_and_b32 s3, s3, 7
    s_mul_i32 s3, s3, 3072
    s_add_u32 s28, s3, s96
    s_add_u32 s3, s79, 6
    s_and_b32 s3, s3, 7
    s_mul_i32 s3, s3, 3072
    s_add_u32 s29, s3, s96
    s_add_u32 s3, s79, 7
    s_and_b32 s3, s3, 7
    s_mul_i32 s3, s3, 3072
    s_add_u32 s30, s3, s96
    s_mul_i32 s95, s95, 3072
    s_add_u32 s31, s95, 49152
    s_bitcmp1_b32 s78, 0
    s_cselect_b32 s3, s28, s20
    s_cselect_b32 s28, s20, s28
    s_mov_b32 s20, s3
    s_cselect_b32 s3, s29, s21
    s_cselect_b32 s29, s21, s29
    s_mov_b32 s21, s3
    s_cselect_b32 s3, s30, s22
    s_cselect_b32 s30, s22, s30
    s_mov_b32 s22, s3
    s_cselect_b32 s3, s31, s23
    s_cselect_b32 s31, s23, s31
    s_mov_b32 s23, s3
    s_sub_u32 s95, 0, s47
    s_cmp_lt_u32 s77, 8
    s_cselect_b32 s95, s47, s95
    v_add_u32 v48, s95, v13
    s_waitcnt vmcnt(19)
    s_barrier
    ds_read_b128 v[72:75], v3 offset:24576
    ds_read_b128 v[76:79], v3 offset:25600
    ds_read_b128 v[80:83], v3 offset:26624
    ds_read_b128 v[84:87], v3 offset:27648
    ds_read_b128 v[88:91], v3 offset:28672
    ds_read_b128 v[92:95], v3 offset:29696
    ds_read_b128 v[96:99], v3 offset:30720
    ds_read_b128 v[100:103], v3 offset:31744
    ds_read_b128 v[104:107], v3 offset:32768
    ds_read_b128 v[108:111], v3 offset:33792
    s_waitcnt vmcnt(8)
L_fs_ck0:
    v_cmp_ne_u32 vcc, s81, v252
    s_cbranch_vccz L_fs_ok0
    buffer_load_dword v252, v255, s[8:11], s82 offen offset:192 sc1
    s_sub_u32 s80, s80, 1
    s_cbranch_scc1 L_end
    s_waitcnt vmcnt(0)
    s_branch L_fs_ck0
L_fs_ok0:
    buffer_load_dwordx4 a[184:187], v48, s[8:11], s20 offen offset:0 sc1
    buffer_load_dwordx4 a[188:191], v48, s[8:11], s20 offen offset:1024 sc1
    buffer_load_dwordx4 a[192:195], v48, s[8:11], s20 offen offset:2048 sc1
    s_waitcnt lgkmcnt(5)
    v_mfma_f32_16x16x32_bf16 v[52:55], v[72:75], v[156:159], v[52:55]
    ds_read_b128 v[112:115], v3 offset:34816
    v_mfma_f32_16x16x32_bf16 v[116:119], v[72:75], v[216:219], 0
    buffer_load_dwordx4 a[196:199], v48, s[8:11], s21 offen offset:0 sc1
    v_mfma_f32_16x16x32_bf16 v[56:59], v[76:79], v[156:159], v[56:59]
    ds_read_b128 v[72:75], v3 offset:35840
    v_mfma_f32_16x16x32_bf16 v[120:123], v[76:79], v[216:219], 0
    ds_write_b64 v37, a[68:69] offset:4096
    v_mfma_f32_16x16x32_bf16 v[60:63], v[80:83], v[156:159], v[60:63]
    ds_read_b128 v[76:79], v3 offset:36864
    v_mfma_f32_16x16x32_bf16 v[124:127], v[80:83], v[216:219], 0
    buffer_load_dwordx4 a[200:203], v48, s[8:11], s21 offen offset:1024 sc1
    v_mfma_f32_16x16x32_bf16 v[64:67], v[84:87], v[156:159], v[64:67]
    ds_read_b128 v[80:83], v3 offset:37888
    v_mfma_f32_16x16x32_bf16 v[128:131], v[84:87], v[216:219], 0
    ds_write_b64 v37, a[70:71] offset:4104
    v_mfma_f32_16x16x32_bf16 v[68:71], v[88:91], v[156:159], v[68:71]
    ds_read_b128 v[84:87], v3 offset:38912
    v_mfma_f32_16x16x32_bf16 v[132:135], v[88:91], v[216:219], 0
    s_waitcnt lgkmcnt(7)
    v_mfma_f32_16x16x32_bf16 v[52:55], v[92:95], v[160:163], v[52:55]
    ds_read_b128 v[88:91], v3 offset:39936
    v_mfma_f32_16x16x32_bf16 v[116:119], v[92:95], v[220:223], v[116:119]
    buffer_load_dwordx4 a[204:207], v48, s[8:11], s21 offen offset:2048 sc1
    v_mfma_f32_16x16x32_bf16 v[56:59], v[96:99], v[160:163], v[56:59]
    ds_read_b128 v[92:95], v3 offset:40960
    v_mfma_f32_16x16x32_bf16 v[120:123], v[96:99], v[220:223], v[120:123]
    ds_write_b64 v37, a[72:73] offset:8192
    v_mfma_f32_16x16x32_bf16 v[60:63], v[100:103], v[160:163], v[60:63]
    ds_read_b128 v[96:99], v3 offset:41984
    v_mfma_f32_16x16x32_bf16 v[124:127], v[100:103], v[220:223], v[124:127]
    buffer_load_dwordx4 a[208:211], v48, s[8:11], s22 offen offset:0 sc1
    v_mfma_f32_16x16x32_bf16 v[64:67], v[104:107], v[160:163], v[64:67]
    ds_read_b128 v[100:103], v3 offset:43008
    v_mfma_f32_16x16x32_bf16 v[128:131], v[104:107], v[220:223], v[128:131]
    ds_write_b64 v37, a[74:75] offset:8200
    v_mfma_f32_16x16x32_bf16 v[68:71], v[108:111], v[160:163], v[68:71]
    ds_read_b128 v[104:107], v3 offset:44032
    v_mfma_f32_16x16x32_bf16 v[132:135], v[108:111], v[220:223], v[132:135]
    buffer_load_dwordx4 a[212:215], v48, s[8:11], s22 offen offset:1024 sc1
    s_waitcnt lgkmcnt(7)
    s_waitcnt vmcnt(8)
    s_mov_b64 exec, 1
    s_cmp_eq_u32 s76, 0
    s_cbranch_scc0 L_st_42_s
    buffer_store_dword v28, off, s[8:11], s85 offset:64
L_st_42_e:
    s_mov_b64 exec, -1
    v_mfma_f32_16x16x32_bf16 v[52:55], v[112:115], v[164:167], v[52:55]
    ds_read_b128 v[108:111], v3 offset:45056
    v_mfma_f32_16x16x32_bf16 v[116:119], v[112:115], v[224:227], v[116:119]
    ds_write_b64 v37, a[76:77] offset:12288
    v_mfma_f32_16x16x32_bf16 v[56:59], v[72:75], v[164:167], v[56:59]
    ds_read_b128 v[112:115], v3 offset:46080
    v_mfma_f32_16x16x32_bf16 v[120:123], v[72:75], v[224:227], v[120:123]
    buffer_load_dwordx4 a[216:219], v48, s[8:11], s22 offen offset:2048 sc1
    v_mfma_f32_16x16x32_bf16 v[60:63], v[76:79], v[164:167], v[60:63]
    ds_read_b128 v[72:75], v3 offset:47104
    v_mfma_f32_16x16x32_bf16 v[124:127], v[76:79], v[224:227], v[124:127]
    ds_write_b64 v37, a[78:79] offset:12296
    v_mfma_f32_16x16x32_bf16 v[64:67], v[80:83], v[164:167], v[64:67]
    ds_read_b128 v[76:79], v3 offset:48128
    v_mfma_f32_16x16x32_bf16 v[128:131], v[80:83], v[224:227], v[128:131]
    buffer_load_dwordx4 a[220:223], v48, s[8:11], s23 offen offset:0 sc1
    v_mfma_f32_16x16x32_bf16 v[68:71], v[84:87], v[164:167], v[68:71]
    ds_read_b128 v[80:83], v3 offset:49152
    v_mfma_f32_16x16x32_bf16 v[132:135], v[84:87], v[224:227], v[132:135]
    s_waitcnt vmcnt(10) lgkmcnt(7)
    v_mfma_f32_16x16x32_bf16 v[116:119], v[88:91], a[184:187], v[116:119]
    ds_read_b128 v[84:87], v3 offset:50176
    buffer_load_dwordx4 a[224:227], v48, s[8:11], s23 offen offset:1024 sc1
    v_mfma_f32_16x16x32_bf16 v[120:123], v[92:95], a[184:187], v[120:123]
    ds_read_b128 v[88:91], v3 offset:51200
    v_xor_b32 v220, 0x100, v14
    v_mfma_f32_16x16x32_bf16 v[124:127], v[96:99], a[184:187], v[124:127]
    ds_read_b128 v[92:95], v3 offset:52224
    buffer_load_dwordx4 a[228:231], v48, s[8:11], s23 offen offset:2048 sc1
    v_mfma_f32_16x16x32_bf16 v[128:131], v[100:103], a[184:187], v[128:131]
    ds_read_b128 v[96:99], v3 offset:53248
    v_xor_b32 v221, 0x100, v15
    v_mfma_f32_16x16x32_bf16 v[132:135], v[104:107], a[184:187], v[132:135]
    ds_read_b128 v[100:103], v3 offset:54272
    s_waitcnt vmcnt(11) lgkmcnt(5)
    v_mfma_f32_16x16x32_bf16 v[116:119], v[108:111], a[188:191], v[116:119]
    ds_read_b128 v[104:107], v3 offset:55296
    buffer_load_dwordx4 a[232:235], v48, s[8:11], s28 offen offset:0 sc1
    v_mfma_f32_16x16x32_bf16 v[120:123], v[112:115], a[188:191], v[120:123]
    ds_read_b128 v[108:111], v3 offset:56320
    s_xor_b32 s97, s85, 32
    v_mfma_f32_16x16x32_bf16 v[124:127], v[72:75], a[188:191], v[124:127]
    ds_read_b128 v[112:115], v3 offset:57344
    v_mfma_f32_16x16x32_bf16 v[128:131], v[76:79], a[188:191], v[128:131]
    ds_read_b128 v[72:75], v3 offset:58368
    buffer_load_dwordx4 a[236:239], v48, s[8:11], s28 offen offset:1024 sc1
    v_mfma_f32_16x16x32_bf16 v[132:135], v[80:83], a[188:191], v[132:135]
    ds_read_b128 v[76:79], v3 offset:59392
    s_waitcnt vmcnt(12) lgkmcnt(5)
    v_mfma_f32_16x16x32_bf16 v[116:119], v[84:87], a[192:195], v[116:119]
    ds_read_b128 v[80:83], v3 offset:60416
    v_mfma_f32_16x16x32_bf16 v[120:123], v[88:91], a[192:195], v[120:123]
    ds_read_b128 v[84:87], v3 offset:61440
    buffer_load_dwordx4 a[240:243], v48, s[8:11], s28 offen offset:2048 sc1
    v_mfma_f32_16x16x32_bf16 v[124:127], v[92:95], a[192:195], v[124:127]
    ds_read_b128 v[88:91], v3 offset:62464
    v_mfma_f32_16x16x32_bf16 v[128:131], v[96:99], a[192:195], v[128:131]
    ds_read_b128 v[92:95], v3 offset:63488
    v_mfma_f32_16x16x32_bf16 v[132:135], v[100:103], a[192:195], v[132:135]
    ds_read_b128 v[96:99], v3 offset:64512
    s_waitcnt vmcnt(12) lgkmcnt(5)
    v_mfma_f32_16x16x32_bf16 v[116:119], v[104:107], a[196:199], v[116:119]
    ds_read_b128 v[100:103], v4 offset:0
    buffer_load_dwordx4 a[244:247], v48, s[8:11], s29 offen offset:0 sc1
    v_mfma_f32_16x16x32_bf16 v[120:123], v[108:111], a[196:199], v[120:123]
    ds_read_b128 v[104:107], v4 offset:1024
    v_mfma_f32_16x16x32_bf16 v[124:127], v[112:115], a[196:199], v[124:127]
    ds_read_b128 v[108:111], v4 offset:2048
    v_mfma_f32_16x16x32_bf16 v[128:131], v[72:75], a[196:199], v[128:131]
    ds_read_b128 v[112:115], v4 offset:3072
    buffer_load_dwordx4 a[248:251], v48, s[8:11], s29 offen offset:1024 sc1
    v_mfma_f32_16x16x32_bf16 v[132:135], v[76:79], a[196:199], v[132:135]
    ds_read_b128 v[72:75], v4 offset:4096
    s_waitcnt vmcnt(13) lgkmcnt(5)
    v_mfma_f32_16x16x32_bf16 v[116:119], v[80:83], a[200:203], v[116:119]
    ds_read_b128 v[76:79], v4 offset:5120
    v_mfma_f32_16x16x32_bf16 v[120:123], v[84:87], a[200:203], v[120:123]
    ds_read_b128 v[80:83], v4 offset:6144
    buffer_load_dwordx4 a[184:187], v48, s[8:11], s29 offen offset:2048 sc1
    v_mfma_f32_16x16x32_bf16 v[124:127], v[88:91], a[200:203], v[124:127]
    ds_read_b128 v[84:87], v4 offset:7168
    v_mfma_f32_16x16x32_bf16 v[128:131], v[92:95], a[200:203], v[128:131]
    ds_read_b128 v[88:91], v4 offset:8192
    v_mfma_f32_16x16x32_bf16 v[132:135], v[96:99], a[200:203], v[132:135]
    ds_read_b128 v[92:95], v4 offset:9216
    s_waitcnt vmcnt(13) lgkmcnt(5)
    v_mfma_f32_16x16x32_bf16 v[116:119], v[100:103], a[204:207], v[116:119]
    ds_read_b128 v[96:99], v4 offset:10240
    buffer_load_dwordx4 a[188:191], v48, s[8:11], s30 offen offset:0 sc1
    v_mfma_f32_16x16x32_bf16 v[120:123], v[104:107], a[204:207], v[120:123]
    ds_read_b128 v[100:103], v4 offset:11264
    v_mfma_f32_16x16x32_bf16 v[124:127], v[108:111], a[204:207], v[124:127]
    ds_read_b128 v[104:107], v4 offset:12288
    v_mfma_f32_16x16x32_bf16 v[128:131], v[112:115], a[204:207], v[128:131]
    ds_read_b128 v[108:111], v4 offset:13312
    buffer_load_dwordx4 a[192:195], v48, s[8:11], s30 offen offset:1024 sc1
    v_mfma_f32_16x16x32_bf16 v[132:135], v[72:75], a[204:207], v[132:135]
    ds_read_b128 v[112:115], v4 offset:14336
    s_waitcnt vmcnt(14) lgkmcnt(5)
    v_mfma_f32_16x16x32_bf16 v[116:119], v[76:79], a[208:211], v[116:119]
    ds_read_b128 v[72:75], v4 offset:15360
    v_mfma_f32_16x16x32_bf16 v[120:123], v[80:83], a[208:211], v[120:123]
    ds_read_b128 v[76:79], v4 offset:16384
    buffer_load_dword v252, v27, s[8:11], s82 offen offset:64 sc1
    v_mfma_f32_16x16x32_bf16 v[124:127], v[84:87], a[208:211], v[124:127]
    ds_read_b128 v[80:83], v4 offset:17408
    v_mfma_f32_16x16x32_bf16 v[128:131], v[88:91], a[208:211], v[128:131]
    ds_read_b128 v[84:87], v4 offset:18432
    v_mfma_f32_16x16x32_bf16 v[132:135], v[92:95], a[208:211], v[132:135]
    ds_read_b128 v[88:91], v4 offset:19456
    s_waitcnt vmcnt(14) lgkmcnt(5)
    v_mfma_f32_16x16x32_bf16 v[116:119], v[96:99], a[212:215], v[116:119]
    ds_read_b128 v[92:95], v4 offset:20480
    buffer_load_dwordx4 a[196:199], v48, s[8:11], s30 offen offset:2048 sc1
    v_mfma_f32_16x16x32_bf16 v[120:123], v[100:103], a[212:215], v[120:123]
    ds_read_b128 v[96:99], v4 offset:21504
    v_mfma_f32_16x16x32_bf16 v[124:127], v[104:107], a[212:215], v[124:127]
    ds_read_b128 v[100:103], v4 offset:22528
    buffer_load_dwordx4 a[200:203], v48, s[8:11], s31 offen offset:0 sc1
    v_mfma_f32_16x16x32_bf16 v[128:131], v[108:111], a[212:215], v[128:131]
    ds_read_b128 v[104:107], v4 offset:23552
    v_mfma_f32_16x16x32_bf16 v[132:135], v[112:115], a[212:215], v[132:135]
    ds_read_b128 v[108:111], v4 offset:24576
    s_waitcnt vmcnt(14) lgkmcnt(5)
    v_mfma_f32_16x16x32_bf16 v[116:119], v[72:75], a[216:219], v[116:119]
    ds_read_b128 v[112:115], v4 offset:25600
    v_mfma_f32_16x16x32_bf16 v[120:123], v[76:79], a[216:219], v[120:123]
    ds_read_b128 v[72:75], v4 offset:26624
    buffer_load_dwordx4 a[204:207], v48, s[8:11], s31 offen offset:1024 sc1
    v_mfma_f32_16x16x32_bf16 v[124:127], v[80:83], a[216:219], v[124:127]
    ds_read_b128 v[76:79], v4 offset:27648
    v_mfma_f32_16x16x32_bf16 v[128:131], v[84:87], a[216:219], v[128:131]
    ds_read_b128 v[80:83], v2 offset:0
    v_mfma_f32_16x16x32_bf16 v[132:135], v[88:91], a[216:219], v[132:135]
    ds_read_b128 v[84:87], v2 offset:1024
    s_waitcnt vmcnt(14) lgkmcnt(5)
    v_mfma_f32_16x16x32_bf16 v[116:119], v[92:95], a[220:223], v[116:119]
    ds_read_b128 v[88:91], v2 offset:2048
    buffer_load_dwordx4 a[208:211], v48, s[8:11], s31 offen offset:2048 sc1
    v_mfma_f32_16x16x32_bf16 v[120:123], v[96:99], a[220:223], v[120:123]
    ds_read_b128 v[92:95], v2 offset:3072
    s_add_u32 m0, s74, 65536
    v_mfma_f32_16x16x32_bf16 v[124:127], v[100:103], a[220:223], v[124:127]
    ds_read_b128 v[96:99], v2 offset:4096
    buffer_load_dwordx4 v32, s[4:7], m0 offen sc1 lds
    v_mfma_f32_16x16x32_bf16 v[128:131], v[104:107], a[220:223], v[128:131]
    ds_read_b128 v[100:103], v2 offset:5120
    v_mfma_f32_16x16x32_bf16 v[132:135], v[108:111], a[220:223], v[132:135]
    ds_read_b128 v[104:107], v2 offset:6144
    s_waitcnt vmcnt(15) lgkmcnt(5)
    s_waitcnt vmcnt(5)
L_fk_ck0:
    v_cmp_ne_u32 vcc, s81, v252
    s_cbranch_vccz L_fk_ok0
    buffer_load_dword v252, v27, s[8:11], s82 offen offset:64 sc1
    s_sub_u32 s80, s80, 1
    s_cbranch_scc1 L_end
    s_waitcnt vmcnt(0)
    s_branch L_fk_ck0
L_fk_ok0:
    s_add_u32 s81, s81, 32
    v_mov_b32 v28, s81
    v_mfma_f32_16x16x32_bf16 v[116:119], v[112:115], a[224:227], v[116:119]
    ds_read_b128 v[108:111], v2 offset:7168
    v_mfma_f32_16x16x32_bf16 v[120:123], v[72:75], a[224:227], v[120:123]
    ds_read_b128 v[112:115], v2 offset:8192
    buffer_load_dwordx4 a[212:215], v13, s[8:11], s20 offen offset:0 sc1
    v_mfma_f32_16x16x32_bf16 v[124:127], v[76:79], a[224:227], v[124:127]
    ds_read_b128 v[72:75], v2 offset:9216
    v_mfma_f32_16x16x32_bf16 v[128:131], v[80:83], a[224:227], v[128:131]
    ds_read_b128 v[76:79], v2 offset:10240
    v_mfma_f32_16x16x32_bf16 v[132:135], v[84:87], a[224:227], v[132:135]
    ds_read_b128 v[80:83], v2 offset:11264
    s_waitcnt lgkmcnt(5)
    v_mfma_f32_16x16x32_bf16 v[116:119], v[88:91], a[228:231], v[116:119]
    s_barrier
    ds_read_b128 v[84:87], v2 offset:12288
    buffer_load_dwordx4 a[216:219], v13, s[8:11], s20 offen offset:1024 sc1
    v_mfma_f32_16x16x32_bf16 v[120:123], v[92:95], a[228:231], v[120:123]
    ds_read_b128 v[88:91], v2 offset:13312
    v_mfma_f32_16x16x32_bf16 v[124:127], v[96:99], a[228:231], v[124:127]
    ds_read_b128 v[92:95], v2 offset:14336
    buffer_load_dwordx4 a[220:223], v13, s[8:11], s20 offen offset:2048 sc1
    v_mfma_f32_16x16x32_bf16 v[128:131], v[100:103], a[228:231], v[128:131]
    ds_read_b128 v[96:99], v2 offset:15360
    v_mfma_f32_16x16x32_bf16 v[132:135], v[104:107], a[228:231], v[132:135]
    ds_read_b128 v[100:103], v2 offset:16384
    s_waitcnt lgkmcnt(5)
    v_mfma_f32_16x16x32_bf16 v[116:119], v[108:111], a[232:235], v[116:119]
    ds_read_b128 v[104:107], v2 offset:17408
    v_mfma_f32_16x16x32_bf16 v[120:123], v[112:115], a[232:235], v[120:123]
    ds_read_b128 v[108:111], v2 offset:18432
    buffer_load_dwordx4 a[224:227], v13, s[8:11], s21 offen offset:0 sc1
    v_mfma_f32_16x16x32_bf16 v[124:127], v[72:75], a[232:235], v[124:127]
    ds_read_b128 v[112:115], v2 offset:19456
    v_mfma_f32_16x16x32_bf16 v[128:131], v[76:79], a[232:235], v[128:131]
    ds_read_b128 v[72:75], v2 offset:20480
    v_mfma_f32_16x16x32_bf16 v[132:135], v[80:83], a[232:235], v[132:135]
    ds_read_b128 v[76:79], v2 offset:21504
    s_waitcnt lgkmcnt(5)
    v_mfma_f32_16x16x32_bf16 v[116:119], v[84:87], a[236:239], v[116:119]
    ds_read_b128 v[80:83], v2 offset:22528
    buffer_load_dwordx4 a[228:231], v13, s[8:11], s21 offen offset:1024 sc1
    v_mfma_f32_16x16x32_bf16 v[120:123], v[88:91], a[236:239], v[120:123]
    ds_read_b128 v[84:87], v2 offset:23552
    v_mfma_f32_16x16x32_bf16 v[124:127], v[92:95], a[236:239], v[124:127]
    ds_read_b128 v[88:91], v2 offset:24576
    buffer_load_dwordx4 a[232:235], v13, s[8:11], s21 offen offset:2048 sc1
    v_mfma_f32_16x16x32_bf16 v[128:131], v[96:99], a[236:239], v[128:131]
    ds_read_b128 v[92:95], v2 offset:25600
    v_mfma_f32_16x16x32_bf16 v[132:135], v[100:103], a[236:239], v[132:135]
    ds_read_b128 v[96:99], v2 offset:26624
    s_waitcnt lgkmcnt(5)
    v_mfma_f32_16x16x32_bf16 v[116:119], v[104:107], a[240:243], v[116:119]
    ds_read_b128 v[100:103], v2 offset:27648
    v_mfma_f32_16x16x32_bf16 v[120:123], v[108:111], a[240:243], v[120:123]
    ds_read_b128 v[104:107], v2 offset:28672
    v_mfma_f32_16x16x32_bf16 v[124:127], v[112:115], a[240:243], v[124:127]
    ds_read_b128 v[108:111], v2 offset:29696
    v_mfma_f32_16x16x32_bf16 v[128:131], v[72:75], a[240:243], v[128:131]
    ds_read_b128 v[112:115], v2 offset:30720
    v_mfma_f32_16x16x32_bf16 v[132:135], v[76:79], a[240:243], v[132:135]
    ds_read_b128 v[72:75], v2 offset:31744
    s_waitcnt lgkmcnt(5)
    v_mfma_f32_16x16x32_bf16 v[116:119], v[80:83], a[244:247], v[116:119]
    ds_read_b128 v[76:79], v2 offset:32768
    buffer_load_dwordx4 a[236:239], v13, s[8:11], s22 offen offset:0 sc1
    v_mfma_f32_16x16x32_bf16 v[120:123], v[84:87], a[244:247], v[120:123]
    ds_read_b128 v[80:83], v2 offset:33792
L_pad7:
    s_cbranch_execz L_pad11
    v_mfma_f32_16x16x32_bf16 v[124:127], v[88:91], a[244:247], v[124:127]
    ds_read_b128 v[84:87], v2 offset:34816
    buffer_load_dwordx4 a[240:243], v13, s[8:11], s22 offen offset:1024 sc1
    v_mfma_f32_16x16x32_bf16 v[128:131], v[92:95], a[244:247], v[128:131]
    ds_read_b128 v[88:91], v2 offset:35840
    v_mfma_f32_16x16x32_bf16 v[132:135], v[96:99], a[244:247], v[132:135]
    ds_read_b128 v[92:95], v2 offset:36864
    s_waitcnt lgkmcnt(5)
    v_mfma_f32_16x16x32_bf16 v[116:119], v[100:103], a[248:251], v[116:119]
    ds_read_b128 v[96:99], v2 offset:37888
    v_mfma_f32_16x16x32_bf16 v[120:123], v[104:107], a[248:251], v[120:123]
    ds_read_b128 v[100:103], v2 offset:38912
    v_mfma_f32_16x16x32_bf16 v[124:127], v[108:111], a[248:251], v[124:127]
    ds_read_b128 v[104:107], v2 offset:39936
    v_mfma_f32_16x16x32_bf16 v[128:131], v[112:115], a[248:251], v[128:131]
    ds_read_b128 v[108:111], v2 offset:40960
    v_mfma_f32_16x16x32_bf16 v[132:135], v[72:75], a[248:251], v[132:135]
    ds_read_b128 v[112:115], v2 offset:41984
    s_waitcnt lgkmcnt(5)
    v_mfma_f32_16x16x32_bf16 v[116:119], v[76:79], a[184:187], v[116:119]
    s_waitcnt vmcnt(8)
    s_barrier
    ds_read_b128 v[72:75], v2 offset:43008
    buffer_load_dwordx4 a[244:247], v13, s[8:11], s22 offen offset:2048 sc1
    v_mfma_f32_16x16x32_bf16 v[120:123], v[80:83], a[184:187], v[120:123]
    ds_read_b128 v[76:79], v2 offset:44032
    v_mfma_f32_16x16x32_bf16 v[124:127], v[84:87], a[184:187], v[124:127]
    ds_read_b128 v[80:83], v2 offset:45056
    buffer_load_dwordx4 a[248:251], v13, s[8:11], s23 offen offset:0 sc1
    v_mfma_f32_16x16x32_bf16 v[128:131], v[88:91], a[184:187], v[128:131]
    ds_read_b128 v[84:87], v2 offset:46080
    v_mfma_f32_16x16x32_bf16 v[132:135], v[92:95], a[184:187], v[132:135]
    ds_read_b128 v[88:91], v2 offset:47104
    s_waitcnt lgkmcnt(5)
    v_mfma_f32_16x16x32_bf16 v[116:119], v[96:99], a[188:191], v[116:119]
    ds_read_b128 v[92:95], v2 offset:48128
    v_mfma_f32_16x16x32_bf16 v[120:123], v[100:103], a[188:191], v[120:123]
    ds_read_b128 v[96:99], v2 offset:49152
    v_mfma_f32_16x16x32_bf16 v[124:127], v[104:107], a[188:191], v[124:127]
    ds_read_b128 v[100:103], v2 offset:50176
    v_mfma_f32_16x16x32_bf16 v[128:131], v[108:111], a[188:191], v[128:131]
    ds_read_b128 v[104:107], v2 offset:51200
    v_mfma_f32_16x16x32_bf16 v[132:135], v[112:115], a[188:191], v[132:135]
    ds_read_b128 v[108:111], v2 offset:52224
    s_waitcnt lgkmcnt(5)
    v_mfma_f32_16x16x32_bf16 v[116:119], v[72:75], a[192:195], v[116:119]
    ds_read_b128 v[112:115], v2 offset:53248
    buffer_load_dwordx4 a[184:187], v13, s[8:11], s23 offen offset:1024 sc1
    v_mfma_f32_16x16x32_bf16 v[120:123], v[76:79], a[192:195], v[120:123]
    ds_read_b128 v[72:75], v2 offset:54272
    v_mfma_f32_16x16x32_bf16 v[124:127], v[80:83], a[192:195], v[124:127]
    ds_read_b128 v[76:79], v2 offset:55296
    buffer_load_dwordx4 a[188:191], v13, s[8:11], s23 offen offset:2048 sc1
    v_mfma_f32_16x16x32_bf16 v[128:131], v[84:87], a[192:195], v[128:131]
    ds_read_b128 v[80:83], v2 offset:56320
    v_mfma_f32_16x16x32_bf16 v[132:135], v[88:91], a[192:195], v[132:135]
    ds_read_b128 v[84:87], v2 offset:57344
    s_waitcnt lgkmcnt(5)
    v_mfma_f32_16x16x32_bf16 v[116:119], v[92:95], a[196:199], v[116:119]
    ds_read_b128 v[88:91], v2 offset:58368
    v_mfma_f32_16x16x32_bf16 v[120:123], v[96:99], a[196:199], v[120:123]
    ds_read_b128 v[92:95], v2 offset:59392
    v_mfma_f32_16x16x32_bf16 v[124:127], v[100:103], a[196:199], v[124:127]
    ds_read_b128 v[96:99], v2 offset:60416
    v_mfma_f32_16x16x32_bf16 v[128:131], v[104:107], a[196:199], v[128:131]
    ds_read_b128 v[100:103], v2 offset:61440
    buffer_load_dwordx4 a[192:195], v13, s[8:11], s28 offen offset:0 sc1
    v_mfma_f32_16x16x32_bf16 v[132:135], v[108:111], a[196:199], v[132:135]
    ds_read_b128 v[104:107], v2 offset:62464
    s_waitcnt lgkmcnt(5)
    v_mfma_f32_16x16x32_bf16 v[116:119], v[112:115], a[200:203], v[116:119]
    ds_read_b128 v[108:111], v2 offset:63488
    v_mfma_f32_16x16x32_bf16 v[120:123], v[72:75], a[200:203], v[120:123]
    ds_read_b128 v[112:115], v2 offset:64512
    v_mfma_f32_16x16x32_bf16 v[124:127], v[76:79], a[200:203], v[124:127]
    ds_read_b128 v[72:75], v3 offset:0
    buffer_load_dwordx4 a[196:199], v13, s[8:11], s28 offen offset:1024 sc1
    v_mfma_f32_16x16x32_bf16 v[128:131], v[80:83], a[200:203], v[128:131]
    ds_read_b128 v[76:79], v3 offset:1024
    v_mfma_f32_16x16x32_bf16 v[132:135], v[84:87], a[200:203], v[132:135]
    ds_read_b128 v[80:83], v3 offset:2048
    s_waitcnt lgkmcnt(5)
    v_mfma_f32_16x16x32_bf16 v[116:119], v[88:91], a[204:207], v[116:119]
    ds_read_b128 v[84:87], v3 offset:39936
    v_mfma_f32_16x16x32_bf16 v[120:123], v[92:95], a[204:207], v[120:123]
    ds_read_b128 v[88:91], v3 offset:40960
    v_mfma_f32_16x16x32_bf16 v[124:127], v[96:99], a[204:207], v[124:127]
    ds_read_b128 v[92:95], v3 offset:41984
    v_mfma_f32_16x16x32_bf16 v[128:131], v[100:103], a[204:207], v[128:131]
    ds_read_b128 v[96:99], v3 offset:43008
    buffer_load_dwordx4 a[200:203], v13, s[8:11], s28 offen offset:2048 sc1
    v_mfma_f32_16x16x32_bf16 v[132:135], v[104:107], a[204:207], v[132:135]
    ds_read_b128 v[100:103], v3 offset:44032
    s_waitcnt lgkmcnt(5)
    v_mfma_f32_16x16x32_bf16 v[116:119], v[108:111], a[208:211], v[116:119]
    ds_read_b128 v[104:107], v3 offset:45056
    v_mfma_f32_16x16x32_bf16 v[120:123], v[112:115], a[208:211], v[120:123]
    ds_read_b128 v[108:111], v3 offset:46080
    v_mfma_f32_16x16x32_bf16 v[124:127], v[72:75], a[208:211], v[124:127]
    ds_read_b128 v[112:115], v3 offset:47104
    buffer_load_dwordx4 a[204:207], v13, s[8:11], s29 offen offset:0 sc1
    v_mfma_f32_16x16x32_bf16 v[128:131], v[76:79], a[208:211], v[128:131]
    ds_read_b128 v[72:75], v3 offset:48128
    v_mfma_f32_16x16x32_bf16 v[132:135], v[80:83], a[208:211], v[132:135]
    ds_read_b128 v[76:79], v3 offset:49152
    s_waitcnt vmcnt(15) lgkmcnt(5)
    v_mfma_f32_16x16x32_bf16 v[52:55], v[84:87], a[212:215], v[52:55]
    ds_read_b128 v[80:83], v3 offset:50176
    v_mfma_f32_16x16x32_bf16 v[56:59], v[88:91], a[212:215], v[56:59]
    ds_read_b128 v[84:87], v3 offset:51200
    v_mfma_f32_16x16x32_bf16 v[60:63], v[92:95], a[212:215], v[60:63]
    ds_read_b128 v[88:91], v3 offset:52224
    v_mfma_f32_16x16x32_bf16 v[64:67], v[96:99], a[212:215], v[64:67]
    ds_read_b128 v[92:95], v3 offset:53248
    v_mfma_f32_16x16x32_bf16 v[68:71], v[100:103], a[212:215], v[68:71]
    ds_read_b128 v[96:99], v3 offset:54272
    s_waitcnt vmcnt(14) lgkmcnt(5)
    v_mfma_f32_16x16x32_bf16 v[52:55], v[104:107], a[216:219], v[52:55]
    ds_read_b128 v[100:103], v3 offset:55296
    buffer_load_dwordx4 a[208:211], v13, s[8:11], s29 offen offset:1024 sc1
    v_mfma_f32_16x16x32_bf16 v[56:59], v[108:111], a[216:219], v[56:59]
    ds_read_b128 v[104:107], v3 offset:56320
    v_cvt_pk_bf16_f32 v208, v116, v117
    v_mfma_f32_16x16x32_bf16 v[60:63], v[112:115], a[216:219], v[60:63]
    ds_read_b128 v[108:111], v3 offset:57344
    v_cvt_pk_bf16_f32 v209, v118, v119
    v_mfma_f32_16x16x32_bf16 v[64:67], v[72:75], a[216:219], v[64:67]
    ds_read_b128 v[112:115], v3 offset:58368
    buffer_load_dwordx4 a[212:215], v13, s[8:11], s29 offen offset:2048 sc1
    v_mfma_f32_16x16x32_bf16 v[68:71], v[76:79], a[216:219], v[68:71]
    ds_read_b128 v[72:75], v3 offset:59392
    s_waitcnt vmcnt(15) lgkmcnt(5)
    v_mfma_f32_16x16x32_bf16 v[52:55], v[80:83], a[220:223], v[52:55]
    ds_read_b128 v[76:79], v3 offset:60416
    v_cvt_pk_bf16_f32 v210, v120, v121
    v_mfma_f32_16x16x32_bf16 v[56:59], v[84:87], a[220:223], v[56:59]
    ds_read_b128 v[80:83], v3 offset:61440
    v_cvt_pk_bf16_f32 v211, v122, v123
    v_mfma_f32_16x16x32_bf16 v[60:63], v[88:91], a[220:223], v[60:63]
    ds_read_b128 v[84:87], v3 offset:62464
    buffer_load_dwordx4 a[216:219], v13, s[8:11], s30 offen offset:0 sc1
    v_mfma_f32_16x16x32_bf16 v[64:67], v[92:95], a[220:223], v[64:67]
    ds_read_b128 v[88:91], v3 offset:63488
    v_cvt_pk_bf16_f32 v212, v124, v125
    v_mfma_f32_16x16x32_bf16 v[68:71], v[96:99], a[220:223], v[68:71]
    ds_read_b128 v[92:95], v3 offset:64512
    s_waitcnt vmcnt(15) lgkmcnt(5)
    s_nop 0
    v_cvt_pk_bf16_f32 v213, v126, v127
    v_cvt_pk_bf16_f32 v214, v128, v129
    v_cvt_pk_bf16_f32 v215, v130, v131
    v_cvt_pk_bf16_f32 v216, v132, v133
    v_cvt_pk_bf16_f32 v217, v134, v135
    v_mfma_f32_16x16x32_bf16 v[52:55], v[100:103], a[224:227], v[52:55]
    ds_read_b128 v[96:99], v4 offset:0
    v_mfma_f32_16x16x32_bf16 v[56:59], v[104:107], a[224:227], v[56:59]
    ds_read_b128 v[100:103], v4 offset:1024
    s_cmp_eq_u32 s76, 0
    s_cbranch_scc0 L_st_44_s
    buffer_store_dwordx4 v[208:211], v220, s[48:51], 0 offen
L_st_44_e:
    v_mfma_f32_16x16x32_bf16 v[60:63], v[108:111], a[224:227], v[60:63]
    ds_read_b128 v[104:107], v4 offset:2048
    v_mfma_f32_16x16x32_bf16 v[64:67], v[112:115], a[224:227], v[64:67]
    ds_read_b128 v[108:111], v4 offset:3072
    v_mfma_f32_16x16x32_bf16 v[68:71], v[72:75], a[224:227], v[68:71]
    ds_read_b128 v[112:115], v4 offset:4096
    s_waitcnt vmcnt(15) lgkmcnt(5)
    v_mfma_f32_16x16x32_bf16 v[52:55], v[76:79], a[228:231], v[52:55]
    ds_read_b128 v[72:75], v4 offset:5120
    s_cmp_eq_u32 s76, 0
    s_cbranch_scc0 L_st_45_s
    buffer_store_dwordx4 v[212:215], v220, s[48:51], 0 offen offset:2048
L_st_45_e:
    v_mfma_f32_16x16x32_bf16 v[56:59], v[80:83], a[228:231], v[56:59]
    ds_read_b128 v[76:79], v4 offset:6144
    v_mfma_f32_16x16x32_bf16 v[60:63], v[84:87], a[228:231], v[60:63]
    ds_read_b128 v[80:83], v4 offset:7168
    v_mfma_f32_16x16x32_bf16 v[64:67], v[88:91], a[228:231], v[64:67]
    ds_read_b128 v[84:87], v4 offset:8192
    v_mfma_f32_16x16x32_bf16 v[68:71], v[92:95], a[228:231], v[68:71]
    ds_read_b128 v[88:91], v4 offset:9216
    s_waitcnt vmcnt(15) lgkmcnt(5)
    v_mfma_f32_16x16x32_bf16 v[52:55], v[96:99], a[232:235], v[52:55]
    ds_read_b128 v[92:95], v4 offset:10240
    s_cmp_eq_u32 s76, 0
    s_cbranch_scc0 L_st_46_s
    buffer_store_dwordx2 v[216:217], v221, s[48:51], 0 offen
L_st_46_e:
    v_mfma_f32_16x16x32_bf16 v[56:59], v[100:103], a[232:235], v[56:59]
    ds_read_b128 v[96:99], v4 offset:11264
    v_mfma_f32_16x16x32_bf16 v[60:63], v[104:107], a[232:235], v[60:63]
    ds_read_b128 v[100:103], v4 offset:12288
    v_mfma_f32_16x16x32_bf16 v[64:67], v[108:111], a[232:235], v[64:67]
    ds_read_b128 v[104:107], v4 offset:13312
    buffer_load_dwordx4 a[220:223], v13, s[8:11], s30 offen offset:1024 sc1
    v_mfma_f32_16x16x32_bf16 v[68:71], v[112:115], a[232:235], v[68:71]
    ds_read_b128 v[108:111], v4 offset:14336
    s_waitcnt vmcnt(16) lgkmcnt(5)
    v_mfma_f32_16x16x32_bf16 v[52:55], v[72:75], a[236:239], v[52:55]
    ds_read_b128 v[112:115], v4 offset:15360
    v_mfma_f32_16x16x32_bf16 v[56:59], v[76:79], a[236:239], v[56:59]
    ds_read_b128 v[72:75], v4 offset:16384
    v_mfma_f32_16x16x32_bf16 v[60:63], v[80:83], a[236:239], v[60:63]
    ds_read_b128 v[76:79], v4 offset:17408
    buffer_load_dwordx4 a[224:227], v13, s[8:11], s30 offen offset:2048 sc1
    v_mfma_f32_16x16x32_bf16 v[64:67], v[84:87], a[236:239], v[64:67]
    ds_read_b128 v[80:83], v4 offset:18432
    v_mfma_f32_16x16x32_bf16 v[68:71], v[88:91], a[236:239], v[68:71]
    ds_read_b128 v[84:87], v4 offset:19456
    s_waitcnt vmcnt(16) lgkmcnt(5)
    v_mfma_f32_16x16x32_bf16 v[52:55], v[92:95], a[240:243], v[52:55]
    ds_read_b128 v[88:91], v4 offset:20480
    v_mfma_f32_16x16x32_bf16 v[56:59], v[96:99], a[240:243], v[56:59]
    ds_read_b128 v[92:95], v4 offset:21504
    buffer_load_dwordx4 a[228:231], v13, s[8:11], s31 offen offset:0 sc1
    v_mfma_f32_16x16x32_bf16 v[60:63], v[100:103], a[240:243], v[60:63]
    ds_read_b128 v[96:99], v4 offset:22528
    v_mfma_f32_16x16x32_bf16 v[64:67], v[104:107], a[240:243], v[64:67]
    ds_read_b128 v[100:103], v4 offset:23552
    v_mfma_f32_16x16x32_bf16 v[68:71], v[108:111], a[240:243], v[68:71]
    ds_read_b128 v[104:107], v4 offset:24576
    s_waitcnt vmcnt(16) lgkmcnt(5)
    v_mfma_f32_16x16x32_bf16 v[52:55], v[112:115], a[244:247], v[52:55]
    ds_read_b128 v[108:111], v4 offset:25600
    buffer_load_dwordx4 a[232:235], v13, s[8:11], s31 offen offset:1024 sc1
    v_mfma_f32_16x16x32_bf16 v[56:59], v[72:75], a[244:247], v[56:59]
    ds_read_b128 v[112:115], v4 offset:26624
    v_mfma_f32_16x16x32_bf16 v[60:63], v[76:79], a[244:247], v[60:63]
    ds_read_b128 v[72:75], v4 offset:27648
    v_mfma_f32_16x16x32_bf16 v[64:67], v[80:83], a[244:247], v[64:67]
    ds_read_b128 v[76:79], v2 offset:0
    v_mfma_f32_16x16x32_bf16 v[68:71], v[84:87], a[244:247], v[68:71]
    ds_read_b128 v[80:83], v2 offset:1024
    s_waitcnt vmcnt(16) lgkmcnt(5)
    v_mfma_f32_16x16x32_bf16 v[52:55], v[88:91], a[248:251], v[52:55]
    ds_read_b128 v[84:87], v2 offset:2048
    buffer_load_dwordx4 a[236:239], v13, s[8:11], s31 offen offset:2048 sc1
    v_mfma_f32_16x16x32_bf16 v[56:59], v[92:95], a[248:251], v[56:59]
    ds_read_b128 v[88:91], v2 offset:3072
    v_mfma_f32_16x16x32_bf16 v[60:63], v[96:99], a[248:251], v[60:63]
    ds_read_b128 v[92:95], v2 offset:4096
    v_mfma_f32_16x16x32_bf16 v[64:67], v[100:103], a[248:251], v[64:67]
    ds_read_b128 v[96:99], v2 offset:5120
    v_mfma_f32_16x16x32_bf16 v[68:71], v[104:107], a[248:251], v[68:71]
    ds_read_b128 v[100:103], v2 offset:6144
    s_waitcnt vmcnt(16) lgkmcnt(5)
    v_mfma_f32_16x16x32_bf16 v[52:55], v[108:111], a[184:187], v[52:55]
    ds_read_b128 v[104:107], v2 offset:7168
    v_mfma_f32_16x16x32_bf16 v[56:59], v[112:115], a[184:187], v[56:59]
    ds_read_b128 v[108:111], v2 offset:8192
    v_mfma_f32_16x16x32_bf16 v[60:63], v[72:75], a[184:187], v[60:63]
    ds_read_b128 v[112:115], v2 offset:9216
    v_mfma_f32_16x16x32_bf16 v[64:67], v[76:79], a[184:187], v[64:67]
    ds_read_b128 v[72:75], v2 offset:10240
    v_mfma_f32_16x16x32_bf16 v[68:71], v[80:83], a[184:187], v[68:71]
    ds_read_b128 v[76:79], v2 offset:11264
    s_waitcnt vmcnt(15) lgkmcnt(5)
    s_waitcnt vmcnt(5)
    s_mov_b64 exec, 1
    s_cmp_eq_u32 s76, 0
    s_cbranch_scc0 L_st_47_s
    buffer_store_dword v28, off, s[48:51], s85 offset:128
L_st_47_e:
    s_mov_b64 exec, -1
    v_mfma_f32_16x16x32_bf16 v[52:55], v[84:87], a[188:191], v[52:55]
    ds_read_b128 v[80:83], v2 offset:12288
    v_mfma_f32_16x16x32_bf16 v[56:59], v[88:91], a[188:191], v[56:59]
    ds_read_b128 v[84:87], v2 offset:13312
    v_mfma_f32_16x16x32_bf16 v[60:63], v[92:95], a[188:191], v[60:63]
    ds_read_b128 v[88:91], v2 offset:14336
    v_mfma_f32_16x16x32_bf16 v[64:67], v[96:99], a[188:191], v[64:67]
    ds_read_b128 v[92:95], v2 offset:15360
    v_mfma_f32_16x16x32_bf16 v[68:71], v[100:103], a[188:191], v[68:71]
    ds_read_b128 v[96:99], v2 offset:16384
    s_waitcnt lgkmcnt(5)
    v_mfma_f32_16x16x32_bf16 v[52:55], v[104:107], a[192:195], v[52:55]
    ds_read_b128 v[100:103], v2 offset:17408
    v_mfma_f32_16x16x32_bf16 v[56:59], v[108:111], a[192:195], v[56:59]
    ds_read_b128 v[104:107], v2 offset:18432
    v_mfma_f32_16x16x32_bf16 v[60:63], v[112:115], a[192:195], v[60:63]
    ds_read_b128 v[108:111], v2 offset:19456
    v_mfma_f32_16x16x32_bf16 v[64:67], v[72:75], a[192:195], v[64:67]
    ds_read_b128 v[112:115], v2 offset:20480
    v_mfma_f32_16x16x32_bf16 v[68:71], v[76:79], a[192:195], v[68:71]
    ds_read_b128 v[72:75], v2 offset:21504
    s_waitcnt lgkmcnt(5)
    v_mfma_f32_16x16x32_bf16 v[52:55], v[80:83], a[196:199], v[52:55]
    ds_read_b128 v[76:79], v2 offset:22528
    v_mfma_f32_16x16x32_bf16 v[56:59], v[84:87], a[196:199], v[56:59]
    ds_read_b128 v[80:83], v2 offset:23552
    v_mfma_f32_16x16x32_bf16 v[60:63], v[88:91], a[196:199], v[60:63]
    ds_read_b128 v[84:87], v2 offset:24576
    v_mfma_f32_16x16x32_bf16 v[64:67], v[92:95], a[196:199], v[64:67]
    ds_read_b128 v[88:91], v2 offset:25600
    buffer_load_dword v222, off, s[48:51], s97 offset:128 sc1
    v_mfma_f32_16x16x32_bf16 v[68:71], v[96:99], a[196:199], v[68:71]
    ds_read_b128 v[92:95], v2 offset:26624
    s_waitcnt lgkmcnt(5)
    v_mfma_f32_16x16x32_bf16 v[52:55], v[100:103], a[200:203], v[52:55]
    ds_read_b128 v[96:99], v2 offset:27648
    v_mfma_f32_16x16x32_bf16 v[56:59], v[104:107], a[200:203], v[56:59]
    ds_read_b128 v[100:103], v2 offset:28672
    v_mfma_f32_16x16x32_bf16 v[60:63], v[108:111], a[200:203], v[60:63]
    ds_read_b128 v[104:107], v2 offset:29696
    v_mfma_f32_16x16x32_bf16 v[64:67], v[112:115], a[200:203], v[64:67]
    ds_read_b128 v[108:111], v2 offset:30720
    v_mfma_f32_16x16x32_bf16 v[68:71], v[72:75], a[200:203], v[68:71]
    ds_read_b128 v[112:115], v2 offset:31744
    s_waitcnt lgkmcnt(5)
    v_mfma_f32_16x16x32_bf16 v[52:55], v[76:79], a[204:207], v[52:55]
    ds_read_b128 v[72:75], v2 offset:32768
    v_mfma_f32_16x16x32_bf16 v[56:59], v[80:83], a[204:207], v[56:59]
    ds_read_b128 v[76:79], v2 offset:33792
    v_mfma_f32_16x16x32_bf16 v[60:63], v[84:87], a[204:207], v[60:63]
    ds_read_b128 v[80:83], v2 offset:34816
    v_mfma_f32_16x16x32_bf16 v[64:67], v[88:91], a[204:207], v[64:67]
    ds_read_b128 v[84:87], v2 offset:35840
    v_mfma_f32_16x16x32_bf16 v[68:71], v[92:95], a[204:207], v[68:71]
    ds_read_b128 v[88:91], v2 offset:36864
    s_waitcnt lgkmcnt(5)
    s_waitcnt vmcnt(0)
L_gx_ck0:
    v_cmp_ne_u32 vcc, s81, v222
    s_cbranch_vccz L_gx_ok0
    buffer_load_dword v222, off, s[48:51], s97 offset:128 sc1
    s_sub_u32 s80, s80, 1
    s_cbranch_scc1 L_end
    s_waitcnt vmcnt(0)
    s_branch L_gx_ck0
L_gx_ok0:
    v_mfma_f32_16x16x32_bf16 v[52:55], v[96:99], a[208:211], v[52:55]
    ds_read_b128 v[92:95], v2 offset:37888
    v_mfma_f32_16x16x32_bf16 v[56:59], v[100:103], a[208:211], v[56:59]
    ds_read_b128 v[96:99], v2 offset:38912
    v_mfma_f32_16x16x32_bf16 v[60:63], v[104:107], a[208:211], v[60:63]
    ds_read_b128 v[100:103], v2 offset:39936
    v_mfma_f32_16x16x32_bf16 v[64:67], v[108:111], a[208:211], v[64:67]
    ds_read_b128 v[104:107], v2 offset:40960
    v_mfma_f32_16x16x32_bf16 v[68:71], v[112:115], a[208:211], v[68:71]
    ds_read_b128 v[108:111], v2 offset:41984
    s_waitcnt lgkmcnt(5)
    v_mfma_f32_16x16x32_bf16 v[52:55], v[72:75], a[212:215], v[52:55]
    ds_read_b128 v[112:115], v2 offset:43008
    buffer_load_dwordx4 v[224:227], v14, s[48:51], 0 offen sc1
    v_mfma_f32_16x16x32_bf16 v[56:59], v[76:79], a[212:215], v[56:59]
    ds_read_b128 v[72:75], v2 offset:44032
    v_mfma_f32_16x16x32_bf16 v[60:63], v[80:83], a[212:215], v[60:63]
    ds_read_b128 v[76:79], v2 offset:45056
    v_mfma_f32_16x16x32_bf16 v[64:67], v[84:87], a[212:215], v[64:67]
    ds_read_b128 v[80:83], v2 offset:46080
    buffer_load_dwordx4 v[228:231], v14, s[48:51], 0 offen offset:2048 sc1
    v_mfma_f32_16x16x32_bf16 v[68:71], v[88:91], a[212:215], v[68:71]
    ds_read_b128 v[84:87], v2 offset:47104
    s_waitcnt lgkmcnt(5)
    v_mfma_f32_16x16x32_bf16 v[52:55], v[92:95], a[216:219], v[52:55]
    ds_read_b128 v[88:91], v2 offset:48128
    v_mfma_f32_16x16x32_bf16 v[56:59], v[96:99], a[216:219], v[56:59]
    ds_read_b128 v[92:95], v2 offset:49152
    v_mfma_f32_16x16x32_bf16 v[60:63], v[100:103], a[216:219], v[60:63]
    ds_read_b128 v[96:99], v2 offset:50176
    buffer_load_dwordx2 v[232:233], v15, s[48:51], 0 offen sc1
    v_mfma_f32_16x16x32_bf16 v[64:67], v[104:107], a[216:219], v[64:67]
    ds_read_b128 v[100:103], v2 offset:51200
    v_mfma_f32_16x16x32_bf16 v[68:71], v[108:111], a[216:219], v[68:71]
    ds_read_b128 v[104:107], v2 offset:52224
    s_waitcnt lgkmcnt(5)
    v_mfma_f32_16x16x32_bf16 v[52:55], v[112:115], a[220:223], v[52:55]
    ds_read_b128 v[108:111], v2 offset:53248
    v_mfma_f32_16x16x32_bf16 v[56:59], v[72:75], a[220:223], v[56:59]
    ds_read_b128 v[112:115], v2 offset:54272
    v_mfma_f32_16x16x32_bf16 v[60:63], v[76:79], a[220:223], v[60:63]
    ds_read_b128 v[72:75], v2 offset:55296
    v_mfma_f32_16x16x32_bf16 v[64:67], v[80:83], a[220:223], v[64:67]
    ds_read_b128 v[76:79], v2 offset:56320
    v_mfma_f32_16x16x32_bf16 v[68:71], v[84:87], a[220:223], v[68:71]
    ds_read_b128 v[80:83], v2 offset:57344
    s_waitcnt lgkmcnt(5)
    v_mfma_f32_16x16x32_bf16 v[52:55], v[88:91], a[224:227], v[52:55]
    ds_read_b128 v[84:87], v2 offset:58368
    v_mfma_f32_16x16x32_bf16 v[56:59], v[92:95], a[224:227], v[56:59]
    ds_read_b128 v[88:91], v2 offset:59392
    v_mfma_f32_16x16x32_bf16 v[60:63], v[96:99], a[224:227], v[60:63]
    ds_read_b128 v[92:95], v2 offset:60416
    v_mfma_f32_16x16x32_bf16 v[64:67], v[100:103], a[224:227], v[64:67]
    ds_read_b128 v[96:99], v2 offset:61440
    v_mfma_f32_16x16x32_bf16 v[68:71], v[104:107], a[224:227], v[68:71]
    ds_read_b128 v[100:103], v2 offset:62464
    s_waitcnt lgkmcnt(5)
    v_mfma_f32_16x16x32_bf16 v[52:55], v[108:111], a[228:231], v[52:55]
    ds_read_b128 v[104:107], v2 offset:63488
    v_mfma_f32_16x16x32_bf16 v[56:59], v[112:115], a[228:231], v[56:59]
    ds_read_b128 v[108:111], v2 offset:64512
    v_mfma_f32_16x16x32_bf16 v[60:63], v[72:75], a[228:231], v[60:63]
    ds_read_b128 v[112:115], v3 offset:0
    v_mfma_f32_16x16x32_bf16 v[64:67], v[76:79], a[228:231], v[64:67]
    ds_read_b128 v[72:75], v3 offset:1024
    v_mfma_f32_16x16x32_bf16 v[68:71], v[80:83], a[228:231], v[68:71]
    ds_read_b128 v[76:79], v3 offset:2048
    s_waitcnt lgkmcnt(5)
    v_mfma_f32_16x16x32_bf16 v[52:55], v[84:87], a[232:235], v[52:55]
    s_waitcnt vmcnt(0)
    v_lshlrev_b32 v136, 16, v224
    v_mfma_f32_16x16x32_bf16 v[56:59], v[88:91], a[232:235], v[56:59]
    v_and_b32 v137, 0xffff0000, v224
    v_lshlrev_b32 v138, 16, v225
    v_mfma_f32_16x16x32_bf16 v[60:63], v[92:95], a[232:235], v[60:63]
    v_and_b32 v139, 0xffff0000, v225
    v_lshlrev_b32 v140, 16, v226
    v_mfma_f32_16x16x32_bf16 v[64:67], v[96:99], a[232:235], v[64:67]
    v_and_b32 v141, 0xffff0000, v226
    v_lshlrev_b32 v142, 16, v227
    v_mfma_f32_16x16x32_bf16 v[68:71], v[100:103], a[232:235], v[68:71]
    v_and_b32 v143, 0xffff0000, v227
    s_waitcnt lgkmcnt(0)
    v_mfma_f32_16x16x32_bf16 v[52:55], v[104:107], a[236:239], v[52:55]
    v_lshlrev_b32 v144, 16, v228
    v_and_b32 v145, 0xffff0000, v228
    v_mfma_f32_16x16x32_bf16 v[56:59], v[108:111], a[236:239], v[56:59]
    v_lshlrev_b32 v146, 16, v229
    v_and_b32 v147, 0xffff0000, v229
    v_mfma_f32_16x16x32_bf16 v[60:63], v[112:115], a[236:239], v[60:63]
    v_lshlrev_b32 v148, 16, v230
    v_and_b32 v149, 0xffff0000, v230
    v_mfma_f32_16x16x32_bf16 v[64:67], v[72:75], a[236:239], v[64:67]
    v_lshlrev_b32 v150, 16, v231
    v_and_b32 v151, 0xffff0000, v231
    v_mfma_f32_16x16x32_bf16 v[68:71], v[76:79], a[236:239], v[68:71]
    v_lshlrev_b32 v152, 16, v232
    v_and_b32 v153, 0xffff0000, v232
    v_lshlrev_b32_e64 v154, 16, v233
    v_and_b32 v155, 0xffff0000, v233
    v_pk_add_f32 v[52:53], v[52:53], v[136:137]
    v_pk_add_f32 v[54:55], v[54:55], v[138:139]
    v_pk_add_f32 v[56:57], v[56:57], v[140:141]
    v_pk_add_f32 v[58:59], v[58:59], v[142:143]
    v_pk_add_f32 v[60:61], v[60:61], v[144:145]
    v_pk_add_f32 v[62:63], v[62:63], v[146:147]
    v_pk_add_f32 v[64:65], v[64:65], v[148:149]
    v_pk_add_f32 v[66:67], v[66:67], v[150:151]
    v_pk_add_f32 v[68:69], v[68:69], v[152:153]
    v_pk_add_f32 v[70:71], v[70:71], v[154:155]
L_p50:
    s_cmp_eq_u32 s76, 0
    s_cbranch_scc0 L_sec_49_s
    v_cvt_pk_bf16_f32 v208, v52, v53
    v_cvt_pk_bf16_f32 v209, v54, v55
    v_cvt_pk_bf16_f32 v210, v56, v57
    v_cvt_pk_bf16_f32 v211, v58, v59
    buffer_store_dwordx4 v[208:211], v14, s[48:51], 0 offen
    v_cvt_pk_bf16_f32 v212, v60, v61
    v_cvt_pk_bf16_f32 v213, v62, v63
    v_cvt_pk_bf16_f32 v214, v64, v65
    v_cvt_pk_bf16_f32 v215, v66, v67
    v_cvt_pk_bf16_f32 v216, v68, v69
    v_cvt_pk_bf16_f32 v217, v70, v71
    v_pk_add_f32 v[228:229], v[52:53], v[54:55]
    v_pk_mul_f32 v[230:231], v[52:53], v[52:53]
    v_pk_fma_f32 v[230:231], v[54:55], v[54:55], v[230:231]
    v_pk_add_f32 v[228:229], v[228:229], v[56:57]
    v_pk_fma_f32 v[230:231], v[56:57], v[56:57], v[230:231]
    v_pk_add_f32 v[228:229], v[228:229], v[58:59]
    buffer_store_dwordx4 v[212:215], v14, s[48:51], 0 offen offset:2048
    v_pk_fma_f32 v[230:231], v[58:59], v[58:59], v[230:231]
    v_pk_add_f32 v[228:229], v[228:229], v[60:61]
    v_pk_fma_f32 v[230:231], v[60:61], v[60:61], v[230:231]
    v_pk_add_f32 v[228:229], v[228:229], v[62:63]
    v_pk_fma_f32 v[230:231], v[62:63], v[62:63], v[230:231]
    v_pk_add_f32 v[228:229], v[228:229], v[64:65]
    v_pk_fma_f32 v[230:231], v[64:65], v[64:65], v[230:231]
    v_pk_add_f32 v[228:229], v[228:229], v[66:67]
    v_pk_fma_f32 v[230:231], v[66:67], v[66:67], v[230:231]
    v_pk_add_f32 v[228:229], v[228:229], v[68:69]
    v_pk_fma_f32 v[230:231], v[68:69], v[68:69], v[230:231]
    v_pk_add_f32 v[228:229], v[228:229], v[70:71]
    v_pk_fma_f32 v[230:231], v[70:71], v[70:71], v[230:231]
    v_add_f32 v228, v228, v229
    v_add_f32 v230, v230, v231
    buffer_store_dwordx2 v[216:217], v15, s[48:51], 0 offen
    s_nop 0
    v_permlane32_swap_b32 v228, v230
    v_add_f32 v228, v228, v230
    v_mov_b32 v230, v228
    s_nop 1
    v_permlane16_swap_b32 v228, v230
    v_add_f32 v230, v228, v230
    buffer_store_dword v230, v18, s[48:51], 0 offen
    s_barrier
    ds_write_b128 v36, a[0:3] offset:0
    ds_write_b128 v36, a[4:7] offset:4096
    ds_write_b128 v36, a[8:11] offset:8192
    ds_write_b128 v36, a[12:15] offset:12288
    ds_write_b128 v36, a[16:19] offset:16384
    ds_write_b128 v36, a[20:23] offset:20480
    ds_write_b128 v36, a[24:27] offset:24576
    s_waitcnt vmcnt(0)
    s_mov_b64 exec, 1
    buffer_store_dword v28, off, s[48:51], s84 offset:0
    s_mov_b64 exec, -1
    s_mov_b64 s[8:9], s[48:49]
    s_add_u32 s48, s48, s56
    s_addc_u32 s49, s49, 0
L_sec_49_e:
    ds_write_b128 v36, a[28:31] offset:28672
    ds_write_b128 v36, a[32:35] offset:32768
    ds_write_b128 v36, a[36:39] offset:36864
    ds_write_b128 v36, a[40:43] offset:40960
    ds_write_b128 v36, a[44:47] offset:45056
    s_mov_b32 s75, 1
    v_add_u32 v30, s89, v2
    v_add_u32 v49, s68, v36
    s_waitcnt lgkmcnt(6)
    s_barrier
    s_nop 0
    ds_read_b64_tr_b16 v[136:137], v5 offset:0
    ds_read_b64_tr_b16 v[138:139], v5 offset:1024
    ds_read_b64_tr_b16 v[140:141], v5 offset:256
    ds_read_b64_tr_b16 v[142:143], v5 offset:1280
    ds_read_b64_tr_b16 v[144:145], v5 offset:512
    ds_read_b64_tr_b16 v[146:147], v5 offset:1536
    ds_read_b64_tr_b16 v[148:149], v8 offset:768
    ds_read_b64_tr_b16 v[150:151], v8 offset:1792
    ds_read_b64_tr_b16 v[152:153], v5 offset:4096
    ds_read_b64_tr_b16 v[154:155], v5 offset:5120
L_poll_52:
    buffer_load_dword v252, v27, s[8:11], s82 offen offset:0 sc1
    s_sub_u32 s80, s80, 1
    s_cbranch_scc1 L_end
    s_waitcnt vmcnt(0)
    v_cmp_ne_u32 vcc, s81, v252
    s_cbranch_vccnz L_poll_52
    buffer_load_dwordx4 a[0:3], v11, s[8:11], 0 offen offset:0 sc1
    buffer_load_dwordx4 a[4:7], v11, s[8:11], 0 offen offset:1024 sc1
    buffer_load_dwordx4 a[8:11], v11, s[8:11], 0 offen offset:2048 sc1
    s_waitcnt vmcnt(2) lgkmcnt(6)
    v_mfma_f32_32x32x16_bf16 v[72:87], v[136:139], a[0:3], 0
    ds_read_b64_tr_b16 v[156:157], v5 offset:4352
    ds_read_b64_tr_b16 v[158:159], v5 offset:5376
    buffer_load_dwordx4 a[12:15], v11, s[8:11], 0 offen offset:3072 sc1
    v_mfma_f32_32x32x16_bf16 v[88:103], v[140:143], a[0:3], 0
    ds_read_b64_tr_b16 v[136:137], v5 offset:4608
    ds_read_b64_tr_b16 v[138:139], v5 offset:5632
    ds_write_b64 v36, a[48:49] offset:49152
    s_waitcnt lgkmcnt(7)
    v_mfma_f32_32x32x16_bf16 v[104:119], v[144:147], a[0:3], 0
    ds_read_b64_tr_b16 v[140:141], v8 offset:4864
    ds_read_b64_tr_b16 v[142:143], v8 offset:5888
    buffer_load_dwordx4 a[16:19], v11, s[8:11], s32 offen offset:0 sc1
    v_mfma_f32_32x32x16_bf16 v[120:135], v[148:151], a[0:3], 0
    ds_read_b64_tr_b16 v[144:145], v5 offset:8192
    ds_read_b64_tr_b16 v[146:147], v5 offset:9216
    ds_write_b64 v36, a[50:51] offset:49160
    s_waitcnt vmcnt(3) lgkmcnt(8)
    v_mfma_f32_32x32x16_bf16 v[72:87], v[152:155], a[4:7], v[72:87]
    ds_read_b64_tr_b16 v[148:149], v5 offset:8448
    ds_read_b64_tr_b16 v[150:151], v5 offset:9472
    buffer_load_dwordx4 a[20:23], v11, s[8:11], s32 offen offset:1024 sc1
    v_mfma_f32_32x32x16_bf16 v[88:103], v[156:159], a[4:7], v[88:103]
    ds_read_b64_tr_b16 v[152:153], v5 offset:8704
    ds_read_b64_tr_b16 v[154:155], v5 offset:9728
    ds_write_b64 v36, a[52:53] offset:53248
    s_waitcnt lgkmcnt(8)
    v_mfma_f32_32x32x16_bf16 v[104:119], v[136:139], a[4:7], v[104:119]
    ds_read_b64_tr_b16 v[156:157], v8 offset:8960
    ds_read_b64_tr_b16 v[158:159], v8 offset:9984
    buffer_load_dwordx4 a[24:27], v11, s[8:11], s32 offen offset:2048 sc1
    v_mfma_f32_32x32x16_bf16 v[120:135], v[140:143], a[4:7], v[120:135]
    ds_read_b64_tr_b16 v[136:137], v5 offset:12288
    ds_read_b64_tr_b16 v[138:139], v5 offset:13312
L_pad8:
    s_cbranch_execz L_pad12
    ds_write_b64 v36, a[54:55] offset:53256
    s_waitcnt vmcnt(4) lgkmcnt(8)
    v_mfma_f32_32x32x16_bf16 v[72:87], v[144:147], a[8:11], v[72:87]
    ds_read_b64_tr_b16 v[140:141], v5 offset:12544
    ds_read_b64_tr_b16 v[142:143], v5 offset:13568
    buffer_load_dwordx4 v[244:247], v19, s[8:11], 0 offen offset:0 sc1
    v_mfma_f32_32x32x16_bf16 v[88:103], v[148:151], a[8:11], v[88:103]
    ds_read_b64_tr_b16 v[144:145], v5 offset:12800
    ds_read_b64_tr_b16 v[146:147], v5 offset:13824
    ds_write_b64 v36, a[56:57] offset:57344
    s_waitcnt lgkmcnt(8)
    v_mfma_f32_32x32x16_bf16 v[104:119], v[152:155], a[8:11], v[104:119]
    ds_read_b64_tr_b16 v[148:149], v8 offset:13056
    ds_read_b64_tr_b16 v[150:151], v8 offset:14080
    buffer_load_dwordx4 a[28:31], v11, s[8:11], s32 offen offset:3072 sc1
    v_mfma_f32_32x32x16_bf16 v[120:135], v[156:159], a[8:11], v[120:135]
    ds_read_b64_tr_b16 v[152:153], v5 offset:16384
    ds_read_b64_tr_b16 v[154:155], v5 offset:17408
    ds_write_b64 v36, a[58:59] offset:57352
    s_waitcnt vmcnt(5) lgkmcnt(8)
    v_mfma_f32_32x32x16_bf16 v[72:87], v[136:139], a[12:15], v[72:87]
    ds_read_b64_tr_b16 v[156:157], v5 offset:16640
    ds_read_b64_tr_b16 v[158:159], v5 offset:17664
    buffer_load_dwordx4 v[248:251], v19, s[8:11], 0 offen offset:1024 sc1
    v_mfma_f32_32x32x16_bf16 v[88:103], v[140:143], a[12:15], v[88:103]
    ds_read_b64_tr_b16 v[136:137], v5 offset:16896
    ds_read_b64_tr_b16 v[138:139], v5 offset:17920
    ds_write_b64 v36, a[60:61] offset:61440
    s_waitcnt lgkmcnt(8)
    v_mfma_f32_32x32x16_bf16 v[104:119], v[144:147], a[12:15], v[104:119]
    ds_read_b64_tr_b16 v[140:141], v8 offset:17152
    ds_read_b64_tr_b16 v[142:143], v8 offset:18176
    buffer_load_dwordx4 a[32:35], v11, s[8:11], s33 offen offset:0 sc1
    v_mfma_f32_32x32x16_bf16 v[120:135], v[148:151], a[12:15], v[120:135]
    ds_read_b64_tr_b16 v[144:145], v5 offset:20480
    ds_read_b64_tr_b16 v[146:147], v5 offset:21504
    ds_write_b64 v36, a[62:63] offset:61448
    s_waitcnt vmcnt(6) lgkmcnt(8)
    v_mfma_f32_32x32x16_bf16 v[72:87], v[152:155], a[16:19], v[72:87]
    ds_read_b64_tr_b16 v[148:149], v5 offset:20736
    ds_read_b64_tr_b16 v[150:151], v5 offset:21760
    buffer_load_dwordx4 a[184:187], v49, s[4:7], 0 offen sc1
    v_mfma_f32_32x32x16_bf16 v[88:103], v[156:159], a[16:19], v[88:103]
    ds_read_b64_tr_b16 v[152:153], v5 offset:20992
    ds_read_b64_tr_b16 v[154:155], v5 offset:22016
    ds_write_b64 v37, a[64:65] offset:0
    s_waitcnt lgkmcnt(8)
    v_mfma_f32_32x32x16_bf16 v[104:119], v[136:139], a[16:19], v[104:119]
    ds_read_b64_tr_b16 v[156:157], v8 offset:21248
    ds_read_b64_tr_b16 v[158:159], v8 offset:22272
    buffer_load_dwordx4 a[36:39], v11, s[8:11], s33 offen offset:1024 sc1
    v_mfma_f32_32x32x16_bf16 v[120:135], v[140:143], a[16:19], v[120:135]
    s_barrier
    ds_read_b64_tr_b16 v[136:137], v5 offset:24576
    ds_read_b64_tr_b16 v[138:139], v5 offset:25600
    ds_write_b64 v37, a[66:67] offset:8
    s_waitcnt vmcnt(7) lgkmcnt(8)
    v_mfma_f32_32x32x16_bf16 v[72:87], v[144:147], a[20:23], v[72:87]
    ds_read_b64_tr_b16 v[140:141], v5 offset:24832
    ds_read_b64_tr_b16 v[142:143], v5 offset:25856
    buffer_load_dwordx4 a[188:191], v49, s[4:7], s32 offen sc1
    v_mfma_f32_32x32x16_bf16 v[88:103], v[148:151], a[20:23], v[88:103]
    ds_read_b64_tr_b16 v[144:145], v5 offset:25088
    ds_read_b64_tr_b16 v[146:147], v5 offset:26112
    v_lshrrev_b32 v254, 8, v2
    v_cmp_eq_u32 vcc, 2, v254
    s_lshr_b32 s3, s74, 2
    s_add_u32 s3, s3, 105984
    v_add_u32 v254, s3, v2
    v_add_u32 v48, 81920, v36
    v_cndmask_b32 v48, v48, v254, vcc
    v_mov_b32 v243, 4096
    v_mov_b32 v254, 1024
    v_cndmask_b32 v243, v243, v254, vcc
    ds_write_b64 v48, a[80:81] offset:0
    s_waitcnt lgkmcnt(8)
    v_mfma_f32_32x32x16_bf16 v[104:119], v[152:155], a[20:23], v[104:119]
    ds_read_b64_tr_b16 v[148:149], v8 offset:25344
    ds_read_b64_tr_b16 v[150:151], v8 offset:26368
    buffer_load_dwordx4 a[40:43], v11, s[8:11], s33 offen offset:2048 sc1
    v_mfma_f32_32x32x16_bf16 v[120:135], v[156:159], a[20:23], v[120:135]
    ds_read_b64_tr_b16 v[152:153], v5 offset:28672
    ds_read_b64_tr_b16 v[154:155], v5 offset:29696
    ds_write_b64 v48, a[82:83] offset:8
    s_waitcnt vmcnt(8) lgkmcnt(8)
    v_mfma_f32_32x32x16_bf16 v[72:87], v[136:139], a[24:27], v[72:87]
    ds_read_b64_tr_b16 v[156:157], v5 offset:28928
    ds_read_b64_tr_b16 v[158:159], v5 offset:29952
    buffer_load_dwordx4 a[44:47], v11, s[8:11], s33 offen offset:3072 sc1
    v_mfma_f32_32x32x16_bf16 v[88:103], v[140:143], a[24:27], v[88:103]
    ds_read_b64_tr_b16 v[136:137], v5 offset:29184
    ds_read_b64_tr_b16 v[138:139], v5 offset:30208
    v_add_u32 v48, v48, v243
    ds_write_b64 v48, a[84:85] offset:0
    s_waitcnt lgkmcnt(8)
    v_mfma_f32_32x32x16_bf16 v[104:119], v[144:147], a[24:27], v[104:119]
    ds_read_b64_tr_b16 v[140:141], v8 offset:29440
    ds_read_b64_tr_b16 v[142:143], v8 offset:30464
    buffer_load_dwordx4 a[192:195], v49, s[4:7], s33 offen sc1
    v_mfma_f32_32x32x16_bf16 v[120:135], v[148:151], a[24:27], v[120:135]
    ds_read_b64_tr_b16 v[144:145], v5 offset:32768
    ds_read_b64_tr_b16 v[146:147], v5 offset:33792
    ds_write_b64 v48, a[86:87] offset:8
    s_waitcnt vmcnt(8) lgkmcnt(8)
    v_mfma_f32_32x32x16_bf16 v[72:87], v[152:155], a[28:31], v[72:87]
    ds_read_b64_tr_b16 v[148:149], v5 offset:33024
    ds_read_b64_tr_b16 v[150:151], v5 offset:34048
    buffer_load_dwordx4 a[48:51], v11, s[8:11], s34 offen offset:0 sc1
    v_mfma_f32_32x32x16_bf16 v[88:103], v[156:159], a[28:31], v[88:103]
    ds_read_b64_tr_b16 v[152:153], v5 offset:33280
    ds_read_b64_tr_b16 v[154:155], v5 offset:34304
    v_add_u32 v48, v48, v243
    ds_write_b64 v48, a[88:89] offset:0
    s_waitcnt lgkmcnt(8)
    v_mfma_f32_32x32x16_bf16 v[104:119], v[136:139], a[28:31], v[104:119]
    ds_read_b64_tr_b16 v[156:157], v8 offset:33536
    ds_read_b64_tr_b16 v[158:159], v8 offset:34560
    buffer_load_dwordx4 a[52:55], v11, s[8:11], s34 offen offset:1024 sc1
    v_mfma_f32_32x32x16_bf16 v[120:135], v[140:143], a[28:31], v[120:135]
    ds_read_b64_tr_b16 v[136:137], v5 offset:36864
    ds_read_b64_tr_b16 v[138:139], v5 offset:37888
    ds_write_b64 v48, a[90:91] offset:8
    s_waitcnt vmcnt(8) lgkmcnt(8)
    v_mfma_f32_32x32x16_bf16 v[72:87], v[144:147], a[32:35], v[72:87]
    ds_read_b64_tr_b16 v[140:141], v5 offset:37120
    ds_read_b64_tr_b16 v[142:143], v5 offset:38144
    buffer_load_dwordx4 a[196:199], v49, s[4:7], s34 offen sc1
    v_mfma_f32_32x32x16_bf16 v[88:103], v[148:151], a[32:35], v[88:103]
    ds_read_b64_tr_b16 v[144:145], v5 offset:37376
    ds_read_b64_tr_b16 v[146:147], v5 offset:38400
    v_add_u32 v48, v48, v243
    ds_write_b64 v48, a[92:93] offset:0
    s_waitcnt lgkmcnt(8)
    v_mfma_f32_32x32x16_bf16 v[104:119], v[152:155], a[32:35], v[104:119]
    ds_read_b64_tr_b16 v[148:149], v8 offset:37632
    ds_read_b64_tr_b16 v[150:151], v8 offset:38656
    buffer_load_dwordx4 a[56:59], v11, s[8:11], s34 offen offset:2048 sc1
    v_mfma_f32_32x32x16_bf16 v[120:135], v[156:159], a[32:35], v[120:135]
    ds_read_b64_tr_b16 v[152:153], v5 offset:40960
    ds_read_b64_tr_b16 v[154:155], v5 offset:41984
    ds_write_b64 v48, a[94:95] offset:8
    s_waitcnt vmcnt(8) lgkmcnt(8)
    v_mfma_f32_32x32x16_bf16 v[72:87], v[136:139], a[36:39], v[72:87]
    ds_read_b64_tr_b16 v[156:157], v5 offset:41216
    ds_read_b64_tr_b16 v[158:159], v5 offset:42240
    buffer_load_dwordx4 a[60:63], v11, s[8:11], s34 offen offset:3072 sc1
    v_mfma_f32_32x32x16_bf16 v[88:103], v[140:143], a[36:39], v[88:103]
    ds_read_b64_tr_b16 v[136:137], v5 offset:41472
    ds_read_b64_tr_b16 v[138:139], v5 offset:42496
    v_add_u32 v48, v48, v243
    ds_write_b64 v48, a[96:97] offset:0
    s_waitcnt lgkmcnt(8)
    v_mfma_f32_32x32x16_bf16 v[104:119], v[144:147], a[36:39], v[104:119]
    ds_read_b64_tr_b16 v[140:141], v8 offset:41728
    ds_read_b64_tr_b16 v[142:143], v8 offset:42752
    buffer_load_dwordx4 a[200:203], v49, s[4:7], s35 offen sc1
    v_mfma_f32_32x32x16_bf16 v[120:135], v[148:151], a[36:39], v[120:135]
    ds_read_b64_tr_b16 v[144:145], v5 offset:45056
    ds_read_b64_tr_b16 v[146:147], v5 offset:46080
    ds_write_b64 v48, a[98:99] offset:8
    s_waitcnt vmcnt(8) lgkmcnt(8)
    v_mfma_f32_32x32x16_bf16 v[72:87], v[152:155], a[40:43], v[72:87]
    ds_read_b64_tr_b16 v[148:149], v5 offset:45312
    ds_read_b64_tr_b16 v[150:151], v5 offset:46336
    buffer_load_dwordx4 a[64:67], v11, s[8:11], s35 offen offset:0 sc1
    v_mfma_f32_32x32x16_bf16 v[88:103], v[156:159], a[40:43], v[88:103]
    ds_read_b64_tr_b16 v[152:153], v5 offset:45568
    ds_read_b64_tr_b16 v[154:155], v5 offset:46592
    v_add_u32 v48, v48, v243
    ds_write_b64 v48, a[100:101] offset:0
    s_waitcnt lgkmcnt(8)
    v_mfma_f32_32x32x16_bf16 v[104:119], v[136:139], a[40:43], v[104:119]
    ds_read_b64_tr_b16 v[156:157], v8 offset:45824
    ds_read_b64_tr_b16 v[158:159], v8 offset:46848
    buffer_load_dwordx4 a[68:71], v11, s[8:11], s35 offen offset:1024 sc1
    v_mfma_f32_32x32x16_bf16 v[120:135], v[140:143], a[40:43], v[120:135]
    s_barrier
    ds_read_b64_tr_b16 v[136:137], v5 offset:49152
    ds_read_b64_tr_b16 v[138:139], v5 offset:50176
    ds_write_b64 v48, a[102:103] offset:8
    s_waitcnt vmcnt(9) lgkmcnt(8)
    v_mfma_f32_32x32x16_bf16 v[72:87], v[144:147], a[44:47], v[72:87]
    ds_read_b64_tr_b16 v[140:141], v5 offset:49408
    ds_read_b64_tr_b16 v[142:143], v5 offset:50432
    buffer_load_dwordx4 a[204:207], v49, s[4:7], s36 offen sc1
    v_mfma_f32_32x32x16_bf16 v[88:103], v[148:151], a[44:47], v[88:103]
    ds_read_b64_tr_b16 v[144:145], v5 offset:49664
    ds_read_b64_tr_b16 v[146:147], v5 offset:50688
    v_and_b32 v254, 4096, v243
    v_mad_i32_i24 v48, v254, 5, v48
    v_add_u32 v48, v48, v243
    ds_write_b64 v48, a[104:105] offset:0
    s_waitcnt lgkmcnt(8)
    v_mfma_f32_32x32x16_bf16 v[104:119], v[152:155], a[44:47], v[104:119]
    ds_read_b64_tr_b16 v[148:149], v8 offset:49920
    ds_read_b64_tr_b16 v[150:151], v8 offset:50944
    buffer_load_dwordx4 a[72:75], v11, s[8:11], s35 offen offset:2048 sc1
    v_mfma_f32_32x32x16_bf16 v[120:135], v[156:159], a[44:47], v[120:135]
    ds_read_b64_tr_b16 v[152:153], v5 offset:53248
    ds_read_b64_tr_b16 v[154:155], v5 offset:54272
    ds_write_b64 v48, a[106:107] offset:8
    s_waitcnt vmcnt(9) lgkmcnt(8)
    v_mfma_f32_32x32x16_bf16 v[72:87], v[136:139], a[48:51], v[72:87]
    ds_read_b64_tr_b16 v[156:157], v5 offset:53504
    ds_read_b64_tr_b16 v[158:159], v5 offset:54528
    buffer_load_dwordx4 a[76:79], v11, s[8:11], s35 offen offset:3072 sc1
    v_mfma_f32_32x32x16_bf16 v[88:103], v[140:143], a[48:51], v[88:103]
    ds_read_b64_tr_b16 v[136:137], v5 offset:53760
    ds_read_b64_tr_b16 v[138:139], v5 offset:54784
    v_add_u32 v48, v48, v243
    ds_write_b64 v48, a[108:109] offset:0
    s_waitcnt lgkmcnt(8)
    v_mfma_f32_32x32x16_bf16 v[104:119], v[144:147], a[48:51], v[104:119]
    ds_read_b64_tr_b16 v[140:141], v8 offset:54016
    ds_read_b64_tr_b16 v[142:143], v8 offset:55040
    buffer_load_dwordx4 a[208:211], v49, s[4:7], s37 offen sc1
    v_mfma_f32_32x32x16_bf16 v[120:135], v[148:151], a[48:51], v[120:135]
    ds_read_b64_tr_b16 v[144:145], v5 offset:57344
    ds_read_b64_tr_b16 v[146:147], v5 offset:58368
    ds_write_b64 v48, a[110:111] offset:8
    s_waitcnt vmcnt(10) lgkmcnt(8)
    v_mfma_f32_32x32x16_bf16 v[72:87], v[152:155], a[52:55], v[72:87]
    ds_read_b64_tr_b16 v[148:149], v5 offset:57600
    ds_read_b64_tr_b16 v[150:151], v5 offset:58624
    buffer_load_dwordx4 a[80:83], v11, s[8:11], s36 offen offset:0 sc1
    v_mfma_f32_32x32x16_bf16 v[88:103], v[156:159], a[52:55], v[88:103]
    ds_read_b64_tr_b16 v[152:153], v5 offset:57856
    ds_read_b64_tr_b16 v[154:155], v5 offset:58880
    v_add_u32 v48, v48, v243
    ds_write_b64 v48, a[112:113] offset:0
    s_waitcnt lgkmcnt(8)
    v_mfma_f32_32x32x16_bf16 v[104:119], v[136:139], a[52:55], v[104:119]
    ds_read_b64_tr_b16 v[156:157], v8 offset:58112
    ds_read_b64_tr_b16 v[158:159], v8 offset:59136
    buffer_load_dwordx4 a[84:87], v11, s[8:11], s36 offen offset:1024 sc1
    v_mfma_f32_32x32x16_bf16 v[120:135], v[140:143], a[52:55], v[120:135]
    ds_read_b64_tr_b16 v[136:137], v5 offset:61440
    ds_read_b64_tr_b16 v[138:139], v5 offset:62464
    ds_write_b64 v48, a[114:115] offset:8
    s_waitcnt vmcnt(10) lgkmcnt(8)
    v_mfma_f32_32x32x16_bf16 v[72:87], v[144:147], a[56:59], v[72:87]
    ds_read_b64_tr_b16 v[140:141], v5 offset:61696
    ds_read_b64_tr_b16 v[142:143], v5 offset:62720
    buffer_load_dwordx4 a[212:215], v49, s[4:7], s38 offen sc1
    v_add_f32 v244, v244, v246
    v_add_f32 v248, v248, v250
    v_mfma_f32_32x32x16_bf16 v[88:103], v[148:151], a[56:59], v[88:103]
    ds_read_b64_tr_b16 v[144:145], v5 offset:61952
    ds_read_b64_tr_b16 v[146:147], v5 offset:62976
    v_add_u32 v48, v48, v243
    ds_write_b64 v48, a[116:117] offset:0
    s_waitcnt lgkmcnt(8)
    v_mfma_f32_32x32x16_bf16 v[104:119], v[152:155], a[56:59], v[104:119]
    ds_read_b64_tr_b16 v[148:149], v8 offset:62208
    ds_read_b64_tr_b16 v[150:151], v8 offset:63232
    buffer_load_dwordx4 a[88:91], v11, s[8:11], s36 offen offset:2048 sc1
    v_add_f32 v245, v245, v247
    v_add_f32 v249, v249, v251
    v_mfma_f32_32x32x16_bf16 v[120:135], v[156:159], a[56:59], v[120:135]
    ds_read_b64_tr_b16 v[152:153], v6 offset:0
    ds_read_b64_tr_b16 v[154:155], v6 offset:1024
    ds_write_b64 v48, a[118:119] offset:8
    s_waitcnt vmcnt(11) lgkmcnt(8)
    v_mfma_f32_32x32x16_bf16 v[72:87], v[136:139], a[60:63], v[72:87]
    ds_read_b64_tr_b16 v[156:157], v6 offset:256
    ds_read_b64_tr_b16 v[158:159], v6 offset:1280
    buffer_load_dwordx4 a[92:95], v11, s[8:11], s36 offen offset:3072 sc1
    v_add_f32 v244, v244, v248
    v_add_f32 v245, v245, v249
    v_mfma_f32_32x32x16_bf16 v[88:103], v[140:143], a[60:63], v[88:103]
    ds_read_b64_tr_b16 v[136:137], v6 offset:512
    ds_read_b64_tr_b16 v[138:139], v6 offset:1536
    v_add_u32 v48, v48, v243
    ds_write_b64 v48, a[120:121] offset:0
    s_waitcnt lgkmcnt(8)
    v_mfma_f32_32x32x16_bf16 v[104:119], v[144:147], a[60:63], v[104:119]
    ds_read_b64_tr_b16 v[140:141], v9 offset:768
    ds_read_b64_tr_b16 v[142:143], v9 offset:1792
    buffer_load_dwordx4 a[216:219], v49, s[4:7], s39 offen sc1
    v_mov_b32 v246, v244
    v_mov_b32 v247, v245
    v_mfma_f32_32x32x16_bf16 v[120:135], v[148:151], a[60:63], v[120:135]
    ds_read_b64_tr_b16 v[144:145], v6 offset:4096
    ds_read_b64_tr_b16 v[146:147], v6 offset:5120
    ds_write_b64 v48, a[122:123] offset:8
    s_waitcnt vmcnt(11) lgkmcnt(8)
    v_mfma_f32_32x32x16_bf16 v[72:87], v[152:155], a[64:67], v[72:87]
    ds_read_b64_tr_b16 v[148:149], v6 offset:4352
    ds_read_b64_tr_b16 v[150:151], v6 offset:5376
    buffer_load_dwordx4 a[96:99], v11, s[8:11], s37 offen offset:0 sc1
    v_permlane32_swap_b32 v244, v246
    v_mfma_f32_32x32x16_bf16 v[88:103], v[156:159], a[64:67], v[88:103]
    ds_read_b64_tr_b16 v[152:153], v6 offset:4608
    ds_read_b64_tr_b16 v[154:155], v6 offset:5632
    v_add_u32 v48, v48, v243
    ds_write_b64 v48, a[124:125] offset:0
    s_waitcnt lgkmcnt(8)
    v_mfma_f32_32x32x16_bf16 v[104:119], v[136:139], a[64:67], v[104:119]
    ds_read_b64_tr_b16 v[156:157], v9 offset:4864
    ds_read_b64_tr_b16 v[158:159], v9 offset:5888
    buffer_load_dwordx4 a[100:103], v11, s[8:11], s37 offen offset:1024 sc1
    v_permlane32_swap_b32 v245, v247
    v_mfma_f32_32x32x16_bf16 v[120:135], v[140:143], a[64:67], v[120:135]
    s_barrier
    ds_read_b64_tr_b16 v[136:137], v6 offset:8192
    ds_read_b64_tr_b16 v[138:139], v6 offset:9216
    ds_write_b64 v48, a[126:127] offset:8
    s_waitcnt vmcnt(12) lgkmcnt(8)
    v_mfma_f32_32x32x16_bf16 v[72:87], v[144:147], a[68:71], v[72:87]
    ds_read_b64_tr_b16 v[140:141], v6 offset:8448
    ds_read_b64_tr_b16 v[142:143], v6 offset:9472
    buffer_load_dwordx4 a[220:223], v49, s[4:7], s40 offen sc1
    v_add_f32 v244, v244, v246
    v_add_f32 v245, v245, v247
    v_mfma_f32_32x32x16_bf16 v[88:103], v[148:151], a[68:71], v[88:103]
    ds_read_b64_tr_b16 v[144:145], v6 offset:8704
    ds_read_b64_tr_b16 v[146:147], v6 offset:9728
    v_add_u32 v48, v48, v243
    ds_write_b64 v48, a[128:129] offset:0
    s_waitcnt lgkmcnt(8)
    v_mfma_f32_32x32x16_bf16 v[104:119], v[152:155], a[68:71], v[104:119]
    s_nop 0
    ds_read_b64_tr_b16 v[148:149], v9 offset:8960
    ds_read_b64_tr_b16 v[150:151], v9 offset:9984
    buffer_load_dwordx4 a[104:107], v11, s[8:11], s37 offen offset:2048 sc1
    v_mul_f32 v244, 0xbacccccd, v244
    v_mul_f32 v246, v244, v244
    v_mfma_f32_32x32x16_bf16 v[120:135], v[156:159], a[68:71], v[120:135]
    ds_read_b64_tr_b16 v[152:153], v6 offset:12288
    ds_read_b64_tr_b16 v[154:155], v6 offset:13312
    ds_write_b64 v48, a[130:131] offset:8
    s_waitcnt vmcnt(12) lgkmcnt(8)
    v_mfma_f32_32x32x16_bf16 v[72:87], v[136:139], a[72:75], v[72:87]
    ds_read_b64_tr_b16 v[156:157], v6 offset:12544
    ds_read_b64_tr_b16 v[158:159], v6 offset:13568
    buffer_load_dwordx4 a[108:111], v11, s[8:11], s37 offen offset:3072 sc1
    v_mul_f32 v245, 0x3acccccd, v245
    v_sub_f32 v246, v245, v246
    v_mfma_f32_32x32x16_bf16 v[88:103], v[140:143], a[72:75], v[88:103]
    ds_read_b64_tr_b16 v[136:137], v6 offset:12800
    ds_read_b64_tr_b16 v[138:139], v6 offset:13824
    v_add_u32 v48, v48, v243
    ds_write_b64 v48, a[132:133] offset:0
    s_waitcnt lgkmcnt(8)
    v_mfma_f32_32x32x16_bf16 v[104:119], v[144:147], a[72:75], v[104:119]
    ds_read_b64_tr_b16 v[140:141], v9 offset:13056
    ds_read_b64_tr_b16 v[142:143], v9 offset:14080
    buffer_load_dwordx4 a[112:115], v11, s[8:11], s38 offen offset:0 sc1
    v_max_f32 v246, 0, v246
    v_add_f32 v246, 0x3727c5ac, v246
    v_mfma_f32_32x32x16_bf16 v[120:135], v[148:151], a[72:75], v[120:135]
    ds_read_b64_tr_b16 v[144:145], v6 offset:16384
    ds_read_b64_tr_b16 v[146:147], v6 offset:17408
    ds_write_b64 v48, a[134:135] offset:8
    s_waitcnt vmcnt(13) lgkmcnt(8)
    v_mfma_f32_32x32x16_bf16 v[72:87], v[152:155], a[76:79], v[72:87]
    ds_read_b64_tr_b16 v[148:149], v6 offset:16640
    ds_read_b64_tr_b16 v[150:151], v6 offset:17664
    buffer_load_dwordx4 a[224:227], v49, s[4:7], s41 offen sc1
    v_rsq_f32 v246, v246
    v_mfma_f32_32x32x16_bf16 v[88:103], v[156:159], a[76:79], v[88:103]
    ds_read_b64_tr_b16 v[152:153], v9 offset:17152
    ds_read_b64_tr_b16 v[154:155], v9 offset:18176
    v_and_b32 v254, 4096, v243
    s_mov_b32 s3, -39
    v_mad_i32_i24 v48, v254, s3, v48
    v_add_u32 v48, v48, v243
    ds_write_b64 v48, a[136:137] offset:0
    s_waitcnt lgkmcnt(8)
    v_mfma_f32_32x32x16_bf16 v[104:119], v[136:139], a[76:79], v[104:119]
    ds_read_b64_tr_b16 v[156:157], v6 offset:20480
    ds_read_b64_tr_b16 v[158:159], v6 offset:21504
    buffer_load_dwordx4 a[116:119], v11, s[8:11], s38 offen offset:1024 sc1
    v_mul_f32 v245, v246, v244
    v_mov_b32 v244, v246
    v_mfma_f32_32x32x16_bf16 v[120:135], v[140:143], a[76:79], v[120:135]
    ds_read_b64_tr_b16 v[136:137], v6 offset:20736
    ds_read_b64_tr_b16 v[138:139], v6 offset:21760
    ds_write_b64 v48, a[138:139] offset:8
    s_add_u32 s24, s70, L_at1-L_pc
    s_addc_u32 s25, s71, 0
    v_mov_b32 v0, s24
    v_mov_b32 v1, s25
    s_waitcnt vmcnt(13) lgkmcnt(8)
    v_mfma_f32_32x32x16_bf16 v[72:87], v[144:147], a[80:83], v[72:87]
    ds_read_b64_tr_b16 v[140:141], v9 offset:21248
    ds_read_b64_tr_b16 v[142:143], v9 offset:22272
    global_load_dword a255, v[0:1], off
    ds_read_b128 v[160:163], v45 offset:0
    ds_read_b128 v[164:167], v45 offset:32
    v_mfma_f32_32x32x16_bf16 v[88:103], v[148:151], a[80:83], v[88:103]
    ds_read_b64_tr_b16 v[144:145], v6 offset:24576
    ds_read_b64_tr_b16 v[146:147], v6 offset:25600
    v_add_u32 v48, v48, v243
    ds_write_b64 v48, a[140:141] offset:0
    s_waitcnt vmcnt(13) lgkmcnt(10)
    v_mfma_f32_32x32x16_bf16 v[120:135], v[152:155], a[80:83], v[120:135]
    ds_read_b64_tr_b16 v[148:149], v6 offset:24832
    ds_read_b64_tr_b16 v[150:151], v6 offset:25856
    buffer_load_dwordx4 a[228:231], v49, s[4:7], s42 offen sc1
    ds_read_b128 v[168:171], v45 offset:64
    ds_read_b128 v[172:175], v45 offset:96
    v_mfma_f32_32x32x16_bf16 v[72:87], v[156:159], a[84:87], v[72:87]
    ds_read_b64_tr_b16 v[152:153], v9 offset:25344
    ds_read_b64_tr_b16 v[154:155], v9 offset:26368
    ds_write_b64 v48, a[142:143] offset:8
    s_waitcnt lgkmcnt(12)
    v_mfma_f32_32x32x16_bf16 v[88:103], v[136:139], a[84:87], v[88:103]
    s_nop 0
    ds_read_b64_tr_b16 v[156:157], v6 offset:28672
    ds_read_b64_tr_b16 v[158:159], v6 offset:29696
    buffer_load_dwordx4 a[120:123], v11, s[8:11], s38 offen offset:2048 sc1
    ds_read_b128 v[176:179], v45 offset:384
    ds_read_b128 v[180:183], v45 offset:128
    v_mfma_f32_32x32x16_bf16 v[120:135], v[140:143], a[84:87], v[120:135]
    ds_read_b64_tr_b16 v[136:137], v6 offset:28928
    ds_read_b64_tr_b16 v[138:139], v6 offset:29952
    v_add_u32 v48, v48, v243
    ds_write_b64 v48, a[144:145] offset:0
    s_waitcnt vmcnt(13) lgkmcnt(12)
    v_mfma_f32_32x32x16_bf16 v[72:87], v[144:147], a[88:91], v[72:87]
    ds_read_b64_tr_b16 v[140:141], v9 offset:29440
    ds_read_b64_tr_b16 v[142:143], v9 offset:30464
    buffer_load_dwordx4 a[124:127], v11, s[8:11], s38 offen offset:3072 sc1
    ds_read_b128 v[184:187], v45 offset:160
    ds_read_b128 v[188:191], v45 offset:192
    v_mfma_f32_32x32x16_bf16 v[88:103], v[148:151], a[88:91], v[88:103]
    s_barrier
    ds_read_b64_tr_b16 v[144:145], v6 offset:32768
    ds_read_b64_tr_b16 v[146:147], v6 offset:33792
    ds_write_b64 v48, a[146:147] offset:8
    s_waitcnt vmcnt(13) lgkmcnt(12)
    v_mfma_f32_32x32x16_bf16 v[120:135], v[152:155], a[88:91], v[120:135]
    ds_read_b64_tr_b16 v[148:149], v6 offset:33024
    ds_read_b64_tr_b16 v[150:151], v6 offset:34048
    buffer_load_dwordx4 a[128:131], v11, s[8:11], s39 offen offset:0 sc1
    ds_read_b128 v[192:195], v45 offset:224
    ds_read_b128 v[196:199], v45 offset:416
    v_mfma_f32_32x32x16_bf16 v[72:87], v[156:159], a[92:95], v[72:87]
    ds_read_b64_tr_b16 v[152:153], v9 offset:33536
    ds_read_b64_tr_b16 v[154:155], v9 offset:34560
    v_add_u32 v48, v48, v243
    ds_write_b64 v48, a[148:149] offset:0
    s_waitcnt lgkmcnt(12)
    v_mfma_f32_32x32x16_bf16 v[88:103], v[136:139], a[92:95], v[88:103]
    ds_read_b64_tr_b16 v[156:157], v6 offset:36864
    ds_read_b64_tr_b16 v[158:159], v6 offset:37888
    buffer_load_dwordx4 a[132:135], v11, s[8:11], s39 offen offset:1024 sc1
    ds_read_b128 v[200:203], v45 offset:256
    ds_read_b128 v[204:207], v45 offset:288
    v_mfma_f32_32x32x16_bf16 v[120:135], v[140:143], a[92:95], v[120:135]
    ds_read_b64_tr_b16 v[136:137], v6 offset:37120
    ds_read_b64_tr_b16 v[138:139], v6 offset:38144
    ds_write_b64 v48, a[150:151] offset:8
    s_add_u32 m0, s74, 24576
    s_waitcnt vmcnt(13) lgkmcnt(12)
    v_mfma_f32_32x32x16_bf16 v[72:87], v[144:147], a[96:99], v[72:87]
    s_nop 0
    ds_read_b64_tr_b16 v[140:141], v9 offset:37632
    ds_read_b64_tr_b16 v[142:143], v9 offset:38656
    buffer_load_dwordx4 v30, s[4:7], m0 offen sc1 lds
    ds_read_b128 v[208:211], v45 offset:320
    ds_read_b128 v[212:215], v45 offset:352
    v_mfma_f32_32x32x16_bf16 v[88:103], v[148:151], a[96:99], v[88:103]
    ds_read_b64_tr_b16 v[144:145], v6 offset:61440
    ds_read_b64_tr_b16 v[146:147], v6 offset:62464
    v_add_u32 v48, v48, v243
    ds_write_b64 v48, a[152:153] offset:0
    s_waitcnt vmcnt(13) lgkmcnt(12)
    v_mfma_f32_32x32x16_bf16 v[120:135], v[152:155], a[96:99], v[120:135]
    ds_read_b64_tr_b16 v[148:149], v6 offset:61696
    ds_read_b64_tr_b16 v[150:151], v6 offset:62720
    buffer_load_dwordx4 a[136:139], v11, s[8:11], s39 offen offset:2048 sc1
    ds_read_b128 v[216:219], v45 offset:448
    v_mul_f32 v160, v245, v160
    v_mfma_f32_32x32x16_bf16 v[72:87], v[156:159], a[100:103], v[72:87]
    ds_read_b64_tr_b16 v[152:153], v9 offset:62208
    ds_read_b64_tr_b16 v[154:155], v9 offset:63232
    ds_write_b64 v48, a[154:155] offset:8
    s_waitcnt lgkmcnt(11)
    v_mfma_f32_32x32x16_bf16 v[88:103], v[136:139], a[100:103], v[88:103]
    ds_read_b64_tr_b16 v[156:157], v7 offset:0
    ds_read_b64_tr_b16 v[158:159], v7 offset:1024
    buffer_load_dwordx4 a[140:143], v11, s[8:11], s39 offen offset:3072 sc1
    v_mul_f32 v161, v245, v161
    v_mul_f32 v162, v245, v162
    v_mfma_f32_32x32x16_bf16 v[120:135], v[140:143], a[100:103], v[120:135]
    ds_read_b64_tr_b16 v[136:137], v7 offset:256
    ds_read_b64_tr_b16 v[138:139], v7 offset:1280
    v_add_u32 v48, v48, v243
    ds_write_b64 v48, a[156:157] offset:0
    s_add_u32 m0, s74, 28672
    s_waitcnt vmcnt(13) lgkmcnt(9)
    v_mfma_f32_32x32x16_bf16 v[72:87], v[144:147], a[104:107], v[72:87]
    ds_read_b64_tr_b16 v[140:141], v10 offset:768
    ds_read_b64_tr_b16 v[142:143], v10 offset:1792
    buffer_load_dwordx4 v30, s[4:7], m0 offen sc1 lds
    v_mul_f32 v163, v245, v163
    v_mul_f32 v164, v245, v164
    v_mfma_f32_32x32x16_bf16 v[88:103], v[148:151], a[104:107], v[88:103]
    ds_read_b64_tr_b16 v[144:145], v7 offset:4096
    ds_read_b64_tr_b16 v[146:147], v7 offset:5120
    ds_write_b64 v48, a[158:159] offset:8
    s_waitcnt vmcnt(13) lgkmcnt(8)
    v_mfma_f32_32x32x16_bf16 v[120:135], v[152:155], a[104:107], v[120:135]
    ds_read_b64_tr_b16 v[148:149], v7 offset:4352
    ds_read_b64_tr_b16 v[150:151], v7 offset:5376
    buffer_load_dwordx4 a[144:147], v11, s[8:11], s40 offen offset:0 sc1
    v_mul_f32 v165, v245, v165
    v_mul_f32 v166, v245, v166
    v_mfma_f32_32x32x16_bf16 v[72:87], v[156:159], a[108:111], v[72:87]
    ds_read_b64_tr_b16 v[152:153], v10 offset:4864
    ds_read_b64_tr_b16 v[154:155], v10 offset:5888
    v_mul_f32 v167, v245, v167
    v_mul_f32 v168, v245, v168
    v_mul_f32 v169, v245, v169
    s_waitcnt lgkmcnt(7)
    v_mfma_f32_32x32x16_bf16 v[88:103], v[136:139], a[108:111], v[88:103]
    ds_read_b64_tr_b16 v[156:157], v7 offset:8192
    ds_read_b64_tr_b16 v[158:159], v7 offset:9216
    buffer_load_dwordx4 a[148:151], v11, s[8:11], s40 offen offset:1024 sc1
    v_mul_f32 v170, v245, v170
    v_mul_f32 v171, v245, v171
    v_mfma_f32_32x32x16_bf16 v[120:135], v[140:143], a[108:111], v[120:135]
    ds_read_b64_tr_b16 v[136:137], v7 offset:8448
    ds_read_b64_tr_b16 v[138:139], v7 offset:9472
    s_add_u32 m0, s74, 32768
    v_mul_f32 v172, v245, v172
    v_mul_f32 v173, v245, v173
    s_waitcnt vmcnt(14) lgkmcnt(6)
    v_mfma_f32_32x32x16_bf16 v[72:87], v[144:147], a[112:115], v[72:87]
    ds_read_b64_tr_b16 v[140:141], v10 offset:8960
    ds_read_b64_tr_b16 v[142:143], v10 offset:9984
    buffer_load_dwordx4 v30, s[4:7], m0 offen sc1 lds
    v_mul_f32 v174, v245, v174
    v_mul_f32 v175, v245, v175
    v_mfma_f32_32x32x16_bf16 v[88:103], v[148:151], a[112:115], v[88:103]
    s_barrier
    ds_read_b64_tr_b16 v[144:145], v7 offset:12288
    ds_read_b64_tr_b16 v[146:147], v7 offset:13312
    v_mul_f32 v176, v245, v176
    v_mul_f32 v177, v245, v177
    s_waitcnt vmcnt(13) lgkmcnt(6)
    v_mfma_f32_32x32x16_bf16 v[120:135], v[152:155], a[112:115], v[120:135]
    ds_read_b64_tr_b16 v[148:149], v7 offset:12544
    ds_read_b64_tr_b16 v[150:151], v7 offset:13568
    buffer_load_dwordx4 a[152:155], v11, s[8:11], s40 offen offset:2048 sc1
    v_mul_f32 v178, v245, v178
    v_mul_f32 v179, v245, v179
    v_mfma_f32_32x32x16_bf16 v[72:87], v[156:159], a[116:119], v[72:87]
    ds_read_b64_tr_b16 v[152:153], v10 offset:13056
    ds_read_b64_tr_b16 v[154:155], v10 offset:14080
    v_mul_f32 v180, v245, v180
    v_mul_f32 v181, v245, v181
    v_mul_f32 v182, v245, v182
    s_waitcnt lgkmcnt(6)
    v_mfma_f32_32x32x16_bf16 v[88:103], v[136:139], a[116:119], v[88:103]
    ds_read_b64_tr_b16 v[156:157], v7 offset:16384
    ds_read_b64_tr_b16 v[158:159], v7 offset:17408
    buffer_load_dwordx4 a[156:159], v11, s[8:11], s40 offen offset:3072 sc1
    v_mul_f32 v183, v245, v183
    v_mul_f32 v184, v245, v184
    v_mfma_f32_32x32x16_bf16 v[120:135], v[140:143], a[116:119], v[120:135]
    ds_read_b64_tr_b16 v[136:137], v7 offset:16640
    ds_read_b64_tr_b16 v[138:139], v7 offset:17664
    s_add_u32 m0, s74, 36864
    v_mul_f32 v185, v245, v185
    v_mul_f32 v186, v245, v186
    s_waitcnt vmcnt(12) lgkmcnt(6)
    v_mfma_f32_32x32x16_bf16 v[72:87], v[144:147], a[120:123], v[72:87]
    ds_read_b64_tr_b16 v[140:141], v10 offset:17152
    ds_read_b64_tr_b16 v[142:143], v10 offset:18176
    buffer_load_dwordx4 v30, s[4:7], m0 offen sc1 lds
    v_mul_f32 v187, v245, v187
    v_mul_f32 v188, v245, v188
    v_mfma_f32_32x32x16_bf16 v[88:103], v[148:151], a[120:123], v[88:103]
    ds_read_b64_tr_b16 v[144:145], v7 offset:20480
    ds_read_b64_tr_b16 v[146:147], v7 offset:21504
    s_add_u32 m0, s74, 40960
L_pad9:
    s_cbranch_execz L_pad13
    v_mul_f32 v189, v245, v189
    v_mul_f32 v190, v245, v190
    s_waitcnt vmcnt(12) lgkmcnt(6)
    v_mfma_f32_32x32x16_bf16 v[120:135], v[152:155], a[120:123], v[120:135]
    ds_read_b64_tr_b16 v[148:149], v7 offset:20736
    ds_read_b64_tr_b16 v[150:151], v7 offset:21760
    buffer_load_dwordx4 v30, s[4:7], m0 offen sc1 lds
    v_mul_f32 v191, v245, v191
    v_mul_f32 v192, v245, v192
    v_mfma_f32_32x32x16_bf16 v[72:87], v[156:159], a[124:127], v[72:87]
    ds_read_b64_tr_b16 v[152:153], v10 offset:21248
    ds_read_b64_tr_b16 v[154:155], v10 offset:22272
    s_add_u32 m0, s74, 45056
    v_mul_f32 v193, v245, v193
    v_mul_f32 v194, v245, v194
    s_waitcnt lgkmcnt(6)
    v_mfma_f32_32x32x16_bf16 v[88:103], v[136:139], a[124:127], v[88:103]
    ds_read_b64_tr_b16 v[156:157], v7 offset:24576
    ds_read_b64_tr_b16 v[158:159], v7 offset:25600
    buffer_load_dwordx4 v30, s[4:7], m0 offen sc1 lds
    v_mul_f32 v195, v245, v195
    v_mul_f32 v196, v245, v196
    v_mfma_f32_32x32x16_bf16 v[120:135], v[140:143], a[124:127], v[120:135]
    ds_read_b64_tr_b16 v[136:137], v7 offset:24832
    ds_read_b64_tr_b16 v[138:139], v7 offset:25856
    s_add_u32 m0, s74, 49152
    v_mul_f32 v197, v245, v197
    v_mul_f32 v198, v245, v198
    s_waitcnt vmcnt(13) lgkmcnt(6)
    v_mfma_f32_32x32x16_bf16 v[72:87], v[144:147], a[128:131], v[72:87]
    ds_read_b64_tr_b16 v[140:141], v10 offset:25344
    ds_read_b64_tr_b16 v[142:143], v10 offset:26368
    buffer_load_dwordx4 v30, s[4:7], m0 offen sc1 lds
    v_mul_f32 v199, v245, v199
    v_mul_f32 v200, v245, v200
    v_mfma_f32_32x32x16_bf16 v[88:103], v[148:151], a[128:131], v[88:103]
    ds_read_b64_tr_b16 v[144:145], v5 offset:0
    ds_read_b64_tr_b16 v[146:147], v5 offset:1024
    s_add_u32 m0, s74, 53248
    v_mul_f32 v201, v245, v201
    v_mul_f32 v202, v245, v202
    s_waitcnt vmcnt(13) lgkmcnt(6)
    v_mfma_f32_32x32x16_bf16 v[120:135], v[152:155], a[128:131], v[120:135]
    ds_read_b64_tr_b16 v[148:149], v5 offset:256
    ds_read_b64_tr_b16 v[150:151], v5 offset:1280
    buffer_load_dwordx4 v30, s[4:7], m0 offen sc1 lds
    v_mul_f32 v203, v245, v203
    v_mul_f32 v204, v245, v204
    v_mfma_f32_32x32x16_bf16 v[72:87], v[156:159], a[132:135], v[72:87]
    ds_read_b64_tr_b16 v[152:153], v8 offset:768
    ds_read_b64_tr_b16 v[154:155], v8 offset:1792
    s_add_u32 m0, s74, 57344
    v_mul_f32 v205, v245, v205
    v_mul_f32 v206, v245, v206
    s_waitcnt lgkmcnt(6)
    v_mfma_f32_32x32x16_bf16 v[88:103], v[136:139], a[132:135], v[88:103]
    s_barrier
    ds_read_b64_tr_b16 v[156:157], v5 offset:4096
    ds_read_b64_tr_b16 v[158:159], v5 offset:5120
    buffer_load_dwordx4 v30, s[4:7], m0 offen sc1 lds
    v_mul_f32 v207, v245, v207
    v_mfma_f32_32x32x16_bf16 v[120:135], v[140:143], a[132:135], v[120:135]
    ds_read_b64_tr_b16 v[136:137], v8 offset:4864
    ds_read_b64_tr_b16 v[138:139], v8 offset:5888
    s_add_u32 m0, s74, 61440
    v_mul_f32 v208, v245, v208
    v_mul_f32 v209, v245, v209
    s_waitcnt vmcnt(13) lgkmcnt(6)
    v_mfma_f32_32x32x16_bf16 v[72:87], v[144:147], a[136:139], v[72:87]
    ds_read_b64_tr_b16 v[140:141], v5 offset:8192
    ds_read_b64_tr_b16 v[142:143], v5 offset:9216
    buffer_load_dwordx4 v30, s[4:7], m0 offen sc1 lds
    v_mul_f32 v210, v245, v210
    v_mul_f32 v211, v245, v211
    v_mfma_f32_32x32x16_bf16 v[88:103], v[148:151], a[136:139], v[88:103]
    ds_read_b64_tr_b16 v[144:145], v8 offset:8960
    ds_read_b64_tr_b16 v[146:147], v8 offset:9984
    s_add_u32 m0, s74, 65536
    v_mul_f32 v212, v245, v212
    v_mul_f32 v213, v245, v213
    s_waitcnt vmcnt(13) lgkmcnt(6)
    v_mfma_f32_32x32x16_bf16 v[120:135], v[152:155], a[136:139], v[120:135]
    ds_read_b64_tr_b16 v[148:149], v5 offset:12288
    ds_read_b64_tr_b16 v[150:151], v5 offset:13312
    buffer_load_dwordx4 v30, s[4:7], m0 offen sc1 lds
    v_mul_f32 v214, v245, v214
    v_mul_f32 v215, v245, v215
    v_mfma_f32_32x32x16_bf16 v[72:87], v[156:159], a[140:143], v[72:87]
    ds_read_b64_tr_b16 v[152:153], v8 offset:13056
    ds_read_b64_tr_b16 v[154:155], v8 offset:14080
    s_add_u32 m0, s74, 69632
    v_mul_f32 v216, v245, v216
    v_mul_f32 v217, v245, v217
    s_waitcnt vmcnt(12) lgkmcnt(6)
    v_mfma_f32_32x32x16_bf16 v[120:135], v[136:139], a[140:143], v[120:135]
    ds_read_b64_tr_b16 v[156:157], v5 offset:16384
    ds_read_b64_tr_b16 v[158:159], v5 offset:17408
    buffer_load_dwordx4 v30, s[4:7], m0 offen sc1 lds
    v_mul_f32 v218, v245, v218
    v_mul_f32 v219, v245, v219
    v_mfma_f32_32x32x16_bf16 v[72:87], v[140:143], a[144:147], v[72:87]
    ds_read_b64_tr_b16 v[136:137], v8 offset:17152
    ds_read_b64_tr_b16 v[138:139], v8 offset:18176
    s_add_u32 m0, s74, 73728
    v_add_u32 v31, s90, v2
    v_add_u32 v32, s91, v2
    s_waitcnt vmcnt(12) lgkmcnt(6)
    v_mfma_f32_32x32x16_bf16 v[120:135], v[144:147], a[144:147], v[120:135]
    ds_read_b64_tr_b16 v[140:141], v5 offset:20480
    ds_read_b64_tr_b16 v[142:143], v5 offset:21504
    buffer_load_dwordx4 v30, s[4:7], m0 offen sc1 lds
    s_and_b32 s61, s78, 1
    s_mul_i32 s61, s61, 61440
    v_mfma_f32_32x32x16_bf16 v[72:87], v[148:151], a[148:151], v[72:87]
    ds_read_b64_tr_b16 v[144:145], v8 offset:21248
    ds_read_b64_tr_b16 v[146:147], v8 offset:22272
    s_add_u32 m0, s74, 77824
    s_mul_i32 s64, s61, -2
    v_mov_b32 v230, 0
    s_waitcnt vmcnt(11) lgkmcnt(6)
    v_mfma_f32_32x32x16_bf16 v[120:135], v[152:155], a[148:151], v[120:135]
    ds_read_b64_tr_b16 v[148:149], v5 offset:4352
    ds_read_b64_tr_b16 v[150:151], v5 offset:5376
    buffer_load_dwordx4 v30, s[4:7], m0 offen sc1 lds
    v_mov_b32 v231, 0
    v_xor_b32 v232, 0, v39
    v_mfma_f32_32x32x16_bf16 v[72:87], v[156:159], a[152:155], v[72:87]
    ds_read_b64_tr_b16 v[152:153], v5 offset:8448
    ds_read_b64_tr_b16 v[154:155], v5 offset:9472
    s_add_u32 m0, s74, 81920
    v_xor_b32 v233, 16, v39
    v_xor_b32 v234, 32, v39
    s_waitcnt vmcnt(11) lgkmcnt(6)
    v_mfma_f32_32x32x16_bf16 v[120:135], v[136:139], a[152:155], v[120:135]
    ds_read_b64_tr_b16 v[156:157], v5 offset:12544
    ds_read_b64_tr_b16 v[158:159], v5 offset:13568
    buffer_load_dwordx4 v30, s[4:7], m0 offen sc1 lds
    v_xor_b32 v235, 48, v39
    v_xor_b32 v236, 64, v39
    v_mfma_f32_32x32x16_bf16 v[72:87], v[140:143], a[156:159], v[72:87]
    ds_read_b64_tr_b16 v[136:137], v5 offset:16640
    ds_read_b64_tr_b16 v[138:139], v5 offset:17664
    s_add_u32 m0, s74, 86016
    v_xor_b32 v237, 80, v39
    v_xor_b32 v238, 96, v39
    s_waitcnt lgkmcnt(6)
    v_mfma_f32_32x32x16_bf16 v[120:135], v[144:147], a[156:159], v[120:135]
    s_nop 0
    ds_read_b64_tr_b16 v[140:141], v5 offset:20736
    ds_read_b64_tr_b16 v[142:143], v5 offset:21760
    buffer_load_dwordx4 v30, s[4:7], m0 offen sc1 lds
    v_xor_b32 v239, 112, v39
    v_xor_b32 v240, 32, v40
    v_mfma_f32_32x32x16_bf16 v[88:103], v[148:151], a[140:143], v[88:103]
    v_xor_b32 v241, 64, v40
    s_waitcnt lgkmcnt(4)
    v_mfma_f32_32x32x16_bf16 v[88:103], v[152:155], a[144:147], v[88:103]
    s_nop 0
    v_fma_f32 v72, v72, v244, v160
    v_fma_f32 v73, v73, v244, v161
    v_fma_f32 v74, v74, v244, v162
    v_fma_f32 v75, v75, v244, v163
    v_fma_f32 v76, v76, v244, v164
    v_fma_f32 v77, v77, v244, v165
    v_mfma_f32_32x32x16_bf16 v[88:103], v[156:159], a[148:151], v[88:103]
    v_fma_f32 v78, v78, v244, v166
    v_fma_f32 v79, v79, v244, v167
    v_fma_f32 v80, v80, v244, v168
    v_fma_f32 v81, v81, v244, v169
    v_fma_f32 v82, v82, v244, v170
    s_waitcnt lgkmcnt(0)
    v_mfma_f32_32x32x16_bf16 v[88:103], v[136:139], a[152:155], v[88:103]
    s_nop 0
    v_fma_f32 v83, v83, v244, v171
    v_fma_f32 v84, v84, v244, v172
    v_fma_f32 v85, v85, v244, v173
    v_fma_f32 v86, v86, v244, v174
    v_fma_f32 v87, v87, v244, v175
    v_fma_f32 v120, v120, v244, v176
    v_mfma_f32_32x32x16_bf16 v[88:103], v[140:143], a[156:159], v[88:103]
    v_fma_f32 v121, v121, v244, v177
    v_fma_f32 v122, v122, v244, v178
    v_fma_f32 v123, v123, v244, v179
    v_cvt_pk_bf16_f32 v220, v72, v73
    v_cvt_pk_bf16_f32 v221, v74, v75
    v_cvt_pk_bf16_f32 v222, v76, v77
    v_cvt_pk_bf16_f32 v223, v78, v79
    v_cvt_pk_bf16_f32 v224, v80, v81
    v_cvt_pk_bf16_f32 v225, v82, v83
    v_cvt_pk_bf16_f32 v226, v84, v85
    v_cvt_pk_bf16_f32 v227, v86, v87
    v_cvt_pk_bf16_f32 v228, v120, v121
    v_cvt_pk_bf16_f32 v229, v122, v123
L_at1:
    v_mfma_f32_32x32x16_bf16 v[136:151], a[160:163], v[220:223], 0
    s_barrier
    s_nop 0
    v_fma_f32 v88, v88, v244, v180
    buffer_load_dwordx4 a[232:235], v49, s[4:7], s43 offen sc1
    v_fma_f32 v89, v89, v244, v181
    s_add_u32 m0, s74, 90112
    v_fma_f32 v90, v90, v244, v182
    buffer_load_dwordx4 v30, s[4:7], m0 offen sc1 lds
    v_fma_f32 v91, v91, v244, v183
    v_fma_f32 v92, v92, v244, v184
    v_mfma_f32_32x32x16_bf16 v[152:167], a[172:175], v[220:223], 0
    v_fma_f32 v93, v93, v244, v185
    v_fma_f32 v94, v94, v244, v186
    v_fma_f32 v95, v95, v244, v187
    v_fma_f32 v96, v96, v244, v188
    v_fma_f32 v97, v97, v244, v189
    v_fma_f32 v98, v98, v244, v190
    s_add_u32 m0, s74, 94208
    v_mfma_f32_32x32x16_bf16 v[136:151], a[164:167], v[224:227], v[136:151]
    buffer_load_dwordx4 v30, s[4:7], m0 offen sc1 lds
    v_fma_f32 v99, v99, v244, v191
    v_fma_f32 v100, v100, v244, v192
    v_fma_f32 v101, v101, v244, v193
    v_fma_f32 v102, v102, v244, v194
    v_fma_f32 v103, v103, v244, v195
    v_fma_f32 v124, v124, v244, v196
    v_mfma_f32_32x32x16_bf16 v[152:167], a[176:179], v[224:227], v[152:167]
    v_fma_f32 v125, v125, v244, v197
    v_fma_f32 v126, v126, v244, v198
    v_fma_f32 v127, v127, v244, v199
    v_mov_b32 v82, 0x3f80
    v_mov_b32_e64 v83, 0
    buffer_load_dwordx4 a[236:239], v49, s[4:7], s44 offen sc1
    v_cvt_pk_bf16_f32 v72, v88, v89
    v_mfma_f32_32x32x16_bf16 v[136:151], a[168:171], v[228:231], v[136:151]
    v_cvt_pk_bf16_f32 v73, v90, v91
    v_cvt_pk_bf16_f32 v74, v92, v93
    v_cvt_pk_bf16_f32 v75, v94, v95
    v_cvt_pk_bf16_f32 v76, v96, v97
    s_add_u32 m0, s74, 98304
    v_cvt_pk_bf16_f32 v77, v98, v99
    buffer_load_dwordx4 v30, s[4:7], m0 offen sc1 lds
    v_cvt_pk_bf16_f32 v78, v100, v101
    v_mfma_f32_32x32x16_bf16 v[152:167], a[180:183], v[228:231], v[152:167]
    v_cvt_pk_bf16_f32 v79, v102, v103
    v_cvt_pk_bf16_f32 v80, v124, v125
    v_cvt_pk_bf16_f32 v81, v126, v127
    ds_write_b128 v237, v[72:75]
    s_mov_b32 s100, 0x3fb8aa3b
    s_mov_b32 s101, 0x3fb8aa3b
    v_max3_f32 v254, v136, v137, v138
    v_min3_f32 v255, v136, v137, v138
    v_max3_f32 v254, v254, v139, v140
    v_min3_f32 v255, v255, v139, v140
    v_max3_f32 v254, v254, v141, v142
    v_min3_f32 v255, v255, v141, v142
    s_add_u32 m0, s74, 102400
    v_max3_f32 v254, v254, v143, v144
    buffer_load_dwordx4 v30, s[4:7], m0 offen sc1 lds
    v_min3_f32 v255, v255, v143, v144
    v_max3_f32 v254, v254, v145, v146
    v_min3_f32 v255, v255, v145, v146
    v_max3_f32 v254, v254, v147, v148
    v_min3_f32 v255, v255, v147, v148
    v_max3_f32 v254, v254, v149, v150
    v_min3_f32 v255, v255, v149, v150
    v_max3_f32 v254, v254, v151, v152
    v_min3_f32 v255, v255, v151, v152
    v_max3_f32 v254, v254, v153, v154
    v_min3_f32 v255, v255, v153, v154
    v_max_f32 v254, v254, v155
    v_min_f32 v255, v255, v155
    v_pk_mul_f32 v[254:255], v[254:255], s[100:101] neg_lo:[1,0]
    v_pk_fma_f32 v[160:161], v[136:137], s[100:101], v[254:255] op_sel_hi:[1,1,0]
    v_pk_fma_f32 v[180:181], v[136:137], s[100:101], v[254:255] op_sel:[0,0,1] op_sel_hi:[1,1,1] neg_lo:[1,0,0] neg_hi:[1,0,0]
    v_pk_fma_f32 v[162:163], v[138:139], s[100:101], v[254:255] op_sel_hi:[1,1,0]
    v_pk_fma_f32 v[182:183], v[138:139], s[100:101], v[254:255] op_sel:[0,0,1] op_sel_hi:[1,1,1] neg_lo:[1,0,0] neg_hi:[1,0,0]
    v_pk_fma_f32 v[164:165], v[140:141], s[100:101], v[254:255] op_sel_hi:[1,1,0]
    v_pk_fma_f32 v[184:185], v[140:141], s[100:101], v[254:255] op_sel:[0,0,1] op_sel_hi:[1,1,1] neg_lo:[1,0,0] neg_hi:[1,0,0]
    v_pk_fma_f32 v[166:167], v[142:143], s[100:101], v[254:255] op_sel_hi:[1,1,0]
    v_pk_fma_f32 v[186:187], v[142:143], s[100:101], v[254:255] op_sel:[0,0,1] op_sel_hi:[1,1,1] neg_lo:[1,0,0] neg_hi:[1,0,0]
    s_add_u32 m0, s74, 4096
    v_pk_fma_f32 v[168:169], v[144:145], s[100:101], v[254:255] op_sel_hi:[1,1,0]
    buffer_load_dwordx4 v30, s[4:7], m0 offen sc1 lds
    v_pk_fma_f32 v[188:189], v[144:145], s[100:101], v[254:255] op_sel:[0,0,1] op_sel_hi:[1,1,1] neg_lo:[1,0,0] neg_hi:[1,0,0]
    v_pk_fma_f32 v[170:171], v[146:147], s[100:101], v[254:255] op_sel_hi:[1,1,0]
    buffer_load_dwordx4 a[240:243], v49, s[4:7], s45 offen sc1
    v_pk_fma_f32 v[190:191], v[146:147], s[100:101], v[254:255] op_sel:[0,0,1] op_sel_hi:[1,1,1] neg_lo:[1,0,0] neg_hi:[1,0,0]
    v_pk_fma_f32 v[172:173], v[148:149], s[100:101], v[254:255] op_sel_hi:[1,1,0]
    v_pk_fma_f32 v[192:193], v[148:149], s[100:101], v[254:255] op_sel:[0,0,1] op_sel_hi:[1,1,1] neg_lo:[1,0,0] neg_hi:[1,0,0]
    v_pk_fma_f32 v[174:175], v[150:151], s[100:101], v[254:255] op_sel_hi:[1,1,0]
    v_pk_fma_f32 v[194:195], v[150:151], s[100:101], v[254:255] op_sel:[0,0,1] op_sel_hi:[1,1,1] neg_lo:[1,0,0] neg_hi:[1,0,0]
    v_pk_fma_f32 v[176:177], v[152:153], s[100:101], v[254:255] op_sel_hi:[1,1,0]
    v_pk_fma_f32 v[196:197], v[152:153], s[100:101], v[254:255] op_sel:[0,0,1] op_sel_hi:[1,1,1] neg_lo:[1,0,0] neg_hi:[1,0,0]
    v_pk_fma_f32 v[178:179], v[154:155], s[100:101], v[254:255] op_sel_hi:[1,1,0]
    v_pk_fma_f32 v[198:199], v[154:155], s[100:101], v[254:255] op_sel:[0,0,1] op_sel_hi:[1,1,1] neg_lo:[1,0,0] neg_hi:[1,0,0]
    v_exp_f32 v160, v160
    v_exp_f32 v161, v161
    v_exp_f32 v162, v162
    ds_write_b128 v238, v[76:79]
    v_exp_f32 v163, v163
    s_add_u32 m0, s74, 8192
    v_exp_f32 v164, v164
    buffer_load_dwordx4 v30, s[4:7], m0 offen sc1 lds
    v_exp_f32 v165, v165
    v_exp_f32 v166, v166
    v_exp_f32 v167, v167
    v_exp_f32 v168, v168
    v_exp_f32 v169, v169
    v_exp_f32 v170, v170
    ds_write_b128 v239, v[80:83]
    v_exp_f32 v171, v171
    s_add_u32 m0, s74, 12288
    v_exp_f32 v172, v172
    buffer_load_dwordx4 v30, s[4:7], m0 offen sc1 lds
    v_exp_f32 v173, v173
    v_exp_f32 v174, v174
    v_exp_f32 v175, v175
    v_exp_f32 v176, v176
    buffer_load_dwordx4 a[244:247], v49, s[4:7], s46 offen sc1
    v_exp_f32 v177, v177
    v_exp_f32 v178, v178
    v_exp_f32 v179, v179
    s_add_u32 m0, s74, 16384
    v_pk_add_f32 v[136:137], v[160:161], v[162:163]
    buffer_load_dwordx4 v30, s[4:7], m0 offen sc1 lds
    v_pk_add_f32 v[138:139], v[164:165], v[166:167]
    v_pk_add_f32 v[136:137], v[136:137], v[168:169]
    v_pk_add_f32 v[138:139], v[138:139], v[170:171]
    v_pk_add_f32 v[136:137], v[136:137], v[172:173]
    v_pk_add_f32 v[138:139], v[138:139], v[174:175]
    v_pk_add_f32 v[136:137], v[136:137], v[176:177]
    v_pk_add_f32 v[138:139], v[138:139], v[178:179]
    v_pk_add_f32 v[136:137], v[136:137], v[138:139]
    v_add_f32 v254, v136, v137
    v_rcp_f32 v254, v254
    s_nop 0
    s_nop 0
    v_pk_mul_f32 v[160:161], v[160:161], v[254:255] op_sel_hi:[1,0]
    v_pk_mul_f32 v[162:163], v[162:163], v[254:255] op_sel_hi:[1,0]
    v_pk_mul_f32 v[164:165], v[164:165], v[254:255] op_sel_hi:[1,0]
    v_pk_mul_f32 v[166:167], v[166:167], v[254:255] op_sel_hi:[1,0]
    v_pk_mul_f32 v[168:169], v[168:169], v[254:255] op_sel_hi:[1,0]
    v_pk_mul_f32 v[170:171], v[170:171], v[254:255] op_sel_hi:[1,0]
    v_pk_mul_f32 v[172:173], v[172:173], v[254:255] op_sel_hi:[1,0]
    v_pk_mul_f32 v[174:175], v[174:175], v[254:255] op_sel_hi:[1,0]
    v_pk_mul_f32 v[176:177], v[176:177], v[254:255] op_sel_hi:[1,0]
    v_pk_mul_f32 v[178:179], v[178:179], v[254:255] op_sel_hi:[1,0]
    v_cvt_pk_bf16_f32 v84, v160, v161
    s_add_u32 m0, s74, 20480
    v_cvt_pk_bf16_f32 v85, v162, v163
    buffer_load_dwordx4 v30, s[4:7], m0 offen sc1 lds
    v_cvt_pk_bf16_f32 v86, v164, v165
    v_cvt_pk_bf16_f32 v87, v166, v167
    v_cvt_pk_bf16_f32 v88, v168, v169
    v_cvt_pk_bf16_f32 v89, v170, v171
    v_cvt_pk_bf16_f32 v90, v172, v173
    v_cvt_pk_bf16_f32 v91, v174, v175
    v_cvt_pk_bf16_f32 v92, v176, v177
    v_cvt_pk_bf16_f32 v93, v178, v179
    v_exp_f32 v180, v180
    v_exp_f32 v181, v181
    v_exp_f32 v182, v182
    ds_write_b128 v232, v[84:87]
    v_exp_f32 v183, v183
    v_exp_f32 v184, v184
    v_exp_f32 v185, v185
    v_add_u32 v49, 0x10000, v49
    v_exp_f32 v186, v186
    buffer_load_dwordx4 a[248:251], v49, s[4:7], 0 offen sc1
    v_exp_f32 v187, v187
    v_exp_f32 v188, v188
    v_exp_f32 v189, v189
    v_exp_f32 v190, v190
    v_exp_f32 v191, v191
    ds_write_b128 v233, v[88:91]
    v_exp_f32 v192, v192
    v_exp_f32 v193, v193
    v_exp_f32 v194, v194
    v_exp_f32 v195, v195
    v_exp_f32 v196, v196
    v_exp_f32 v197, v197
    v_exp_f32 v198, v198
    v_exp_f32 v199, v199
    v_pk_add_f32 v[140:141], v[180:181], v[182:183]
    v_pk_add_f32 v[142:143], v[184:185], v[186:187]
    v_pk_add_f32 v[140:141], v[140:141], v[188:189]
    v_pk_add_f32 v[142:143], v[142:143], v[190:191]
    v_pk_add_f32 v[140:141], v[140:141], v[192:193]
    v_pk_add_f32 v[142:143], v[142:143], v[194:195]
    v_pk_add_f32 v[140:141], v[140:141], v[196:197]
    v_pk_add_f32 v[142:143], v[142:143], v[198:199]
    v_pk_add_f32 v[140:141], v[140:141], v[142:143]
    v_add_f32 v255, v140, v141
    v_rcp_f32 v255, v255
    s_nop 0
    s_nop 0
    v_pk_mul_f32 v[180:181], v[180:181], v[254:255] op_sel:[0,1] op_sel_hi:[1,1]
    v_pk_mul_f32 v[182:183], v[182:183], v[254:255] op_sel:[0,1] op_sel_hi:[1,1]
    v_cvt_pk_bf16_f32 v94, v180, v181
    v_cvt_pk_bf16_f32 v95, v182, v183
    ds_write_b128 v234, v[92:95]
    v_pk_mul_f32 v[184:185], v[184:185], v[254:255] op_sel:[0,1] op_sel_hi:[1,1]
    v_pk_mul_f32 v[186:187], v[186:187], v[254:255] op_sel:[0,1] op_sel_hi:[1,1]
    v_pk_mul_f32 v[188:189], v[188:189], v[254:255] op_sel:[0,1] op_sel_hi:[1,1]
    v_pk_mul_f32 v[190:191], v[190:191], v[254:255] op_sel:[0,1] op_sel_hi:[1,1]
    v_cvt_pk_bf16_f32 v96, v184, v185
    v_cvt_pk_bf16_f32 v97, v186, v187
    v_cvt_pk_bf16_f32 v98, v188, v189
    v_cvt_pk_bf16_f32 v99, v190, v191
    ds_write_b128 v235, v[96:99]
    v_pk_mul_f32 v[192:193], v[192:193], v[254:255] op_sel:[0,1] op_sel_hi:[1,1]
    v_pk_mul_f32 v[194:195], v[194:195], v[254:255] op_sel:[0,1] op_sel_hi:[1,1]
    v_pk_mul_f32 v[196:197], v[196:197], v[254:255] op_sel:[0,1] op_sel_hi:[1,1]
    v_pk_mul_f32 v[198:199], v[198:199], v[254:255] op_sel:[0,1] op_sel_hi:[1,1]
    v_cvt_pk_bf16_f32 v100, v192, v193
    v_cvt_pk_bf16_f32 v101, v194, v195
    v_cvt_pk_bf16_f32 v102, v196, v197
    v_cvt_pk_bf16_f32 v103, v198, v199
    ds_write_b128 v236, v[100:103]
    s_waitcnt lgkmcnt(0)
    s_barrier
    ds_read_b64_tr_b16 v[136:137], v41 offset:0
    ds_read_b64_tr_b16 v[138:139], v41 offset:1024
    ds_read_b64_tr_b16 v[140:141], v40 offset:0
    ds_read_b64_tr_b16 v[142:143], v40 offset:1024
    ds_read_b64_tr_b16 v[144:145], v240 offset:0
    ds_read_b64_tr_b16 v[146:147], v240 offset:1024
    ds_read_b64_tr_b16 v[148:149], v241 offset:0
    ds_read_b64_tr_b16 v[150:151], v241 offset:1024
    ds_read_b64_tr_b16 v[152:153], v41 offset:4096
    ds_read_b64_tr_b16 v[154:155], v41 offset:5120
    ds_read_b64_tr_b16 v[156:157], v40 offset:4096
    ds_read_b64_tr_b16 v[158:159], v40 offset:5120
    s_waitcnt lgkmcnt(8)
    v_mfma_f32_16x16x32_bf16 v[72:75], v[140:143], v[136:139], 0
    ds_read_b64_tr_b16 v[160:161], v240 offset:4096
    ds_read_b64_tr_b16 v[162:163], v240 offset:5120
    s_waitcnt lgkmcnt(8)
    v_mfma_f32_16x16x32_bf16 v[76:79], v[144:147], v[136:139], 0
    ds_read_b64_tr_b16 v[164:165], v241 offset:4096
    ds_read_b64_tr_b16 v[166:167], v241 offset:5120
    s_waitcnt lgkmcnt(8)
    v_mfma_f32_16x16x32_bf16 v[80:83], v[148:151], v[136:139], 0
    s_nop 0
    ds_read_b64_tr_b16 v[168:169], v41 offset:8192
    ds_read_b64_tr_b16 v[170:171], v41 offset:9216
    ds_read_b64_tr_b16 v[172:173], v40 offset:8192
    ds_read_b64_tr_b16 v[174:175], v40 offset:9216
    s_waitcnt lgkmcnt(8)
    v_mfma_f32_16x16x32_bf16 v[72:75], v[156:159], v[152:155], v[72:75]
    ds_read_b64_tr_b16 v[176:177], v240 offset:8192
    ds_read_b64_tr_b16 v[178:179], v240 offset:9216
    s_waitcnt lgkmcnt(8)
    v_mfma_f32_16x16x32_bf16 v[76:79], v[160:163], v[152:155], v[76:79]
    ds_read_b64_tr_b16 v[180:181], v241 offset:8192
    ds_read_b64_tr_b16 v[182:183], v241 offset:9216
    s_waitcnt lgkmcnt(8)
    v_mfma_f32_16x16x32_bf16 v[80:83], v[164:167], v[152:155], v[80:83]
    s_nop 0
    ds_read_b64_tr_b16 v[184:185], v41 offset:12288
    ds_read_b64_tr_b16 v[186:187], v41 offset:13312
    ds_read_b64_tr_b16 v[188:189], v40 offset:12288
    ds_read_b64_tr_b16 v[190:191], v40 offset:13312
    s_waitcnt lgkmcnt(8)
    v_mfma_f32_16x16x32_bf16 v[72:75], v[172:175], v[168:171], v[72:75]
    ds_read_b64_tr_b16 v[192:193], v240 offset:12288
    ds_read_b64_tr_b16 v[194:195], v240 offset:13312
    s_waitcnt lgkmcnt(8)
    v_mfma_f32_16x16x32_bf16 v[76:79], v[176:179], v[168:171], v[76:79]
    ds_read_b64_tr_b16 v[196:197], v241 offset:12288
    ds_read_b64_tr_b16 v[198:199], v241 offset:13312
    s_waitcnt lgkmcnt(8)
    v_mfma_f32_16x16x32_bf16 v[80:83], v[180:183], v[168:171], v[80:83]
    s_waitcnt lgkmcnt(4)
    v_mfma_f32_16x16x32_bf16 v[72:75], v[188:191], v[184:187], v[72:75]
    s_waitcnt lgkmcnt(2)
    v_mfma_f32_16x16x32_bf16 v[76:79], v[192:195], v[184:187], v[76:79]
    s_waitcnt lgkmcnt(0)
    v_mfma_f32_16x16x32_bf16 v[80:83], v[196:199], v[184:187], v[80:83]
    s_nop 3
    v_cvt_pk_bf16_f32 v84, v72, v73
    v_min_u32 v84, -2, v84
    v_cvt_pk_bf16_f32 v85, v74, v75
    v_min_u32 v85, -2, v85
    v_cvt_pk_bf16_f32 v86, v76, v77
    v_min_u32 v86, -2, v86
    v_cvt_pk_bf16_f32 v87, v78, v79
    v_min_u32 v87, -2, v87
    buffer_store_dwordx4 v[84:87], v33, s[4:7], 0 offen sc1
    v_cvt_pk_bf16_f32 v88, v80, v81
    v_min_u32 v88, -2, v88
    v_cvt_pk_bf16_f32 v89, v82, v83
    v_min_u32 v89, -2, v89
    buffer_store_dwordx2 v[88:89], v34, s[4:7], 0 offen sc1
    s_xor_b32 s96, s78, 15
    s_lshl_b32 s96, s96, 12
    s_mov_b32 s97, 0
    s_barrier
    v_lshrrev_b32 v246, 9, v2
    v_mul_u32_u24 v246, 1536, v246
    v_sub_u32 v246, v5, v246
    s_nop 0
    v_add_u32 v246, 106496, v246
    ds_read_b64_tr_b16 v[136:137], v246 offset:0
    ds_read_b64_tr_b16 v[138:139], v246 offset:256
    ds_read_b64_tr_b16 v[140:141], v246 offset:1024
    ds_read_b64_tr_b16 v[142:143], v246 offset:1280
    ds_read_b64_tr_b16 v[144:145], v246 offset:2048
    ds_read_b64_tr_b16 v[146:147], v246 offset:2304
    ds_read_b64_tr_b16 v[148:149], v246 offset:3072
    ds_read_b64_tr_b16 v[150:151], v246 offset:3328
    s_waitcnt lgkmcnt(6)
    v_mfma_f32_32x32x16_bf16 v[104:119], v[136:139], a[80:83], v[104:119]
    buffer_load_dword a255, v21, s[52:55], 0 offen offset:0 sc1
    ds_read_b64_tr_b16 v[152:153], v246 offset:4096
    ds_read_b64_tr_b16 v[154:155], v246 offset:4352
    s_waitcnt lgkmcnt(6)
    v_mfma_f32_32x32x16_bf16 v[104:119], v[140:143], a[84:87], v[104:119]
    ds_read_b64_tr_b16 v[156:157], v246 offset:5120
    ds_read_b64_tr_b16 v[158:159], v246 offset:5376
    s_waitcnt lgkmcnt(6)
    v_mfma_f32_32x32x16_bf16 v[104:119], v[144:147], a[88:91], v[104:119]
    buffer_load_dword a255, v21, s[52:55], 0 offen offset:512 sc1
    ds_read_b64_tr_b16 v[136:137], v246 offset:6144
    ds_read_b64_tr_b16 v[138:139], v246 offset:6400
    s_waitcnt lgkmcnt(6)
    v_mfma_f32_32x32x16_bf16 v[104:119], v[148:151], a[92:95], v[104:119]
    ds_read_b64_tr_b16 v[140:141], v246 offset:7168
    ds_read_b64_tr_b16 v[142:143], v246 offset:7424
    s_waitcnt lgkmcnt(6)
    v_mfma_f32_32x32x16_bf16 v[104:119], v[152:155], a[96:99], v[104:119]
    buffer_load_dword a255, v22, s[52:55], 0 offen offset:0 sc1
    ds_read_b64_tr_b16 v[144:145], v246 offset:8192
    ds_read_b64_tr_b16 v[146:147], v246 offset:8448
    s_waitcnt lgkmcnt(6)
    v_mfma_f32_32x32x16_bf16 v[104:119], v[156:159], a[100:103], v[104:119]
    ds_read_b64_tr_b16 v[148:149], v246 offset:9216
    ds_read_b64_tr_b16 v[150:151], v246 offset:9472
    s_waitcnt lgkmcnt(6)
    v_mfma_f32_32x32x16_bf16 v[104:119], v[136:139], a[104:107], v[104:119]
    s_add_u32 m0, s74, 126976
    ds_read_b64_tr_b16 v[152:153], v246 offset:10240
    ds_read_b64_tr_b16 v[154:155], v246 offset:10496
    s_waitcnt lgkmcnt(6)
    v_mfma_f32_32x32x16_bf16 v[104:119], v[140:143], a[108:111], v[104:119]
    buffer_load_dwordx4 v31, s[4:7], m0 offen sc1 lds
    ds_read_b64_tr_b16 v[156:157], v246 offset:11264
    ds_read_b64_tr_b16 v[158:159], v246 offset:11520
    s_waitcnt lgkmcnt(6)
    v_mfma_f32_32x32x16_bf16 v[104:119], v[144:147], a[112:115], v[104:119]
    s_add_u32 m0, s74, 131072
    ds_read_b64_tr_b16 v[136:137], v246 offset:12288
    ds_read_b64_tr_b16 v[138:139], v246 offset:12544
    s_waitcnt lgkmcnt(6)
    v_mfma_f32_32x32x16_bf16 v[104:119], v[148:151], a[116:119], v[104:119]
    buffer_load_dwordx4 v31, s[4:7], m0 offen sc1 lds
    ds_read_b64_tr_b16 v[140:141], v246 offset:13312
    ds_read_b64_tr_b16 v[142:143], v246 offset:13568
    s_waitcnt lgkmcnt(6)
    v_mfma_f32_32x32x16_bf16 v[104:119], v[152:155], a[120:123], v[104:119]
    s_add_u32 m0, s74, 135168
    ds_read_b64_tr_b16 v[144:145], v246 offset:14336
    ds_read_b64_tr_b16 v[146:147], v246 offset:14592
    s_waitcnt lgkmcnt(6)
    v_mfma_f32_32x32x16_bf16 v[104:119], v[156:159], a[124:127], v[104:119]
    buffer_load_dwordx4 v31, s[4:7], m0 offen sc1 lds
    ds_read_b64_tr_b16 v[148:149], v246 offset:15360
    ds_read_b64_tr_b16 v[150:151], v246 offset:15616
    s_waitcnt lgkmcnt(6)
    v_mfma_f32_32x32x16_bf16 v[104:119], v[136:139], a[128:131], v[104:119]
    s_add_u32 m0, s74, 139264
    ds_read_b64_tr_b16 v[152:153], v246 offset:16384
    ds_read_b64_tr_b16 v[154:155], v246 offset:16640
    s_waitcnt lgkmcnt(6)
    v_mfma_f32_32x32x16_bf16 v[104:119], v[140:143], a[132:135], v[104:119]
    buffer_load_dwordx4 v31, s[4:7], m0 offen sc1 lds
    ds_read_b64_tr_b16 v[156:157], v246 offset:17408
    ds_read_b64_tr_b16 v[158:159], v246 offset:17664
    s_waitcnt lgkmcnt(6)
    v_mfma_f32_32x32x16_bf16 v[104:119], v[144:147], a[136:139], v[104:119]
    s_add_u32 m0, s74, 143360
    ds_read_b64_tr_b16 v[136:137], v246 offset:18432
    ds_read_b64_tr_b16 v[138:139], v246 offset:18688
    s_waitcnt lgkmcnt(6)
    v_mfma_f32_32x32x16_bf16 v[104:119], v[148:151], a[140:143], v[104:119]
    buffer_load_dwordx4 v31, s[4:7], m0 offen sc1 lds
    ds_read_b64_tr_b16 v[140:141], v246 offset:19456
    ds_read_b64_tr_b16 v[142:143], v246 offset:19712
    s_waitcnt lgkmcnt(6)
    v_mfma_f32_32x32x16_bf16 v[104:119], v[152:155], a[144:147], v[104:119]
    s_add_u32 m0, s74, 147456
    s_waitcnt lgkmcnt(4)
    v_mfma_f32_32x32x16_bf16 v[104:119], v[156:159], a[148:151], v[104:119]
    buffer_load_dwordx4 v31, s[4:7], m0 offen sc1 lds
    s_waitcnt lgkmcnt(2)
    v_mfma_f32_32x32x16_bf16 v[104:119], v[136:139], a[152:155], v[104:119]
    s_add_u32 m0, s74, 151552
    s_waitcnt lgkmcnt(0)
L_pad10:
    s_cbranch_execz L_pad14
    v_mfma_f32_32x32x16_bf16 v[104:119], v[140:143], a[156:159], v[104:119]
    buffer_load_dwordx4 v31, s[4:7], m0 offen sc1 lds
    s_barrier
    s_nop 0
    s_nop 8
    v_pk_fma_f32 v[104:105], v[104:105], v[244:245], v[200:201] op_sel_hi:[1,0,1]
    v_pk_fma_f32 v[106:107], v[106:107], v[244:245], v[202:203] op_sel_hi:[1,0,1]
    v_pk_fma_f32 v[108:109], v[108:109], v[244:245], v[204:205] op_sel_hi:[1,0,1]
    v_pk_fma_f32 v[110:111], v[110:111], v[244:245], v[206:207] op_sel_hi:[1,0,1]
    v_pk_fma_f32 v[112:113], v[112:113], v[244:245], v[208:209] op_sel_hi:[1,0,1]
    v_pk_fma_f32 v[114:115], v[114:115], v[244:245], v[210:211] op_sel_hi:[1,0,1]
    s_add_u32 m0, s74, 155648
    v_pk_fma_f32 v[116:117], v[116:117], v[244:245], v[212:213] op_sel_hi:[1,0,1]
    buffer_load_dwordx4 v31, s[4:7], m0 offen sc1 lds
    v_pk_fma_f32 v[118:119], v[118:119], v[244:245], v[214:215] op_sel_hi:[1,0,1]
    v_pk_fma_f32 v[128:129], v[128:129], v[244:245], v[216:217] op_sel_hi:[1,0,1]
    v_pk_fma_f32 v[130:131], v[130:131], v[244:245], v[218:219] op_sel_hi:[1,0,1]
    v_cvt_pk_bf16_f32 v220, v104, v105
    v_cvt_pk_bf16_f32 v221, v106, v107
    v_cvt_pk_bf16_f32 v222, v108, v109
    v_cvt_pk_bf16_f32 v223, v110, v111
    v_cvt_pk_bf16_f32 v224, v112, v113
    v_cvt_pk_bf16_f32 v225, v114, v115
    v_cvt_pk_bf16_f32 v226, v116, v117
    v_cvt_pk_bf16_f32 v227, v118, v119
    v_cvt_pk_bf16_f32 v228, v128, v129
    v_cvt_pk_bf16_f32 v229, v130, v131
    s_add_u32 m0, s74, 106496
    v_mfma_f32_32x32x16_bf16 v[136:151], a[160:163], v[220:223], 0
    buffer_load_dwordx4 v31, s[4:7], m0 offen sc1 lds
    v_bfe_u32 v246, v2, 6, 1
    v_lshrrev_b32 v247, 9, v2
    v_xor_b32 v246, v246, v247
    v_bfe_u32 v247, v2, 7, 2
    v_lshl_add_u32 v246, v246, 2, v247
    v_mfma_f32_32x32x16_bf16 v[152:167], a[172:175], v[220:223], 0
    v_bfe_u32 v247, v2, 5, 1
    v_lshl_add_u32 v246, v246, 1, v247
    v_and_b32 v247, 16, v2
    v_mov_b32 v248, 0x3f80
    v_lshlrev_b32 v247, v247, v248
    s_add_u32 m0, s74, 110592
    v_mfma_f32_32x32x16_bf16 v[136:151], a[164:167], v[224:227], v[136:151]
    buffer_load_dwordx4 v31, s[4:7], m0 offen sc1 lds
    v_cmp_eq_u32 vcc, 0, v246
    s_nop 1
    v_cndmask_b32 v248, 0, v247, vcc
    v_mfma_f32_32x32x16_bf16 v[152:167], a[176:179], v[224:227], v[152:167]
    v_cmp_eq_u32 vcc, 1, v246
    s_nop 1
    v_cndmask_b32 v249, 0, v247, vcc
    v_mfma_f32_32x32x16_bf16 v[136:151], a[168:171], v[228:231], v[136:151]
    s_add_u32 m0, s74, 114688
    v_cmp_eq_u32 vcc, 2, v246
    s_nop 1
    v_cndmask_b32 v250, 0, v247, vcc
    v_mfma_f32_32x32x16_bf16 v[152:167], a[180:183], v[228:231], v[152:167]
    buffer_load_dwordx4 v31, s[4:7], m0 offen sc1 lds
    v_cmp_eq_u32 vcc, 3, v246
    s_nop 1
    v_cndmask_b32 v251, 0, v247, vcc
    s_mov_b32 s100, 0x3fb8aa3b
    s_mov_b32 s101, 0x3fb8aa3b
    v_max3_f32 v254, v136, v137, v138
    v_min3_f32 v255, v136, v137, v138
    s_add_u32 m0, s74, 118784
    v_max3_f32 v254, v254, v139, v140
    buffer_load_dwordx4 v31, s[4:7], m0 offen sc1 lds
    v_min3_f32 v255, v255, v139, v140
    v_max3_f32 v254, v254, v141, v142
    v_min3_f32 v255, v255, v141, v142
    v_max3_f32 v254, v254, v143, v144
    v_min3_f32 v255, v255, v143, v144
    v_max3_f32 v254, v254, v145, v146
    v_min3_f32 v255, v255, v145, v146
    v_max3_f32 v254, v254, v147, v148
    v_min3_f32 v255, v255, v147, v148
    v_max3_f32 v254, v254, v149, v150
    v_min3_f32 v255, v255, v149, v150
    v_max3_f32 v254, v254, v151, v152
    v_min3_f32 v255, v255, v151, v152
    s_add_u32 m0, s74, 122880
    v_max3_f32 v254, v254, v153, v154
    buffer_load_dwordx4 v31, s[4:7], m0 offen sc1 lds
    v_min3_f32 v255, v255, v153, v154
    v_max_f32 v254, v254, v155
    v_min_f32 v255, v255, v155
    v_pk_mul_f32 v[254:255], v[254:255], s[100:101] neg_lo:[1,0]
    v_pk_fma_f32 v[160:161], v[136:137], s[100:101], v[254:255] op_sel_hi:[1,1,0]
    v_pk_fma_f32 v[180:181], v[136:137], s[100:101], v[254:255] op_sel:[0,0,1] op_sel_hi:[1,1,1] neg_lo:[1,0,0] neg_hi:[1,0,0]
    v_pk_fma_f32 v[162:163], v[138:139], s[100:101], v[254:255] op_sel_hi:[1,1,0]
    v_pk_fma_f32 v[182:183], v[138:139], s[100:101], v[254:255] op_sel:[0,0,1] op_sel_hi:[1,1,1] neg_lo:[1,0,0] neg_hi:[1,0,0]
    v_pk_fma_f32 v[164:165], v[140:141], s[100:101], v[254:255] op_sel_hi:[1,1,0]
    v_pk_fma_f32 v[184:185], v[140:141], s[100:101], v[254:255] op_sel:[0,0,1] op_sel_hi:[1,1,1] neg_lo:[1,0,0] neg_hi:[1,0,0]
    v_pk_fma_f32 v[166:167], v[142:143], s[100:101], v[254:255] op_sel_hi:[1,1,0]
    v_pk_fma_f32 v[186:187], v[142:143], s[100:101], v[254:255] op_sel:[0,0,1] op_sel_hi:[1,1,1] neg_lo:[1,0,0] neg_hi:[1,0,0]
    v_pk_fma_f32 v[168:169], v[144:145], s[100:101], v[254:255] op_sel_hi:[1,1,0]
    s_xor_b32 s95, s96, 0x0
    s_nop 0
    v_pk_fma_f32 v[188:189], v[144:145], s[100:101], v[254:255] op_sel:[0,0,1] op_sel_hi:[1,1,1] neg_lo:[1,0,0] neg_hi:[1,0,0]
    buffer_load_dwordx4 v[232:235], v35, s[4:7], s95 offen sc1
    v_pk_fma_f32 v[170:171], v[146:147], s[100:101], v[254:255] op_sel_hi:[1,1,0]
    v_pk_fma_f32 v[190:191], v[146:147], s[100:101], v[254:255] op_sel:[0,0,1] op_sel_hi:[1,1,1] neg_lo:[1,0,0] neg_hi:[1,0,0]
    v_pk_fma_f32 v[172:173], v[148:149], s[100:101], v[254:255] op_sel_hi:[1,1,0]
    v_pk_fma_f32 v[192:193], v[148:149], s[100:101], v[254:255] op_sel:[0,0,1] op_sel_hi:[1,1,1] neg_lo:[1,0,0] neg_hi:[1,0,0]
    v_pk_fma_f32 v[174:175], v[150:151], s[100:101], v[254:255] op_sel_hi:[1,1,0]
    v_pk_fma_f32 v[194:195], v[150:151], s[100:101], v[254:255] op_sel:[0,0,1] op_sel_hi:[1,1,1] neg_lo:[1,0,0] neg_hi:[1,0,0]
    v_pk_fma_f32 v[176:177], v[152:153], s[100:101], v[254:255] op_sel_hi:[1,1,0]
    v_pk_fma_f32 v[196:197], v[152:153], s[100:101], v[254:255] op_sel:[0,0,1] op_sel_hi:[1,1,1] neg_lo:[1,0,0] neg_hi:[1,0,0]
    v_pk_fma_f32 v[178:179], v[154:155], s[100:101], v[254:255] op_sel_hi:[1,1,0]
    v_pk_fma_f32 v[198:199], v[154:155], s[100:101], v[254:255] op_sel:[0,0,1] op_sel_hi:[1,1,1] neg_lo:[1,0,0] neg_hi:[1,0,0]
    v_exp_f32 v160, v160
    v_exp_f32 v161, v161
    s_xor_b32 s95, s96, 0x1000
    v_exp_f32 v162, v162
    buffer_load_dwordx4 v[236:239], v35, s[4:7], s95 offen sc1
    v_exp_f32 v163, v163
    v_exp_f32 v164, v164
    v_exp_f32 v165, v165
    v_exp_f32 v166, v166
    v_exp_f32 v167, v167
    v_exp_f32 v168, v168
    s_xor_b32 s95, s96, 0x2000
    v_exp_f32 v169, v169
    buffer_load_dwordx4 v[240:243], v35, s[4:7], s95 offen sc1
    v_exp_f32 v170, v170
    v_exp_f32 v171, v171
    v_exp_f32 v172, v172
    v_exp_f32 v173, v173
    v_exp_f32 v174, v174
    v_exp_f32 v175, v175
    s_xor_b32 s95, s96, 0x3000
    v_exp_f32 v176, v176
    buffer_load_dwordx4 v[92:95], v35, s[4:7], s95 offen sc1
    v_exp_f32 v177, v177
    v_exp_f32 v178, v178
    v_exp_f32 v179, v179
    v_pk_add_f32 v[136:137], v[160:161], v[162:163]
    v_pk_add_f32 v[138:139], v[164:165], v[166:167]
    v_pk_add_f32 v[136:137], v[136:137], v[168:169]
    v_pk_add_f32 v[138:139], v[138:139], v[170:171]
    v_pk_add_f32 v[136:137], v[136:137], v[172:173]
    v_pk_add_f32 v[138:139], v[138:139], v[174:175]
    s_xor_b32 s95, s96, 0x4000
    v_pk_add_f32 v[136:137], v[136:137], v[176:177]
    buffer_load_dwordx4 v[96:99], v35, s[4:7], s95 offen sc1
    v_pk_add_f32 v[138:139], v[138:139], v[178:179]
    v_pk_add_f32 v[136:137], v[136:137], v[138:139]
    v_add_f32 v254, v136, v137
    v_rcp_f32 v254, v254
    s_nop 0
    s_nop 0
    v_pk_mul_f32 v[160:161], v[160:161], v[254:255] op_sel_hi:[1,0]
    v_pk_mul_f32 v[162:163], v[162:163], v[254:255] op_sel_hi:[1,0]
    v_pk_mul_f32 v[164:165], v[164:165], v[254:255] op_sel_hi:[1,0]
    v_pk_mul_f32 v[166:167], v[166:167], v[254:255] op_sel_hi:[1,0]
    v_pk_mul_f32 v[168:169], v[168:169], v[254:255] op_sel_hi:[1,0]
    v_pk_mul_f32 v[170:171], v[170:171], v[254:255] op_sel_hi:[1,0]
    v_pk_mul_f32 v[172:173], v[172:173], v[254:255] op_sel_hi:[1,0]
    v_pk_mul_f32 v[174:175], v[174:175], v[254:255] op_sel_hi:[1,0]
    s_xor_b32 s95, s96, 0x5000
    v_pk_mul_f32 v[176:177], v[176:177], v[254:255] op_sel_hi:[1,0]
    buffer_load_dwordx4 v[100:103], v35, s[4:7], s95 offen sc1
    v_pk_mul_f32 v[178:179], v[178:179], v[254:255] op_sel_hi:[1,0]
    v_cvt_pk_bf16_f32 v72, v160, v161
    v_cvt_pk_bf16_f32 v73, v162, v163
    v_cvt_pk_bf16_f32 v76, v164, v165
    v_cvt_pk_bf16_f32 v77, v166, v167
    v_cvt_pk_bf16_f32 v80, v168, v169
    v_cvt_pk_bf16_f32 v81, v170, v171
    v_cvt_pk_bf16_f32 v84, v172, v173
    v_cvt_pk_bf16_f32 v85, v174, v175
    v_cvt_pk_bf16_f32 v74, v176, v177
    v_cvt_pk_bf16_f32 v75, v178, v179
    v_exp_f32 v180, v180
    s_xor_b32 s95, s96, 0x6000
    v_exp_f32 v181, v181
    buffer_load_dwordx4 v[120:123], v35, s[4:7], s95 offen sc1
    v_exp_f32 v182, v182
    v_exp_f32 v183, v183
    v_exp_f32 v184, v184
    v_exp_f32 v185, v185
    v_exp_f32 v186, v186
    v_exp_f32 v187, v187
    v_exp_f32 v188, v188
    s_xor_b32 s95, s96, 0x7000
    v_exp_f32 v189, v189
    buffer_load_dwordx4 v[124:127], v35, s[4:7], s95 offen sc1
    v_exp_f32 v190, v190
    v_exp_f32 v191, v191
    v_exp_f32 v192, v192
    v_exp_f32 v193, v193
    v_exp_f32 v194, v194
    v_exp_f32 v195, v195
    v_exp_f32 v196, v196
    s_xor_b32 s95, s96, 0x8000
    v_exp_f32 v197, v197
    buffer_load_dwordx4 v[132:135], v35, s[4:7], s95 offen sc1
    v_exp_f32 v198, v198
    v_exp_f32 v199, v199
    v_pk_add_f32 v[140:141], v[180:181], v[182:183]
    v_pk_add_f32 v[142:143], v[184:185], v[186:187]
    v_pk_add_f32 v[140:141], v[140:141], v[188:189]
    v_pk_add_f32 v[142:143], v[142:143], v[190:191]
    v_pk_add_f32 v[140:141], v[140:141], v[192:193]
    v_pk_add_f32 v[142:143], v[142:143], v[194:195]
    v_pk_add_f32 v[140:141], v[140:141], v[196:197]
    v_pk_add_f32 v[142:143], v[142:143], v[198:199]
    s_xor_b32 s95, s96, 0x9000
    v_pk_add_f32 v[140:141], v[140:141], v[142:143]
    buffer_load_dwordx4 v[104:107], v35, s[4:7], s95 offen sc1
    v_add_f32 v255, v140, v141
    v_rcp_f32 v255, v255
    s_nop 0
    s_nop 0
    v_pk_mul_f32 v[180:181], v[180:181], v[254:255] op_sel:[0,1] op_sel_hi:[1,1]
    v_pk_mul_f32 v[182:183], v[182:183], v[254:255] op_sel:[0,1] op_sel_hi:[1,1]
    v_cvt_pk_bf16_f32 v78, v180, v181
    v_cvt_pk_bf16_f32 v79, v182, v183
    v_pk_mul_f32 v[184:185], v[184:185], v[254:255] op_sel:[0,1] op_sel_hi:[1,1]
    v_pk_mul_f32 v[186:187], v[186:187], v[254:255] op_sel:[0,1] op_sel_hi:[1,1]
    v_pk_mul_f32 v[188:189], v[188:189], v[254:255] op_sel:[0,1] op_sel_hi:[1,1]
    v_pk_mul_f32 v[190:191], v[190:191], v[254:255] op_sel:[0,1] op_sel_hi:[1,1]
    v_cvt_pk_bf16_f32 v82, v184, v185
    v_cvt_pk_bf16_f32 v83, v186, v187
    v_cvt_pk_bf16_f32 v86, v188, v189
    v_cvt_pk_bf16_f32 v87, v190, v191
    s_xor_b32 s95, s96, 0xa000
    v_pk_mul_f32 v[192:193], v[192:193], v[254:255] op_sel:[0,1] op_sel_hi:[1,1]
    buffer_load_dwordx4 v[108:111], v35, s[4:7], s95 offen sc1
    v_pk_mul_f32 v[194:195], v[194:195], v[254:255] op_sel:[0,1] op_sel_hi:[1,1]
    v_pk_mul_f32 v[196:197], v[196:197], v[254:255] op_sel:[0,1] op_sel_hi:[1,1]
    v_pk_mul_f32 v[198:199], v[198:199], v[254:255] op_sel:[0,1] op_sel_hi:[1,1]
    v_cvt_pk_bf16_f32 v88, v192, v193
    v_cvt_pk_bf16_f32 v89, v194, v195
    v_cvt_pk_bf16_f32 v90, v196, v197
    v_cvt_pk_bf16_f32 v91, v198, v199
    v_permlane32_swap_b32 v72, v76
    v_permlane32_swap_b32 v73, v77
    v_permlane32_swap_b32 v74, v78
    v_permlane32_swap_b32 v75, v79
    s_xor_b32 s95, s96, 0xb000
    v_permlane32_swap_b32 v80, v84
    buffer_load_dwordx4 v[112:115], v35, s[4:7], s95 offen sc1
    v_permlane32_swap_b32 v81, v85
    v_permlane32_swap_b32 v82, v86
    v_permlane32_swap_b32 v83, v87
    v_mov_b32 v136, 0
    v_mov_b32 v137, 0
    v_mov_b32 v138, 0
    v_mov_b32 v139, 0
    v_mov_b32 v140, 0
    v_mov_b32 v141, 0
    v_mov_b32 v142, 0
    s_xor_b32 s95, s96, 0xc000
    v_mov_b32 v143, 0
    buffer_load_dwordx4 v[116:119], v35, s[4:7], s95 offen sc1
    s_mov_b32 s100, 0x00003f80
    s_mov_b32 s101, 0x3f800000
    s_waitcnt vmcnt(12)
    v_max3_u32 v220, v232, v233, v234
    v_max_u32 v220, v220, v235
    v_cmp_eq_u32 vcc, -1, v220
    s_cbranch_vccnz L_kv_57_r
    v_mfma_f32_32x32x16_bf16 v[136:151], v[248:251], v[232:235], v[136:151]
L_kv_57:
    s_waitcnt vmcnt(11)
    v_max3_u32 v220, v236, v237, v238
    v_max_u32 v220, v220, v239
    v_cmp_eq_u32 vcc, -1, v220
    s_cbranch_vccnz L_kv_58_r
    v_mfma_f32_32x32x16_bf16 v[136:151], v[248:251], v[236:239], v[136:151]
L_kv_58:
    s_waitcnt vmcnt(10)
    v_max3_u32 v220, v240, v241, v242
    v_max_u32 v220, v220, v243
    v_cmp_eq_u32 vcc, -1, v220
    s_cbranch_vccnz L_kv_59_r
    v_mfma_f32_32x32x16_bf16 v[136:151], v[248:251], v[240:243], v[136:151]
L_kv_59:
    s_xor_b32 s95, s96, 0xd000
    buffer_load_dwordx4 v[128:131], v35, s[4:7], s95 offen sc1
    s_waitcnt vmcnt(10)
    v_max3_u32 v220, v92, v93, v94
    v_max_u32 v220, v220, v95
    v_cmp_eq_u32 vcc, -1, v220
    s_cbranch_vccnz L_kv_60_r
    v_mfma_f32_32x32x16_bf16 v[136:151], v[248:251], v[92:95], v[136:151]
L_kv_60:
    s_xor_b32 s95, s96, 0xe000
    buffer_load_dwordx4 v[224:227], v35, s[4:7], s95 offen sc1
    s_waitcnt vmcnt(10)
    v_max3_u32 v220, v96, v97, v98
    v_max_u32 v220, v220, v99
    v_cmp_eq_u32 vcc, -1, v220
    s_cbranch_vccnz L_kv_61_r
    v_mfma_f32_32x32x16_bf16 v[136:151], v[248:251], v[96:99], v[136:151]
L_kv_61:
    s_xor_b32 s95, s96, 0xf000
    buffer_load_dwordx4 v[228:231], v35, s[4:7], s95 offen sc1
    s_waitcnt vmcnt(10)
    v_max3_u32 v220, v100, v101, v102
    v_max_u32 v220, v220, v103
    v_cmp_eq_u32 vcc, -1, v220
    s_cbranch_vccnz L_kv_62_r
    v_mfma_f32_32x32x16_bf16 v[136:151], v[248:251], v[100:103], v[136:151]
L_kv_62:
    s_waitcnt vmcnt(9)
    v_max3_u32 v220, v120, v121, v122
    v_max_u32 v220, v220, v123
    v_cmp_eq_u32 vcc, -1, v220
    s_cbranch_vccnz L_kv_63_r
    v_mfma_f32_32x32x16_bf16 v[136:151], v[248:251], v[120:123], v[136:151]
L_kv_63:
    s_waitcnt vmcnt(8)
    v_max3_u32 v220, v124, v125, v126
    v_max_u32 v220, v220, v127
    v_cmp_eq_u32 vcc, -1, v220
    s_cbranch_vccnz L_kv_64_r
    v_mfma_f32_32x32x16_bf16 v[136:151], v[248:251], v[124:127], v[136:151]
L_kv_64:
    s_waitcnt vmcnt(7)
    v_max3_u32 v220, v132, v133, v134
    v_max_u32 v220, v220, v135
    v_cmp_eq_u32 vcc, -1, v220
    s_cbranch_vccnz L_kv_65_r
    v_mfma_f32_32x32x16_bf16 v[136:151], v[248:251], v[132:135], v[136:151]
L_kv_65:
    s_waitcnt vmcnt(6)
    v_max3_u32 v220, v104, v105, v106
    v_max_u32 v220, v220, v107
    v_cmp_eq_u32 vcc, -1, v220
    s_cbranch_vccnz L_kv_66_r
    v_mfma_f32_32x32x16_bf16 v[136:151], v[248:251], v[104:107], v[136:151]
L_kv_66:
    s_waitcnt vmcnt(5)
    v_max3_u32 v220, v108, v109, v110
    v_max_u32 v220, v220, v111
    v_cmp_eq_u32 vcc, -1, v220
    s_cbranch_vccnz L_kv_67_r
    v_mfma_f32_32x32x16_bf16 v[136:151], v[248:251], v[108:111], v[136:151]
L_kv_67:
    s_waitcnt vmcnt(4)
    v_max3_u32 v220, v112, v113, v114
    v_max_u32 v220, v220, v115
    v_cmp_eq_u32 vcc, -1, v220
    s_cbranch_vccnz L_kv_68_r
    v_mfma_f32_32x32x16_bf16 v[136:151], v[248:251], v[112:115], v[136:151]
L_kv_68:
    s_waitcnt vmcnt(3)
    v_max3_u32 v220, v116, v117, v118
    v_max_u32 v220, v220, v119
    v_cmp_eq_u32 vcc, -1, v220
    s_cbranch_vccnz L_kv_69_r
    v_mfma_f32_32x32x16_bf16 v[136:151], v[248:251], v[116:119], v[136:151]
L_kv_69:
    s_waitcnt vmcnt(2)
    v_max3_u32 v220, v128, v129, v130
    v_max_u32 v220, v220, v131
    v_cmp_eq_u32 vcc, -1, v220
    s_cbranch_vccnz L_kv_70_r
    v_mfma_f32_32x32x16_bf16 v[136:151], v[248:251], v[128:131], v[136:151]
L_kv_70:
    s_waitcnt vmcnt(1)
    v_max3_u32 v220, v224, v225, v226
    v_max_u32 v220, v220, v227
    v_cmp_eq_u32 vcc, -1, v220
    s_cbranch_vccnz L_kv_71_r
    v_mfma_f32_32x32x16_bf16 v[136:151], v[248:251], v[224:227], v[136:151]
L_kv_71:
    s_waitcnt vmcnt(0)
    v_max3_u32 v220, v228, v229, v230
    v_max_u32 v220, v220, v231
    v_cmp_eq_u32 vcc, -1, v220
    s_cbranch_vccnz L_kv_72_r
    v_mfma_f32_32x32x16_bf16 v[136:151], v[248:251], v[228:231], v[136:151]
L_kv_72:
    s_cmp_lg_u32 s97, 0
    s_cbranch_scc1 L_kv_late1
L_kv_done1:
    s_nop 9
    v_cvt_pk_bf16_f32 v216, v136, v137
    v_cvt_pk_bf16_f32 v217, v138, v139
    v_cvt_pk_bf16_f32 v218, v140, v141
    v_cvt_pk_bf16_f32 v219, v142, v143
    ds_write_b128 v47, v[216:219]
    s_waitcnt lgkmcnt(0)
    s_barrier
    ds_read_b128 v[136:139], v42 offset:0
    ds_read_b128 v[144:147], v42 offset:672
    ds_read_b128 v[152:155], v43 offset:0
    ds_read_b128 v[140:143], v42 offset:1680
    ds_read_b128 v[148:151], v42 offset:2352
    ds_read_b128 v[156:159], v44 offset:0
    s_waitcnt lgkmcnt(5)
    v_mfma_f32_32x32x16_bf16 v[200:215], v[136:139], v[72:75], 0
    s_waitcnt lgkmcnt(4)
    v_mfma_f32_32x32x16_bf16 v[200:215], v[144:147], v[80:83], v[200:215]
    s_waitcnt lgkmcnt(3)
    v_mfma_f32_32x32x16_bf16 v[200:215], v[152:155], v[88:91], v[200:215]
    s_waitcnt lgkmcnt(2)
    v_mfma_f32_32x32x16_bf16 v[216:231], v[140:143], v[76:79], 0
    s_waitcnt lgkmcnt(1)
    v_mfma_f32_32x32x16_bf16 v[216:231], v[148:151], v[84:87], v[216:231]
    s_waitcnt lgkmcnt(0)
    v_mfma_f32_32x32x16_bf16 v[216:231], v[156:159], v[88:91], v[216:231]
    s_cmp_eq_u32 s76, 0
    s_cbranch_scc0 L_sec_73_s
    s_nop 3
    v_add_f32 v212, 0x358637bd, v212
    v_rcp_f32 v212, v212
    s_nop 0
    s_nop 0
    v_pk_mul_f32 v[200:201], v[200:201], v[212:213] op_sel_hi:[1,0]
    v_pk_mul_f32 v[202:203], v[202:203], v[212:213] op_sel_hi:[1,0]
    v_pk_mul_f32 v[204:205], v[204:205], v[212:213] op_sel_hi:[1,0]
    v_pk_mul_f32 v[206:207], v[206:207], v[212:213] op_sel_hi:[1,0]
    v_pk_mul_f32 v[208:209], v[208:209], v[212:213] op_sel_hi:[1,0]
    v_pk_mul_f32 v[210:211], v[210:211], v[212:213] op_sel_hi:[1,0]
    v_cvt_pk_bf16_f32 v96, v200, v201
    v_cvt_pk_bf16_f32 v97, v202, v203
    v_cvt_pk_bf16_f32 v98, v204, v205
    v_cvt_pk_bf16_f32 v99, v206, v207
    buffer_store_dwordx4 v[96:99], v21, s[48:51], 0 offen offset:0 nt
    v_cvt_pk_bf16_f32 v104, v208, v209
    v_cvt_pk_bf16_f32 v105, v210, v211
    v_add_f32 v228, 0x358637bd, v228
    v_rcp_f32 v228, v228
    s_nop 0
    v_pk_mul_f32 v[216:217], v[216:217], v[228:229] op_sel_hi:[1,0]
    v_pk_mul_f32 v[218:219], v[218:219], v[228:229] op_sel_hi:[1,0]
    v_pk_mul_f32 v[220:221], v[220:221], v[228:229] op_sel_hi:[1,0]
    v_pk_mul_f32 v[222:223], v[222:223], v[228:229] op_sel_hi:[1,0]
    v_pk_mul_f32 v[224:225], v[224:225], v[228:229] op_sel_hi:[1,0]
    v_pk_mul_f32 v[226:227], v[226:227], v[228:229] op_sel_hi:[1,0]
    v_cvt_pk_bf16_f32 v100, v216, v217
    v_cvt_pk_bf16_f32 v101, v218, v219
    v_cvt_pk_bf16_f32 v102, v220, v221
    v_cvt_pk_bf16_f32 v103, v222, v223
    buffer_store_dwordx4 v[100:103], v21, s[48:51], 0 offen offset:512 nt
    v_cvt_pk_bf16_f32 v106, v224, v225
    v_cvt_pk_bf16_f32 v107, v226, v227
    buffer_store_dwordx4 v[104:107], v22, s[48:51], 0 offen nt
    s_waitcnt vmcnt(0)
    s_mov_b64 exec, 1
    buffer_store_dword v28, off, s[48:51], s85 offset:64
    s_mov_b64 exec, -1
    s_mov_b64 s[8:9], s[48:49]
    s_add_u32 s48, s48, s56
    s_addc_u32 s49, s49, 0
L_sec_73_e:
L_p21:
    s_barrier
    s_nop 0
    ds_read_b128 v[136:139], v2 offset:4096
    ds_read_b128 v[140:143], v2 offset:5120
    ds_read_b128 v[144:147], v2 offset:6144
    ds_read_b128 v[148:151], v2 offset:7168
    ds_read_b128 v[152:155], v2 offset:8192
    ds_read_b128 v[156:159], v2 offset:9216
    ds_read_b128 v[160:163], v2 offset:10240
    ds_read_b128 v[164:167], v2 offset:11264
    ds_read_b128 v[168:171], v2 offset:12288
    ds_read_b128 v[172:175], v2 offset:13312
L_poll_76:
    buffer_load_dword v252, v27, s[8:11], s83 offen offset:64 sc1
    s_sub_u32 s80, s80, 1
    s_cbranch_scc1 L_end
    s_waitcnt vmcnt(0)
    v_cmp_ne_u32 vcc, s81, v252
    s_cbranch_vccnz L_poll_76
    s_nop 0
    buffer_load_dwordx4 v[72:75], v12, s[8:11], 0 offen offset:0 sc1
    buffer_load_dwordx4 v[76:79], v12, s[8:11], 0 offen offset:1024 sc1
    buffer_load_dwordx4 v[80:83], v12, s[8:11], 0 offen offset:2048 sc1
    buffer_load_dwordx4 v[84:87], v12, s[8:11], 0 offen offset:3072 sc1
    s_add_u32 s81, s81, 32
    v_mov_b32 v28, s81
    s_waitcnt vmcnt(3) lgkmcnt(5)
    v_mfma_f32_16x16x32_bf16 v[52:55], v[136:139], v[72:75], v[52:55]
    ds_read_b128 v[176:179], v2 offset:14336
    buffer_load_dwordx4 v[88:91], v12, s[8:11], s32 offen offset:0 sc1
    v_mfma_f32_16x16x32_bf16 v[56:59], v[140:143], v[72:75], v[56:59]
    ds_read_b128 v[136:139], v2 offset:15360
    v_mfma_f32_16x16x32_bf16 v[60:63], v[144:147], v[72:75], v[60:63]
    ds_read_b128 v[140:143], v2 offset:16384
    buffer_load_dwordx4 v[92:95], v12, s[8:11], s32 offen offset:1024 sc1
    v_mfma_f32_16x16x32_bf16 v[64:67], v[148:151], v[72:75], v[64:67]
    ds_read_b128 v[144:147], v2 offset:17408
    v_mfma_f32_16x16x32_bf16 v[68:71], v[152:155], v[72:75], v[68:71]
    ds_read_b128 v[148:151], v2 offset:18432
    s_waitcnt vmcnt(4) lgkmcnt(5)
    v_mfma_f32_16x16x32_bf16 v[52:55], v[156:159], v[76:79], v[52:55]
    ds_read_b128 v[152:155], v2 offset:19456
    buffer_load_dwordx4 v[96:99], v12, s[8:11], s32 offen offset:2048 sc1
    v_mfma_f32_16x16x32_bf16 v[56:59], v[160:163], v[76:79], v[56:59]
    ds_read_b128 v[156:159], v2 offset:20480
    v_mfma_f32_16x16x32_bf16 v[60:63], v[164:167], v[76:79], v[60:63]
    ds_read_b128 v[160:163], v2 offset:21504
    buffer_load_dwordx4 v[100:103], v12, s[8:11], s32 offen offset:3072 sc1
    v_mfma_f32_16x16x32_bf16 v[64:67], v[168:171], v[76:79], v[64:67]
    ds_read_b128 v[164:167], v2 offset:22528
    v_mfma_f32_16x16x32_bf16 v[68:71], v[172:175], v[76:79], v[68:71]
    ds_read_b128 v[168:171], v2 offset:23552
    s_waitcnt vmcnt(5) lgkmcnt(5)
    v_mfma_f32_16x16x32_bf16 v[52:55], v[176:179], v[80:83], v[52:55]
    ds_read_b128 v[172:175], v2 offset:24576
    buffer_load_dwordx4 v[104:107], v12, s[8:11], s33 offen offset:0 sc1
    v_mfma_f32_16x16x32_bf16 v[56:59], v[136:139], v[80:83], v[56:59]
    ds_read_b128 v[176:179], v2 offset:25600
    v_mfma_f32_16x16x32_bf16 v[60:63], v[140:143], v[80:83], v[60:63]
    ds_read_b128 v[136:139], v2 offset:26624
    v_mfma_f32_16x16x32_bf16 v[64:67], v[144:147], v[80:83], v[64:67]
    ds_read_b128 v[140:143], v2 offset:27648
    buffer_load_dwordx4 v[108:111], v12, s[8:11], s33 offen offset:1024 sc1
    v_mfma_f32_16x16x32_bf16 v[68:71], v[148:151], v[80:83], v[68:71]
    ds_read_b128 v[144:147], v2 offset:28672
    s_waitcnt vmcnt(6) lgkmcnt(5)
    v_mfma_f32_16x16x32_bf16 v[52:55], v[152:155], v[84:87], v[52:55]
    ds_read_b128 v[148:151], v2 offset:29696
    buffer_load_dwordx4 v[112:115], v12, s[8:11], s33 offen offset:2048 sc1
    v_mfma_f32_16x16x32_bf16 v[56:59], v[156:159], v[84:87], v[56:59]
    ds_read_b128 v[152:155], v2 offset:30720
    v_mfma_f32_16x16x32_bf16 v[60:63], v[160:163], v[84:87], v[60:63]
    ds_read_b128 v[156:159], v2 offset:31744
    v_mfma_f32_16x16x32_bf16 v[64:67], v[164:167], v[84:87], v[64:67]
    ds_read_b128 v[160:163], v2 offset:32768
    buffer_load_dwordx4 v[116:119], v12, s[8:11], s33 offen offset:3072 sc1
    v_mfma_f32_16x16x32_bf16 v[68:71], v[168:171], v[84:87], v[68:71]
    ds_read_b128 v[164:167], v2 offset:33792
    s_waitcnt vmcnt(7) lgkmcnt(5)
    v_mfma_f32_16x16x32_bf16 v[52:55], v[172:175], v[88:91], v[52:55]
    ds_read_b128 v[168:171], v2 offset:34816
    buffer_load_dwordx4 v[120:123], v12, s[8:11], s34 offen offset:0 sc1
    v_mfma_f32_16x16x32_bf16 v[56:59], v[176:179], v[88:91], v[56:59]
    ds_read_b128 v[172:175], v2 offset:35840
    v_mfma_f32_16x16x32_bf16 v[60:63], v[136:139], v[88:91], v[60:63]
    ds_read_b128 v[176:179], v2 offset:36864
    v_mfma_f32_16x16x32_bf16 v[64:67], v[140:143], v[88:91], v[64:67]
    ds_read_b128 v[136:139], v2 offset:37888
    buffer_load_dwordx4 v[124:127], v12, s[8:11], s34 offen offset:1024 sc1
    v_mfma_f32_16x16x32_bf16 v[68:71], v[144:147], v[88:91], v[68:71]
    ds_read_b128 v[140:143], v2 offset:38912
    s_waitcnt vmcnt(8) lgkmcnt(5)
    v_mfma_f32_16x16x32_bf16 v[52:55], v[148:151], v[92:95], v[52:55]
    ds_read_b128 v[144:147], v2 offset:39936
    v_mfma_f32_16x16x32_bf16 v[56:59], v[152:155], v[92:95], v[56:59]
    ds_read_b128 v[148:151], v2 offset:40960
    buffer_load_dwordx4 v[128:131], v12, s[8:11], s34 offen offset:2048 sc1
    v_mfma_f32_16x16x32_bf16 v[60:63], v[156:159], v[92:95], v[60:63]
    ds_read_b128 v[152:155], v2 offset:41984
    s_add_u32 s24, s70, L_p31+1024-L_pc
    s_addc_u32 s25, s71, 0
    v_mov_b32 v0, s24
    v_mov_b32 v1, s25
    v_mfma_f32_16x16x32_bf16 v[64:67], v[160:163], v[92:95], v[64:67]
    ds_read_b128 v[156:159], v2 offset:43008
    global_load_dword a255, v[0:1], off
    v_mfma_f32_16x16x32_bf16 v[68:71], v[164:167], v[92:95], v[68:71]
    ds_read_b128 v[160:163], v2 offset:44032
    s_waitcnt vmcnt(9) lgkmcnt(5)
    v_mfma_f32_16x16x32_bf16 v[52:55], v[168:171], v[96:99], v[52:55]
    s_barrier
    ds_read_b128 v[164:167], v2 offset:45056
    v_mfma_f32_16x16x32_bf16 v[56:59], v[172:175], v[96:99], v[56:59]
    ds_read_b128 v[168:171], v2 offset:46080
    buffer_load_dwordx4 v[132:135], v12, s[8:11], s34 offen offset:3072 sc1
    v_mfma_f32_16x16x32_bf16 v[60:63], v[176:179], v[96:99], v[60:63]
    ds_read_b128 v[172:175], v2 offset:47104
    v_mfma_f32_16x16x32_bf16 v[64:67], v[136:139], v[96:99], v[64:67]
    ds_read_b128 v[176:179], v2 offset:48128
    buffer_load_dword a255, v16, s[52:55], 0 offen offset:0 sc1
    v_mfma_f32_16x16x32_bf16 v[68:71], v[140:143], v[96:99], v[68:71]
    ds_read_b128 v[136:139], v2 offset:49152
    s_waitcnt vmcnt(10) lgkmcnt(5)
    v_mfma_f32_16x16x32_bf16 v[52:55], v[144:147], v[100:103], v[52:55]
    ds_read_b128 v[140:143], v2 offset:50176
    v_mfma_f32_16x16x32_bf16 v[56:59], v[148:151], v[100:103], v[56:59]
    ds_read_b128 v[144:147], v2 offset:51200
    buffer_load_dwordx4 v[72:75], v12, s[8:11], s35 offen offset:0 sc1
    v_mfma_f32_16x16x32_bf16 v[60:63], v[152:155], v[100:103], v[60:63]
    ds_read_b128 v[148:151], v2 offset:52224
    v_mfma_f32_16x16x32_bf16 v[64:67], v[156:159], v[100:103], v[64:67]
    ds_read_b128 v[152:155], v2 offset:53248
    v_mfma_f32_16x16x32_bf16 v[68:71], v[160:163], v[100:103], v[68:71]
    ds_read_b128 v[156:159], v2 offset:54272
    s_waitcnt vmcnt(10) lgkmcnt(5)
    v_mfma_f32_16x16x32_bf16 v[52:55], v[164:167], v[104:107], v[52:55]
    ds_read_b128 v[160:163], v2 offset:55296
    buffer_load_dword a255, v16, s[52:55], 0 offen offset:2048 sc1
    v_mfma_f32_16x16x32_bf16 v[56:59], v[168:171], v[104:107], v[56:59]
    ds_read_b128 v[164:167], v2 offset:56320
    v_mfma_f32_16x16x32_bf16 v[60:63], v[172:175], v[104:107], v[60:63]
    ds_read_b128 v[168:171], v2 offset:57344
    buffer_load_dwordx4 v[76:79], v12, s[8:11], s35 offen offset:1024 sc1
    v_mfma_f32_16x16x32_bf16 v[64:67], v[176:179], v[104:107], v[64:67]
    ds_read_b128 v[172:175], v2 offset:58368
    v_mfma_f32_16x16x32_bf16 v[68:71], v[136:139], v[104:107], v[68:71]
    ds_read_b128 v[176:179], v2 offset:59392
    s_waitcnt vmcnt(11) lgkmcnt(5)
    v_mfma_f32_16x16x32_bf16 v[52:55], v[140:143], v[108:111], v[52:55]
    ds_read_b128 v[136:139], v2 offset:60416
    buffer_load_dword a255, v17, s[52:55], 0 offen offset:0 sc1
    v_mfma_f32_16x16x32_bf16 v[56:59], v[144:147], v[108:111], v[56:59]
    ds_read_b128 v[140:143], v2 offset:61440
    v_mfma_f32_16x16x32_bf16 v[60:63], v[148:151], v[108:111], v[60:63]
    ds_read_b128 v[144:147], v2 offset:62464
    buffer_load_dwordx4 v[80:83], v12, s[8:11], s35 offen offset:2048 sc1
    v_mfma_f32_16x16x32_bf16 v[64:67], v[152:155], v[108:111], v[64:67]
    ds_read_b128 v[148:151], v2 offset:63488
    v_mfma_f32_16x16x32_bf16 v[68:71], v[156:159], v[108:111], v[68:71]
    ds_read_b128 v[152:155], v2 offset:64512
    s_waitcnt vmcnt(12) lgkmcnt(5)
    v_mfma_f32_16x16x32_bf16 v[52:55], v[160:163], v[112:115], v[52:55]
    ds_read_b128 v[156:159], v3 offset:0
    buffer_load_dword a255, v18, s[52:55], 0 offen offset:0 sc1
    v_mfma_f32_16x16x32_bf16 v[56:59], v[164:167], v[112:115], v[56:59]
    ds_read_b128 v[160:163], v3 offset:1024
    v_mfma_f32_16x16x32_bf16 v[60:63], v[168:171], v[112:115], v[60:63]
    ds_read_b128 v[164:167], v3 offset:2048
    buffer_load_dwordx4 v[84:87], v12, s[8:11], s35 offen offset:3072 sc1
    v_mfma_f32_16x16x32_bf16 v[64:67], v[172:175], v[112:115], v[64:67]
    ds_read_b128 v[168:171], v3 offset:3072
    v_mfma_f32_16x16x32_bf16 v[68:71], v[176:179], v[112:115], v[68:71]
    ds_read_b128 v[172:175], v3 offset:4096
    v_add_u32 v31, 0x27000, v31
    s_add_u32 m0, s74, 0
    s_waitcnt vmcnt(13) lgkmcnt(5)
    v_mfma_f32_16x16x32_bf16 v[52:55], v[136:139], v[116:119], v[52:55]
    ds_read_b128 v[176:179], v3 offset:5120
    buffer_load_dwordx4 v31, s[4:7], m0 offen sc1 lds
    v_mfma_f32_16x16x32_bf16 v[56:59], v[140:143], v[116:119], v[56:59]
    ds_read_b128 v[136:139], v3 offset:6144
    s_add_u32 m0, s74, 4096
L_pad11:
    s_cbranch_execz L_pad15
    v_mfma_f32_16x16x32_bf16 v[60:63], v[144:147], v[116:119], v[60:63]
    ds_read_b128 v[140:143], v3 offset:7168
    buffer_load_dwordx4 v31, s[4:7], m0 offen sc1 lds
    v_mfma_f32_16x16x32_bf16 v[64:67], v[148:151], v[116:119], v[64:67]
    ds_read_b128 v[144:147], v3 offset:8192
    v_mfma_f32_16x16x32_bf16 v[68:71], v[152:155], v[116:119], v[68:71]
    ds_read_b128 v[148:151], v3 offset:9216
    s_add_u32 m0, s74, 8192
    s_waitcnt vmcnt(14) lgkmcnt(5)
    v_mfma_f32_16x16x32_bf16 v[52:55], v[156:159], v[120:123], v[52:55]
    ds_read_b128 v[152:155], v3 offset:10240
    buffer_load_dwordx4 v31, s[4:7], m0 offen sc1 lds
    v_mfma_f32_16x16x32_bf16 v[56:59], v[160:163], v[120:123], v[56:59]
    ds_read_b128 v[156:159], v3 offset:11264
    s_add_u32 m0, s74, 12288
    v_mfma_f32_16x16x32_bf16 v[60:63], v[164:167], v[120:123], v[60:63]
    ds_read_b128 v[160:163], v3 offset:12288
    buffer_load_dwordx4 v31, s[4:7], m0 offen sc1 lds
    v_mfma_f32_16x16x32_bf16 v[64:67], v[168:171], v[120:123], v[64:67]
    ds_read_b128 v[164:167], v3 offset:13312
    v_mfma_f32_16x16x32_bf16 v[68:71], v[172:175], v[120:123], v[68:71]
    ds_read_b128 v[168:171], v3 offset:14336
    s_cmp_eq_u32 s60, 17
    s_cselect_b32 s3, 0xfffdd000, 0
    v_add_u32 v31, s3, v31
    s_add_u32 m0, s74, 16384
    s_waitcnt vmcnt(15) lgkmcnt(5)
    v_mfma_f32_16x16x32_bf16 v[52:55], v[176:179], v[124:127], v[52:55]
    ds_read_b128 v[172:175], v3 offset:15360
    buffer_load_dwordx4 v31, s[4:7], m0 offen sc1 lds
    v_mfma_f32_16x16x32_bf16 v[56:59], v[136:139], v[124:127], v[56:59]
    ds_read_b128 v[176:179], v3 offset:16384
    v_mfma_f32_16x16x32_bf16 v[60:63], v[140:143], v[124:127], v[60:63]
    ds_read_b128 v[136:139], v3 offset:17408
    v_mfma_f32_16x16x32_bf16 v[64:67], v[144:147], v[124:127], v[64:67]
    ds_read_b128 v[140:143], v3 offset:18432
    v_mfma_f32_16x16x32_bf16 v[68:71], v[148:151], v[124:127], v[68:71]
    ds_read_b128 v[144:147], v3 offset:19456
    s_waitcnt vmcnt(15) lgkmcnt(5)
    v_mfma_f32_16x16x32_bf16 v[52:55], v[152:155], v[128:131], v[52:55]
    ds_read_b128 v[148:151], v3 offset:20480
    v_mfma_f32_16x16x32_bf16 v[56:59], v[156:159], v[128:131], v[56:59]
    ds_read_b128 v[152:155], v3 offset:21504
    v_mfma_f32_16x16x32_bf16 v[60:63], v[160:163], v[128:131], v[60:63]
    ds_read_b128 v[156:159], v3 offset:22528
    v_mfma_f32_16x16x32_bf16 v[64:67], v[164:167], v[128:131], v[64:67]
    ds_read_b128 v[160:163], v3 offset:23552
    v_mfma_f32_16x16x32_bf16 v[68:71], v[168:171], v[128:131], v[68:71]
    ds_read_b128 v[164:167], v3 offset:24576
    s_waitcnt vmcnt(13) lgkmcnt(5)
    v_mfma_f32_16x16x32_bf16 v[52:55], v[172:175], v[132:135], v[52:55]
    ds_read_b128 v[168:171], v3 offset:25600
    v_mfma_f32_16x16x32_bf16 v[56:59], v[176:179], v[132:135], v[56:59]
    ds_read_b128 v[172:175], v3 offset:26624
    v_mfma_f32_16x16x32_bf16 v[60:63], v[136:139], v[132:135], v[60:63]
    ds_read_b128 v[176:179], v3 offset:27648
    v_mfma_f32_16x16x32_bf16 v[64:67], v[140:143], v[132:135], v[64:67]
    ds_read_b128 v[136:139], v3 offset:28672
    v_mfma_f32_16x16x32_bf16 v[68:71], v[144:147], v[132:135], v[68:71]
    ds_read_b128 v[140:143], v3 offset:29696
    s_waitcnt vmcnt(11) lgkmcnt(5)
    v_mfma_f32_16x16x32_bf16 v[52:55], v[148:151], v[72:75], v[52:55]
    ds_read_b128 v[144:147], v3 offset:30720
    v_mfma_f32_16x16x32_bf16 v[56:59], v[152:155], v[72:75], v[56:59]
    ds_read_b128 v[148:151], v3 offset:31744
    v_mfma_f32_16x16x32_bf16 v[60:63], v[156:159], v[72:75], v[60:63]
    ds_read_b128 v[152:155], v3 offset:32768
    v_mfma_f32_16x16x32_bf16 v[64:67], v[160:163], v[72:75], v[64:67]
    ds_read_b128 v[156:159], v3 offset:33792
    v_mfma_f32_16x16x32_bf16 v[68:71], v[164:167], v[72:75], v[68:71]
    ds_read_b128 v[160:163], v3 offset:34816
    s_waitcnt vmcnt(9) lgkmcnt(5)
    v_mfma_f32_16x16x32_bf16 v[52:55], v[168:171], v[76:79], v[52:55]
    ds_read_b128 v[164:167], v3 offset:35840
    v_mfma_f32_16x16x32_bf16 v[56:59], v[172:175], v[76:79], v[56:59]
    ds_read_b128 v[168:171], v3 offset:36864
    v_mfma_f32_16x16x32_bf16 v[60:63], v[176:179], v[76:79], v[60:63]
    ds_read_b128 v[172:175], v3 offset:37888
    v_mfma_f32_16x16x32_bf16 v[64:67], v[136:139], v[76:79], v[64:67]
    ds_read_b128 v[176:179], v3 offset:38912
    v_mfma_f32_16x16x32_bf16 v[68:71], v[140:143], v[76:79], v[68:71]
    ds_read_b128 v[136:139], v3 offset:39936
    s_waitcnt vmcnt(7) lgkmcnt(5)
    v_mfma_f32_16x16x32_bf16 v[52:55], v[144:147], v[80:83], v[52:55]
    v_mfma_f32_16x16x32_bf16 v[56:59], v[148:151], v[80:83], v[56:59]
    v_mfma_f32_16x16x32_bf16 v[60:63], v[152:155], v[80:83], v[60:63]
    v_mfma_f32_16x16x32_bf16 v[64:67], v[156:159], v[80:83], v[64:67]
    v_mfma_f32_16x16x32_bf16 v[68:71], v[160:163], v[80:83], v[68:71]
    s_waitcnt vmcnt(5) lgkmcnt(0)
    v_mfma_f32_16x16x32_bf16 v[52:55], v[164:167], v[84:87], v[52:55]
    v_mfma_f32_16x16x32_bf16 v[56:59], v[168:171], v[84:87], v[56:59]
    v_mfma_f32_16x16x32_bf16 v[60:63], v[172:175], v[84:87], v[60:63]
    v_mfma_f32_16x16x32_bf16 v[64:67], v[176:179], v[84:87], v[64:67]
    v_mfma_f32_16x16x32_bf16 v[68:71], v[136:139], v[84:87], v[68:71]
    s_cmp_eq_u32 s76, 0
    s_cbranch_scc0 L_sec_82_s
    s_nop 0
    s_nop 0
    v_cvt_pk_bf16_f32 v208, v52, v53
    v_cvt_pk_bf16_f32 v209, v54, v55
    v_cvt_pk_bf16_f32 v210, v56, v57
    v_cvt_pk_bf16_f32 v211, v58, v59
    buffer_store_dwordx4 v[208:211], v16, s[48:51], 0 offen nt
    v_cvt_pk_bf16_f32 v212, v60, v61
    v_cvt_pk_bf16_f32 v213, v62, v63
    v_cvt_pk_bf16_f32 v214, v64, v65
    v_cvt_pk_bf16_f32 v215, v66, v67
    v_cvt_pk_bf16_f32 v216, v68, v69
    v_cvt_pk_bf16_f32 v217, v70, v71
    v_pk_add_f32 v[228:229], v[52:53], v[54:55]
    v_pk_mul_f32 v[230:231], v[52:53], v[52:53]
    v_pk_fma_f32 v[230:231], v[54:55], v[54:55], v[230:231]
    v_pk_add_f32 v[228:229], v[228:229], v[56:57]
    v_pk_fma_f32 v[230:231], v[56:57], v[56:57], v[230:231]
    v_pk_add_f32 v[228:229], v[228:229], v[58:59]
    buffer_store_dwordx4 v[212:215], v16, s[48:51], 0 offen offset:2048 nt
    v_pk_fma_f32 v[230:231], v[58:59], v[58:59], v[230:231]
    v_pk_add_f32 v[228:229], v[228:229], v[60:61]
    v_pk_fma_f32 v[230:231], v[60:61], v[60:61], v[230:231]
    v_pk_add_f32 v[228:229], v[228:229], v[62:63]
    v_pk_fma_f32 v[230:231], v[62:63], v[62:63], v[230:231]
    v_pk_add_f32 v[228:229], v[228:229], v[64:65]
    v_pk_fma_f32 v[230:231], v[64:65], v[64:65], v[230:231]
    v_pk_add_f32 v[228:229], v[228:229], v[66:67]
    v_pk_fma_f32 v[230:231], v[66:67], v[66:67], v[230:231]
    v_pk_add_f32 v[228:229], v[228:229], v[68:69]
    v_pk_fma_f32 v[230:231], v[68:69], v[68:69], v[230:231]
    v_pk_add_f32 v[228:229], v[228:229], v[70:71]
    v_pk_fma_f32 v[230:231], v[70:71], v[70:71], v[230:231]
    v_add_f32 v228, v228, v229
    v_add_f32 v230, v230, v231
    buffer_store_dwordx2 v[216:217], v17, s[48:51], 0 offen nt
    s_nop 0
    v_permlane32_swap_b32 v228, v230
    v_add_f32 v228, v228, v230
    v_mov_b32 v230, v228
    s_nop 1
    v_permlane16_swap_b32 v228, v230
    v_add_f32 v230, v228, v230
    buffer_store_dword v230, v18, s[48:51], 0 offen nt
    s_barrier
    ds_write_b128 v36, a[184:187] offset:20480
    ds_write_b128 v36, a[188:191] offset:24576
    ds_write_b128 v36, a[192:195] offset:28672
    ds_write_b128 v36, a[196:199] offset:32768
    s_waitcnt vmcnt(0)
    s_mov_b64 exec, 1
    buffer_store_dword v28, off, s[48:51], s84 offset:0
    s_mov_b64 exec, -1
    s_mov_b64 s[8:9], s[48:49]
    s_add_u32 s48, s48, s56
    s_addc_u32 s49, s49, 0
L_sec_82_e:
    ds_write_b128 v36, a[200:203] offset:36864
    ds_write_b128 v36, a[204:207] offset:40960
    ds_write_b128 v36, a[208:211] offset:45056
    ds_write_b128 v36, a[212:215] offset:49152
L_p31:
    s_lshr_b32 s95, s77, 3
    s_mul_i32 s26, s95, s47
    s_sub_u32 s27, s47, s26
    s_lshl_b32 s96, s95, 8
    v_add_u32 v132, s96, v20
    v_xor_b32 v133, 0x100, v132
    s_lshl2_add_u32 s96, s96, s65
    v_add_u32 v48, s96, v11
    v_xor_b32 v131, 0x400, v48
    s_mul_i32 s57, s65, -2
    s_lshl_b32 s96, s95, 5
    v_and_or_b32 v255, v27, 28, s96
    s_cmp_ge_u32 s79, 6
    s_cselect_b32 s95, 0x40000, 0
    v_add_u32 v128, s95, v2
    v_add_u32 v129, s95, v3
    v_add_u32 v130, s95, v4
    s_barrier
    ds_read_b128 v[136:139], v3 offset:40960
    ds_read_b128 v[140:143], v3 offset:41984
    ds_read_b128 v[144:147], v3 offset:43008
    ds_read_b128 v[148:151], v3 offset:44032
    ds_read_b128 v[152:155], v3 offset:45056
L_poll_85:
    buffer_load_dword v252, v27, s[8:11], s82 offen offset:0 sc1
    s_sub_u32 s80, s80, 1
    s_cbranch_scc1 L_end
    s_waitcnt vmcnt(0)
    v_cmp_ne_u32 vcc, s81, v252
    s_cbranch_vccnz L_poll_85
    s_nop 0
    buffer_load_dwordx4 a[0:3], v48, s[8:11], 0 offen offset:0 sc1
    buffer_load_dwordx4 a[4:7], v131, s[8:11], 0 offen offset:0 sc1
    buffer_load_dwordx4 a[8:11], v48, s[8:11], 0 offen offset:2048 sc1
    buffer_load_dwordx4 a[12:15], v131, s[8:11], 0 offen offset:2048 sc1
    buffer_load_dwordx4 a[16:19], v48, s[8:11], s32 offen offset:0 sc1
    buffer_load_dwordx4 a[20:23], v131, s[8:11], s32 offen offset:0 sc1
    buffer_load_dwordx4 a[24:27], v48, s[8:11], s32 offen offset:2048 sc1
    buffer_load_dwordx4 a[28:31], v131, s[8:11], s32 offen offset:2048 sc1
    s_add_u32 m0, s74, 90112
    s_waitcnt vmcnt(6) lgkmcnt(3)
    v_mfma_f32_16x16x32_bf16 v[72:75], v[136:139], a[0:3], 0
    ds_read_b128 v[156:159], v3 offset:46080
    v_mfma_f32_16x16x32_bf16 v[100:103], v[136:139], a[4:7], 0
    buffer_load_dwordx4 v32, s[4:7], m0 offen sc1 lds
    v_mfma_f32_16x16x32_bf16 v[76:79], v[140:143], a[0:3], 0
    ds_write_b128 v36, a[216:219] offset:53248
    v_mfma_f32_16x16x32_bf16 v[104:107], v[140:143], a[4:7], 0
    s_add_u32 m0, s74, 94208
    s_waitcnt lgkmcnt(3)
    v_mfma_f32_16x16x32_bf16 v[80:83], v[144:147], a[0:3], 0
    ds_read_b128 v[136:139], v129 offset:47104
    ds_read_b128 v[140:143], v3 offset:48128
    v_mfma_f32_16x16x32_bf16 v[108:111], v[144:147], a[4:7], 0
    buffer_load_dwordx4 v32, s[4:7], m0 offen sc1 lds
    v_mfma_f32_16x16x32_bf16 v[84:87], v[148:151], a[0:3], 0
    ds_read_b128 v[144:147], v3 offset:49152
    v_mfma_f32_16x16x32_bf16 v[112:115], v[148:151], a[4:7], 0
    s_waitcnt lgkmcnt(4)
    v_mfma_f32_16x16x32_bf16 v[88:91], v[152:155], a[0:3], 0
    ds_read_b128 v[148:151], v3 offset:50176
    v_mfma_f32_16x16x32_bf16 v[116:119], v[152:155], a[4:7], 0
    buffer_load_dwordx4 a[32:35], v48, s[8:11], s33 offen offset:0 sc1
    v_mfma_f32_16x16x32_bf16 v[92:95], v[156:159], a[0:3], 0
    ds_write_b128 v36, a[220:223] offset:57344
    v_mfma_f32_16x16x32_bf16 v[120:123], v[156:159], a[4:7], 0
    s_add_u32 m0, s74, 98304
    s_waitcnt vmcnt(7) lgkmcnt(3)
    v_mfma_f32_16x16x32_bf16 v[96:99], v[136:139], a[0:3], 0
    ds_read_b128 v[152:155], v3 offset:51200
    ds_read_b128 v[156:159], v3 offset:52224
    v_mfma_f32_16x16x32_bf16 v[124:127], v[136:139], a[4:7], 0
    buffer_load_dwordx4 v32, s[4:7], m0 offen sc1 lds
    v_mfma_f32_16x16x32_bf16 v[72:75], v[140:143], a[8:11], v[72:75]
    ds_read_b128 v[136:139], v3 offset:53248
    ds_read_b128 v[160:163], v46 offset:512
    v_mfma_f32_16x16x32_bf16 v[100:103], v[140:143], a[12:15], v[100:103]
    ds_read_b128 v[188:191], v46 offset:1024
    s_waitcnt lgkmcnt(6)
    v_mfma_f32_16x16x32_bf16 v[76:79], v[144:147], a[8:11], v[76:79]
    ds_read_b128 v[140:143], v129 offset:54272
    ds_read_b128 v[164:167], v46 offset:576
    v_mfma_f32_16x16x32_bf16 v[104:107], v[144:147], a[12:15], v[104:107]
    buffer_load_dwordx4 a[36:39], v131, s[8:11], s33 offen offset:0 sc1
    v_mfma_f32_16x16x32_bf16 v[80:83], v[148:151], a[8:11], v[80:83]
    ds_write_b128 v36, a[224:227] offset:61440
    v_mfma_f32_16x16x32_bf16 v[108:111], v[148:151], a[12:15], v[108:111]
    s_waitcnt lgkmcnt(6)
    v_mfma_f32_16x16x32_bf16 v[84:87], v[152:155], a[8:11], v[84:87]
    ds_read_b128 v[144:147], v3 offset:55296
    ds_read_b128 v[148:151], v3 offset:56320
    v_mfma_f32_16x16x32_bf16 v[112:115], v[152:155], a[12:15], v[112:115]
    buffer_load_dwordx4 v[244:247], v132, s[8:11], 0 offen offset:0 sc1
    v_mfma_f32_16x16x32_bf16 v[88:91], v[156:159], a[8:11], v[88:91]
    ds_read_b128 v[152:155], v3 offset:57344
    ds_read_b128 v[192:195], v46 offset:1088
    v_mfma_f32_16x16x32_bf16 v[116:119], v[156:159], a[12:15], v[116:119]
    ds_read_b128 v[168:171], v46 offset:640
    s_waitcnt lgkmcnt(7)
    v_mfma_f32_16x16x32_bf16 v[92:95], v[136:139], a[8:11], v[92:95]
    ds_read_b128 v[156:159], v3 offset:58368
    ds_read_b128 v[196:199], v46 offset:1152
    v_mfma_f32_16x16x32_bf16 v[120:123], v[136:139], a[12:15], v[120:123]
    buffer_load_dwordx4 a[40:43], v48, s[8:11], s33 offen offset:2048 sc1
    v_mfma_f32_16x16x32_bf16 v[96:99], v[140:143], a[8:11], v[96:99]
    ds_write_b128 v37, a[228:231] offset:0
    v_mfma_f32_16x16x32_bf16 v[124:127], v[140:143], a[12:15], v[124:127]
    s_waitcnt vmcnt(9) lgkmcnt(6)
    v_mfma_f32_16x16x32_bf16 v[72:75], v[144:147], a[16:19], v[72:75]
    ds_read_b128 v[136:139], v3 offset:59392
    ds_read_b128 v[140:143], v3 offset:60416
    v_mfma_f32_16x16x32_bf16 v[100:103], v[144:147], a[20:23], v[100:103]
    buffer_load_dwordx4 v[248:251], v133, s[8:11], 0 offen offset:0 sc1
    v_mfma_f32_16x16x32_bf16 v[76:79], v[148:151], a[16:19], v[76:79]
    ds_read_b128 v[144:147], v129 offset:61440
    ds_read_b128 v[172:175], v46 offset:704
    v_mfma_f32_16x16x32_bf16 v[104:107], v[148:151], a[20:23], v[104:107]
    ds_read_b128 v[200:203], v46 offset:1216
    s_waitcnt lgkmcnt(7)
    v_mfma_f32_16x16x32_bf16 v[80:83], v[152:155], a[16:19], v[80:83]
    ds_read_b128 v[148:151], v3 offset:62464
    ds_read_b128 v[176:179], v46 offset:768
    v_mfma_f32_16x16x32_bf16 v[108:111], v[152:155], a[20:23], v[108:111]
    buffer_load_dwordx4 a[44:47], v131, s[8:11], s33 offen offset:2048 sc1
    v_mfma_f32_16x16x32_bf16 v[84:87], v[156:159], a[16:19], v[84:87]
    ds_write_b128 v37, a[232:235] offset:4096
    v_mfma_f32_16x16x32_bf16 v[112:115], v[156:159], a[20:23], v[112:115]
    s_waitcnt lgkmcnt(6)
    v_mfma_f32_16x16x32_bf16 v[88:91], v[136:139], a[16:19], v[88:91]
    ds_read_b128 v[152:155], v3 offset:63488
    ds_read_b128 v[156:159], v3 offset:64512
    v_mfma_f32_16x16x32_bf16 v[116:119], v[136:139], a[20:23], v[116:119]
    buffer_load_dwordx4 a[48:51], v48, s[8:11], s34 offen offset:0 sc1
    v_mfma_f32_16x16x32_bf16 v[92:95], v[140:143], a[16:19], v[92:95]
    ds_read_b128 v[136:139], v4 offset:0
    ds_read_b128 v[204:207], v46 offset:1280
    v_mfma_f32_16x16x32_bf16 v[120:123], v[140:143], a[20:23], v[120:123]
    s_cmp_ge_u32 s73, 3
    s_cselect_b32 s3, s61, 0
    v_add_u32 v32, s3, v32
    s_add_u32 m0, s74, 102400
    s_waitcnt vmcnt(10) lgkmcnt(6)
    v_mfma_f32_16x16x32_bf16 v[96:99], v[144:147], a[16:19], v[96:99]
    ds_read_b128 v[140:143], v4 offset:1024
    ds_read_b128 v[180:183], v46 offset:832
    v_mfma_f32_16x16x32_bf16 v[124:127], v[144:147], a[20:23], v[124:127]
    buffer_load_dwordx4 v32, s[4:7], m0 offen sc1 lds
    s_mul_i32 s95, s77, 4352
    s_add_u32 s95, s95, s82
    s_add_u32 s95, s95, 43008
    v_min_u32 v254, 128, v2
    v_lshl_add_u32 v254, v254, 3, s95
    v_mfma_f32_16x16x32_bf16 v[72:75], v[148:151], a[24:27], v[72:75]
    ds_write_b128 v37, a[236:239] offset:8192
    v_mfma_f32_16x16x32_bf16 v[100:103], v[148:151], a[28:31], v[100:103]
    s_waitcnt lgkmcnt(5)
    v_mfma_f32_16x16x32_bf16 v[76:79], v[152:155], a[24:27], v[76:79]
    ds_read_b128 v[144:147], v4 offset:2048
    ds_read_b128 v[148:151], v130 offset:3072
    v_mfma_f32_16x16x32_bf16 v[104:107], v[152:155], a[28:31], v[104:107]
    buffer_load_dwordx4 a[52:55], v131, s[8:11], s34 offen offset:0 sc1
    v_mfma_f32_16x16x32_bf16 v[80:83], v[156:159], a[24:27], v[80:83]
    ds_read_b128 v[152:155], v4 offset:4096
    ds_read_b128 v[208:211], v46 offset:1344
    v_mfma_f32_16x16x32_bf16 v[108:111], v[156:159], a[28:31], v[108:111]
    ds_read_b128 v[184:187], v46 offset:896
    s_waitcnt lgkmcnt(7)
    v_mfma_f32_16x16x32_bf16 v[84:87], v[136:139], a[24:27], v[84:87]
    ds_read_b128 v[156:159], v4 offset:5120
    ds_read_b128 v[212:215], v46 offset:1408
    v_mfma_f32_16x16x32_bf16 v[112:115], v[136:139], a[28:31], v[112:115]
    buffer_load_dword a255, v254, s[52:55], 0 offen offset:0 sc1
    v_mfma_f32_16x16x32_bf16 v[88:91], v[140:143], a[24:27], v[88:91]
    ds_write_b128 v37, a[240:243] offset:12288
    v_mfma_f32_16x16x32_bf16 v[116:119], v[140:143], a[28:31], v[116:119]
    s_waitcnt lgkmcnt(6)
    v_mfma_f32_16x16x32_bf16 v[92:95], v[144:147], a[24:27], v[92:95]
    ds_read_b128 v[136:139], v4 offset:6144
    ds_read_b128 v[140:143], v4 offset:7168
    v_mfma_f32_16x16x32_bf16 v[120:123], v[144:147], a[28:31], v[120:123]
    buffer_load_dwordx4 a[56:59], v48, s[8:11], s34 offen offset:2048 sc1
    v_mfma_f32_16x16x32_bf16 v[96:99], v[148:151], a[24:27], v[96:99]
    ds_read_b128 v[144:147], v4 offset:8192
    v_mfma_f32_16x16x32_bf16 v[124:127], v[148:151], a[28:31], v[124:127]
    s_waitcnt vmcnt(9) lgkmcnt(5)
    v_mfma_f32_16x16x32_bf16 v[72:75], v[152:155], a[32:35], v[72:75]
    ds_read_b128 v[148:151], v4 offset:9216
    v_mfma_f32_16x16x32_bf16 v[100:103], v[152:155], a[36:39], v[100:103]
    buffer_load_dword a255, v254, s[52:55], 0 offen offset:1152 sc1
    v_mfma_f32_16x16x32_bf16 v[76:79], v[156:159], a[32:35], v[76:79]
    ds_write_b128 v37, a[244:247] offset:16384
    v_mfma_f32_16x16x32_bf16 v[104:107], v[156:159], a[36:39], v[104:107]
    s_waitcnt lgkmcnt(3)
    v_mfma_f32_16x16x32_bf16 v[80:83], v[136:139], a[32:35], v[80:83]
    ds_read_b128 v[152:155], v130 offset:10240
    s_barrier
    ds_read_b128 v[156:159], v4 offset:11264
    v_mfma_f32_16x16x32_bf16 v[108:111], v[136:139], a[36:39], v[108:111]
    buffer_load_dwordx4 a[60:63], v131, s[8:11], s34 offen offset:2048 sc1
    v_mfma_f32_16x16x32_bf16 v[84:87], v[140:143], a[32:35], v[84:87]
    ds_read_b128 v[136:139], v4 offset:12288
    v_mfma_f32_16x16x32_bf16 v[112:115], v[140:143], a[36:39], v[112:115]
    s_waitcnt lgkmcnt(4)
    v_mfma_f32_16x16x32_bf16 v[88:91], v[144:147], a[32:35], v[88:91]
    ds_read_b128 v[140:143], v4 offset:13312
    v_mfma_f32_16x16x32_bf16 v[116:119], v[144:147], a[36:39], v[116:119]
    buffer_load_dwordx4 a[0:3], v48, s[8:11], s35 offen offset:0 sc1
    v_mfma_f32_16x16x32_bf16 v[92:95], v[148:151], a[32:35], v[92:95]
    ds_write_b128 v37, a[248:251] offset:20480
    v_mfma_f32_16x16x32_bf16 v[120:123], v[148:151], a[36:39], v[120:123]
    s_waitcnt vmcnt(8) lgkmcnt(3)
    v_mfma_f32_16x16x32_bf16 v[96:99], v[152:155], a[32:35], v[96:99]
    ds_read_b128 v[144:147], v4 offset:14336
    ds_read_b128 v[148:151], v4 offset:15360
    v_mfma_f32_16x16x32_bf16 v[124:127], v[152:155], a[36:39], v[124:127]
    buffer_load_dword a255, v254, s[52:55], 0 offen offset:2304 sc1
    v_mfma_f32_16x16x32_bf16 v[72:75], v[156:159], a[40:43], v[72:75]
    ds_read_b128 v[152:155], v4 offset:16384
    v_mfma_f32_16x16x32_bf16 v[100:103], v[156:159], a[44:47], v[100:103]
    s_waitcnt lgkmcnt(4)
    v_mfma_f32_16x16x32_bf16 v[76:79], v[136:139], a[40:43], v[76:79]
    ds_read_b128 v[156:159], v130 offset:17408
    v_mfma_f32_16x16x32_bf16 v[104:107], v[136:139], a[44:47], v[104:107]
    buffer_load_dwordx4 a[4:7], v131, s[8:11], s35 offen offset:0 sc1
    v_mfma_f32_16x16x32_bf16 v[80:83], v[140:143], a[40:43], v[80:83]
    ds_read_b128 v[136:139], v4 offset:18432
    v_mfma_f32_16x16x32_bf16 v[108:111], v[140:143], a[44:47], v[108:111]
    s_waitcnt lgkmcnt(3)
    v_mfma_f32_16x16x32_bf16 v[84:87], v[144:147], a[40:43], v[84:87]
    ds_read_b128 v[140:143], v4 offset:19456
    v_mfma_f32_16x16x32_bf16 v[112:115], v[144:147], a[44:47], v[112:115]
    buffer_load_dword a255, v254, s[52:55], 0 offen offset:3200 sc1
    v_mfma_f32_16x16x32_bf16 v[88:91], v[148:151], a[40:43], v[88:91]
    ds_read_b128 v[144:147], v4 offset:20480
    v_mfma_f32_16x16x32_bf16 v[116:119], v[148:151], a[44:47], v[116:119]
    s_waitcnt lgkmcnt(3)
    v_mfma_f32_16x16x32_bf16 v[92:95], v[152:155], a[40:43], v[92:95]
    ds_read_b128 v[148:151], v4 offset:21504
    v_mfma_f32_16x16x32_bf16 v[120:123], v[152:155], a[44:47], v[120:123]
    buffer_load_dwordx4 a[8:11], v48, s[8:11], s35 offen offset:2048 sc1
    v_mfma_f32_16x16x32_bf16 v[96:99], v[156:159], a[40:43], v[96:99]
    ds_read_b128 v[152:155], v4 offset:22528
    v_mfma_f32_16x16x32_bf16 v[124:127], v[156:159], a[44:47], v[124:127]
    s_cmp_le_u32 s73, 2
    s_cselect_b32 s3, s61, 0
    v_add_u32 v32, s3, v32
    s_add_u32 m0, s74, 106496
    s_waitcnt vmcnt(9) lgkmcnt(3)
    v_mfma_f32_16x16x32_bf16 v[72:75], v[136:139], a[48:51], v[72:75]
    ds_read_b128 v[156:159], v4 offset:23552
    v_add_f32 v248, v248, v250
    v_mfma_f32_16x16x32_bf16 v[100:103], v[136:139], a[52:55], v[100:103]
    buffer_load_dwordx4 v32, s[4:7], m0 offen sc1 lds
    v_mfma_f32_16x16x32_bf16 v[76:79], v[140:143], a[48:51], v[76:79]
    ds_read_b128 v[136:139], v130 offset:24576
    v_add_f32 v249, v249, v251
    v_mfma_f32_16x16x32_bf16 v[104:107], v[140:143], a[52:55], v[104:107]
    v_mov_b32 v250, v248
    s_waitcnt lgkmcnt(3)
    v_mfma_f32_16x16x32_bf16 v[80:83], v[144:147], a[48:51], v[80:83]
    ds_read_b128 v[140:143], v4 offset:25600
    v_mov_b32 v251, v249
    v_mfma_f32_16x16x32_bf16 v[108:111], v[144:147], a[52:55], v[108:111]
    buffer_load_dwordx4 a[12:15], v131, s[8:11], s35 offen offset:2048 sc1
    v_mfma_f32_16x16x32_bf16 v[84:87], v[148:151], a[48:51], v[84:87]
    ds_read_b128 v[144:147], v4 offset:26624
    v_permlane32_swap_b32 v248, v250
    v_mfma_f32_16x16x32_bf16 v[112:115], v[148:151], a[52:55], v[112:115]
    v_add_u32 v48, s57, v48
    s_waitcnt lgkmcnt(3)
    v_mfma_f32_16x16x32_bf16 v[88:91], v[152:155], a[48:51], v[88:91]
    ds_read_b128 v[148:151], v4 offset:27648
    v_permlane32_swap_b32 v249, v251
    v_mfma_f32_16x16x32_bf16 v[116:119], v[152:155], a[52:55], v[116:119]
    buffer_load_dwordx4 a[16:19], v48, s[8:11], s36 offen offset:0 sc1
    v_mfma_f32_16x16x32_bf16 v[92:95], v[156:159], a[48:51], v[92:95]
    ds_read_b128 v[152:155], v2 offset:0
    v_add_f32 v248, v248, v250
    v_mfma_f32_16x16x32_bf16 v[120:123], v[156:159], a[52:55], v[120:123]
    s_add_u32 m0, s74, 110592
    s_waitcnt vmcnt(8) lgkmcnt(3)
    v_mfma_f32_16x16x32_bf16 v[96:99], v[136:139], a[48:51], v[96:99]
    ds_read_b128 v[156:159], v2 offset:1024
    v_add_f32 v249, v249, v251
    v_mfma_f32_16x16x32_bf16 v[124:127], v[136:139], a[52:55], v[124:127]
    buffer_load_dwordx4 v32, s[4:7], m0 offen sc1 lds
    v_mfma_f32_16x16x32_bf16 v[72:75], v[140:143], a[56:59], v[72:75]
    ds_read_b128 v[136:139], v2 offset:2048
    v_mov_b32 v250, v248
    v_mfma_f32_16x16x32_bf16 v[100:103], v[140:143], a[60:63], v[100:103]
    v_add_u32 v131, s57, v131
    s_waitcnt lgkmcnt(3)
    v_mfma_f32_16x16x32_bf16 v[76:79], v[144:147], a[56:59], v[76:79]
    ds_read_b128 v[140:143], v128 offset:3072
    v_mov_b32 v251, v249
    v_mfma_f32_16x16x32_bf16 v[104:107], v[144:147], a[60:63], v[104:107]
    buffer_load_dwordx4 a[20:23], v131, s[8:11], s36 offen offset:0 sc1
    v_mfma_f32_16x16x32_bf16 v[80:83], v[148:151], a[56:59], v[80:83]
    ds_read_b128 v[144:147], v2 offset:4096
    v_permlane16_swap_b32 v248, v250
    v_mfma_f32_16x16x32_bf16 v[108:111], v[148:151], a[60:63], v[108:111]
    s_add_u32 m0, s74, 114688
    s_waitcnt lgkmcnt(3)
    v_mfma_f32_16x16x32_bf16 v[84:87], v[152:155], a[56:59], v[84:87]
    ds_read_b128 v[148:151], v2 offset:5120
    v_permlane16_swap_b32 v249, v251
    v_mfma_f32_16x16x32_bf16 v[112:115], v[152:155], a[60:63], v[112:115]
    buffer_load_dwordx4 v32, s[4:7], m0 offen sc1 lds
    v_mfma_f32_16x16x32_bf16 v[88:91], v[156:159], a[56:59], v[88:91]
    ds_read_b128 v[152:155], v2 offset:6144
    v_add_f32 v248, v248, v250
    v_mfma_f32_16x16x32_bf16 v[116:119], v[156:159], a[60:63], v[116:119]
    v_add_f32 v249, v249, v251
    s_waitcnt lgkmcnt(3)
    v_mfma_f32_16x16x32_bf16 v[92:95], v[136:139], a[56:59], v[92:95]
    ds_read_b128 v[156:159], v2 offset:7168
    v_mul_f32 v248, 0xbacccccd, v248
    v_mfma_f32_16x16x32_bf16 v[120:123], v[136:139], a[60:63], v[120:123]
    buffer_load_dwordx4 a[24:27], v48, s[8:11], s36 offen offset:2048 sc1
    v_mfma_f32_16x16x32_bf16 v[96:99], v[140:143], a[56:59], v[96:99]
    ds_read_b128 v[136:139], v2 offset:8192
    v_mul_f32 v250, v248, v248
    v_mfma_f32_16x16x32_bf16 v[124:127], v[140:143], a[60:63], v[124:127]
    v_mul_f32 v249, 0x3acccccd, v249
    s_waitcnt vmcnt(9) lgkmcnt(3)
    v_mfma_f32_16x16x32_bf16 v[72:75], v[144:147], a[0:3], v[72:75]
    ds_read_b128 v[140:143], v2 offset:9216
    v_sub_f32 v250, v249, v250
    v_mfma_f32_16x16x32_bf16 v[100:103], v[144:147], a[4:7], v[100:103]
    buffer_load_dwordx4 a[28:31], v131, s[8:11], s36 offen offset:2048 sc1
    v_mfma_f32_16x16x32_bf16 v[76:79], v[148:151], a[0:3], v[76:79]
    ds_read_b128 v[144:147], v128 offset:10240
    v_max_f32 v250, 0, v250
    v_mfma_f32_16x16x32_bf16 v[104:107], v[148:151], a[4:7], v[104:107]
    s_add_u32 m0, s74, 118784
    s_waitcnt lgkmcnt(3)
    v_mfma_f32_16x16x32_bf16 v[80:83], v[152:155], a[0:3], v[80:83]
    ds_read_b128 v[148:151], v2 offset:11264
    v_add_f32 v250, 0x3727c5ac, v250
    v_mfma_f32_16x16x32_bf16 v[108:111], v[152:155], a[4:7], v[108:111]
    buffer_load_dwordx4 v32, s[4:7], m0 offen sc1 lds
    v_mfma_f32_16x16x32_bf16 v[84:87], v[156:159], a[0:3], v[84:87]
    ds_read_b128 v[152:155], v2 offset:12288
    v_rsq_f32 v250, v250
    v_mfma_f32_16x16x32_bf16 v[112:115], v[156:159], a[4:7], v[112:115]
    v_mul_f32 v249, v250, v248
    s_waitcnt lgkmcnt(3)
    v_mfma_f32_16x16x32_bf16 v[88:91], v[136:139], a[0:3], v[88:91]
    ds_read_b128 v[156:159], v2 offset:13312
    v_mov_b32 v248, v250
    v_mfma_f32_16x16x32_bf16 v[116:119], v[136:139], a[4:7], v[116:119]
    buffer_load_dwordx4 a[32:35], v131, s[8:11], s37 offen offset:0 sc1
    v_mfma_f32_16x16x32_bf16 v[92:95], v[140:143], a[0:3], v[92:95]
    ds_read_b128 v[136:139], v2 offset:14336
    v_fma_f32 v216, v160, v249, v188
    v_mfma_f32_16x16x32_bf16 v[120:123], v[140:143], a[4:7], v[120:123]
    v_fma_f32 v217, v161, v249, v189
    s_waitcnt vmcnt(8) lgkmcnt(3)
    v_mfma_f32_16x16x32_bf16 v[96:99], v[144:147], a[0:3], v[96:99]
    ds_read_b128 v[140:143], v2 offset:15360
    v_fma_f32 v218, v162, v249, v190
    v_mfma_f32_16x16x32_bf16 v[124:127], v[144:147], a[4:7], v[124:127]
    buffer_load_dwordx4 a[36:39], v131, s[8:11], s37 offen offset:2048 sc1
    v_mfma_f32_16x16x32_bf16 v[72:75], v[148:151], a[8:11], v[72:75]
    ds_read_b128 v[144:147], v2 offset:16384
    v_fma_f32 v219, v163, v249, v191
    v_mfma_f32_16x16x32_bf16 v[100:103], v[148:151], a[12:15], v[100:103]
    v_fma_f32 v220, v164, v249, v192
    s_waitcnt lgkmcnt(3)
    v_mfma_f32_16x16x32_bf16 v[76:79], v[152:155], a[8:11], v[76:79]
    ds_read_b128 v[148:151], v128 offset:17408
    v_fma_f32 v221, v165, v249, v193
    v_mfma_f32_16x16x32_bf16 v[104:107], v[152:155], a[12:15], v[104:107]
    buffer_load_dwordx4 a[40:43], v131, s[8:11], s38 offen offset:0 sc1
    v_mfma_f32_16x16x32_bf16 v[80:83], v[156:159], a[8:11], v[80:83]
    s_barrier
    ds_read_b128 v[152:155], v2 offset:18432
    v_mfma_f32_16x16x32_bf16 v[108:111], v[156:159], a[12:15], v[108:111]
    s_add_u32 m0, s74, 122880
    s_waitcnt lgkmcnt(3)
    v_mfma_f32_16x16x32_bf16 v[84:87], v[136:139], a[8:11], v[84:87]
    ds_read_b128 v[156:159], v2 offset:19456
    v_fma_f32 v222, v166, v249, v194
    v_mfma_f32_16x16x32_bf16 v[112:115], v[136:139], a[12:15], v[112:115]
    buffer_load_dwordx4 v32, s[4:7], m0 offen sc1 lds
    v_mfma_f32_16x16x32_bf16 v[88:91], v[140:143], a[8:11], v[88:91]
    ds_read_b128 v[136:139], v2 offset:20480
    v_fma_f32 v223, v167, v249, v195
    v_mfma_f32_16x16x32_bf16 v[116:119], v[140:143], a[12:15], v[116:119]
    v_fma_f32 v224, v168, v249, v196
    s_waitcnt lgkmcnt(3)
    v_mfma_f32_16x16x32_bf16 v[92:95], v[144:147], a[8:11], v[92:95]
    ds_read_b128 v[140:143], v2 offset:21504
    v_fma_f32 v225, v169, v249, v197
    v_mfma_f32_16x16x32_bf16 v[120:123], v[144:147], a[12:15], v[120:123]
    buffer_load_dwordx4 a[44:47], v131, s[8:11], s38 offen offset:2048 sc1
    v_mfma_f32_16x16x32_bf16 v[96:99], v[148:151], a[8:11], v[96:99]
    ds_read_b128 v[144:147], v2 offset:22528
    v_fma_f32 v226, v170, v249, v198
    v_mfma_f32_16x16x32_bf16 v[124:127], v[148:151], a[12:15], v[124:127]
    v_fma_f32 v227, v171, v249, v199
    s_waitcnt vmcnt(9) lgkmcnt(3)
    v_mfma_f32_16x16x32_bf16 v[72:75], v[152:155], a[16:19], v[72:75]
    ds_read_b128 v[148:151], v2 offset:23552
    v_fma_f32 v228, v172, v249, v200
    v_mfma_f32_16x16x32_bf16 v[100:103], v[152:155], a[20:23], v[100:103]
    buffer_load_dwordx4 a[48:51], v131, s[8:11], s39 offen offset:0 sc1
    v_mfma_f32_16x16x32_bf16 v[76:79], v[156:159], a[16:19], v[76:79]
    ds_read_b128 v[152:155], v128 offset:24576
    v_fma_f32 v229, v173, v249, v201
    v_mfma_f32_16x16x32_bf16 v[104:107], v[156:159], a[20:23], v[104:107]
    s_add_u32 m0, s74, 126976
    s_waitcnt lgkmcnt(3)
    v_mfma_f32_16x16x32_bf16 v[80:83], v[136:139], a[16:19], v[80:83]
    ds_read_b128 v[156:159], v2 offset:25600
L_pad12:
    s_cbranch_execz L_pad16
    v_fma_f32 v230, v174, v249, v202
    v_mfma_f32_16x16x32_bf16 v[108:111], v[136:139], a[20:23], v[108:111]
    buffer_load_dwordx4 v32, s[4:7], m0 offen sc1 lds
    v_mfma_f32_16x16x32_bf16 v[84:87], v[140:143], a[16:19], v[84:87]
    ds_read_b128 v[136:139], v2 offset:26624
    v_fma_f32 v231, v175, v249, v203
    v_mfma_f32_16x16x32_bf16 v[112:115], v[140:143], a[20:23], v[112:115]
    v_fma_f32 v232, v176, v249, v204
    s_waitcnt lgkmcnt(3)
    v_mfma_f32_16x16x32_bf16 v[88:91], v[144:147], a[16:19], v[88:91]
    ds_read_b128 v[140:143], v2 offset:27648
    v_fma_f32 v233, v177, v249, v205
    v_mfma_f32_16x16x32_bf16 v[116:119], v[144:147], a[20:23], v[116:119]
    buffer_load_dwordx4 a[52:55], v131, s[8:11], s39 offen offset:2048 sc1
    v_mfma_f32_16x16x32_bf16 v[92:95], v[148:151], a[16:19], v[92:95]
    ds_read_b128 v[144:147], v2 offset:28672
    v_fma_f32 v234, v178, v249, v206
    v_mfma_f32_16x16x32_bf16 v[120:123], v[148:151], a[20:23], v[120:123]
    v_fma_f32 v235, v179, v249, v207
    s_waitcnt vmcnt(9) lgkmcnt(3)
    v_mfma_f32_16x16x32_bf16 v[96:99], v[152:155], a[16:19], v[96:99]
    ds_read_b128 v[148:151], v2 offset:29696
    v_fma_f32 v236, v180, v249, v208
    v_mfma_f32_16x16x32_bf16 v[124:127], v[152:155], a[20:23], v[124:127]
    buffer_load_dwordx4 a[56:59], v131, s[8:11], s40 offen offset:0 sc1
    v_mfma_f32_16x16x32_bf16 v[72:75], v[156:159], a[24:27], v[72:75]
    ds_read_b128 v[152:155], v2 offset:30720
    v_fma_f32 v237, v181, v249, v209
    v_mfma_f32_16x16x32_bf16 v[100:103], v[156:159], a[28:31], v[100:103]
    s_add_u32 m0, s74, 131072
    s_waitcnt lgkmcnt(3)
    v_mfma_f32_16x16x32_bf16 v[76:79], v[136:139], a[24:27], v[76:79]
    ds_read_b128 v[156:159], v128 offset:31744
    v_fma_f32 v238, v182, v249, v210
    v_mfma_f32_16x16x32_bf16 v[104:107], v[136:139], a[28:31], v[104:107]
    buffer_load_dwordx4 v32, s[4:7], m0 offen sc1 lds
    v_mfma_f32_16x16x32_bf16 v[80:83], v[140:143], a[24:27], v[80:83]
    ds_read_b128 a[64:67], v2 offset:32768
    ds_read_b128 a[68:71], v2 offset:33792
    v_mfma_f32_16x16x32_bf16 v[108:111], v[140:143], a[28:31], v[108:111]
    v_fma_f32 v239, v183, v249, v211
    s_waitcnt lgkmcnt(4)
    v_mfma_f32_16x16x32_bf16 v[84:87], v[144:147], a[24:27], v[84:87]
    ds_read_b128 a[72:75], v2 offset:34816
    ds_read_b128 a[76:79], v2 offset:35840
    v_mfma_f32_16x16x32_bf16 v[112:115], v[144:147], a[28:31], v[112:115]
    buffer_load_dwordx4 a[60:63], v131, s[8:11], s40 offen offset:2048 sc1
    v_mfma_f32_16x16x32_bf16 v[88:91], v[148:151], a[24:27], v[88:91]
    ds_read_b128 a[80:83], v2 offset:36864
    ds_read_b128 v[136:139], v2 offset:37888
    v_mfma_f32_16x16x32_bf16 v[116:119], v[148:151], a[28:31], v[116:119]
    v_fma_f32 v240, v184, v249, v212
    s_waitcnt lgkmcnt(6)
    v_mfma_f32_16x16x32_bf16 v[92:95], v[152:155], a[24:27], v[92:95]
    ds_read_b128 v[140:143], v128 offset:38912
    ds_read_b128 v[144:147], v2 offset:39936
    v_mfma_f32_16x16x32_bf16 v[120:123], v[152:155], a[28:31], v[120:123]
    buffer_load_dwordx4 a[0:3], v48, s[8:11], s37 offen offset:0 sc1
    v_mfma_f32_16x16x32_bf16 v[96:99], v[156:159], a[24:27], v[96:99]
    ds_read_b128 v[148:151], v2 offset:40960
    ds_read_b128 v[152:155], v2 offset:41984
    v_mfma_f32_16x16x32_bf16 v[124:127], v[156:159], a[28:31], v[124:127]
    s_add_u32 m0, s74, 135168
    s_waitcnt vmcnt(11) lgkmcnt(5)
    v_mfma_f32_16x16x32_bf16 v[100:103], a[64:67], a[32:35], v[100:103]
    ds_read_b128 v[156:159], v2 offset:43008
    buffer_load_dwordx4 v32, s[4:7], m0 offen sc1 lds
    v_mfma_f32_16x16x32_bf16 v[104:107], a[68:71], a[32:35], v[104:107]
    ds_read_b128 a[64:67], v2 offset:44032
    v_fma_f32 v241, v185, v249, v213
    v_mfma_f32_16x16x32_bf16 v[108:111], a[72:75], a[32:35], v[108:111]
    ds_read_b128 a[68:71], v2 offset:45056
    v_fma_f32 v242, v186, v249, v214
    v_mfma_f32_16x16x32_bf16 v[112:115], a[76:79], a[32:35], v[112:115]
    ds_read_b128 a[72:75], v128 offset:46080
    v_fma_f32 v243, v187, v249, v215
    v_mfma_f32_16x16x32_bf16 v[116:119], a[80:83], a[32:35], v[116:119]
    ds_read_b128 a[76:79], v2 offset:47104
    s_waitcnt vmcnt(11) lgkmcnt(5)
    v_mfma_f32_16x16x32_bf16 v[120:123], v[136:139], a[32:35], v[120:123]
    ds_read_b128 a[80:83], v2 offset:48128
    buffer_load_dwordx4 a[4:7], v48, s[8:11], s37 offen offset:2048 sc1
    v_mfma_f32_16x16x32_bf16 v[124:127], v[140:143], a[32:35], v[124:127]
    ds_read_b128 v[136:139], v2 offset:49152
    v_add_f32 v244, v244, v246
    v_mfma_f32_16x16x32_bf16 v[100:103], v[144:147], a[36:39], v[100:103]
    ds_read_b128 v[140:143], v2 offset:50176
    v_add_f32 v245, v245, v247
    v_mfma_f32_16x16x32_bf16 v[104:107], v[148:151], a[36:39], v[104:107]
    ds_read_b128 v[144:147], v2 offset:51200
    buffer_load_dwordx4 a[8:11], v48, s[8:11], s38 offen offset:0 sc1
    v_mfma_f32_16x16x32_bf16 v[108:111], v[152:155], a[36:39], v[108:111]
    ds_read_b128 v[148:151], v2 offset:52224
    s_waitcnt vmcnt(12) lgkmcnt(5)
    v_mfma_f32_16x16x32_bf16 v[112:115], v[156:159], a[36:39], v[112:115]
    ds_read_b128 v[152:155], v128 offset:53248
    v_mov_b32 v246, v244
    v_mfma_f32_16x16x32_bf16 v[116:119], a[64:67], a[36:39], v[116:119]
    s_barrier
    ds_read_b128 v[156:159], v2 offset:54272
    v_mfma_f32_16x16x32_bf16 v[120:123], a[68:71], a[36:39], v[120:123]
    ds_read_b128 a[64:67], v2 offset:55296
    buffer_load_dwordx4 a[12:15], v48, s[8:11], s38 offen offset:2048 sc1
    v_mfma_f32_16x16x32_bf16 v[124:127], a[72:75], a[36:39], v[124:127]
    ds_read_b128 a[68:71], v2 offset:56320
    v_mov_b32 v247, v245
    v_mfma_f32_16x16x32_bf16 v[100:103], a[76:79], a[40:43], v[100:103]
    ds_read_b128 a[72:75], v2 offset:57344
    s_waitcnt lgkmcnt(5)
    v_mfma_f32_16x16x32_bf16 v[104:107], a[80:83], a[40:43], v[104:107]
    ds_read_b128 a[76:79], v2 offset:58368
    s_add_u32 m0, s74, 139264
    v_mfma_f32_16x16x32_bf16 v[108:111], v[136:139], a[40:43], v[108:111]
    ds_read_b128 a[80:83], v2 offset:59392
    buffer_load_dwordx4 v32, s[4:7], m0 offen sc1 lds
    v_mfma_f32_16x16x32_bf16 v[112:115], v[140:143], a[40:43], v[112:115]
    ds_read_b128 v[136:139], v128 offset:60416
    v_permlane32_swap_b32 v244, v246
    v_mfma_f32_16x16x32_bf16 v[116:119], v[144:147], a[40:43], v[116:119]
    ds_read_b128 v[140:143], v2 offset:61440
    v_permlane32_swap_b32 v245, v247
    v_mfma_f32_16x16x32_bf16 v[120:123], v[148:151], a[40:43], v[120:123]
    ds_read_b128 v[144:147], v2 offset:62464
    s_waitcnt vmcnt(12) lgkmcnt(5)
    v_mfma_f32_16x16x32_bf16 v[124:127], v[152:155], a[40:43], v[124:127]
    ds_read_b128 v[148:151], v2 offset:63488
    buffer_load_dwordx4 a[16:19], v48, s[8:11], s39 offen offset:0 sc1
    v_mfma_f32_16x16x32_bf16 v[100:103], v[156:159], a[44:47], v[100:103]
    ds_read_b128 v[152:155], v2 offset:64512
    v_add_f32 v244, v244, v246
    v_mfma_f32_16x16x32_bf16 v[104:107], a[64:67], a[44:47], v[104:107]
    ds_read_b128 v[156:159], v3 offset:0
    v_add_f32 v245, v245, v247
    v_mfma_f32_16x16x32_bf16 v[108:111], a[68:71], a[44:47], v[108:111]
    ds_read_b128 a[64:67], v3 offset:1024
    v_mov_b32 v246, v244
    v_mfma_f32_16x16x32_bf16 v[112:115], a[72:75], a[44:47], v[112:115]
    ds_read_b128 a[68:71], v129 offset:2048
    s_add_u32 m0, s74, 143360
    s_waitcnt vmcnt(12) lgkmcnt(5)
    v_mfma_f32_16x16x32_bf16 v[116:119], a[76:79], a[44:47], v[116:119]
    ds_read_b128 a[72:75], v3 offset:3072
    buffer_load_dwordx4 v32, s[4:7], m0 offen sc1 lds
    v_mfma_f32_16x16x32_bf16 v[120:123], a[80:83], a[44:47], v[120:123]
    ds_read_b128 a[76:79], v3 offset:4096
    v_mov_b32 v247, v245
    v_mfma_f32_16x16x32_bf16 v[124:127], v[136:139], a[44:47], v[124:127]
    ds_read_b128 a[80:83], v3 offset:5120
    v_permlane16_swap_b32 v244, v246
    v_mfma_f32_16x16x32_bf16 v[100:103], v[140:143], a[48:51], v[100:103]
    ds_read_b128 v[136:139], v3 offset:6144
    buffer_load_dwordx4 a[20:23], v48, s[8:11], s39 offen offset:2048 sc1
    v_mfma_f32_16x16x32_bf16 v[104:107], v[144:147], a[48:51], v[104:107]
    ds_read_b128 v[140:143], v3 offset:7168
    s_waitcnt lgkmcnt(5)
    v_mfma_f32_16x16x32_bf16 v[108:111], v[148:151], a[48:51], v[108:111]
    ds_read_b128 v[144:147], v3 offset:8192
    v_permlane16_swap_b32 v245, v247
    v_mfma_f32_16x16x32_bf16 v[112:115], v[152:155], a[48:51], v[112:115]
    ds_read_b128 v[148:151], v129 offset:9216
    v_add_f32 v244, v244, v246
    v_mfma_f32_16x16x32_bf16 v[116:119], v[156:159], a[48:51], v[116:119]
    ds_read_b128 v[152:155], v3 offset:10240
    buffer_load_dwordx4 a[24:27], v48, s[8:11], s40 offen offset:0 sc1
    v_mfma_f32_16x16x32_bf16 v[120:123], a[64:67], a[48:51], v[120:123]
    ds_read_b128 v[156:159], v3 offset:11264
    v_add_f32 v245, v245, v247
    v_mfma_f32_16x16x32_bf16 v[124:127], a[68:71], a[48:51], v[124:127]
    ds_read_b128 a[64:67], v3 offset:12288
    s_waitcnt vmcnt(13) lgkmcnt(5)
    v_mfma_f32_16x16x32_bf16 v[100:103], a[72:75], a[52:55], v[100:103]
    ds_read_b128 a[68:71], v3 offset:13312
    v_mul_f32 v244, 0xbacccccd, v244
    v_mfma_f32_16x16x32_bf16 v[104:107], a[76:79], a[52:55], v[104:107]
    ds_read_b128 a[72:75], v3 offset:14336
    buffer_load_dwordx4 a[28:31], v48, s[8:11], s40 offen offset:2048 sc1
    v_mfma_f32_16x16x32_bf16 v[108:111], a[80:83], a[52:55], v[108:111]
    ds_read_b128 a[76:79], v3 offset:15360
    v_mul_f32 v246, v244, v244
    v_mfma_f32_16x16x32_bf16 v[112:115], v[136:139], a[52:55], v[112:115]
    ds_read_b128 a[80:83], v129 offset:16384
    v_mul_f32 v245, 0x3acccccd, v245
    v_mfma_f32_16x16x32_bf16 v[116:119], v[140:143], a[52:55], v[116:119]
    ds_read_b128 v[136:139], v3 offset:17408
    s_add_u32 m0, s74, 147456
    s_waitcnt vmcnt(13) lgkmcnt(5)
    v_mfma_f32_16x16x32_bf16 v[120:123], v[144:147], a[52:55], v[120:123]
    ds_read_b128 v[140:143], v3 offset:18432
    buffer_load_dwordx4 v32, s[4:7], m0 offen sc1 lds
    v_mfma_f32_16x16x32_bf16 v[124:127], v[148:151], a[52:55], v[124:127]
    ds_read_b128 v[144:147], v3 offset:19456
    v_sub_f32 v246, v245, v246
    v_mfma_f32_16x16x32_bf16 v[100:103], v[152:155], a[56:59], v[100:103]
    ds_read_b128 v[148:151], v3 offset:20480
    v_max_f32 v246, 0, v246
    v_mfma_f32_16x16x32_bf16 v[104:107], v[156:159], a[56:59], v[104:107]
    ds_read_b128 v[152:155], v3 offset:21504
    v_add_f32 v246, 0x3727c5ac, v246
    v_mfma_f32_16x16x32_bf16 v[108:111], a[64:67], a[56:59], v[108:111]
    ds_read_b128 v[156:159], v3 offset:22528
    s_waitcnt vmcnt(12) lgkmcnt(5)
    v_mfma_f32_16x16x32_bf16 v[112:115], a[68:71], a[56:59], v[112:115]
    ds_read_b128 a[64:67], v129 offset:23552
    v_rsq_f32 v246, v246
    v_mfma_f32_16x16x32_bf16 v[116:119], a[72:75], a[56:59], v[116:119]
    ds_read_b128 a[68:71], v2 offset:32768
    v_mul_f32 v245, v246, v244
    v_mfma_f32_16x16x32_bf16 v[120:123], a[76:79], a[56:59], v[120:123]
    ds_read_b128 a[72:75], v2 offset:33792
    v_mov_b32 v244, v246
    v_mfma_f32_16x16x32_bf16 v[124:127], a[80:83], a[56:59], v[124:127]
    ds_read_b128 a[76:79], v2 offset:34816
    v_fmac_f32 v188, v160, v245
    v_mfma_f32_16x16x32_bf16 v[100:103], v[136:139], a[60:63], v[100:103]
    ds_read_b128 a[80:83], v2 offset:35840
    s_waitcnt lgkmcnt(5)
    v_mfma_f32_16x16x32_bf16 v[104:107], v[140:143], a[60:63], v[104:107]
    ds_read_b128 v[136:139], v2 offset:36864
    v_fmac_f32 v189, v161, v245
    v_mfma_f32_16x16x32_bf16 v[108:111], v[144:147], a[60:63], v[108:111]
    ds_read_b128 v[140:143], v2 offset:37888
    s_add_u32 m0, s74, 151552
    v_mfma_f32_16x16x32_bf16 v[112:115], v[148:151], a[60:63], v[112:115]
    ds_read_b128 v[144:147], v128 offset:38912
    buffer_load_dwordx4 v32, s[4:7], m0 offen sc1 lds
    v_mfma_f32_16x16x32_bf16 v[116:119], v[152:155], a[60:63], v[116:119]
    ds_read_b128 v[148:151], v2 offset:39936
    v_fmac_f32 v190, v162, v245
    v_mfma_f32_16x16x32_bf16 v[120:123], v[156:159], a[60:63], v[120:123]
    ds_read_b128 v[152:155], v2 offset:40960
    s_waitcnt vmcnt(12) lgkmcnt(5)
    v_mfma_f32_16x16x32_bf16 v[124:127], a[64:67], a[60:63], v[124:127]
    ds_read_b128 v[156:159], v2 offset:41984
    v_fmac_f32 v191, v163, v245
    s_cmp_eq_u32 s76, 0
    s_cbranch_scc0 L_sec_90_s
    v_pk_fma_f32 v[100:101], v[100:101], v[248:249], v[216:217] op_sel_hi:[1,0,1]
    v_max_f32 v100, 0, v100
    v_max_f32 v101, 0, v101
    v_pk_mul_f32 v[100:101], v[100:101], v[100:101]
    v_cvt_pk_bf16_f32 v216, v100, v101
    v_pk_fma_f32 v[102:103], v[102:103], v[248:249], v[218:219] op_sel_hi:[1,0,1]
    v_max_f32 v102, 0, v102
    v_max_f32 v103, 0, v103
    v_pk_mul_f32 v[102:103], v[102:103], v[102:103]
    v_cvt_pk_bf16_f32 v217, v102, v103
    v_pk_fma_f32 v[104:105], v[104:105], v[248:249], v[220:221] op_sel_hi:[1,0,1]
    v_max_f32 v104, 0, v104
    v_max_f32 v105, 0, v105
    v_pk_mul_f32 v[104:105], v[104:105], v[104:105]
    v_cvt_pk_bf16_f32 v218, v104, v105
    v_pk_fma_f32 v[106:107], v[106:107], v[248:249], v[222:223] op_sel_hi:[1,0,1]
    v_max_f32 v106, 0, v106
    v_max_f32_e64 v107, 0, v107
    v_pk_mul_f32 v[106:107], v[106:107], v[106:107]
    v_cvt_pk_bf16_f32 v219, v106, v107
    buffer_store_dwordx4 v[216:219], v23, s[48:51], s27 offen offset:0 nt
    v_pk_fma_f32 v[108:109], v[108:109], v[248:249], v[224:225] op_sel_hi:[1,0,1]
    v_max_f32 v108, 0, v108
    v_max_f32 v109, 0, v109
    v_pk_mul_f32 v[108:109], v[108:109], v[108:109]
    v_cvt_pk_bf16_f32 v220, v108, v109
    v_pk_fma_f32 v[110:111], v[110:111], v[248:249], v[226:227] op_sel_hi:[1,0,1]
    v_max_f32 v110, 0, v110
    v_max_f32 v111, 0, v111
    v_pk_mul_f32 v[110:111], v[110:111], v[110:111]
    v_cvt_pk_bf16_f32 v221, v110, v111
    v_pk_fma_f32 v[112:113], v[112:113], v[248:249], v[228:229] op_sel_hi:[1,0,1]
    v_max_f32 v112, 0, v112
    v_max_f32 v113, 0, v113
    v_pk_mul_f32 v[112:113], v[112:113], v[112:113]
    v_cvt_pk_bf16_f32 v222, v112, v113
    v_pk_fma_f32 v[114:115], v[114:115], v[248:249], v[230:231] op_sel_hi:[1,0,1]
    v_max_f32 v114, 0, v114
    v_max_f32 v115, 0, v115
    v_pk_mul_f32 v[114:115], v[114:115], v[114:115]
    v_cvt_pk_bf16_f32 v223, v114, v115
    buffer_store_dwordx4 v[220:223], v23, s[48:51], s27 offen offset:1024 nt
    v_pk_fma_f32 v[116:117], v[116:117], v[248:249], v[232:233] op_sel_hi:[1,0,1]
    v_max_f32 v116, 0, v116
    v_max_f32 v117, 0, v117
    v_pk_mul_f32 v[116:117], v[116:117], v[116:117]
    v_cvt_pk_bf16_f32 v224, v116, v117
    v_pk_fma_f32 v[118:119], v[118:119], v[248:249], v[234:235] op_sel_hi:[1,0,1]
    v_max_f32 v118, 0, v118
    v_max_f32 v119, 0, v119
    v_pk_mul_f32 v[118:119], v[118:119], v[118:119]
    v_cvt_pk_bf16_f32 v225, v118, v119
    v_pk_fma_f32 v[120:121], v[120:121], v[248:249], v[236:237] op_sel_hi:[1,0,1]
    v_max_f32 v120, 0, v120
    v_max_f32 v121, 0, v121
    v_pk_mul_f32 v[120:121], v[120:121], v[120:121]
    v_cvt_pk_bf16_f32 v226, v120, v121
    v_pk_fma_f32 v[122:123], v[122:123], v[248:249], v[238:239] op_sel_hi:[1,0,1]
    v_max_f32 v122, 0, v122
    v_max_f32 v123, 0, v123
    v_pk_mul_f32 v[122:123], v[122:123], v[122:123]
    v_cvt_pk_bf16_f32 v227, v122, v123
    buffer_store_dwordx4 v[224:227], v23, s[48:51], s27 offen offset:2048 nt
    v_pk_fma_f32 v[124:125], v[124:125], v[248:249], v[240:241] op_sel_hi:[1,0,1]
    v_max_f32 v124, 0, v124
    v_max_f32 v125, 0, v125
    v_pk_mul_f32 v[124:125], v[124:125], v[124:125]
    v_cvt_pk_bf16_f32 v228, v124, v125
    v_pk_fma_f32 v[126:127], v[126:127], v[248:249], v[242:243] op_sel_hi:[1,0,1]
    v_max_f32 v126, 0, v126
    v_max_f32 v127, 0, v127
    v_pk_mul_f32 v[126:127], v[126:127], v[126:127]
    v_cvt_pk_bf16_f32 v229, v126, v127
    buffer_store_dwordx2 v[228:229], v24, s[48:51], s27 offen nt
L_sec_90_e:
    v_mfma_f32_16x16x32_bf16 v[72:75], a[68:71], a[0:3], v[72:75]
    ds_read_b128 a[64:67], v2 offset:43008
    v_fmac_f32 v192, v164, v245
    v_mfma_f32_16x16x32_bf16 v[76:79], a[72:75], a[0:3], v[76:79]
    ds_read_b128 a[68:71], v2 offset:44032
    v_fmac_f32 v193, v165, v245
    v_mfma_f32_16x16x32_bf16 v[80:83], a[76:79], a[0:3], v[80:83]
    ds_read_b128 a[72:75], v2 offset:45056
    v_fmac_f32 v194, v166, v245
    v_mfma_f32_16x16x32_bf16 v[84:87], a[80:83], a[0:3], v[84:87]
    ds_read_b128 a[76:79], v128 offset:46080
    s_add_u32 m0, s74, 155648
    s_waitcnt vmcnt(14) lgkmcnt(5)
    v_mfma_f32_16x16x32_bf16 v[88:91], v[136:139], a[0:3], v[88:91]
    ds_read_b128 a[80:83], v2 offset:47104
    buffer_load_dwordx4 v32, s[4:7], m0 offen sc1 lds
    v_mfma_f32_16x16x32_bf16 v[92:95], v[140:143], a[0:3], v[92:95]
    ds_read_b128 v[136:139], v2 offset:48128
    v_fmac_f32 v195, v167, v245
    v_mfma_f32_16x16x32_bf16 v[96:99], v[144:147], a[0:3], v[96:99]
    ds_read_b128 v[140:143], v2 offset:49152
    v_fmac_f32 v196, v168, v245
    v_mfma_f32_16x16x32_bf16 v[72:75], v[148:151], a[4:7], v[72:75]
    ds_read_b128 v[144:147], v2 offset:50176
    v_fmac_f32 v197, v169, v245
    v_mfma_f32_16x16x32_bf16 v[76:79], v[152:155], a[4:7], v[76:79]
    ds_read_b128 v[148:151], v2 offset:51200
    s_waitcnt lgkmcnt(5)
    v_mfma_f32_16x16x32_bf16 v[80:83], v[156:159], a[4:7], v[80:83]
    ds_read_b128 v[152:155], v2 offset:52224
    v_fmac_f32 v198, v170, v245
    v_mfma_f32_16x16x32_bf16 v[84:87], a[64:67], a[4:7], v[84:87]
    ds_read_b128 v[156:159], v128 offset:53248
    v_fmac_f32 v199, v171, v245
    v_mfma_f32_16x16x32_bf16 v[88:91], a[68:71], a[4:7], v[88:91]
    ds_read_b128 a[64:67], v2 offset:54272
    v_add_u32 v32, 0x27000, v32
    s_add_u32 m0, s74, 0
    v_mfma_f32_16x16x32_bf16 v[92:95], a[72:75], a[4:7], v[92:95]
    ds_read_b128 a[68:71], v2 offset:55296
    buffer_load_dwordx4 v32, s[4:7], m0 offen sc1 lds
    v_mfma_f32_16x16x32_bf16 v[96:99], a[76:79], a[4:7], v[96:99]
    ds_read_b128 a[72:75], v2 offset:56320
    s_waitcnt vmcnt(15) lgkmcnt(5)
    v_mfma_f32_16x16x32_bf16 v[72:75], a[80:83], a[8:11], v[72:75]
    ds_read_b128 a[76:79], v2 offset:57344
    v_fmac_f32 v200, v172, v245
    v_mfma_f32_16x16x32_bf16 v[76:79], v[136:139], a[8:11], v[76:79]
    ds_read_b128 a[80:83], v2 offset:58368
    v_fmac_f32 v201, v173, v245
    v_mfma_f32_16x16x32_bf16 v[80:83], v[140:143], a[8:11], v[80:83]
    ds_read_b128 v[136:139], v2 offset:59392
    v_fmac_f32 v202, v174, v245
    v_mfma_f32_16x16x32_bf16 v[84:87], v[144:147], a[8:11], v[84:87]
    ds_read_b128 v[140:143], v128 offset:60416
    v_fmac_f32 v203, v175, v245
    v_mfma_f32_16x16x32_bf16 v[88:91], v[148:151], a[8:11], v[88:91]
    s_barrier
    ds_read_b128 v[144:147], v2 offset:61440
    s_waitcnt vmcnt(14) lgkmcnt(5)
    v_mfma_f32_16x16x32_bf16 v[92:95], v[152:155], a[8:11], v[92:95]
    ds_read_b128 v[148:151], v2 offset:62464
    v_fmac_f32 v204, v176, v245
    v_mfma_f32_16x16x32_bf16 v[96:99], v[156:159], a[8:11], v[96:99]
    ds_read_b128 v[152:155], v2 offset:63488
    v_fmac_f32 v205, v177, v245
    v_mfma_f32_16x16x32_bf16 v[72:75], a[64:67], a[12:15], v[72:75]
    ds_read_b128 v[156:159], v2 offset:64512
    v_fmac_f32 v206, v178, v245
    v_mfma_f32_16x16x32_bf16 v[76:79], a[68:71], a[12:15], v[76:79]
    ds_read_b128 a[64:67], v3 offset:0
    v_fmac_f32 v207, v179, v245
    v_mfma_f32_16x16x32_bf16 v[80:83], a[72:75], a[12:15], v[80:83]
    ds_read_b128 a[68:71], v3 offset:1024
    s_cmp_ge_u32 s73, 3
    s_cselect_b32 s3, s64, 0
    v_add_u32 v32, s3, v32
    s_add_u32 m0, s74, 4096
    s_waitcnt vmcnt(12) lgkmcnt(5)
    v_mfma_f32_16x16x32_bf16 v[84:87], a[76:79], a[12:15], v[84:87]
    ds_read_b128 a[72:75], v129 offset:2048
    buffer_load_dwordx4 v32, s[4:7], m0 offen sc1 lds
    v_mfma_f32_16x16x32_bf16 v[88:91], a[80:83], a[12:15], v[88:91]
    ds_read_b128 a[76:79], v3 offset:3072
    v_fmac_f32 v208, v180, v245
    v_mfma_f32_16x16x32_bf16 v[92:95], v[136:139], a[12:15], v[92:95]
    ds_read_b128 a[80:83], v3 offset:4096
    v_fmac_f32 v209, v181, v245
    v_mfma_f32_16x16x32_bf16 v[96:99], v[140:143], a[12:15], v[96:99]
    ds_read_b128 v[136:139], v3 offset:5120
    v_fmac_f32 v210, v182, v245
    s_waitcnt vmcnt(3)
    s_mov_b64 exec, 1
    s_cmp_eq_u32 s76, 0
    s_cbranch_scc0 L_st_91_s
    buffer_store_dword v28, off, s[48:51], s85 offset:192
L_st_91_e:
    s_mov_b64 exec, -1
    v_mfma_f32_16x16x32_bf16 v[72:75], v[144:147], a[16:19], v[72:75]
    ds_read_b128 v[140:143], v3 offset:6144
    s_cmp_le_u32 s73, 2
    s_cselect_b32 s3, s64, 0
    v_add_u32 v32, s3, v32
    s_add_u32 m0, s74, 8192
    s_waitcnt lgkmcnt(5)
    v_mfma_f32_16x16x32_bf16 v[76:79], v[148:151], a[16:19], v[76:79]
    ds_read_b128 v[144:147], v3 offset:7168
    buffer_load_dwordx4 v32, s[4:7], m0 offen sc1 lds
    v_mfma_f32_16x16x32_bf16 v[80:83], v[152:155], a[16:19], v[80:83]
    ds_read_b128 v[148:151], v3 offset:8192
    v_fmac_f32 v211, v183, v245
    v_mfma_f32_16x16x32_bf16 v[84:87], v[156:159], a[16:19], v[84:87]
    ds_read_b128 v[152:155], v129 offset:9216
    s_add_u32 m0, s74, 12288
    v_mfma_f32_16x16x32_bf16 v[88:91], a[64:67], a[16:19], v[88:91]
    ds_read_b128 v[156:159], v3 offset:10240
    buffer_load_dwordx4 v32, s[4:7], m0 offen sc1 lds
    v_mfma_f32_16x16x32_bf16 v[92:95], a[68:71], a[16:19], v[92:95]
    ds_read_b128 a[64:67], v3 offset:11264
    s_waitcnt lgkmcnt(5)
    v_mfma_f32_16x16x32_bf16 v[96:99], a[72:75], a[16:19], v[96:99]
    ds_read_b128 a[68:71], v3 offset:12288
    v_fmac_f32 v212, v184, v245
    v_mfma_f32_16x16x32_bf16 v[72:75], a[76:79], a[20:23], v[72:75]
    ds_read_b128 a[72:75], v3 offset:13312
    s_add_u32 m0, s74, 16384
    v_mfma_f32_16x16x32_bf16 v[76:79], a[80:83], a[20:23], v[76:79]
    ds_read_b128 a[76:79], v3 offset:14336
    buffer_load_dwordx4 v32, s[4:7], m0 offen sc1 lds
    v_mfma_f32_16x16x32_bf16 v[80:83], v[136:139], a[20:23], v[80:83]
    ds_read_b128 a[80:83], v3 offset:15360
    v_fmac_f32 v213, v185, v245
    v_mfma_f32_16x16x32_bf16 v[84:87], v[140:143], a[20:23], v[84:87]
    ds_read_b128 v[136:139], v129 offset:16384
    s_waitcnt lgkmcnt(5)
    v_mfma_f32_16x16x32_bf16 v[88:91], v[144:147], a[20:23], v[88:91]
    ds_read_b128 v[140:143], v3 offset:17408
    s_add_u32 m0, s74, 20480
    v_mfma_f32_16x16x32_bf16 v[92:95], v[148:151], a[20:23], v[92:95]
    ds_read_b128 v[144:147], v3 offset:18432
    buffer_load_dwordx4 v32, s[4:7], m0 offen sc1 lds
    v_mfma_f32_16x16x32_bf16 v[96:99], v[152:155], a[20:23], v[96:99]
    ds_read_b128 v[148:151], v3 offset:19456
    v_fmac_f32 v214, v186, v245
    v_mfma_f32_16x16x32_bf16 v[72:75], v[156:159], a[24:27], v[72:75]
    ds_read_b128 v[152:155], v3 offset:20480
    v_fmac_f32 v215, v187, v245
    v_mfma_f32_16x16x32_bf16 v[76:79], a[64:67], a[24:27], v[76:79]
    ds_read_b128 v[156:159], v3 offset:21504
    s_add_u32 m0, s74, 24576
    s_waitcnt lgkmcnt(5)
    v_mfma_f32_16x16x32_bf16 v[80:83], a[68:71], a[24:27], v[80:83]
    ds_read_b128 a[64:67], v3 offset:22528
    buffer_load_dwordx4 v32, s[4:7], m0 offen sc1 lds
    v_mfma_f32_16x16x32_bf16 v[84:87], a[72:75], a[24:27], v[84:87]
    ds_read_b128 a[68:71], v129 offset:23552
    v_mfma_f32_16x16x32_bf16 v[88:91], a[76:79], a[24:27], v[88:91]
    v_mfma_f32_16x16x32_bf16 v[92:95], a[80:83], a[24:27], v[92:95]
    v_mfma_f32_16x16x32_bf16 v[96:99], v[136:139], a[24:27], v[96:99]
    s_add_u32 m0, s74, 28672
    s_waitcnt lgkmcnt(2)
    v_mfma_f32_16x16x32_bf16 v[72:75], v[140:143], a[28:31], v[72:75]
    buffer_load_dwordx4 v32, s[4:7], m0 offen sc1 lds
    v_mfma_f32_16x16x32_bf16 v[76:79], v[144:147], a[28:31], v[76:79]
    v_mfma_f32_16x16x32_bf16 v[80:83], v[148:151], a[28:31], v[80:83]
    s_add_u32 m0, s74, 32768
    v_mfma_f32_16x16x32_bf16 v[84:87], v[152:155], a[28:31], v[84:87]
    buffer_load_dwordx4 v32, s[4:7], m0 offen sc1 lds
    v_mfma_f32_16x16x32_bf16 v[88:91], v[156:159], a[28:31], v[88:91]
    s_waitcnt lgkmcnt(0)
    v_mfma_f32_16x16x32_bf16 v[92:95], a[64:67], a[28:31], v[92:95]
    v_mfma_f32_16x16x32_bf16 v[96:99], a[68:71], a[28:31], v[96:99]
    ds_read_b128 v[136:139], v46 offset:1536
    ds_read_b128 v[140:143], v46 offset:1600
    ds_read_b128 v[144:147], v46 offset:1664
    ds_read_b128 v[148:151], v46 offset:1728
    ds_read_b128 v[152:155], v46 offset:1792
    buffer_load_dword v252, v255, s[48:51], s82 offen offset:192 sc1
    s_cmp_eq_u32 s76, 0
    s_cbranch_scc0 L_sec_93_s
    v_pk_fma_f32 v[72:73], v[72:73], v[244:245], v[188:189] op_sel_hi:[1,0,1]
    s_add_u32 m0, s74, 36864
    v_max_f32 v72, 0, v72
    buffer_load_dwordx4 v32, s[4:7], m0 offen sc1 lds
    v_max_f32 v73, 0, v73
    v_pk_mul_f32 v[72:73], v[72:73], v[72:73]
    v_cvt_pk_bf16_f32 v156, v72, v73
    v_pk_fma_f32 v[74:75], v[74:75], v[244:245], v[190:191] op_sel_hi:[1,0,1]
    v_max_f32 v74, 0, v74
    v_max_f32 v75, 0, v75
    v_pk_mul_f32 v[74:75], v[74:75], v[74:75]
    v_cvt_pk_bf16_f32 v157, v74, v75
    v_pk_fma_f32 v[76:77], v[76:77], v[244:245], v[192:193] op_sel_hi:[1,0,1]
    v_max_f32 v76, 0, v76
    v_max_f32 v77, 0, v77
    v_pk_mul_f32 v[76:77], v[76:77], v[76:77]
    v_cvt_pk_bf16_f32 v158, v76, v77
    v_pk_fma_f32 v[78:79], v[78:79], v[244:245], v[194:195] op_sel_hi:[1,0,1]
    v_max_f32 v78, 0, v78
    v_max_f32 v79, 0, v79
    v_pk_mul_f32 v[78:79], v[78:79], v[78:79]
    v_cvt_pk_bf16_f32 v159, v78, v79
    buffer_store_dwordx4 v[156:159], v23, s[48:51], s26 offen offset:0 nt
    v_pk_fma_f32 v[80:81], v[80:81], v[244:245], v[196:197] op_sel_hi:[1,0,1]
    v_max_f32 v80, 0, v80
    v_max_f32 v81, 0, v81
    s_add_u32 m0, s74, 40960
    v_pk_mul_f32 v[80:81], v[80:81], v[80:81]
    buffer_load_dwordx4 v32, s[4:7], m0 offen sc1 lds
    v_cvt_pk_bf16_f32 v160, v80, v81
    v_pk_fma_f32 v[82:83], v[82:83], v[244:245], v[198:199] op_sel_hi:[1,0,1]
    v_max_f32 v82, 0, v82
    v_max_f32 v83, 0, v83
    v_pk_mul_f32 v[82:83], v[82:83], v[82:83]
    v_cvt_pk_bf16_f32 v161, v82, v83
    v_pk_fma_f32 v[84:85], v[84:85], v[244:245], v[200:201] op_sel_hi:[1,0,1]
    v_max_f32 v84, 0, v84
    v_max_f32 v85, 0, v85
    v_pk_mul_f32 v[84:85], v[84:85], v[84:85]
    v_cvt_pk_bf16_f32 v162, v84, v85
    v_pk_fma_f32 v[86:87], v[86:87], v[244:245], v[202:203] op_sel_hi:[1,0,1]
    v_max_f32 v86, 0, v86
    v_max_f32 v87, 0, v87
    v_pk_mul_f32 v[86:87], v[86:87], v[86:87]
    v_cvt_pk_bf16_f32 v163, v86, v87
    buffer_store_dwordx4 v[160:163], v23, s[48:51], s26 offen offset:1024 nt
    v_pk_fma_f32 v[88:89], v[88:89], v[244:245], v[204:205] op_sel_hi:[1,0,1]
    v_max_f32 v88, 0, v88
    v_max_f32 v89, 0, v89
    v_pk_mul_f32 v[88:89], v[88:89], v[88:89]
    v_cvt_pk_bf16_f32 v164, v88, v89
    s_add_u32 m0, s74, 45056
    v_pk_fma_f32 v[90:91], v[90:91], v[244:245], v[206:207] op_sel_hi:[1,0,1]
    buffer_load_dwordx4 v32, s[4:7], m0 offen sc1 lds
    v_max_f32 v90, 0, v90
    v_max_f32 v91, 0, v91
    v_pk_mul_f32 v[90:91], v[90:91], v[90:91]
    v_cvt_pk_bf16_f32 v165, v90, v91
    v_pk_fma_f32 v[92:93], v[92:93], v[244:245], v[208:209] op_sel_hi:[1,0,1]
    v_max_f32 v92, 0, v92
    v_max_f32 v93, 0, v93
    v_pk_mul_f32 v[92:93], v[92:93], v[92:93]
    v_cvt_pk_bf16_f32 v166, v92, v93
    v_pk_fma_f32 v[94:95], v[94:95], v[244:245], v[210:211] op_sel_hi:[1,0,1]
    v_max_f32 v94, 0, v94
    v_max_f32 v95, 0, v95
    v_pk_mul_f32 v[94:95], v[94:95], v[94:95]
    v_cvt_pk_bf16_f32 v167, v94, v95
    buffer_store_dwordx4 v[164:167], v23, s[48:51], s26 offen offset:2048 nt
    v_pk_fma_f32 v[96:97], v[96:97], v[244:245], v[212:213] op_sel_hi:[1,0,1]
    v_max_f32 v96, 0, v96
    v_max_f32 v97, 0, v97
    v_pk_mul_f32 v[96:97], v[96:97], v[96:97]
    v_cvt_pk_bf16_f32 v168, v96, v97
    v_pk_fma_f32 v[98:99], v[98:99], v[244:245], v[214:215] op_sel_hi:[1,0,1]
    v_max_f32 v98, 0, v98
    v_max_f32 v99, 0, v99
    v_pk_mul_f32 v[98:99], v[98:99], v[98:99]
    v_cvt_pk_bf16_f32 v169, v98, v99
    buffer_store_dwordx2 v[168:169], v24, s[48:51], s26 offen nt
    s_waitcnt lgkmcnt(0)
    s_nop 0
    v_pk_add_f32 v[52:53], v[52:53], v[136:137]
    v_pk_add_f32 v[54:55], v[54:55], v[138:139]
    v_pk_add_f32 v[56:57], v[56:57], v[140:141]
    v_pk_add_f32 v[58:59], v[58:59], v[142:143]
    v_pk_add_f32 v[60:61], v[60:61], v[144:145]
    v_pk_add_f32 v[62:63], v[62:63], v[146:147]
    v_pk_add_f32 v[64:65], v[64:65], v[148:149]
    v_pk_add_f32 v[66:67], v[66:67], v[150:151]
    v_pk_add_f32 v[68:69], v[68:69], v[152:153]
    v_pk_add_f32 v[70:71], v[70:71], v[154:155]
    s_mov_b64 s[8:9], s[48:49]
    s_add_u32 s48, s48, s56
    s_addc_u32 s49, s49, 0
L_sec_93_e:
L_p41:
    s_sub_u32 s95, 0, s47
    s_cmp_lt_u32 s77, 8
    s_cselect_b32 s95, s47, s95
    v_add_u32 v48, s95, v13
    s_waitcnt vmcnt(14)
    s_barrier
    s_nop 0
    ds_read_b128 v[72:75], v3 offset:24576
L_pad13:
    s_cbranch_execz L_pad17
    s_nop 0
    ds_read_b128 v[76:79], v3 offset:25600
    ds_read_b128 v[80:83], v3 offset:26624
    ds_read_b128 v[84:87], v3 offset:27648
    ds_read_b128 v[88:91], v3 offset:28672
    ds_read_b128 v[92:95], v3 offset:29696
    ds_read_b128 v[96:99], v3 offset:30720
    ds_read_b128 v[100:103], v3 offset:31744
    ds_read_b128 v[104:107], v3 offset:32768
    ds_read_b128 v[108:111], v3 offset:33792
    s_waitcnt vmcnt(7)
L_fs_ck1:
    v_cmp_ne_u32 vcc, s81, v252
    s_cbranch_vccz L_fs_ok1
    buffer_load_dword v252, v255, s[8:11], s82 offen offset:192 sc1
    s_sub_u32 s80, s80, 1
    s_cbranch_scc1 L_end
    s_waitcnt vmcnt(0)
    s_branch L_fs_ck1
L_fs_ok1:
    buffer_load_dwordx4 a[184:187], v48, s[8:11], s20 offen offset:0 sc1
    buffer_load_dwordx4 a[188:191], v48, s[8:11], s20 offen offset:1024 sc1
    buffer_load_dwordx4 a[192:195], v48, s[8:11], s20 offen offset:2048 sc1
    s_waitcnt lgkmcnt(5)
    v_mfma_f32_16x16x32_bf16 v[52:55], v[72:75], v[156:159], v[52:55]
    ds_read_b128 v[112:115], v3 offset:34816
    v_mfma_f32_16x16x32_bf16 v[116:119], v[72:75], v[216:219], 0
    buffer_load_dwordx4 a[196:199], v48, s[8:11], s21 offen offset:0 sc1
    v_mfma_f32_16x16x32_bf16 v[56:59], v[76:79], v[156:159], v[56:59]
    ds_read_b128 v[72:75], v3 offset:35840
    v_mfma_f32_16x16x32_bf16 v[120:123], v[76:79], v[216:219], 0
    v_mfma_f32_16x16x32_bf16 v[60:63], v[80:83], v[156:159], v[60:63]
    ds_read_b128 v[76:79], v3 offset:36864
    v_mfma_f32_16x16x32_bf16 v[124:127], v[80:83], v[216:219], 0
    buffer_load_dwordx4 a[200:203], v48, s[8:11], s21 offen offset:1024 sc1
    v_mfma_f32_16x16x32_bf16 v[64:67], v[84:87], v[156:159], v[64:67]
    ds_read_b128 v[80:83], v3 offset:37888
    v_mfma_f32_16x16x32_bf16 v[128:131], v[84:87], v[216:219], 0
    v_mfma_f32_16x16x32_bf16 v[68:71], v[88:91], v[156:159], v[68:71]
    ds_read_b128 v[84:87], v3 offset:38912
    v_mfma_f32_16x16x32_bf16 v[132:135], v[88:91], v[216:219], 0
    s_waitcnt lgkmcnt(5)
    v_mfma_f32_16x16x32_bf16 v[52:55], v[92:95], v[160:163], v[52:55]
    ds_read_b128 v[88:91], v3 offset:39936
    v_mfma_f32_16x16x32_bf16 v[116:119], v[92:95], v[220:223], v[116:119]
    buffer_load_dwordx4 a[204:207], v48, s[8:11], s21 offen offset:2048 sc1
    v_mfma_f32_16x16x32_bf16 v[56:59], v[96:99], v[160:163], v[56:59]
    ds_read_b128 v[92:95], v3 offset:40960
    v_mfma_f32_16x16x32_bf16 v[120:123], v[96:99], v[220:223], v[120:123]
    v_mfma_f32_16x16x32_bf16 v[60:63], v[100:103], v[160:163], v[60:63]
    ds_read_b128 v[96:99], v3 offset:41984
    v_mfma_f32_16x16x32_bf16 v[124:127], v[100:103], v[220:223], v[124:127]
    buffer_load_dwordx4 a[208:211], v48, s[8:11], s22 offen offset:0 sc1
    v_mfma_f32_16x16x32_bf16 v[64:67], v[104:107], v[160:163], v[64:67]
    ds_read_b128 v[100:103], v3 offset:43008
    v_mfma_f32_16x16x32_bf16 v[128:131], v[104:107], v[220:223], v[128:131]
    v_mfma_f32_16x16x32_bf16 v[68:71], v[108:111], v[160:163], v[68:71]
    ds_read_b128 v[104:107], v3 offset:44032
    v_mfma_f32_16x16x32_bf16 v[132:135], v[108:111], v[220:223], v[132:135]
    buffer_load_dwordx4 a[212:215], v48, s[8:11], s22 offen offset:1024 sc1
    s_waitcnt lgkmcnt(5)
    s_waitcnt vmcnt(8)
    s_mov_b64 exec, 1
    s_cmp_eq_u32 s76, 0
    s_cbranch_scc0 L_st_94_s
    buffer_store_dword v28, off, s[8:11], s85 offset:64
L_st_94_e:
    s_mov_b64 exec, -1
    v_mfma_f32_16x16x32_bf16 v[52:55], v[112:115], v[164:167], v[52:55]
    ds_read_b128 v[108:111], v3 offset:45056
    v_mfma_f32_16x16x32_bf16 v[116:119], v[112:115], v[224:227], v[116:119]
    s_add_u32 m0, s74, 49152
    v_mfma_f32_16x16x32_bf16 v[56:59], v[72:75], v[164:167], v[56:59]
    ds_read_b128 v[112:115], v3 offset:46080
    v_mfma_f32_16x16x32_bf16 v[120:123], v[72:75], v[224:227], v[120:123]
    buffer_load_dwordx4 v32, s[4:7], m0 offen sc1 lds
    v_mfma_f32_16x16x32_bf16 v[60:63], v[76:79], v[164:167], v[60:63]
    ds_read_b128 v[72:75], v3 offset:47104
    v_mfma_f32_16x16x32_bf16 v[124:127], v[76:79], v[224:227], v[124:127]
    s_add_u32 m0, s74, 53248
    v_mfma_f32_16x16x32_bf16 v[64:67], v[80:83], v[164:167], v[64:67]
    ds_read_b128 v[76:79], v3 offset:48128
    v_mfma_f32_16x16x32_bf16 v[128:131], v[80:83], v[224:227], v[128:131]
    buffer_load_dwordx4 v32, s[4:7], m0 offen sc1 lds
    v_mfma_f32_16x16x32_bf16 v[68:71], v[84:87], v[164:167], v[68:71]
    ds_read_b128 v[80:83], v3 offset:49152
    v_mfma_f32_16x16x32_bf16 v[132:135], v[84:87], v[224:227], v[132:135]
    s_add_u32 m0, s74, 57344
    s_waitcnt vmcnt(10) lgkmcnt(5)
    v_mfma_f32_16x16x32_bf16 v[116:119], v[88:91], a[184:187], v[116:119]
    ds_read_b128 v[84:87], v3 offset:50176
    buffer_load_dwordx4 v32, s[4:7], m0 offen sc1 lds
    v_mfma_f32_16x16x32_bf16 v[120:123], v[92:95], a[184:187], v[120:123]
    ds_read_b128 v[88:91], v3 offset:51200
    v_xor_b32 v220, 0x100, v14
    v_mfma_f32_16x16x32_bf16 v[124:127], v[96:99], a[184:187], v[124:127]
    ds_read_b128 v[92:95], v3 offset:52224
    buffer_load_dwordx4 a[216:219], v48, s[8:11], s22 offen offset:2048 sc1
    v_mfma_f32_16x16x32_bf16 v[128:131], v[100:103], a[184:187], v[128:131]
    ds_read_b128 v[96:99], v3 offset:53248
    v_xor_b32 v221, 0x100, v15
    v_mfma_f32_16x16x32_bf16 v[132:135], v[104:107], a[184:187], v[132:135]
    ds_read_b128 v[100:103], v3 offset:54272
    s_add_u32 m0, s74, 61440
    s_waitcnt vmcnt(11) lgkmcnt(5)
    v_mfma_f32_16x16x32_bf16 v[116:119], v[108:111], a[188:191], v[116:119]
    ds_read_b128 v[104:107], v3 offset:55296
    buffer_load_dwordx4 v32, s[4:7], m0 offen sc1 lds
    v_mfma_f32_16x16x32_bf16 v[120:123], v[112:115], a[188:191], v[120:123]
    ds_read_b128 v[108:111], v3 offset:56320
    s_xor_b32 s97, s85, 32
    v_mfma_f32_16x16x32_bf16 v[124:127], v[72:75], a[188:191], v[124:127]
    ds_read_b128 v[112:115], v3 offset:57344
    v_readfirstlane_b32 s95, v25
    v_mfma_f32_16x16x32_bf16 v[128:131], v[76:79], a[188:191], v[128:131]
    ds_read_b128 v[72:75], v3 offset:58368
    buffer_load_dwordx4 a[220:223], v48, s[8:11], s23 offen offset:0 sc1
    v_mfma_f32_16x16x32_bf16 v[132:135], v[80:83], a[188:191], v[132:135]
    ds_read_b128 v[76:79], v3 offset:59392
    s_waitcnt vmcnt(12) lgkmcnt(5)
    v_mfma_f32_16x16x32_bf16 v[116:119], v[84:87], a[192:195], v[116:119]
    ds_read_b128 v[80:83], v3 offset:60416
    s_mul_i32 s96, s74, 3
    v_mfma_f32_16x16x32_bf16 v[120:123], v[88:91], a[192:195], v[120:123]
    ds_read_b128 v[84:87], v3 offset:61440
    buffer_load_dwordx4 a[224:227], v48, s[8:11], s23 offen offset:1024 sc1
    v_mfma_f32_16x16x32_bf16 v[124:127], v[92:95], a[192:195], v[124:127]
    ds_read_b128 v[88:91], v3 offset:62464
    s_add_u32 s96, s96, 77824
    v_mfma_f32_16x16x32_bf16 v[128:131], v[96:99], a[192:195], v[128:131]
    ds_read_b128 v[92:95], v3 offset:63488
    v_add_u32 v242, 0, v2
    v_mfma_f32_16x16x32_bf16 v[132:135], v[100:103], a[192:195], v[132:135]
    ds_read_b128 v[96:99], v3 offset:64512
    s_add_u32 m0, s74, 65536
    s_waitcnt vmcnt(12) lgkmcnt(5)
    v_mfma_f32_16x16x32_bf16 v[116:119], v[104:107], a[196:199], v[116:119]
    ds_read_b128 v[100:103], v4 offset:0
    buffer_load_dwordx4 v32, s[4:7], m0 offen sc1 lds
    v_mfma_f32_16x16x32_bf16 v[120:123], v[108:111], a[196:199], v[120:123]
    ds_read_b128 v[104:107], v4 offset:1024
    v_mul_u32_u24 v243, 6554, v242
    v_mfma_f32_16x16x32_bf16 v[124:127], v[112:115], a[196:199], v[124:127]
    ds_read_b128 v[108:111], v4 offset:2048
    v_lshrrev_b32 v243, 20, v243
    v_mfma_f32_16x16x32_bf16 v[128:131], v[72:75], a[196:199], v[128:131]
    ds_read_b128 v[112:115], v4 offset:3072
    buffer_load_dwordx4 a[228:231], v48, s[8:11], s23 offen offset:2048 sc1
    v_mfma_f32_16x16x32_bf16 v[132:135], v[76:79], a[196:199], v[132:135]
    ds_read_b128 v[72:75], v4 offset:4096
    s_waitcnt vmcnt(13) lgkmcnt(5)
    v_mfma_f32_16x16x32_bf16 v[116:119], v[80:83], a[200:203], v[116:119]
    ds_read_b128 v[76:79], v4 offset:5120
    v_mul_u32_u24 v243, 1120, v243
    v_mfma_f32_16x16x32_bf16 v[120:123], v[84:87], a[200:203], v[120:123]
    ds_read_b128 v[80:83], v4 offset:6144
    buffer_load_dwordx4 a[232:235], v48, s[8:11], s28 offen offset:0 sc1
    v_mfma_f32_16x16x32_bf16 v[124:127], v[88:91], a[200:203], v[124:127]
    ds_read_b128 v[84:87], v4 offset:7168
    v_add3_u32 v236, v242, v243, s95
    v_mfma_f32_16x16x32_bf16 v[128:131], v[92:95], a[200:203], v[128:131]
    ds_read_b128 v[88:91], v4 offset:8192
    v_add_u32 v242, 1024, v2
    v_mfma_f32_16x16x32_bf16 v[132:135], v[96:99], a[200:203], v[132:135]
    ds_read_b128 v[92:95], v4 offset:9216
    s_waitcnt vmcnt(13) lgkmcnt(5)
    v_mfma_f32_16x16x32_bf16 v[116:119], v[100:103], a[204:207], v[116:119]
    ds_read_b128 v[96:99], v4 offset:10240
    buffer_load_dwordx4 a[236:239], v48, s[8:11], s28 offen offset:1024 sc1
    v_mfma_f32_16x16x32_bf16 v[120:123], v[104:107], a[204:207], v[120:123]
    ds_read_b128 v[100:103], v4 offset:11264
    v_mul_u32_u24 v243, 6554, v242
    v_mfma_f32_16x16x32_bf16 v[124:127], v[108:111], a[204:207], v[124:127]
    ds_read_b128 v[104:107], v4 offset:12288
    v_lshrrev_b32 v243, 20, v243
    v_mfma_f32_16x16x32_bf16 v[128:131], v[112:115], a[204:207], v[128:131]
    ds_read_b128 v[108:111], v4 offset:13312
    buffer_load_dwordx4 a[240:243], v48, s[8:11], s28 offen offset:2048 sc1
    v_mfma_f32_16x16x32_bf16 v[132:135], v[72:75], a[204:207], v[132:135]
    ds_read_b128 v[112:115], v4 offset:14336
    s_waitcnt vmcnt(14) lgkmcnt(5)
    v_mfma_f32_16x16x32_bf16 v[116:119], v[76:79], a[208:211], v[116:119]
    ds_read_b128 v[72:75], v4 offset:15360
    v_mul_u32_u24 v243, 1120, v243
    v_mfma_f32_16x16x32_bf16 v[120:123], v[80:83], a[208:211], v[120:123]
    ds_read_b128 v[76:79], v4 offset:16384
    buffer_load_dword v252, v27, s[8:11], s82 offen offset:64 sc1
    v_mfma_f32_16x16x32_bf16 v[124:127], v[84:87], a[208:211], v[124:127]
    ds_read_b128 v[80:83], v4 offset:17408
    v_add3_u32 v237, v242, v243, s95
    v_mfma_f32_16x16x32_bf16 v[128:131], v[88:91], a[208:211], v[128:131]
    ds_read_b128 v[84:87], v4 offset:18432
    v_add_u32 v242, 2048, v2
    v_mfma_f32_16x16x32_bf16 v[132:135], v[92:95], a[208:211], v[132:135]
    ds_read_b128 v[88:91], v4 offset:19456
    s_waitcnt vmcnt(14) lgkmcnt(5)
    v_mfma_f32_16x16x32_bf16 v[116:119], v[96:99], a[212:215], v[116:119]
    ds_read_b128 v[92:95], v4 offset:20480
    buffer_load_dwordx4 a[244:247], v48, s[8:11], s29 offen offset:0 sc1
    v_mfma_f32_16x16x32_bf16 v[120:123], v[100:103], a[212:215], v[120:123]
    ds_read_b128 v[96:99], v4 offset:21504
    v_mul_u32_u24 v243, 6554, v242
    v_mfma_f32_16x16x32_bf16 v[124:127], v[104:107], a[212:215], v[124:127]
    ds_read_b128 v[100:103], v4 offset:22528
    buffer_load_dwordx4 a[248:251], v48, s[8:11], s29 offen offset:1024 sc1
    v_mfma_f32_16x16x32_bf16 v[128:131], v[108:111], a[212:215], v[128:131]
    ds_read_b128 v[104:107], v4 offset:23552
    v_lshrrev_b32 v243, 20, v243
    v_mfma_f32_16x16x32_bf16 v[132:135], v[112:115], a[212:215], v[132:135]
    ds_read_b128 v[108:111], v4 offset:24576
    s_waitcnt vmcnt(11) lgkmcnt(5)
    v_mfma_f32_16x16x32_bf16 v[116:119], v[72:75], a[216:219], v[116:119]
    ds_read_b128 v[112:115], v4 offset:25600
    v_mul_u32_u24 v243, 1120, v243
    v_mfma_f32_16x16x32_bf16 v[120:123], v[76:79], a[216:219], v[120:123]
    ds_read_b128 v[72:75], v4 offset:26624
    buffer_load_dwordx4 a[184:187], v48, s[8:11], s29 offen offset:2048 sc1
    v_mfma_f32_16x16x32_bf16 v[124:127], v[80:83], a[216:219], v[124:127]
    ds_read_b128 v[76:79], v4 offset:27648
    v_add3_u32 v238, v242, v243, s95
    v_mfma_f32_16x16x32_bf16 v[128:131], v[84:87], a[216:219], v[128:131]
    ds_read_b128 v[80:83], v2 offset:0
    v_add_u32 v239, s96, v2
    v_mfma_f32_16x16x32_bf16 v[132:135], v[88:91], a[216:219], v[132:135]
    ds_read_b128 v[84:87], v2 offset:1024
    s_waitcnt vmcnt(10) lgkmcnt(5)
    v_mfma_f32_16x16x32_bf16 v[116:119], v[92:95], a[220:223], v[116:119]
    ds_read_b128 v[88:91], v2 offset:2048
    buffer_load_dwordx4 a[188:191], v48, s[8:11], s30 offen offset:0 sc1
    v_mfma_f32_16x16x32_bf16 v[120:123], v[96:99], a[220:223], v[120:123]
    ds_read_b128 v[92:95], v2 offset:3072
    v_mul_u32_u24 v243, 40, v27
    v_mfma_f32_16x16x32_bf16 v[124:127], v[100:103], a[220:223], v[124:127]
    ds_read_b128 v[96:99], v2 offset:4096
    buffer_load_dwordx4 a[192:195], v48, s[8:11], s30 offen offset:1024 sc1
    v_mfma_f32_16x16x32_bf16 v[128:131], v[104:107], a[220:223], v[128:131]
    ds_read_b128 v[100:103], v2 offset:5120
    v_add_u32 v243, s96, v243
    v_mfma_f32_16x16x32_bf16 v[132:135], v[108:111], a[220:223], v[132:135]
    ds_read_b128 v[104:107], v2 offset:6144
    s_waitcnt vmcnt(11) lgkmcnt(5)
    s_waitcnt vmcnt(5)
L_fk_ck1:
    v_cmp_ne_u32 vcc, s81, v252
    s_cbranch_vccz L_fk_ok1
    buffer_load_dword v252, v27, s[8:11], s82 offen offset:64 sc1
    s_sub_u32 s80, s80, 1
    s_cbranch_scc1 L_end
    s_waitcnt vmcnt(0)
    s_branch L_fk_ck1
L_fk_ok1:
    s_add_u32 s81, s81, 32
    v_mov_b32 v28, s81
    v_mfma_f32_16x16x32_bf16 v[116:119], v[112:115], a[224:227], v[116:119]
    ds_read_b128 v[108:111], v2 offset:7168
    v_lshrrev_b32 v242, 8, v2
    v_mfma_f32_16x16x32_bf16 v[120:123], v[72:75], a[224:227], v[120:123]
    ds_read_b128 v[112:115], v2 offset:8192
    buffer_load_dwordx4 a[196:199], v48, s[8:11], s30 offen offset:2048 sc1
    v_mfma_f32_16x16x32_bf16 v[124:127], v[76:79], a[224:227], v[124:127]
    ds_read_b128 v[72:75], v2 offset:9216
    v_lshl_add_u32 v240, v242, 4, v243
    v_mfma_f32_16x16x32_bf16 v[128:131], v[80:83], a[224:227], v[128:131]
    ds_read_b128 v[76:79], v2 offset:10240
    v_lshl_add_u32 v241, v242, 3, v243
    v_mfma_f32_16x16x32_bf16 v[132:135], v[84:87], a[224:227], v[132:135]
    ds_read_b128 v[80:83], v2 offset:11264
    s_waitcnt lgkmcnt(5)
    v_mfma_f32_16x16x32_bf16 v[116:119], v[88:91], a[228:231], v[116:119]
    s_barrier
    ds_read_b128 v[84:87], v2 offset:12288
    buffer_load_dwordx4 a[200:203], v48, s[8:11], s31 offen offset:0 sc1
    v_mfma_f32_16x16x32_bf16 v[120:123], v[92:95], a[228:231], v[120:123]
    ds_read_b128 v[88:91], v2 offset:13312
    v_mfma_f32_16x16x32_bf16 v[124:127], v[96:99], a[228:231], v[124:127]
    ds_read_b128 v[92:95], v2 offset:14336
    buffer_load_dwordx4 a[204:207], v48, s[8:11], s31 offen offset:1024 sc1
    v_mfma_f32_16x16x32_bf16 v[128:131], v[100:103], a[228:231], v[128:131]
    ds_read_b128 v[96:99], v2 offset:15360
    v_mfma_f32_16x16x32_bf16 v[132:135], v[104:107], a[228:231], v[132:135]
    ds_read_b128 v[100:103], v2 offset:16384
    s_waitcnt lgkmcnt(5)
    v_mfma_f32_16x16x32_bf16 v[116:119], v[108:111], a[232:235], v[116:119]
    ds_read_b128 v[104:107], v2 offset:17408
    v_mfma_f32_16x16x32_bf16 v[120:123], v[112:115], a[232:235], v[120:123]
    ds_read_b128 v[108:111], v2 offset:18432
    buffer_load_dwordx4 a[208:211], v48, s[8:11], s31 offen offset:2048 sc1
    v_mfma_f32_16x16x32_bf16 v[124:127], v[72:75], a[232:235], v[124:127]
    ds_read_b128 v[112:115], v2 offset:19456
    v_mfma_f32_16x16x32_bf16 v[128:131], v[76:79], a[232:235], v[128:131]
    ds_read_b128 v[72:75], v2 offset:20480
    v_mfma_f32_16x16x32_bf16 v[132:135], v[80:83], a[232:235], v[132:135]
    ds_read_b128 v[76:79], v2 offset:21504
    s_waitcnt lgkmcnt(5)
    v_mfma_f32_16x16x32_bf16 v[116:119], v[84:87], a[236:239], v[116:119]
    ds_read_b128 v[80:83], v2 offset:22528
    buffer_load_dwordx4 a[212:215], v13, s[8:11], s20 offen offset:0 sc1
    v_mfma_f32_16x16x32_bf16 v[120:123], v[88:91], a[236:239], v[120:123]
    ds_read_b128 v[84:87], v2 offset:23552
    v_mfma_f32_16x16x32_bf16 v[124:127], v[92:95], a[236:239], v[124:127]
    ds_read_b128 v[88:91], v2 offset:24576
    buffer_load_dwordx4 a[216:219], v13, s[8:11], s20 offen offset:1024 sc1
    v_mfma_f32_16x16x32_bf16 v[128:131], v[96:99], a[236:239], v[128:131]
    ds_read_b128 v[92:95], v2 offset:25600
    v_mfma_f32_16x16x32_bf16 v[132:135], v[100:103], a[236:239], v[132:135]
    ds_read_b128 v[96:99], v2 offset:26624
    s_waitcnt lgkmcnt(5)
    v_mfma_f32_16x16x32_bf16 v[116:119], v[104:107], a[240:243], v[116:119]
    ds_read_b128 v[100:103], v2 offset:27648
    buffer_load_dwordx4 a[220:223], v13, s[8:11], s20 offen offset:2048 sc1
    v_mfma_f32_16x16x32_bf16 v[120:123], v[108:111], a[240:243], v[120:123]
    ds_read_b128 v[104:107], v2 offset:28672
    v_mfma_f32_16x16x32_bf16 v[124:127], v[112:115], a[240:243], v[124:127]
    ds_read_b128 v[108:111], v2 offset:29696
    v_mfma_f32_16x16x32_bf16 v[128:131], v[72:75], a[240:243], v[128:131]
    ds_read_b128 v[112:115], v2 offset:30720
    v_mfma_f32_16x16x32_bf16 v[132:135], v[76:79], a[240:243], v[132:135]
    ds_read_b128 v[72:75], v2 offset:31744
    s_waitcnt vmcnt(11) lgkmcnt(5)
    v_mfma_f32_16x16x32_bf16 v[116:119], v[80:83], a[244:247], v[116:119]
    ds_read_b128 v[76:79], v2 offset:32768
    buffer_load_dwordx4 a[224:227], v13, s[8:11], s21 offen offset:0 sc1
    v_mfma_f32_16x16x32_bf16 v[120:123], v[84:87], a[244:247], v[120:123]
    ds_read_b128 v[80:83], v2 offset:33792
    v_mfma_f32_16x16x32_bf16 v[124:127], v[88:91], a[244:247], v[124:127]
    ds_read_b128 v[84:87], v2 offset:34816
    buffer_load_dwordx4 a[228:231], v13, s[8:11], s21 offen offset:1024 sc1
    v_mfma_f32_16x16x32_bf16 v[128:131], v[92:95], a[244:247], v[128:131]
    ds_read_b128 v[88:91], v2 offset:35840
    v_mfma_f32_16x16x32_bf16 v[132:135], v[96:99], a[244:247], v[132:135]
    ds_read_b128 v[92:95], v2 offset:36864
    s_waitcnt vmcnt(12) lgkmcnt(5)
    v_mfma_f32_16x16x32_bf16 v[116:119], v[100:103], a[248:251], v[116:119]
    ds_read_b128 v[96:99], v2 offset:37888
    buffer_load_dwordx4 a[232:235], v13, s[8:11], s21 offen offset:2048 sc1
    v_mfma_f32_16x16x32_bf16 v[120:123], v[104:107], a[248:251], v[120:123]
    ds_read_b128 v[100:103], v2 offset:38912
    v_mfma_f32_16x16x32_bf16 v[124:127], v[108:111], a[248:251], v[124:127]
    ds_read_b128 v[104:107], v2 offset:39936
    v_mfma_f32_16x16x32_bf16 v[128:131], v[112:115], a[248:251], v[128:131]
    ds_read_b128 v[108:111], v2 offset:40960
    v_mfma_f32_16x16x32_bf16 v[132:135], v[72:75], a[248:251], v[132:135]
    ds_read_b128 v[112:115], v2 offset:41984
    s_waitcnt vmcnt(12) lgkmcnt(5)
    v_mfma_f32_16x16x32_bf16 v[116:119], v[76:79], a[184:187], v[116:119]
    s_barrier
    ds_read_b128 v[72:75], v2 offset:43008
    buffer_load_dwordx4 a[236:239], v13, s[8:11], s22 offen offset:0 sc1
    v_mfma_f32_16x16x32_bf16 v[120:123], v[80:83], a[184:187], v[120:123]
    ds_read_b128 v[76:79], v2 offset:44032
    v_mfma_f32_16x16x32_bf16 v[124:127], v[84:87], a[184:187], v[124:127]
    ds_read_b128 v[80:83], v2 offset:45056
    buffer_load_dwordx4 a[240:243], v13, s[8:11], s22 offen offset:1024 sc1
    v_mfma_f32_16x16x32_bf16 v[128:131], v[88:91], a[184:187], v[128:131]
    ds_read_b128 v[84:87], v2 offset:46080
    v_mfma_f32_16x16x32_bf16 v[132:135], v[92:95], a[184:187], v[132:135]
    ds_read_b128 v[88:91], v2 offset:47104
    s_waitcnt vmcnt(13) lgkmcnt(5)
    v_mfma_f32_16x16x32_bf16 v[116:119], v[96:99], a[188:191], v[116:119]
    ds_read_b128 v[92:95], v2 offset:48128
    buffer_load_dwordx4 a[244:247], v13, s[8:11], s22 offen offset:2048 sc1
    v_mfma_f32_16x16x32_bf16 v[120:123], v[100:103], a[188:191], v[120:123]
    ds_read_b128 v[96:99], v2 offset:49152
    v_mfma_f32_16x16x32_bf16 v[124:127], v[104:107], a[188:191], v[124:127]
    ds_read_b128 v[100:103], v2 offset:50176
    v_mfma_f32_16x16x32_bf16 v[128:131], v[108:111], a[188:191], v[128:131]
    ds_read_b128 v[104:107], v2 offset:51200
    v_mfma_f32_16x16x32_bf16 v[132:135], v[112:115], a[188:191], v[132:135]
    ds_read_b128 v[108:111], v2 offset:52224
    s_waitcnt vmcnt(13) lgkmcnt(5)
    v_mfma_f32_16x16x32_bf16 v[116:119], v[72:75], a[192:195], v[116:119]
    ds_read_b128 v[112:115], v2 offset:53248
    buffer_load_dwordx4 a[248:251], v13, s[8:11], s23 offen offset:0 sc1
    v_mfma_f32_16x16x32_bf16 v[120:123], v[76:79], a[192:195], v[120:123]
    ds_read_b128 v[72:75], v2 offset:54272
    v_mfma_f32_16x16x32_bf16 v[124:127], v[80:83], a[192:195], v[124:127]
    ds_read_b128 v[76:79], v2 offset:55296
    buffer_load_dwordx4 a[184:187], v13, s[8:11], s23 offen offset:1024 sc1
    v_mfma_f32_16x16x32_bf16 v[128:131], v[84:87], a[192:195], v[128:131]
    ds_read_b128 v[80:83], v2 offset:56320
    v_mfma_f32_16x16x32_bf16 v[132:135], v[88:91], a[192:195], v[132:135]
    ds_read_b128 v[84:87], v2 offset:57344
    s_waitcnt vmcnt(14) lgkmcnt(5)
    v_mfma_f32_16x16x32_bf16 v[116:119], v[92:95], a[196:199], v[116:119]
    ds_read_b128 v[88:91], v2 offset:58368
    buffer_load_dwordx4 a[188:191], v13, s[8:11], s23 offen offset:2048 sc1
    v_mfma_f32_16x16x32_bf16 v[120:123], v[96:99], a[196:199], v[120:123]
    ds_read_b128 v[92:95], v2 offset:59392
    v_mfma_f32_16x16x32_bf16 v[124:127], v[100:103], a[196:199], v[124:127]
    ds_read_b128 v[96:99], v2 offset:60416
    v_mfma_f32_16x16x32_bf16 v[128:131], v[104:107], a[196:199], v[128:131]
    ds_read_b128 v[100:103], v2 offset:61440
    buffer_load_dwordx4 a[192:195], v13, s[8:11], s28 offen offset:0 sc1
    v_mfma_f32_16x16x32_bf16 v[132:135], v[108:111], a[196:199], v[132:135]
    ds_read_b128 v[104:107], v2 offset:62464
    s_waitcnt vmcnt(15) lgkmcnt(5)
    v_mfma_f32_16x16x32_bf16 v[116:119], v[112:115], a[200:203], v[116:119]
    ds_read_b128 v[108:111], v2 offset:63488
    v_mfma_f32_16x16x32_bf16 v[120:123], v[72:75], a[200:203], v[120:123]
    ds_read_b128 v[112:115], v2 offset:64512
    v_mfma_f32_16x16x32_bf16 v[124:127], v[76:79], a[200:203], v[124:127]
    ds_read_b128 v[72:75], v3 offset:0
    buffer_load_dwordx4 a[196:199], v13, s[8:11], s28 offen offset:1024 sc1
    v_mfma_f32_16x16x32_bf16 v[128:131], v[80:83], a[200:203], v[128:131]
    ds_read_b128 v[76:79], v3 offset:1024
    v_mfma_f32_16x16x32_bf16 v[132:135], v[84:87], a[200:203], v[132:135]
    ds_read_b128 v[80:83], v3 offset:2048
    s_waitcnt vmcnt(15) lgkmcnt(5)
    v_mfma_f32_16x16x32_bf16 v[116:119], v[88:91], a[204:207], v[116:119]
    ds_read_b128 v[84:87], v3 offset:39936
    v_mfma_f32_16x16x32_bf16 v[120:123], v[92:95], a[204:207], v[120:123]
    ds_read_b128 v[88:91], v3 offset:40960
    v_mfma_f32_16x16x32_bf16 v[124:127], v[96:99], a[204:207], v[124:127]
    ds_read_b128 v[92:95], v3 offset:41984
    v_mfma_f32_16x16x32_bf16 v[128:131], v[100:103], a[204:207], v[128:131]
    ds_read_b128 v[96:99], v3 offset:43008
    buffer_load_dwordx4 a[200:203], v13, s[8:11], s28 offen offset:2048 sc1
    v_mfma_f32_16x16x32_bf16 v[132:135], v[104:107], a[204:207], v[132:135]
    ds_read_b128 v[100:103], v3 offset:44032
    s_waitcnt vmcnt(15) lgkmcnt(5)
    v_mfma_f32_16x16x32_bf16 v[116:119], v[108:111], a[208:211], v[116:119]
    ds_read_b128 v[104:107], v3 offset:45056
    v_mfma_f32_16x16x32_bf16 v[120:123], v[112:115], a[208:211], v[120:123]
    ds_read_b128 v[108:111], v3 offset:46080
    v_mfma_f32_16x16x32_bf16 v[124:127], v[72:75], a[208:211], v[124:127]
    ds_read_b128 v[112:115], v3 offset:47104
    buffer_load_dwordx4 a[204:207], v13, s[8:11], s29 offen offset:0 sc1
    v_mfma_f32_16x16x32_bf16 v[128:131], v[76:79], a[208:211], v[128:131]
    ds_read_b128 v[72:75], v3 offset:48128
    v_mfma_f32_16x16x32_bf16 v[132:135], v[80:83], a[208:211], v[132:135]
    ds_read_b128 v[76:79], v3 offset:49152
    s_waitcnt vmcnt(15) lgkmcnt(5)
    v_mfma_f32_16x16x32_bf16 v[52:55], v[84:87], a[212:215], v[52:55]
    ds_read_b128 v[80:83], v3 offset:50176
    v_mfma_f32_16x16x32_bf16 v[56:59], v[88:91], a[212:215], v[56:59]
    ds_read_b128 v[84:87], v3 offset:51200
    v_mfma_f32_16x16x32_bf16 v[60:63], v[92:95], a[212:215], v[60:63]
    ds_read_b128 v[88:91], v3 offset:52224
    v_mfma_f32_16x16x32_bf16 v[64:67], v[96:99], a[212:215], v[64:67]
    ds_read_b128 v[92:95], v3 offset:53248
    v_mfma_f32_16x16x32_bf16 v[68:71], v[100:103], a[212:215], v[68:71]
    ds_read_b128 v[96:99], v3 offset:54272
    s_waitcnt vmcnt(14) lgkmcnt(5)
    v_mfma_f32_16x16x32_bf16 v[52:55], v[104:107], a[216:219], v[52:55]
    ds_read_b128 v[100:103], v3 offset:55296
    buffer_load_dwordx4 a[208:211], v13, s[8:11], s29 offen offset:1024 sc1
    v_mfma_f32_16x16x32_bf16 v[56:59], v[108:111], a[216:219], v[56:59]
    ds_read_b128 v[104:107], v3 offset:56320
    v_cvt_pk_bf16_f32 v208, v116, v117
    v_mfma_f32_16x16x32_bf16 v[60:63], v[112:115], a[216:219], v[60:63]
    ds_read_b128 v[108:111], v3 offset:57344
    v_cvt_pk_bf16_f32 v209, v118, v119
    v_mfma_f32_16x16x32_bf16 v[64:67], v[72:75], a[216:219], v[64:67]
    ds_read_b128 v[112:115], v3 offset:58368
    buffer_load_dwordx4 a[212:215], v13, s[8:11], s29 offen offset:2048 sc1
    v_mfma_f32_16x16x32_bf16 v[68:71], v[76:79], a[216:219], v[68:71]
    ds_read_b128 v[72:75], v3 offset:59392
    s_waitcnt vmcnt(15) lgkmcnt(5)
    v_mfma_f32_16x16x32_bf16 v[52:55], v[80:83], a[220:223], v[52:55]
    ds_read_b128 v[76:79], v3 offset:60416
    v_cvt_pk_bf16_f32 v210, v120, v121
    v_mfma_f32_16x16x32_bf16 v[56:59], v[84:87], a[220:223], v[56:59]
    ds_read_b128 v[80:83], v3 offset:61440
    v_cvt_pk_bf16_f32 v211, v122, v123
    v_mfma_f32_16x16x32_bf16 v[60:63], v[88:91], a[220:223], v[60:63]
    ds_read_b128 v[84:87], v3 offset:62464
    buffer_load_dwordx4 a[216:219], v13, s[8:11], s30 offen offset:0 sc1
    v_mfma_f32_16x16x32_bf16 v[64:67], v[92:95], a[220:223], v[64:67]
    ds_read_b128 v[88:91], v3 offset:63488
    v_cvt_pk_bf16_f32 v212, v124, v125
    v_mfma_f32_16x16x32_bf16 v[68:71], v[96:99], a[220:223], v[68:71]
    ds_read_b128 v[92:95], v3 offset:64512
    s_waitcnt vmcnt(15) lgkmcnt(5)
    s_nop 0
    v_cvt_pk_bf16_f32 v213, v126, v127
    v_cvt_pk_bf16_f32 v214, v128, v129
    v_cvt_pk_bf16_f32 v215, v130, v131
    v_cvt_pk_bf16_f32 v216, v132, v133
    v_cvt_pk_bf16_f32 v217, v134, v135
    v_mfma_f32_16x16x32_bf16 v[52:55], v[100:103], a[224:227], v[52:55]
    ds_read_b128 v[96:99], v4 offset:0
    v_mfma_f32_16x16x32_bf16 v[56:59], v[104:107], a[224:227], v[56:59]
    ds_read_b128 v[100:103], v4 offset:1024
    s_cmp_eq_u32 s76, 0
    s_cbranch_scc0 L_st_96_s
    buffer_store_dwordx4 v[208:211], v220, s[48:51], 0 offen nt
L_st_96_e:
    v_mfma_f32_16x16x32_bf16 v[60:63], v[108:111], a[224:227], v[60:63]
    ds_read_b128 v[104:107], v4 offset:2048
    v_mfma_f32_16x16x32_bf16 v[64:67], v[112:115], a[224:227], v[64:67]
    ds_read_b128 v[108:111], v4 offset:3072
    v_mfma_f32_16x16x32_bf16 v[68:71], v[72:75], a[224:227], v[68:71]
    ds_read_b128 v[112:115], v4 offset:4096
    s_waitcnt vmcnt(15) lgkmcnt(5)
    v_mfma_f32_16x16x32_bf16 v[52:55], v[76:79], a[228:231], v[52:55]
    ds_read_b128 v[72:75], v4 offset:5120
    s_cmp_eq_u32 s76, 0
    s_cbranch_scc0 L_st_97_s
    buffer_store_dwordx4 v[212:215], v220, s[48:51], 0 offen offset:2048 nt
L_st_97_e:
    v_mfma_f32_16x16x32_bf16 v[56:59], v[80:83], a[228:231], v[56:59]
    ds_read_b128 v[76:79], v4 offset:6144
    v_mfma_f32_16x16x32_bf16 v[60:63], v[84:87], a[228:231], v[60:63]
    ds_read_b128 v[80:83], v4 offset:7168
    v_mfma_f32_16x16x32_bf16 v[64:67], v[88:91], a[228:231], v[64:67]
    ds_read_b128 v[84:87], v4 offset:8192
    v_mfma_f32_16x16x32_bf16 v[68:71], v[92:95], a[228:231], v[68:71]
    ds_read_b128 v[88:91], v4 offset:9216
    s_waitcnt vmcnt(15) lgkmcnt(5)
    v_mfma_f32_16x16x32_bf16 v[52:55], v[96:99], a[232:235], v[52:55]
    ds_read_b128 v[92:95], v4 offset:10240
    s_cmp_eq_u32 s76, 0
    s_cbranch_scc0 L_st_98_s
    buffer_store_dwordx2 v[216:217], v221, s[48:51], 0 offen nt
L_st_98_e:
    v_mfma_f32_16x16x32_bf16 v[56:59], v[100:103], a[232:235], v[56:59]
    ds_read_b128 v[96:99], v4 offset:11264
    v_mfma_f32_16x16x32_bf16 v[60:63], v[104:107], a[232:235], v[60:63]
    ds_read_b128 v[100:103], v4 offset:12288
    v_mfma_f32_16x16x32_bf16 v[64:67], v[108:111], a[232:235], v[64:67]
    ds_read_b128 v[104:107], v4 offset:13312
    buffer_load_dwordx4 a[220:223], v13, s[8:11], s30 offen offset:1024 sc1
    v_mfma_f32_16x16x32_bf16 v[68:71], v[112:115], a[232:235], v[68:71]
    ds_read_b128 v[108:111], v4 offset:14336
    s_waitcnt vmcnt(16) lgkmcnt(5)
    v_mfma_f32_16x16x32_bf16 v[52:55], v[72:75], a[236:239], v[52:55]
    ds_read_b128 v[112:115], v4 offset:15360
    v_mfma_f32_16x16x32_bf16 v[56:59], v[76:79], a[236:239], v[56:59]
    ds_read_b128 v[72:75], v4 offset:16384
    v_mfma_f32_16x16x32_bf16 v[60:63], v[80:83], a[236:239], v[60:63]
    ds_read_b128 v[76:79], v4 offset:17408
    buffer_load_dwordx4 a[224:227], v13, s[8:11], s30 offen offset:2048 sc1
    v_mfma_f32_16x16x32_bf16 v[64:67], v[84:87], a[236:239], v[64:67]
    ds_read_b128 v[80:83], v4 offset:18432
    v_mfma_f32_16x16x32_bf16 v[68:71], v[88:91], a[236:239], v[68:71]
    ds_read_b128 v[84:87], v4 offset:19456
    s_waitcnt vmcnt(16) lgkmcnt(5)
    v_mfma_f32_16x16x32_bf16 v[52:55], v[92:95], a[240:243], v[52:55]
    ds_read_b128 v[88:91], v4 offset:20480
    v_mfma_f32_16x16x32_bf16 v[56:59], v[96:99], a[240:243], v[56:59]
    ds_read_b128 v[92:95], v4 offset:21504
    buffer_load_dwordx4 a[228:231], v13, s[8:11], s31 offen offset:0 sc1
    v_mfma_f32_16x16x32_bf16 v[60:63], v[100:103], a[240:243], v[60:63]
    ds_read_b128 v[96:99], v4 offset:22528
    v_mfma_f32_16x16x32_bf16 v[64:67], v[104:107], a[240:243], v[64:67]
    ds_read_b128 v[100:103], v4 offset:23552
    v_mfma_f32_16x16x32_bf16 v[68:71], v[108:111], a[240:243], v[68:71]
    ds_read_b128 v[104:107], v4 offset:24576
    s_waitcnt vmcnt(16) lgkmcnt(5)
    v_mfma_f32_16x16x32_bf16 v[52:55], v[112:115], a[244:247], v[52:55]
    ds_read_b128 v[108:111], v4 offset:25600
    buffer_load_dwordx4 a[232:235], v13, s[8:11], s31 offen offset:1024 sc1
    v_mfma_f32_16x16x32_bf16 v[56:59], v[72:75], a[244:247], v[56:59]
    ds_read_b128 v[112:115], v4 offset:26624
    v_mfma_f32_16x16x32_bf16 v[60:63], v[76:79], a[244:247], v[60:63]
    ds_read_b128 v[72:75], v4 offset:27648
    v_mfma_f32_16x16x32_bf16 v[64:67], v[80:83], a[244:247], v[64:67]
    ds_read_b128 v[76:79], v2 offset:0
    v_mfma_f32_16x16x32_bf16 v[68:71], v[84:87], a[244:247], v[68:71]
L_pad14:
    s_cbranch_execz L_pad18
    ds_read_b128 v[80:83], v2 offset:1024
    s_waitcnt vmcnt(16) lgkmcnt(5)
    v_mfma_f32_16x16x32_bf16 v[52:55], v[88:91], a[248:251], v[52:55]
    ds_read_b128 v[84:87], v2 offset:2048
    buffer_load_dwordx4 a[236:239], v13, s[8:11], s31 offen offset:2048 sc1
    v_mfma_f32_16x16x32_bf16 v[56:59], v[92:95], a[248:251], v[56:59]
    ds_read_b128 v[88:91], v2 offset:3072
    v_mfma_f32_16x16x32_bf16 v[60:63], v[96:99], a[248:251], v[60:63]
    ds_read_b128 v[92:95], v2 offset:4096
    v_mfma_f32_16x16x32_bf16 v[64:67], v[100:103], a[248:251], v[64:67]
    ds_read_b128 v[96:99], v2 offset:5120
    v_mfma_f32_16x16x32_bf16 v[68:71], v[104:107], a[248:251], v[68:71]
    ds_read_b128 v[100:103], v2 offset:6144
    s_waitcnt vmcnt(16) lgkmcnt(5)
    v_mfma_f32_16x16x32_bf16 v[52:55], v[108:111], a[184:187], v[52:55]
    ds_read_b128 v[104:107], v2 offset:7168
    v_mfma_f32_16x16x32_bf16 v[56:59], v[112:115], a[184:187], v[56:59]
    ds_read_b128 v[108:111], v2 offset:8192
    v_mfma_f32_16x16x32_bf16 v[60:63], v[72:75], a[184:187], v[60:63]
    ds_read_b128 v[112:115], v2 offset:9216
    v_mfma_f32_16x16x32_bf16 v[64:67], v[76:79], a[184:187], v[64:67]
    ds_read_b128 v[72:75], v2 offset:10240
    v_mfma_f32_16x16x32_bf16 v[68:71], v[80:83], a[184:187], v[68:71]
    ds_read_b128 v[76:79], v2 offset:11264
    s_waitcnt vmcnt(15) lgkmcnt(5)
    s_waitcnt vmcnt(5)
    s_mov_b64 exec, 1
    s_cmp_eq_u32 s76, 0
    s_cbranch_scc0 L_st_99_s
    buffer_store_dword v28, off, s[48:51], s85 offset:128 nt
L_st_99_e:
    s_mov_b64 exec, -1
    v_mfma_f32_16x16x32_bf16 v[52:55], v[84:87], a[188:191], v[52:55]
    ds_read_b128 v[80:83], v2 offset:12288
    v_mfma_f32_16x16x32_bf16 v[56:59], v[88:91], a[188:191], v[56:59]
    ds_read_b128 v[84:87], v2 offset:13312
    v_mfma_f32_16x16x32_bf16 v[60:63], v[92:95], a[188:191], v[60:63]
    ds_read_b128 v[88:91], v2 offset:14336
    v_mfma_f32_16x16x32_bf16 v[64:67], v[96:99], a[188:191], v[64:67]
    ds_read_b128 v[92:95], v2 offset:15360
    v_mfma_f32_16x16x32_bf16 v[68:71], v[100:103], a[188:191], v[68:71]
    ds_read_b128 v[96:99], v2 offset:16384
    s_waitcnt lgkmcnt(5)
    v_mfma_f32_16x16x32_bf16 v[52:55], v[104:107], a[192:195], v[52:55]
    ds_read_b128 v[100:103], v2 offset:17408
    v_mfma_f32_16x16x32_bf16 v[56:59], v[108:111], a[192:195], v[56:59]
    ds_read_b128 v[104:107], v2 offset:18432
    v_mfma_f32_16x16x32_bf16 v[60:63], v[112:115], a[192:195], v[60:63]
    ds_read_b128 v[108:111], v2 offset:19456
    v_mfma_f32_16x16x32_bf16 v[64:67], v[72:75], a[192:195], v[64:67]
    ds_read_b128 v[112:115], v2 offset:20480
    v_mfma_f32_16x16x32_bf16 v[68:71], v[76:79], a[192:195], v[68:71]
    ds_read_b128 v[72:75], v2 offset:21504
    s_waitcnt lgkmcnt(5)
    v_mfma_f32_16x16x32_bf16 v[52:55], v[80:83], a[196:199], v[52:55]
    ds_read_b128 v[76:79], v2 offset:22528
    v_mfma_f32_16x16x32_bf16 v[56:59], v[84:87], a[196:199], v[56:59]
    ds_read_b128 v[80:83], v2 offset:23552
    v_mfma_f32_16x16x32_bf16 v[60:63], v[88:91], a[196:199], v[60:63]
    ds_read_b128 v[84:87], v2 offset:24576
    v_mfma_f32_16x16x32_bf16 v[64:67], v[92:95], a[196:199], v[64:67]
    ds_read_b128 v[88:91], v2 offset:25600
    buffer_load_dword v222, off, s[48:51], s97 offset:128 sc1
    v_mfma_f32_16x16x32_bf16 v[68:71], v[96:99], a[196:199], v[68:71]
    ds_read_b128 v[92:95], v2 offset:26624
    s_waitcnt lgkmcnt(5)
    v_mfma_f32_16x16x32_bf16 v[52:55], v[100:103], a[200:203], v[52:55]
    ds_read_b128 v[96:99], v2 offset:27648
    v_mfma_f32_16x16x32_bf16 v[56:59], v[104:107], a[200:203], v[56:59]
    ds_read_b128 v[100:103], v2 offset:28672
    v_mfma_f32_16x16x32_bf16 v[60:63], v[108:111], a[200:203], v[60:63]
    ds_read_b128 v[104:107], v2 offset:29696
    v_mfma_f32_16x16x32_bf16 v[64:67], v[112:115], a[200:203], v[64:67]
    ds_read_b128 v[108:111], v2 offset:30720
    v_mfma_f32_16x16x32_bf16 v[68:71], v[72:75], a[200:203], v[68:71]
    ds_read_b128 v[112:115], v2 offset:31744
    s_waitcnt lgkmcnt(5)
    v_mfma_f32_16x16x32_bf16 v[52:55], v[76:79], a[204:207], v[52:55]
    ds_read_b128 v[72:75], v2 offset:32768
    v_mfma_f32_16x16x32_bf16 v[56:59], v[80:83], a[204:207], v[56:59]
    ds_read_b128 v[76:79], v2 offset:33792
    v_mfma_f32_16x16x32_bf16 v[60:63], v[84:87], a[204:207], v[60:63]
    ds_read_b128 v[80:83], v2 offset:34816
    v_mfma_f32_16x16x32_bf16 v[64:67], v[88:91], a[204:207], v[64:67]
    ds_read_b128 v[84:87], v2 offset:35840
    v_mfma_f32_16x16x32_bf16 v[68:71], v[92:95], a[204:207], v[68:71]
    ds_read_b128 v[88:91], v2 offset:36864
    s_waitcnt lgkmcnt(5)
    s_waitcnt vmcnt(0)
L_gx_ck1:
    v_cmp_ne_u32 vcc, s81, v222
    s_cbranch_vccz L_gx_ok1
    buffer_load_dword v222, off, s[48:51], s97 offset:128 sc1
    s_sub_u32 s80, s80, 1
    s_cbranch_scc1 L_end
    s_waitcnt vmcnt(0)
    s_branch L_gx_ck1
L_gx_ok1:
    v_mfma_f32_16x16x32_bf16 v[52:55], v[96:99], a[208:211], v[52:55]
    ds_read_b128 v[92:95], v2 offset:37888
    v_mfma_f32_16x16x32_bf16 v[56:59], v[100:103], a[208:211], v[56:59]
    ds_read_b128 v[96:99], v2 offset:38912
    v_mfma_f32_16x16x32_bf16 v[60:63], v[104:107], a[208:211], v[60:63]
    ds_read_b128 v[100:103], v2 offset:39936
    v_mfma_f32_16x16x32_bf16 v[64:67], v[108:111], a[208:211], v[64:67]
    ds_read_b128 v[104:107], v2 offset:40960
    v_mfma_f32_16x16x32_bf16 v[68:71], v[112:115], a[208:211], v[68:71]
    ds_read_b128 v[108:111], v2 offset:41984
    s_waitcnt lgkmcnt(5)
    v_mfma_f32_16x16x32_bf16 v[52:55], v[72:75], a[212:215], v[52:55]
    ds_read_b128 v[112:115], v2 offset:43008
    buffer_load_dwordx4 v[224:227], v14, s[48:51], 0 offen sc1
    v_mfma_f32_16x16x32_bf16 v[56:59], v[76:79], a[212:215], v[56:59]
    ds_read_b128 v[72:75], v2 offset:44032
    v_mfma_f32_16x16x32_bf16 v[60:63], v[80:83], a[212:215], v[60:63]
    ds_read_b128 v[76:79], v2 offset:45056
    v_mfma_f32_16x16x32_bf16 v[64:67], v[84:87], a[212:215], v[64:67]
    ds_read_b128 v[80:83], v2 offset:46080
    buffer_load_dwordx4 v[228:231], v14, s[48:51], 0 offen offset:2048 sc1
    v_mfma_f32_16x16x32_bf16 v[68:71], v[88:91], a[212:215], v[68:71]
    ds_read_b128 v[84:87], v2 offset:47104
    s_waitcnt lgkmcnt(5)
    v_mfma_f32_16x16x32_bf16 v[52:55], v[92:95], a[216:219], v[52:55]
    ds_read_b128 v[88:91], v2 offset:48128
    v_mfma_f32_16x16x32_bf16 v[56:59], v[96:99], a[216:219], v[56:59]
    ds_read_b128 v[92:95], v2 offset:49152
    v_mfma_f32_16x16x32_bf16 v[60:63], v[100:103], a[216:219], v[60:63]
    ds_read_b128 v[96:99], v2 offset:50176
    buffer_load_dwordx2 v[232:233], v15, s[48:51], 0 offen sc1
    v_mfma_f32_16x16x32_bf16 v[64:67], v[104:107], a[216:219], v[64:67]
    ds_read_b128 v[100:103], v2 offset:51200
    v_mfma_f32_16x16x32_bf16 v[68:71], v[108:111], a[216:219], v[68:71]
    ds_read_b128 v[104:107], v2 offset:52224
    s_waitcnt lgkmcnt(5)
    v_mfma_f32_16x16x32_bf16 v[52:55], v[112:115], a[220:223], v[52:55]
    ds_read_b128 v[108:111], v2 offset:53248
    v_mfma_f32_16x16x32_bf16 v[56:59], v[72:75], a[220:223], v[56:59]
    ds_read_b128 v[112:115], v2 offset:54272
    v_mfma_f32_16x16x32_bf16 v[60:63], v[76:79], a[220:223], v[60:63]
    ds_read_b128 v[72:75], v2 offset:55296
    v_mfma_f32_16x16x32_bf16 v[64:67], v[80:83], a[220:223], v[64:67]
    ds_read_b128 v[76:79], v2 offset:56320
    v_mfma_f32_16x16x32_bf16 v[68:71], v[84:87], a[220:223], v[68:71]
    ds_read_b128 v[80:83], v2 offset:57344
    s_waitcnt lgkmcnt(5)
    v_mfma_f32_16x16x32_bf16 v[52:55], v[88:91], a[224:227], v[52:55]
    ds_read_b128 v[84:87], v2 offset:58368
    v_mfma_f32_16x16x32_bf16 v[56:59], v[92:95], a[224:227], v[56:59]
    ds_read_b128 v[88:91], v2 offset:59392
    v_mfma_f32_16x16x32_bf16 v[60:63], v[96:99], a[224:227], v[60:63]
    ds_read_b128 v[92:95], v2 offset:60416
    v_mfma_f32_16x16x32_bf16 v[64:67], v[100:103], a[224:227], v[64:67]
    ds_read_b128 v[96:99], v2 offset:61440
    v_mfma_f32_16x16x32_bf16 v[68:71], v[104:107], a[224:227], v[68:71]
    ds_read_b128 v[100:103], v2 offset:62464
    s_waitcnt lgkmcnt(5)
    v_mfma_f32_16x16x32_bf16 v[52:55], v[108:111], a[228:231], v[52:55]
    ds_read_b128 v[104:107], v2 offset:63488
    v_mfma_f32_16x16x32_bf16 v[56:59], v[112:115], a[228:231], v[56:59]
    ds_read_b128 v[108:111], v2 offset:64512
    v_mfma_f32_16x16x32_bf16 v[60:63], v[72:75], a[228:231], v[60:63]
    ds_read_b128 v[112:115], v3 offset:0
    v_mfma_f32_16x16x32_bf16 v[64:67], v[76:79], a[228:231], v[64:67]
    ds_read_b128 v[72:75], v3 offset:1024
    v_mfma_f32_16x16x32_bf16 v[68:71], v[80:83], a[228:231], v[68:71]
    ds_read_b128 v[76:79], v3 offset:2048
    s_waitcnt lgkmcnt(5)
    v_mfma_f32_16x16x32_bf16 v[52:55], v[84:87], a[232:235], v[52:55]
    s_waitcnt vmcnt(0)
    v_lshlrev_b32 v136, 16, v224
    v_mfma_f32_16x16x32_bf16 v[56:59], v[88:91], a[232:235], v[56:59]
    v_and_b32 v137, 0xffff0000, v224
    v_lshlrev_b32 v138, 16, v225
    v_mfma_f32_16x16x32_bf16 v[60:63], v[92:95], a[232:235], v[60:63]
    v_and_b32 v139, 0xffff0000, v225
    v_lshlrev_b32 v140, 16, v226
    v_mfma_f32_16x16x32_bf16 v[64:67], v[96:99], a[232:235], v[64:67]
    v_and_b32 v141, 0xffff0000, v226
    v_lshlrev_b32 v142, 16, v227
    v_mfma_f32_16x16x32_bf16 v[68:71], v[100:103], a[232:235], v[68:71]
    v_and_b32 v143, 0xffff0000, v227
    s_waitcnt lgkmcnt(0)
    v_mfma_f32_16x16x32_bf16 v[52:55], v[104:107], a[236:239], v[52:55]
    v_lshlrev_b32 v144, 16, v228
    v_and_b32 v145, 0xffff0000, v228
    v_mfma_f32_16x16x32_bf16 v[56:59], v[108:111], a[236:239], v[56:59]
    v_lshlrev_b32 v146, 16, v229
    v_and_b32 v147, 0xffff0000, v229
    v_mfma_f32_16x16x32_bf16 v[60:63], v[112:115], a[236:239], v[60:63]
    v_lshlrev_b32 v148, 16, v230
    v_and_b32 v149, 0xffff0000, v230
    v_mfma_f32_16x16x32_bf16 v[64:67], v[72:75], a[236:239], v[64:67]
    v_lshlrev_b32 v150, 16, v231
    v_and_b32 v151, 0xffff0000, v231
    v_mfma_f32_16x16x32_bf16 v[68:71], v[76:79], a[236:239], v[68:71]
    v_lshlrev_b32 v152, 16, v232
    v_and_b32 v153, 0xffff0000, v232
    v_lshlrev_b32 v154, 16, v233
    v_and_b32 v155, 0xffff0000, v233
    v_pk_add_f32 v[52:53], v[52:53], v[136:137]
    v_pk_add_f32 v[54:55], v[54:55], v[138:139]
    v_pk_add_f32 v[56:57], v[56:57], v[140:141]
    v_pk_add_f32 v[58:59], v[58:59], v[142:143]
    v_pk_add_f32 v[60:61], v[60:61], v[144:145]
    v_pk_add_f32 v[62:63], v[62:63], v[146:147]
    v_pk_add_f32 v[64:65], v[64:65], v[148:149]
    v_pk_add_f32 v[66:67], v[66:67], v[150:151]
    v_pk_add_f32 v[68:69], v[68:69], v[152:153]
    v_pk_add_f32 v[70:71], v[70:71], v[154:155]
L_p51:
L_final:
    v_cvt_pk_bf16_f32 v208, v52, v53
    v_cvt_pk_bf16_f32 v209, v54, v55
    v_cvt_pk_bf16_f32 v210, v56, v57
    v_cvt_pk_bf16_f32 v211, v58, v59
    ds_write_b128 v240, v[208:211]
    v_cvt_pk_bf16_f32 v212, v60, v61
    v_cvt_pk_bf16_f32 v213, v62, v63
    v_cvt_pk_bf16_f32 v214, v64, v65
    v_cvt_pk_bf16_f32 v215, v66, v67
    v_cvt_pk_bf16_f32 v216, v68, v69
    v_cvt_pk_bf16_f32 v217, v70, v71
    ds_write_b128 v240, v[212:215] offset:64
    ds_write_b64 v241, v[216:217] offset:128
    ds_read_b128 v[136:139], v239 offset:0
    ds_read_b128 v[140:143], v239 offset:1024
    ds_read_b128 v[144:147], v239 offset:2048
    s_waitcnt lgkmcnt(2)
    buffer_store_dwordx4 v[136:139], v236, s[16:19], 0 offen nt
    s_waitcnt lgkmcnt(1)
    buffer_store_dwordx4 v[140:143], v237, s[16:19], 0 offen nt
    s_mov_b32 exec_hi, 0
    s_waitcnt lgkmcnt(0)
    buffer_store_dwordx4 v[144:147], v238, s[16:19], 0 offen nt
    s_mov_b64 exec, -1
    s_or_b32 s95, s2, s73
    s_cmp_eq_u32 s95, 0
    s_cbranch_scc0 L_ow_104
    s_mov_b64 exec, 1
    buffer_store_dword v29, off, s[4:7], 0
    s_mov_b64 exec, -1
L_ow_104:
L_end:
    s_endpgm
L_p0_more:
    s_sleep 4
    buffer_load_dword v206, v27, s[4:7], s87 offen sc1
    s_sub_u32 s80, s80, 1
    s_cbranch_scc1 L_end
    s_waitcnt vmcnt(0)
    s_branch L_p0_ck
L_xf_more:
    v_cmp_lt_u32 vcc, 15, v205
    s_cbranch_vccz L_xf_slow
    s_sleep 8
    buffer_load_dword v205, v27, s[4:7], s97 offen sc1
    s_sub_u32 s80, s80, 1
    s_cbranch_scc1 L_end
    s_waitcnt vmcnt(0)
    s_branch L_xf_ck
L_xf_slow:
    s_mov_b32 s76, 1
    s_mov_b32 s81, s72
    v_mov_b32 v28, s72
    s_mov_b32 s56, 0xa00000
    s_add_u32 s48, s48, 0xa00000
    s_addc_u32 s49, s49, 0
    s_mov_b32 s54, 0
    s_branch L_xf_ok
L_pre_more:
    s_sleep 4
    buffer_load_dword v200, v204, s[4:7], 0 offen sc1
    s_sub_u32 s80, s80, 1
    s_cbranch_scc1 L_end
    s_waitcnt vmcnt(0)
    s_branch L_pre_ck
L_kv_10_r:
    s_xor_b32 s95, s96, 0x0
    buffer_load_dwordx4 v[232:235], v35, s[4:7], s95 offen sc1
    s_bitset1_b32 s97, 0
    s_branch L_kv_10
L_kv_11_r:
    s_xor_b32 s95, s96, 0x1000
    buffer_load_dwordx4 v[236:239], v35, s[4:7], s95 offen sc1
    s_bitset1_b32 s97, 1
    s_branch L_kv_11
L_kv_12_r:
    s_xor_b32 s95, s96, 0x2000
    buffer_load_dwordx4 v[240:243], v35, s[4:7], s95 offen sc1
    s_bitset1_b32 s97, 2
    s_branch L_kv_12
L_kv_13_r:
    s_xor_b32 s95, s96, 0x3000
    buffer_load_dwordx4 v[92:95], v35, s[4:7], s95 offen sc1
    s_bitset1_b32 s97, 3
    s_branch L_kv_13
L_kv_14_r:
    s_xor_b32 s95, s96, 0x4000
    buffer_load_dwordx4 v[96:99], v35, s[4:7], s95 offen sc1
    s_bitset1_b32 s97, 4
    s_branch L_kv_14
L_kv_15_r:
    s_xor_b32 s95, s96, 0x5000
    buffer_load_dwordx4 v[100:103], v35, s[4:7], s95 offen sc1
    s_bitset1_b32 s97, 5
    s_branch L_kv_15
L_kv_16_r:
    s_xor_b32 s95, s96, 0x6000
    buffer_load_dwordx4 v[120:123], v35, s[4:7], s95 offen sc1
    s_bitset1_b32 s97, 6
    s_branch L_kv_16
L_kv_17_r:
    s_xor_b32 s95, s96, 0x7000
    buffer_load_dwordx4 v[124:127], v35, s[4:7], s95 offen sc1
    s_bitset1_b32 s97, 7
    s_branch L_kv_17
L_kv_18_r:
    s_xor_b32 s95, s96, 0x8000
    buffer_load_dwordx4 v[132:135], v35, s[4:7], s95 offen sc1
    s_bitset1_b32 s97, 8
    s_branch L_kv_18
L_kv_19_r:
    s_xor_b32 s95, s96, 0x9000
    buffer_load_dwordx4 v[104:107], v35, s[4:7], s95 offen sc1
    s_bitset1_b32 s97, 9
    s_branch L_kv_19
L_kv_20_r:
    s_xor_b32 s95, s96, 0xa000
    buffer_load_dwordx4 v[108:111], v35, s[4:7], s95 offen sc1
    s_bitset1_b32 s97, 10
    s_branch L_kv_20
L_kv_21_r:
    s_xor_b32 s95, s96, 0xb000
    buffer_load_dwordx4 v[112:115], v35, s[4:7], s95 offen sc1
    s_bitset1_b32 s97, 11
    s_branch L_kv_21
L_kv_22_r:
    s_xor_b32 s95, s96, 0xc000
    buffer_load_dwordx4 v[116:119], v35, s[4:7], s95 offen sc1
    s_bitset1_b32 s97, 12
    s_branch L_kv_22
L_kv_23_r:
    s_xor_b32 s95, s96, 0xd000
    buffer_load_dwordx4 v[128:131], v35, s[4:7], s95 offen sc1
    s_bitset1_b32 s97, 13
    s_branch L_kv_23
L_kv_24_r:
    s_xor_b32 s95, s96, 0xe000
    buffer_load_dwordx4 v[224:227], v35, s[4:7], s95 offen sc1
    s_bitset1_b32 s97, 14
    s_branch L_kv_24
L_kv_25_r:
    s_xor_b32 s95, s96, 0xf000
    buffer_load_dwordx4 v[228:231], v35, s[4:7], s95 offen sc1
    s_bitset1_b32 s97, 15
    s_branch L_kv_25
L_kv_late0:
    s_sub_u32 s80, s80, 1
    s_cbranch_scc1 L_end
    s_waitcnt vmcnt(0)
    s_bitcmp1_b32 s97, 0
    s_cbranch_scc0 L_kvl0_0
    v_max3_u32 v220, v232, v233, v234
    v_max_u32 v220, v220, v235
    v_cmp_eq_u32 vcc, -1, v220
    s_cbranch_vccnz L_kvl0_0r
    v_mfma_f32_32x32x16_bf16 v[136:151], v[248:251], v[232:235], v[136:151]
    s_bitset0_b32 s97, 0
L_kvl0_0:
    s_bitcmp1_b32 s97, 1
    s_cbranch_scc0 L_kvl0_1
    v_max3_u32 v220, v236, v237, v238
    v_max_u32 v220, v220, v239
    v_cmp_eq_u32 vcc, -1, v220
    s_cbranch_vccnz L_kvl0_1r
    v_mfma_f32_32x32x16_bf16 v[136:151], v[248:251], v[236:239], v[136:151]
    s_bitset0_b32 s97, 1
L_kvl0_1:
    s_bitcmp1_b32 s97, 2
    s_cbranch_scc0 L_kvl0_2
    v_max3_u32 v220, v240, v241, v242
    v_max_u32 v220, v220, v243
    v_cmp_eq_u32 vcc, -1, v220
    s_cbranch_vccnz L_kvl0_2r
    v_mfma_f32_32x32x16_bf16 v[136:151], v[248:251], v[240:243], v[136:151]
    s_bitset0_b32 s97, 2
L_kvl0_2:
    s_bitcmp1_b32 s97, 3
    s_cbranch_scc0 L_kvl0_3
    v_max3_u32 v220, v92, v93, v94
    v_max_u32 v220, v220, v95
    v_cmp_eq_u32 vcc, -1, v220
    s_cbranch_vccnz L_kvl0_3r
    v_mfma_f32_32x32x16_bf16 v[136:151], v[248:251], v[92:95], v[136:151]
    s_bitset0_b32 s97, 3
L_kvl0_3:
    s_bitcmp1_b32 s97, 4
    s_cbranch_scc0 L_kvl0_4
    v_max3_u32 v220, v96, v97, v98
    v_max_u32 v220, v220, v99
    v_cmp_eq_u32 vcc, -1, v220
    s_cbranch_vccnz L_kvl0_4r
    v_mfma_f32_32x32x16_bf16 v[136:151], v[248:251], v[96:99], v[136:151]
    s_bitset0_b32 s97, 4
L_kvl0_4:
    s_bitcmp1_b32 s97, 5
    s_cbranch_scc0 L_kvl0_5
    v_max3_u32 v220, v100, v101, v102
    v_max_u32 v220, v220, v103
    v_cmp_eq_u32 vcc, -1, v220
    s_cbranch_vccnz L_kvl0_5r
    v_mfma_f32_32x32x16_bf16 v[136:151], v[248:251], v[100:103], v[136:151]
    s_bitset0_b32 s97, 5
L_kvl0_5:
    s_bitcmp1_b32 s97, 6
    s_cbranch_scc0 L_kvl0_6
    v_max3_u32 v220, v120, v121, v122
    v_max_u32 v220, v220, v123
    v_cmp_eq_u32 vcc, -1, v220
    s_cbranch_vccnz L_kvl0_6r
    v_mfma_f32_32x32x16_bf16 v[136:151], v[248:251], v[120:123], v[136:151]
    s_bitset0_b32 s97, 6
L_kvl0_6:
    s_bitcmp1_b32 s97, 7
    s_cbranch_scc0 L_kvl0_7
    v_max3_u32 v220, v124, v125, v126
    v_max_u32 v220, v220, v127
    v_cmp_eq_u32 vcc, -1, v220
    s_cbranch_vccnz L_kvl0_7r
    v_mfma_f32_32x32x16_bf16 v[136:151], v[248:251], v[124:127], v[136:151]
    s_bitset0_b32 s97, 7
L_kvl0_7:
    s_bitcmp1_b32 s97, 8
    s_cbranch_scc0 L_kvl0_8
    v_max3_u32 v220, v132, v133, v134
    v_max_u32 v220, v220, v135
    v_cmp_eq_u32 vcc, -1, v220
    s_cbranch_vccnz L_kvl0_8r
    v_mfma_f32_32x32x16_bf16 v[136:151], v[248:251], v[132:135], v[136:151]
    s_bitset0_b32 s97, 8
L_kvl0_8:
    s_bitcmp1_b32 s97, 9
    s_cbranch_scc0 L_kvl0_9
    v_max3_u32 v220, v104, v105, v106
    v_max_u32 v220, v220, v107
    v_cmp_eq_u32 vcc, -1, v220
    s_cbranch_vccnz L_kvl0_9r
    v_mfma_f32_32x32x16_bf16 v[136:151], v[248:251], v[104:107], v[136:151]
    s_bitset0_b32 s97, 9
L_kvl0_9:
    s_bitcmp1_b32 s97, 10
    s_cbranch_scc0 L_kvl0_10
    v_max3_u32 v220, v108, v109, v110
    v_max_u32 v220, v220, v111
    v_cmp_eq_u32 vcc, -1, v220
    s_cbranch_vccnz L_kvl0_10r
    v_mfma_f32_32x32x16_bf16 v[136:151], v[248:251], v[108:111], v[136:151]
    s_bitset0_b32 s97, 10
L_kvl0_10:
    s_bitcmp1_b32 s97, 11
    s_cbranch_scc0 L_kvl0_11
    v_max3_u32 v220, v112, v113, v114
    v_max_u32 v220, v220, v115
    v_cmp_eq_u32 vcc, -1, v220
    s_cbranch_vccnz L_kvl0_11r
    v_mfma_f32_32x32x16_bf16 v[136:151], v[248:251], v[112:115], v[136:151]
    s_bitset0_b32 s97, 11
L_kvl0_11:
    s_bitcmp1_b32 s97, 12
    s_cbranch_scc0 L_kvl0_12
    v_max3_u32 v220, v116, v117, v118
    v_max_u32 v220, v220, v119
    v_cmp_eq_u32 vcc, -1, v220
    s_cbranch_vccnz L_kvl0_12r
    v_mfma_f32_32x32x16_bf16 v[136:151], v[248:251], v[116:119], v[136:151]
    s_bitset0_b32 s97, 12
L_kvl0_12:
    s_bitcmp1_b32 s97, 13
    s_cbranch_scc0 L_kvl0_13
    v_max3_u32 v220, v128, v129, v130
    v_max_u32 v220, v220, v131
    v_cmp_eq_u32 vcc, -1, v220
    s_cbranch_vccnz L_kvl0_13r
    v_mfma_f32_32x32x16_bf16 v[136:151], v[248:251], v[128:131], v[136:151]
    s_bitset0_b32 s97, 13
L_kvl0_13:
    s_bitcmp1_b32 s97, 14
    s_cbranch_scc0 L_kvl0_14
    v_max3_u32 v220, v224, v225, v226
    v_max_u32 v220, v220, v227
    v_cmp_eq_u32 vcc, -1, v220
    s_cbranch_vccnz L_kvl0_14r
    v_mfma_f32_32x32x16_bf16 v[136:151], v[248:251], v[224:227], v[136:151]
    s_bitset0_b32 s97, 14
L_kvl0_14:
    s_bitcmp1_b32 s97, 15
    s_cbranch_scc0 L_kvl0_15
    v_max3_u32 v220, v228, v229, v230
    v_max_u32 v220, v220, v231
    v_cmp_eq_u32 vcc, -1, v220
    s_cbranch_vccnz L_kvl0_15r
    v_mfma_f32_32x32x16_bf16 v[136:151], v[248:251], v[228:231], v[136:151]
    s_bitset0_b32 s97, 15
L_kvl0_15:
    s_cmp_eq_u32 s97, 0
    s_nop 9
    s_cbranch_scc1 L_kv_done0
    s_sleep 4
    s_branch L_kv_late0
L_kvl0_0r:
    s_xor_b32 s95, s96, 0x0
    buffer_load_dwordx4 v[232:235], v35, s[4:7], s95 offen sc1
    s_branch L_kvl0_0
L_kvl0_1r:
    s_xor_b32 s95, s96, 0x1000
    buffer_load_dwordx4 v[236:239], v35, s[4:7], s95 offen sc1
    s_branch L_kvl0_1
L_kvl0_2r:
    s_xor_b32 s95, s96, 0x2000
    buffer_load_dwordx4 v[240:243], v35, s[4:7], s95 offen sc1
    s_branch L_kvl0_2
L_kvl0_3r:
    s_xor_b32 s95, s96, 0x3000
    buffer_load_dwordx4 v[92:95], v35, s[4:7], s95 offen sc1
    s_branch L_kvl0_3
L_kvl0_4r:
    s_xor_b32 s95, s96, 0x4000
    buffer_load_dwordx4 v[96:99], v35, s[4:7], s95 offen sc1
    s_branch L_kvl0_4
L_kvl0_5r:
    s_xor_b32 s95, s96, 0x5000
    buffer_load_dwordx4 v[100:103], v35, s[4:7], s95 offen sc1
    s_branch L_kvl0_5
L_kvl0_6r:
    s_xor_b32 s95, s96, 0x6000
    buffer_load_dwordx4 v[120:123], v35, s[4:7], s95 offen sc1
    s_branch L_kvl0_6
L_kvl0_7r:
    s_xor_b32 s95, s96, 0x7000
    buffer_load_dwordx4 v[124:127], v35, s[4:7], s95 offen sc1
    s_branch L_kvl0_7
L_kvl0_8r:
    s_xor_b32 s95, s96, 0x8000
    buffer_load_dwordx4 v[132:135], v35, s[4:7], s95 offen sc1
    s_branch L_kvl0_8
L_kvl0_9r:
    s_xor_b32 s95, s96, 0x9000
    buffer_load_dwordx4 v[104:107], v35, s[4:7], s95 offen sc1
    s_branch L_kvl0_9
L_kvl0_10r:
    s_xor_b32 s95, s96, 0xa000
    buffer_load_dwordx4 v[108:111], v35, s[4:7], s95 offen sc1
    s_branch L_kvl0_10
L_kvl0_11r:
    s_xor_b32 s95, s96, 0xb000
    buffer_load_dwordx4 v[112:115], v35, s[4:7], s95 offen sc1
    s_branch L_kvl0_11
L_kvl0_12r:
    s_xor_b32 s95, s96, 0xc000
    buffer_load_dwordx4 v[116:119], v35, s[4:7], s95 offen sc1
    s_branch L_kvl0_12
L_kvl0_13r:
    s_xor_b32 s95, s96, 0xd000
    buffer_load_dwordx4 v[128:131], v35, s[4:7], s95 offen sc1
    s_branch L_kvl0_13
L_kvl0_14r:
    s_xor_b32 s95, s96, 0xe000
    buffer_load_dwordx4 v[224:227], v35, s[4:7], s95 offen sc1
    s_branch L_kvl0_14
L_kvl0_15r:
    s_xor_b32 s95, s96, 0xf000
    buffer_load_dwordx4 v[228:231], v35, s[4:7], s95 offen sc1
    s_branch L_kvl0_15
L_sec_26_s:
    s_nop 7
    s_nop 3
    v_add_f32 v212, 0x358637bd, v212
    v_rcp_f32 v212, v212
    s_nop 0
    v_pk_mul_f32 v[200:201], v[200:201], v[212:213] op_sel_hi:[1,0]
    v_pk_mul_f32 v[202:203], v[202:203], v[212:213] op_sel_hi:[1,0]
    v_pk_mul_f32 v[204:205], v[204:205], v[212:213] op_sel_hi:[1,0]
    v_pk_mul_f32 v[206:207], v[206:207], v[212:213] op_sel_hi:[1,0]
    v_pk_mul_f32 v[208:209], v[208:209], v[212:213] op_sel_hi:[1,0]
    v_pk_mul_f32 v[210:211], v[210:211], v[212:213] op_sel_hi:[1,0]
    v_cvt_pk_bf16_f32 v96, v200, v201
    v_cvt_pk_bf16_f32 v97, v202, v203
    v_cvt_pk_bf16_f32 v98, v204, v205
    v_cvt_pk_bf16_f32 v99, v206, v207
    buffer_store_dwordx4 v[96:99], v21, s[48:51], 0 offen offset:0 sc1
    v_cvt_pk_bf16_f32 v104, v208, v209
    v_cvt_pk_bf16_f32 v105, v210, v211
    v_add_f32 v228, 0x358637bd, v228
    v_rcp_f32 v228, v228
    s_nop 0
    v_pk_mul_f32 v[216:217], v[216:217], v[228:229] op_sel_hi:[1,0]
    v_pk_mul_f32 v[218:219], v[218:219], v[228:229] op_sel_hi:[1,0]
    v_pk_mul_f32 v[220:221], v[220:221], v[228:229] op_sel_hi:[1,0]
    v_pk_mul_f32 v[222:223], v[222:223], v[228:229] op_sel_hi:[1,0]
    v_pk_mul_f32 v[224:225], v[224:225], v[228:229] op_sel_hi:[1,0]
    v_pk_mul_f32 v[226:227], v[226:227], v[228:229] op_sel_hi:[1,0]
    v_cvt_pk_bf16_f32 v100, v216, v217
    v_cvt_pk_bf16_f32 v101, v218, v219
    v_cvt_pk_bf16_f32 v102, v220, v221
    v_cvt_pk_bf16_f32 v103, v222, v223
    buffer_store_dwordx4 v[100:103], v21, s[48:51], 0 offen offset:512 sc1
    v_cvt_pk_bf16_f32 v106, v224, v225
    v_cvt_pk_bf16_f32 v107, v226, v227
    buffer_store_dwordx4 v[104:107], v22, s[48:51], 0 offen sc1
    s_add_u32 m0, s74, 155648
    s_nop 0
    buffer_load_dwordx4 v31, s[4:7], m0 offen sc1 lds
    s_waitcnt vmcnt(1)
    s_mov_b64 exec, 1
    buffer_store_dword v28, off, s[48:51], s85 offset:64 sc1
    s_mov_b64 exec, -1
    s_mov_b64 s[8:9], s[48:49]
    s_add_u32 s48, s48, s56
    s_addc_u32 s49, s49, 0
    s_nop 7
    s_nop 3
    s_branch L_sec_26_e
L_sec_34_s:
    s_nop 7
    s_nop 3
    v_cvt_pk_bf16_f32 v208, v52, v53
    v_cvt_pk_bf16_f32 v209, v54, v55
    v_cvt_pk_bf16_f32 v210, v56, v57
    v_cvt_pk_bf16_f32 v211, v58, v59
    buffer_store_dwordx4 v[208:211], v16, s[48:51], 0 offen sc1
    v_cvt_pk_bf16_f32 v212, v60, v61
    v_cvt_pk_bf16_f32 v213, v62, v63
    v_cvt_pk_bf16_f32 v214, v64, v65
    v_cvt_pk_bf16_f32 v215, v66, v67
    v_cvt_pk_bf16_f32 v216, v68, v69
    v_cvt_pk_bf16_f32 v217, v70, v71
    v_pk_add_f32 v[228:229], v[52:53], v[54:55]
    v_pk_mul_f32 v[230:231], v[52:53], v[52:53]
    v_pk_fma_f32 v[230:231], v[54:55], v[54:55], v[230:231]
    v_pk_add_f32 v[228:229], v[228:229], v[56:57]
    v_pk_fma_f32 v[230:231], v[56:57], v[56:57], v[230:231]
    v_pk_add_f32 v[228:229], v[228:229], v[58:59]
    buffer_store_dwordx4 v[212:215], v16, s[48:51], 0 offen offset:2048 sc1
    v_pk_fma_f32 v[230:231], v[58:59], v[58:59], v[230:231]
    v_pk_add_f32 v[228:229], v[228:229], v[60:61]
    v_pk_fma_f32 v[230:231], v[60:61], v[60:61], v[230:231]
    v_pk_add_f32 v[228:229], v[228:229], v[62:63]
    v_pk_fma_f32 v[230:231], v[62:63], v[62:63], v[230:231]
    v_pk_add_f32 v[228:229], v[228:229], v[64:65]
    v_pk_fma_f32 v[230:231], v[64:65], v[64:65], v[230:231]
    v_pk_add_f32 v[228:229], v[228:229], v[66:67]
    v_pk_fma_f32 v[230:231], v[66:67], v[66:67], v[230:231]
    v_pk_add_f32 v[228:229], v[228:229], v[68:69]
    v_pk_fma_f32 v[230:231], v[68:69], v[68:69], v[230:231]
    v_pk_add_f32 v[228:229], v[228:229], v[70:71]
    v_pk_fma_f32 v[230:231], v[70:71], v[70:71], v[230:231]
    v_add_f32 v228, v228, v229
    v_add_f32 v230, v230, v231
    buffer_store_dwordx2 v[216:217], v17, s[48:51], 0 offen sc1
    s_nop 0
    v_permlane32_swap_b32 v228, v230
    v_add_f32 v228, v228, v230
    v_mov_b32 v230, v228
    s_nop 1
    v_permlane16_swap_b32 v228, v230
    v_add_f32 v230, v228, v230
    buffer_store_dword v230, v18, s[48:51], 0 offen sc1
    s_barrier
    ds_write_b128 v36, a[184:187] offset:20480
    ds_write_b128 v36, a[188:191] offset:24576
    ds_write_b128 v36, a[192:195] offset:28672
    ds_write_b128 v36, a[196:199] offset:32768
    s_waitcnt vmcnt(0)
    s_mov_b64 exec, 1
    buffer_store_dword v28, off, s[48:51], s84 offset:0 sc1
    s_mov_b64 exec, -1
    s_mov_b64 s[8:9], s[48:49]
    s_add_u32 s48, s48, s56
    s_addc_u32 s49, s49, 0
    s_nop 7
    s_nop 3
    s_branch L_sec_34_e
L_sec_38_s:
    s_nop 7
    s_nop 3
    v_pk_fma_f32 v[100:101], v[100:101], v[248:249], v[216:217] op_sel_hi:[1,0,1]
    v_max_f32 v100, 0, v100
    v_max_f32 v101, 0, v101
    v_pk_mul_f32 v[100:101], v[100:101], v[100:101]
    v_cvt_pk_bf16_f32 v216, v100, v101
    v_pk_fma_f32 v[102:103], v[102:103], v[248:249], v[218:219] op_sel_hi:[1,0,1]
    v_max_f32 v102, 0, v102
    v_max_f32 v103, 0, v103
    v_pk_mul_f32 v[102:103], v[102:103], v[102:103]
    v_cvt_pk_bf16_f32 v217, v102, v103
    v_pk_fma_f32 v[104:105], v[104:105], v[248:249], v[220:221] op_sel_hi:[1,0,1]
    v_max_f32 v104, 0, v104
    v_max_f32 v105, 0, v105
    v_pk_mul_f32 v[104:105], v[104:105], v[104:105]
    v_cvt_pk_bf16_f32 v218, v104, v105
    v_pk_fma_f32 v[106:107], v[106:107], v[248:249], v[222:223] op_sel_hi:[1,0,1]
    v_max_f32 v106, 0, v106
    v_max_f32_e64 v107, 0, v107
    v_pk_mul_f32 v[106:107], v[106:107], v[106:107]
    v_cvt_pk_bf16_f32 v219, v106, v107
    buffer_store_dwordx4 v[216:219], v23, s[48:51], s27 offen offset:0 sc1
    v_pk_fma_f32 v[108:109], v[108:109], v[248:249], v[224:225] op_sel_hi:[1,0,1]
    v_max_f32 v108, 0, v108
    v_max_f32 v109, 0, v109
    v_pk_mul_f32 v[108:109], v[108:109], v[108:109]
    v_cvt_pk_bf16_f32 v220, v108, v109
    v_pk_fma_f32 v[110:111], v[110:111], v[248:249], v[226:227] op_sel_hi:[1,0,1]
    v_max_f32 v110, 0, v110
    v_max_f32 v111, 0, v111
    v_pk_mul_f32 v[110:111], v[110:111], v[110:111]
    v_cvt_pk_bf16_f32 v221, v110, v111
    v_pk_fma_f32 v[112:113], v[112:113], v[248:249], v[228:229] op_sel_hi:[1,0,1]
    v_max_f32 v112, 0, v112
    v_max_f32 v113, 0, v113
    v_pk_mul_f32 v[112:113], v[112:113], v[112:113]
    v_cvt_pk_bf16_f32 v222, v112, v113
    v_pk_fma_f32 v[114:115], v[114:115], v[248:249], v[230:231] op_sel_hi:[1,0,1]
    v_max_f32 v114, 0, v114
    v_max_f32 v115, 0, v115
    v_pk_mul_f32 v[114:115], v[114:115], v[114:115]
    v_cvt_pk_bf16_f32 v223, v114, v115
    buffer_store_dwordx4 v[220:223], v23, s[48:51], s27 offen offset:1024 sc1
    v_pk_fma_f32 v[116:117], v[116:117], v[248:249], v[232:233] op_sel_hi:[1,0,1]
    v_max_f32 v116, 0, v116
    v_max_f32 v117, 0, v117
    v_pk_mul_f32 v[116:117], v[116:117], v[116:117]
    v_cvt_pk_bf16_f32 v224, v116, v117
    v_pk_fma_f32 v[118:119], v[118:119], v[248:249], v[234:235] op_sel_hi:[1,0,1]
    v_max_f32 v118, 0, v118
    v_max_f32 v119, 0, v119
    v_pk_mul_f32 v[118:119], v[118:119], v[118:119]
    v_cvt_pk_bf16_f32 v225, v118, v119
    v_pk_fma_f32 v[120:121], v[120:121], v[248:249], v[236:237] op_sel_hi:[1,0,1]
    v_max_f32 v120, 0, v120
    v_max_f32 v121, 0, v121
    v_pk_mul_f32 v[120:121], v[120:121], v[120:121]
    v_cvt_pk_bf16_f32 v226, v120, v121
    v_pk_fma_f32 v[122:123], v[122:123], v[248:249], v[238:239] op_sel_hi:[1,0,1]
    v_max_f32 v122, 0, v122
    v_max_f32 v123, 0, v123
    v_pk_mul_f32 v[122:123], v[122:123], v[122:123]
    v_cvt_pk_bf16_f32 v227, v122, v123
    buffer_store_dwordx4 v[224:227], v23, s[48:51], s27 offen offset:2048 sc1
    v_pk_fma_f32 v[124:125], v[124:125], v[248:249], v[240:241] op_sel_hi:[1,0,1]
    v_max_f32 v124, 0, v124
    v_max_f32 v125, 0, v125
    v_pk_mul_f32 v[124:125], v[124:125], v[124:125]
    v_cvt_pk_bf16_f32 v228, v124, v125
    v_pk_fma_f32 v[126:127], v[126:127], v[248:249], v[242:243] op_sel_hi:[1,0,1]
    v_max_f32 v126, 0, v126
    v_max_f32 v127, 0, v127
    v_pk_mul_f32 v[126:127], v[126:127], v[126:127]
    v_cvt_pk_bf16_f32 v229, v126, v127
    buffer_store_dwordx2 v[228:229], v24, s[48:51], s27 offen sc1
    s_nop 7
    s_nop 3
    s_branch L_sec_38_e
L_st_39_s:
    buffer_store_dword v28, off, s[48:51], s85 offset:192 sc1
    s_nop 0
    s_branch L_st_39_e
L_sec_41_s:
    s_nop 7
    s_nop 3
    v_pk_fma_f32 v[72:73], v[72:73], v[244:245], v[188:189] op_sel_hi:[1,0,1]
    s_add_u32 m0, s74, 49152
    v_max_f32 v72, 0, v72
    buffer_load_dwordx4 v32, s[4:7], m0 offen sc1 lds
    v_max_f32 v73, 0, v73
    v_pk_mul_f32 v[72:73], v[72:73], v[72:73]
    v_cvt_pk_bf16_f32 v156, v72, v73
    v_pk_fma_f32 v[74:75], v[74:75], v[244:245], v[190:191] op_sel_hi:[1,0,1]
    v_max_f32 v74, 0, v74
    v_max_f32 v75, 0, v75
    v_pk_mul_f32 v[74:75], v[74:75], v[74:75]
    v_cvt_pk_bf16_f32 v157, v74, v75
    v_pk_fma_f32 v[76:77], v[76:77], v[244:245], v[192:193] op_sel_hi:[1,0,1]
    v_max_f32 v76, 0, v76
    v_max_f32 v77, 0, v77
    v_pk_mul_f32 v[76:77], v[76:77], v[76:77]
    v_cvt_pk_bf16_f32 v158, v76, v77
    v_pk_fma_f32 v[78:79], v[78:79], v[244:245], v[194:195] op_sel_hi:[1,0,1]
    v_max_f32 v78, 0, v78
    v_max_f32_e64 v79, 0, v79
    v_pk_mul_f32 v[78:79], v[78:79], v[78:79]
    v_cvt_pk_bf16_f32 v159, v78, v79
    buffer_store_dwordx4 v[156:159], v23, s[48:51], s26 offen offset:0 sc1
    v_pk_fma_f32 v[80:81], v[80:81], v[244:245], v[196:197] op_sel_hi:[1,0,1]
    v_max_f32 v80, 0, v80
    v_max_f32 v81, 0, v81
    s_add_u32 m0, s74, 53248
    v_pk_mul_f32 v[80:81], v[80:81], v[80:81]
    buffer_load_dwordx4 v32, s[4:7], m0 offen sc1 lds
    v_cvt_pk_bf16_f32 v160, v80, v81
    v_pk_fma_f32 v[82:83], v[82:83], v[244:245], v[198:199] op_sel_hi:[1,0,1]
    v_max_f32 v82, 0, v82
    v_max_f32 v83, 0, v83
    v_pk_mul_f32 v[82:83], v[82:83], v[82:83]
    v_cvt_pk_bf16_f32 v161, v82, v83
    v_pk_fma_f32 v[84:85], v[84:85], v[244:245], v[200:201] op_sel_hi:[1,0,1]
    v_max_f32 v84, 0, v84
    v_max_f32 v85, 0, v85
    v_pk_mul_f32 v[84:85], v[84:85], v[84:85]
    v_cvt_pk_bf16_f32 v162, v84, v85
    v_pk_fma_f32 v[86:87], v[86:87], v[244:245], v[202:203] op_sel_hi:[1,0,1]
    v_max_f32 v86, 0, v86
    v_max_f32 v87, 0, v87
    v_pk_mul_f32 v[86:87], v[86:87], v[86:87]
    v_cvt_pk_bf16_f32 v163, v86, v87
    buffer_store_dwordx4 v[160:163], v23, s[48:51], s26 offen offset:1024 sc1
    v_pk_fma_f32 v[88:89], v[88:89], v[244:245], v[204:205] op_sel_hi:[1,0,1]
    v_max_f32 v88, 0, v88
    v_max_f32 v89, 0, v89
    v_pk_mul_f32 v[88:89], v[88:89], v[88:89]
    v_cvt_pk_bf16_f32 v164, v88, v89
    s_add_u32 m0, s74, 57344
    v_pk_fma_f32 v[90:91], v[90:91], v[244:245], v[206:207] op_sel_hi:[1,0,1]
    buffer_load_dwordx4 v32, s[4:7], m0 offen sc1 lds
    v_max_f32 v90, 0, v90
    v_max_f32 v91, 0, v91
    v_pk_mul_f32 v[90:91], v[90:91], v[90:91]
    v_cvt_pk_bf16_f32 v165, v90, v91
    v_pk_fma_f32 v[92:93], v[92:93], v[244:245], v[208:209] op_sel_hi:[1,0,1]
    v_max_f32 v92, 0, v92
    v_max_f32 v93, 0, v93
    v_pk_mul_f32 v[92:93], v[92:93], v[92:93]
    v_cvt_pk_bf16_f32 v166, v92, v93
    v_pk_fma_f32 v[94:95], v[94:95], v[244:245], v[210:211] op_sel_hi:[1,0,1]
    v_max_f32 v94, 0, v94
    v_max_f32 v95, 0, v95
    v_pk_mul_f32 v[94:95], v[94:95], v[94:95]
    v_cvt_pk_bf16_f32 v167, v94, v95
    buffer_store_dwordx4 v[164:167], v23, s[48:51], s26 offen offset:2048 sc1
    v_pk_fma_f32 v[96:97], v[96:97], v[244:245], v[212:213] op_sel_hi:[1,0,1]
    v_max_f32 v96, 0, v96
    v_max_f32 v97, 0, v97
    v_pk_mul_f32 v[96:97], v[96:97], v[96:97]
    v_cvt_pk_bf16_f32 v168, v96, v97
    v_pk_fma_f32 v[98:99], v[98:99], v[244:245], v[214:215] op_sel_hi:[1,0,1]
    v_max_f32 v98, 0, v98
    s_add_u32 m0, s74, 61440
    v_max_f32 v99, 0, v99
    buffer_load_dwordx4 v32, s[4:7], m0 offen sc1 lds
    v_pk_mul_f32 v[98:99], v[98:99], v[98:99]
    v_cvt_pk_bf16_f32 v169, v98, v99
    buffer_store_dwordx2 v[168:169], v24, s[48:51], s26 offen sc1
    s_waitcnt lgkmcnt(0)
    s_nop 0
    v_pk_add_f32 v[52:53], v[52:53], v[136:137]
    v_pk_add_f32 v[54:55], v[54:55], v[138:139]
    v_pk_add_f32 v[56:57], v[56:57], v[140:141]
    v_pk_add_f32 v[58:59], v[58:59], v[142:143]
    v_pk_add_f32 v[60:61], v[60:61], v[144:145]
    v_pk_add_f32 v[62:63], v[62:63], v[146:147]
    v_pk_add_f32 v[64:65], v[64:65], v[148:149]
    v_pk_add_f32 v[66:67], v[66:67], v[150:151]
    v_pk_add_f32 v[68:69], v[68:69], v[152:153]
    v_pk_add_f32 v[70:71], v[70:71], v[154:155]
    s_mov_b64 s[8:9], s[48:49]
    s_add_u32 s48, s48, s56
    s_addc_u32 s49, s49, 0
    s_nop 7
    s_nop 3
    s_branch L_sec_41_e
L_st_42_s:
    buffer_store_dword v28, off, s[8:11], s85 offset:64 sc1
    s_nop 0
    s_branch L_st_42_e
L_st_44_s:
    buffer_store_dwordx4 v[208:211], v220, s[48:51], 0 offen sc1
    s_nop 0
    s_branch L_st_44_e
L_st_45_s:
    buffer_store_dwordx4 v[212:215], v220, s[48:51], 0 offen offset:2048 sc1
    s_nop 0
    s_branch L_st_45_e
L_st_46_s:
    buffer_store_dwordx2 v[216:217], v221, s[48:51], 0 offen sc1
    s_nop 0
    s_branch L_st_46_e
L_st_47_s:
    buffer_store_dword v28, off, s[48:51], s85 offset:128 sc1
    s_nop 0
    s_branch L_st_47_e
L_sec_49_s:
    s_nop 7
    s_nop 3
    v_cvt_pk_bf16_f32 v208, v52, v53
    v_cvt_pk_bf16_f32 v209, v54, v55
    v_cvt_pk_bf16_f32 v210, v56, v57
    v_cvt_pk_bf16_f32 v211, v58, v59
    buffer_store_dwordx4 v[208:211], v14, s[48:51], 0 offen sc1
    v_cvt_pk_bf16_f32 v212, v60, v61
    v_cvt_pk_bf16_f32 v213, v62, v63
    v_cvt_pk_bf16_f32 v214, v64, v65
    v_cvt_pk_bf16_f32 v215, v66, v67
    v_cvt_pk_bf16_f32 v216, v68, v69
    v_cvt_pk_bf16_f32 v217, v70, v71
    v_pk_add_f32 v[228:229], v[52:53], v[54:55]
    v_pk_mul_f32 v[230:231], v[52:53], v[52:53]
    v_pk_fma_f32 v[230:231], v[54:55], v[54:55], v[230:231]
    v_pk_add_f32 v[228:229], v[228:229], v[56:57]
    v_pk_fma_f32 v[230:231], v[56:57], v[56:57], v[230:231]
    v_pk_add_f32 v[228:229], v[228:229], v[58:59]
    buffer_store_dwordx4 v[212:215], v14, s[48:51], 0 offen offset:2048 sc1
    v_pk_fma_f32 v[230:231], v[58:59], v[58:59], v[230:231]
    v_pk_add_f32 v[228:229], v[228:229], v[60:61]
    v_pk_fma_f32 v[230:231], v[60:61], v[60:61], v[230:231]
    v_pk_add_f32 v[228:229], v[228:229], v[62:63]
    v_pk_fma_f32 v[230:231], v[62:63], v[62:63], v[230:231]
    v_pk_add_f32 v[228:229], v[228:229], v[64:65]
    v_pk_fma_f32 v[230:231], v[64:65], v[64:65], v[230:231]
    v_pk_add_f32 v[228:229], v[228:229], v[66:67]
    v_pk_fma_f32 v[230:231], v[66:67], v[66:67], v[230:231]
    v_pk_add_f32 v[228:229], v[228:229], v[68:69]
    v_pk_fma_f32 v[230:231], v[68:69], v[68:69], v[230:231]
    v_pk_add_f32 v[228:229], v[228:229], v[70:71]
    v_pk_fma_f32 v[230:231], v[70:71], v[70:71], v[230:231]
    v_add_f32 v228, v228, v229
    v_add_f32 v230, v230, v231
    buffer_store_dwordx2 v[216:217], v15, s[48:51], 0 offen sc1
    s_nop 0
    v_permlane32_swap_b32 v228, v230
    v_add_f32 v228, v228, v230
    v_mov_b32 v230, v228
    s_nop 1
    v_permlane16_swap_b32 v228, v230
    v_add_f32 v230, v228, v230
    buffer_store_dword v230, v18, s[48:51], 0 offen sc1
    s_barrier
    ds_write_b128 v36, a[0:3] offset:0
    ds_write_b128 v36, a[4:7] offset:4096
    ds_write_b128 v36, a[8:11] offset:8192
    ds_write_b128 v36, a[12:15] offset:12288
    ds_write_b128 v36, a[16:19] offset:16384
    ds_write_b128 v36, a[20:23] offset:20480
    ds_write_b128 v36, a[24:27] offset:24576
    s_waitcnt vmcnt(0)
    s_mov_b64 exec, 1
    buffer_store_dword v28, off, s[48:51], s84 offset:0 sc1
    s_mov_b64 exec, -1
    s_mov_b64 s[8:9], s[48:49]
    s_add_u32 s48, s48, s56
    s_addc_u32 s49, s49, 0
    s_nop 7
    s_nop 3
    s_branch L_sec_49_e
L_kv_57_r:
    s_xor_b32 s95, s96, 0x0
    buffer_load_dwordx4 v[232:235], v35, s[4:7], s95 offen sc1
    s_bitset1_b32 s97, 0
    s_branch L_kv_57
L_kv_58_r:
    s_xor_b32 s95, s96, 0x1000
    buffer_load_dwordx4 v[236:239], v35, s[4:7], s95 offen sc1
    s_bitset1_b32 s97, 1
    s_branch L_kv_58
L_kv_59_r:
    s_xor_b32 s95, s96, 0x2000
    buffer_load_dwordx4 v[240:243], v35, s[4:7], s95 offen sc1
    s_bitset1_b32 s97, 2
    s_branch L_kv_59
L_kv_60_r:
    s_xor_b32 s95, s96, 0x3000
    buffer_load_dwordx4 v[92:95], v35, s[4:7], s95 offen sc1
    s_bitset1_b32 s97, 3
    s_branch L_kv_60
L_kv_61_r:
    s_xor_b32 s95, s96, 0x4000
    buffer_load_dwordx4 v[96:99], v35, s[4:7], s95 offen sc1
    s_bitset1_b32 s97, 4
    s_branch L_kv_61
L_kv_62_r:
    s_xor_b32 s95, s96, 0x5000
    buffer_load_dwordx4 v[100:103], v35, s[4:7], s95 offen sc1
    s_bitset1_b32 s97, 5
    s_branch L_kv_62
L_kv_63_r:
    s_xor_b32 s95, s96, 0x6000
    buffer_load_dwordx4 v[120:123], v35, s[4:7], s95 offen sc1
    s_bitset1_b32 s97, 6
    s_branch L_kv_63
L_kv_64_r:
    s_xor_b32 s95, s96, 0x7000
    buffer_load_dwordx4 v[124:127], v35, s[4:7], s95 offen sc1
    s_bitset1_b32 s97, 7
    s_branch L_kv_64
L_kv_65_r:
    s_xor_b32 s95, s96, 0x8000
    buffer_load_dwordx4 v[132:135], v35, s[4:7], s95 offen sc1
    s_bitset1_b32 s97, 8
    s_branch L_kv_65
L_kv_66_r:
    s_xor_b32 s95, s96, 0x9000
    buffer_load_dwordx4 v[104:107], v35, s[4:7], s95 offen sc1
    s_bitset1_b32 s97, 9
    s_branch L_kv_66
L_kv_67_r:
    s_xor_b32 s95, s96, 0xa000
    buffer_load_dwordx4 v[108:111], v35, s[4:7], s95 offen sc1
    s_bitset1_b32 s97, 10
    s_branch L_kv_67
L_kv_68_r:
    s_xor_b32 s95, s96, 0xb000
    buffer_load_dwordx4 v[112:115], v35, s[4:7], s95 offen sc1
    s_bitset1_b32 s97, 11
    s_branch L_kv_68
L_kv_69_r:
    s_xor_b32 s95, s96, 0xc000
    buffer_load_dwordx4 v[116:119], v35, s[4:7], s95 offen sc1
    s_bitset1_b32 s97, 12
    s_branch L_kv_69
L_kv_70_r:
    s_xor_b32 s95, s96, 0xd000
    buffer_load_dwordx4 v[128:131], v35, s[4:7], s95 offen sc1
    s_bitset1_b32 s97, 13
    s_branch L_kv_70
L_kv_71_r:
    s_xor_b32 s95, s96, 0xe000
    buffer_load_dwordx4 v[224:227], v35, s[4:7], s95 offen sc1
    s_bitset1_b32 s97, 14
    s_branch L_kv_71
L_kv_72_r:
    s_xor_b32 s95, s96, 0xf000
    buffer_load_dwordx4 v[228:231], v35, s[4:7], s95 offen sc1
    s_bitset1_b32 s97, 15
    s_branch L_kv_72
L_kv_late1:
    s_sub_u32 s80, s80, 1
    s_cbranch_scc1 L_end
    s_waitcnt vmcnt(0)
    s_bitcmp1_b32 s97, 0
    s_cbranch_scc0 L_kvl1_0
    v_max3_u32 v220, v232, v233, v234
    v_max_u32 v220, v220, v235
    v_cmp_eq_u32 vcc, -1, v220
    s_cbranch_vccnz L_kvl1_0r
    v_mfma_f32_32x32x16_bf16 v[136:151], v[248:251], v[232:235], v[136:151]
    s_bitset0_b32 s97, 0
L_kvl1_0:
    s_bitcmp1_b32 s97, 1
    s_cbranch_scc0 L_kvl1_1
    v_max3_u32 v220, v236, v237, v238
    v_max_u32 v220, v220, v239
    v_cmp_eq_u32 vcc, -1, v220
    s_cbranch_vccnz L_kvl1_1r
    v_mfma_f32_32x32x16_bf16 v[136:151], v[248:251], v[236:239], v[136:151]
    s_bitset0_b32 s97, 1
L_kvl1_1:
    s_bitcmp1_b32 s97, 2
    s_cbranch_scc0 L_kvl1_2
    v_max3_u32 v220, v240, v241, v242
    v_max_u32 v220, v220, v243
    v_cmp_eq_u32 vcc, -1, v220
    s_cbranch_vccnz L_kvl1_2r
    v_mfma_f32_32x32x16_bf16 v[136:151], v[248:251], v[240:243], v[136:151]
    s_bitset0_b32 s97, 2
L_kvl1_2:
    s_bitcmp1_b32 s97, 3
    s_cbranch_scc0 L_kvl1_3
    v_max3_u32 v220, v92, v93, v94
    v_max_u32 v220, v220, v95
    v_cmp_eq_u32 vcc, -1, v220
    s_cbranch_vccnz L_kvl1_3r
    v_mfma_f32_32x32x16_bf16 v[136:151], v[248:251], v[92:95], v[136:151]
    s_bitset0_b32 s97, 3
L_kvl1_3:
    s_bitcmp1_b32 s97, 4
    s_cbranch_scc0 L_kvl1_4
    v_max3_u32 v220, v96, v97, v98
    v_max_u32 v220, v220, v99
    v_cmp_eq_u32 vcc, -1, v220
    s_cbranch_vccnz L_kvl1_4r
    v_mfma_f32_32x32x16_bf16 v[136:151], v[248:251], v[96:99], v[136:151]
    s_bitset0_b32 s97, 4
L_kvl1_4:
    s_bitcmp1_b32 s97, 5
    s_cbranch_scc0 L_kvl1_5
    v_max3_u32 v220, v100, v101, v102
    v_max_u32 v220, v220, v103
    v_cmp_eq_u32 vcc, -1, v220
    s_cbranch_vccnz L_kvl1_5r
    v_mfma_f32_32x32x16_bf16 v[136:151], v[248:251], v[100:103], v[136:151]
    s_bitset0_b32 s97, 5
L_kvl1_5:
    s_bitcmp1_b32 s97, 6
    s_cbranch_scc0 L_kvl1_6
    v_max3_u32 v220, v120, v121, v122
    v_max_u32 v220, v220, v123
    v_cmp_eq_u32 vcc, -1, v220
    s_cbranch_vccnz L_kvl1_6r
    v_mfma_f32_32x32x16_bf16 v[136:151], v[248:251], v[120:123], v[136:151]
    s_bitset0_b32 s97, 6
L_kvl1_6:
    s_bitcmp1_b32 s97, 7
    s_cbranch_scc0 L_kvl1_7
    v_max3_u32 v220, v124, v125, v126
    v_max_u32 v220, v220, v127
    v_cmp_eq_u32 vcc, -1, v220
    s_cbranch_vccnz L_kvl1_7r
    v_mfma_f32_32x32x16_bf16 v[136:151], v[248:251], v[124:127], v[136:151]
    s_bitset0_b32 s97, 7
L_kvl1_7:
    s_bitcmp1_b32 s97, 8
    s_cbranch_scc0 L_kvl1_8
    v_max3_u32 v220, v132, v133, v134
    v_max_u32 v220, v220, v135
    v_cmp_eq_u32 vcc, -1, v220
    s_cbranch_vccnz L_kvl1_8r
    v_mfma_f32_32x32x16_bf16 v[136:151], v[248:251], v[132:135], v[136:151]
    s_bitset0_b32 s97, 8
L_kvl1_8:
    s_bitcmp1_b32 s97, 9
    s_cbranch_scc0 L_kvl1_9
    v_max3_u32 v220, v104, v105, v106
    v_max_u32 v220, v220, v107
    v_cmp_eq_u32 vcc, -1, v220
    s_cbranch_vccnz L_kvl1_9r
    v_mfma_f32_32x32x16_bf16 v[136:151], v[248:251], v[104:107], v[136:151]
    s_bitset0_b32 s97, 9
L_kvl1_9:
    s_bitcmp1_b32 s97, 10
    s_cbranch_scc0 L_kvl1_10
    v_max3_u32 v220, v108, v109, v110
    v_max_u32 v220, v220, v111
    v_cmp_eq_u32 vcc, -1, v220
    s_cbranch_vccnz L_kvl1_10r
    v_mfma_f32_32x32x16_bf16 v[136:151], v[248:251], v[108:111], v[136:151]
    s_bitset0_b32 s97, 10
L_kvl1_10:
    s_bitcmp1_b32 s97, 11
    s_cbranch_scc0 L_kvl1_11
    v_max3_u32 v220, v112, v113, v114
    v_max_u32 v220, v220, v115
    v_cmp_eq_u32 vcc, -1, v220
    s_cbranch_vccnz L_kvl1_11r
    v_mfma_f32_32x32x16_bf16 v[136:151], v[248:251], v[112:115], v[136:151]
    s_bitset0_b32 s97, 11
L_kvl1_11:
    s_bitcmp1_b32 s97, 12
    s_cbranch_scc0 L_kvl1_12
    v_max3_u32 v220, v116, v117, v118
    v_max_u32 v220, v220, v119
    v_cmp_eq_u32 vcc, -1, v220
    s_cbranch_vccnz L_kvl1_12r
    v_mfma_f32_32x32x16_bf16 v[136:151], v[248:251], v[116:119], v[136:151]
    s_bitset0_b32 s97, 12
L_kvl1_12:
    s_bitcmp1_b32 s97, 13
    s_cbranch_scc0 L_kvl1_13
    v_max3_u32 v220, v128, v129, v130
    v_max_u32 v220, v220, v131
    v_cmp_eq_u32 vcc, -1, v220
    s_cbranch_vccnz L_kvl1_13r
    v_mfma_f32_32x32x16_bf16 v[136:151], v[248:251], v[128:131], v[136:151]
    s_bitset0_b32 s97, 13
L_kvl1_13:
    s_bitcmp1_b32 s97, 14
    s_cbranch_scc0 L_kvl1_14
    v_max3_u32 v220, v224, v225, v226
    v_max_u32 v220, v220, v227
    v_cmp_eq_u32 vcc, -1, v220
    s_cbranch_vccnz L_kvl1_14r
    v_mfma_f32_32x32x16_bf16 v[136:151], v[248:251], v[224:227], v[136:151]
    s_bitset0_b32 s97, 14
L_kvl1_14:
    s_bitcmp1_b32 s97, 15
    s_cbranch_scc0 L_kvl1_15
    v_max3_u32 v220, v228, v229, v230
    v_max_u32 v220, v220, v231
    v_cmp_eq_u32 vcc, -1, v220
    s_cbranch_vccnz L_kvl1_15r
    v_mfma_f32_32x32x16_bf16 v[136:151], v[248:251], v[228:231], v[136:151]
    s_bitset0_b32 s97, 15
L_kvl1_15:
    s_cmp_eq_u32 s97, 0
    s_nop 9
    s_cbranch_scc1 L_kv_done1
    s_sleep 4
    s_branch L_kv_late1
L_kvl1_0r:
    s_xor_b32 s95, s96, 0x0
    buffer_load_dwordx4 v[232:235], v35, s[4:7], s95 offen sc1
    s_branch L_kvl1_0
L_kvl1_1r:
    s_xor_b32 s95, s96, 0x1000
    buffer_load_dwordx4 v[236:239], v35, s[4:7], s95 offen sc1
    s_branch L_kvl1_1
L_kvl1_2r:
    s_xor_b32 s95, s96, 0x2000
    buffer_load_dwordx4 v[240:243], v35, s[4:7], s95 offen sc1
    s_branch L_kvl1_2
L_kvl1_3r:
    s_xor_b32 s95, s96, 0x3000
    buffer_load_dwordx4 v[92:95], v35, s[4:7], s95 offen sc1
    s_branch L_kvl1_3
L_kvl1_4r:
    s_xor_b32 s95, s96, 0x4000
    buffer_load_dwordx4 v[96:99], v35, s[4:7], s95 offen sc1
    s_branch L_kvl1_4
L_kvl1_5r:
    s_xor_b32 s95, s96, 0x5000
    buffer_load_dwordx4 v[100:103], v35, s[4:7], s95 offen sc1
    s_branch L_kvl1_5
L_kvl1_6r:
    s_xor_b32 s95, s96, 0x6000
    buffer_load_dwordx4 v[120:123], v35, s[4:7], s95 offen sc1
    s_branch L_kvl1_6
L_kvl1_7r:
    s_xor_b32 s95, s96, 0x7000
    buffer_load_dwordx4 v[124:127], v35, s[4:7], s95 offen sc1
    s_branch L_kvl1_7
L_kvl1_8r:
    s_xor_b32 s95, s96, 0x8000
    buffer_load_dwordx4 v[132:135], v35, s[4:7], s95 offen sc1
    s_branch L_kvl1_8
L_kvl1_9r:
    s_xor_b32 s95, s96, 0x9000
    buffer_load_dwordx4 v[104:107], v35, s[4:7], s95 offen sc1
    s_branch L_kvl1_9
L_kvl1_10r:
    s_xor_b32 s95, s96, 0xa000
    buffer_load_dwordx4 v[108:111], v35, s[4:7], s95 offen sc1
    s_branch L_kvl1_10
L_kvl1_11r:
    s_xor_b32 s95, s96, 0xb000
    buffer_load_dwordx4 v[112:115], v35, s[4:7], s95 offen sc1
    s_branch L_kvl1_11
L_kvl1_12r:
    s_xor_b32 s95, s96, 0xc000
    buffer_load_dwordx4 v[116:119], v35, s[4:7], s95 offen sc1
    s_branch L_kvl1_12
L_kvl1_13r:
    s_xor_b32 s95, s96, 0xd000
    buffer_load_dwordx4 v[128:131], v35, s[4:7], s95 offen sc1
    s_branch L_kvl1_13
L_kvl1_14r:
    s_xor_b32 s95, s96, 0xe000
    buffer_load_dwordx4 v[224:227], v35, s[4:7], s95 offen sc1
    s_branch L_kvl1_14
L_kvl1_15r:
    s_xor_b32 s95, s96, 0xf000
    buffer_load_dwordx4 v[228:231], v35, s[4:7], s95 offen sc1
    s_branch L_kvl1_15
L_sec_73_s:
    s_nop 7
    s_nop 3
    v_add_f32 v212, 0x358637bd, v212
    v_rcp_f32 v212, v212
    s_nop 0
    s_nop 0
    v_pk_mul_f32 v[200:201], v[200:201], v[212:213] op_sel_hi:[1,0]
    v_pk_mul_f32 v[202:203], v[202:203], v[212:213] op_sel_hi:[1,0]
    v_pk_mul_f32 v[204:205], v[204:205], v[212:213] op_sel_hi:[1,0]
    v_pk_mul_f32 v[206:207], v[206:207], v[212:213] op_sel_hi:[1,0]
    v_pk_mul_f32 v[208:209], v[208:209], v[212:213] op_sel_hi:[1,0]
    v_pk_mul_f32 v[210:211], v[210:211], v[212:213] op_sel_hi:[1,0]
    v_cvt_pk_bf16_f32 v96, v200, v201
    v_cvt_pk_bf16_f32 v97, v202, v203
    v_cvt_pk_bf16_f32 v98, v204, v205
    v_cvt_pk_bf16_f32 v99, v206, v207
    buffer_store_dwordx4 v[96:99], v21, s[48:51], 0 offen offset:0 sc1
    v_cvt_pk_bf16_f32 v104, v208, v209
    v_cvt_pk_bf16_f32 v105, v210, v211
    v_add_f32 v228, 0x358637bd, v228
    v_rcp_f32 v228, v228
    s_nop 0
    v_pk_mul_f32 v[216:217], v[216:217], v[228:229] op_sel_hi:[1,0]
    v_pk_mul_f32 v[218:219], v[218:219], v[228:229] op_sel_hi:[1,0]
    v_pk_mul_f32 v[220:221], v[220:221], v[228:229] op_sel_hi:[1,0]
    v_pk_mul_f32 v[222:223], v[222:223], v[228:229] op_sel_hi:[1,0]
    v_pk_mul_f32 v[224:225], v[224:225], v[228:229] op_sel_hi:[1,0]
    v_pk_mul_f32 v[226:227], v[226:227], v[228:229] op_sel_hi:[1,0]
    v_cvt_pk_bf16_f32 v100, v216, v217
    v_cvt_pk_bf16_f32 v101, v218, v219
    v_cvt_pk_bf16_f32 v102, v220, v221
    v_cvt_pk_bf16_f32 v103, v222, v223
    buffer_store_dwordx4 v[100:103], v21, s[48:51], 0 offen offset:512 sc1
    v_cvt_pk_bf16_f32 v106, v224, v225
    v_cvt_pk_bf16_f32 v107, v226, v227
    buffer_store_dwordx4 v[104:107], v22, s[48:51], 0 offen sc1
    s_waitcnt vmcnt(0)
    s_mov_b64 exec, 1
    buffer_store_dword v28, off, s[48:51], s85 offset:64 sc1
    s_mov_b64 exec, -1
    s_mov_b64 s[8:9], s[48:49]
    s_add_u32 s48, s48, s56
    s_addc_u32 s49, s49, 0
    s_nop 7
    s_nop 3
    s_branch L_sec_73_e
L_sec_82_s:
    s_nop 7
    s_nop 0
    s_nop 2
    v_cvt_pk_bf16_f32 v208, v52, v53
    v_cvt_pk_bf16_f32 v209, v54, v55
    v_cvt_pk_bf16_f32 v210, v56, v57
    v_cvt_pk_bf16_f32 v211, v58, v59
    buffer_store_dwordx4 v[208:211], v16, s[48:51], 0 offen sc1
    v_cvt_pk_bf16_f32 v212, v60, v61
    v_cvt_pk_bf16_f32 v213, v62, v63
    v_cvt_pk_bf16_f32 v214, v64, v65
    v_cvt_pk_bf16_f32 v215, v66, v67
    v_cvt_pk_bf16_f32 v216, v68, v69
    v_cvt_pk_bf16_f32 v217, v70, v71
    v_pk_add_f32 v[228:229], v[52:53], v[54:55]
    v_pk_mul_f32 v[230:231], v[52:53], v[52:53]
    v_pk_fma_f32 v[230:231], v[54:55], v[54:55], v[230:231]
    v_pk_add_f32 v[228:229], v[228:229], v[56:57]
    v_pk_fma_f32 v[230:231], v[56:57], v[56:57], v[230:231]
    v_pk_add_f32 v[228:229], v[228:229], v[58:59]
    buffer_store_dwordx4 v[212:215], v16, s[48:51], 0 offen offset:2048 sc1
    v_pk_fma_f32 v[230:231], v[58:59], v[58:59], v[230:231]
    v_pk_add_f32 v[228:229], v[228:229], v[60:61]
    v_pk_fma_f32 v[230:231], v[60:61], v[60:61], v[230:231]
    v_pk_add_f32 v[228:229], v[228:229], v[62:63]
    v_pk_fma_f32 v[230:231], v[62:63], v[62:63], v[230:231]
    v_pk_add_f32 v[228:229], v[228:229], v[64:65]
    v_pk_fma_f32 v[230:231], v[64:65], v[64:65], v[230:231]
    v_pk_add_f32 v[228:229], v[228:229], v[66:67]
    v_pk_fma_f32 v[230:231], v[66:67], v[66:67], v[230:231]
    v_pk_add_f32 v[228:229], v[228:229], v[68:69]
    v_pk_fma_f32 v[230:231], v[68:69], v[68:69], v[230:231]
    v_pk_add_f32 v[228:229], v[228:229], v[70:71]
    v_pk_fma_f32 v[230:231], v[70:71], v[70:71], v[230:231]
    v_add_f32 v228, v228, v229
    v_add_f32 v230, v230, v231
    buffer_store_dwordx2 v[216:217], v17, s[48:51], 0 offen sc1
    s_nop 0
    v_permlane32_swap_b32 v228, v230
    v_add_f32 v228, v228, v230
    v_mov_b32 v230, v228
    s_nop 1
    v_permlane16_swap_b32 v228, v230
    v_add_f32 v230, v228, v230
    buffer_store_dword v230, v18, s[48:51], 0 offen sc1
    s_barrier
    ds_write_b128 v36, a[184:187] offset:20480
    ds_write_b128 v36, a[188:191] offset:24576
    ds_write_b128 v36, a[192:195] offset:28672
    ds_write_b128 v36, a[196:199] offset:32768
    s_waitcnt vmcnt(0)
    s_mov_b64 exec, 1
    buffer_store_dword v28, off, s[48:51], s84 offset:0 sc1
    s_mov_b64 exec, -1
    s_mov_b64 s[8:9], s[48:49]
    s_add_u32 s48, s48, s56
    s_addc_u32 s49, s49, 0
    s_nop 7
    s_nop 3
    s_branch L_sec_82_e
L_sec_90_s:
    s_nop 7
    s_nop 3
    v_pk_fma_f32 v[100:101], v[100:101], v[248:249], v[216:217] op_sel_hi:[1,0,1]
    v_max_f32 v100, 0, v100
    v_max_f32 v101, 0, v101
    v_pk_mul_f32 v[100:101], v[100:101], v[100:101]
    v_cvt_pk_bf16_f32 v216, v100, v101
    v_pk_fma_f32 v[102:103], v[102:103], v[248:249], v[218:219] op_sel_hi:[1,0,1]
    v_max_f32 v102, 0, v102
    v_max_f32 v103, 0, v103
    v_pk_mul_f32 v[102:103], v[102:103], v[102:103]
    v_cvt_pk_bf16_f32 v217, v102, v103
    v_pk_fma_f32 v[104:105], v[104:105], v[248:249], v[220:221] op_sel_hi:[1,0,1]
    v_max_f32 v104, 0, v104
    v_max_f32 v105, 0, v105
    v_pk_mul_f32 v[104:105], v[104:105], v[104:105]
    v_cvt_pk_bf16_f32 v218, v104, v105
    v_pk_fma_f32 v[106:107], v[106:107], v[248:249], v[222:223] op_sel_hi:[1,0,1]
    v_max_f32 v106, 0, v106
    v_max_f32_e64 v107, 0, v107
    v_pk_mul_f32 v[106:107], v[106:107], v[106:107]
    v_cvt_pk_bf16_f32 v219, v106, v107
    buffer_store_dwordx4 v[216:219], v23, s[48:51], s27 offen offset:0 sc1
    v_pk_fma_f32 v[108:109], v[108:109], v[248:249], v[224:225] op_sel_hi:[1,0,1]
    v_max_f32 v108, 0, v108
    v_max_f32 v109, 0, v109
    v_pk_mul_f32 v[108:109], v[108:109], v[108:109]
    v_cvt_pk_bf16_f32 v220, v108, v109
    v_pk_fma_f32 v[110:111], v[110:111], v[248:249], v[226:227] op_sel_hi:[1,0,1]
    v_max_f32 v110, 0, v110
    v_max_f32 v111, 0, v111
    v_pk_mul_f32 v[110:111], v[110:111], v[110:111]
    v_cvt_pk_bf16_f32 v221, v110, v111
    v_pk_fma_f32 v[112:113], v[112:113], v[248:249], v[228:229] op_sel_hi:[1,0,1]
    v_max_f32 v112, 0, v112
    v_max_f32 v113, 0, v113
    v_pk_mul_f32 v[112:113], v[112:113], v[112:113]
    v_cvt_pk_bf16_f32 v222, v112, v113
    v_pk_fma_f32 v[114:115], v[114:115], v[248:249], v[230:231] op_sel_hi:[1,0,1]
    v_max_f32 v114, 0, v114
    v_max_f32 v115, 0, v115
    v_pk_mul_f32 v[114:115], v[114:115], v[114:115]
    v_cvt_pk_bf16_f32 v223, v114, v115
    buffer_store_dwordx4 v[220:223], v23, s[48:51], s27 offen offset:1024 sc1
    v_pk_fma_f32 v[116:117], v[116:117], v[248:249], v[232:233] op_sel_hi:[1,0,1]
    v_max_f32 v116, 0, v116
    v_max_f32 v117, 0, v117
    v_pk_mul_f32 v[116:117], v[116:117], v[116:117]
    v_cvt_pk_bf16_f32 v224, v116, v117
    v_pk_fma_f32 v[118:119], v[118:119], v[248:249], v[234:235] op_sel_hi:[1,0,1]
    v_max_f32 v118, 0, v118
    v_max_f32 v119, 0, v119
    v_pk_mul_f32 v[118:119], v[118:119], v[118:119]
    v_cvt_pk_bf16_f32 v225, v118, v119
    v_pk_fma_f32 v[120:121], v[120:121], v[248:249], v[236:237] op_sel_hi:[1,0,1]
    v_max_f32 v120, 0, v120
    v_max_f32 v121, 0, v121
    v_pk_mul_f32 v[120:121], v[120:121], v[120:121]
    v_cvt_pk_bf16_f32 v226, v120, v121
    v_pk_fma_f32 v[122:123], v[122:123], v[248:249], v[238:239] op_sel_hi:[1,0,1]
    v_max_f32 v122, 0, v122
    v_max_f32 v123, 0, v123
    v_pk_mul_f32 v[122:123], v[122:123], v[122:123]
    v_cvt_pk_bf16_f32 v227, v122, v123
    buffer_store_dwordx4 v[224:227], v23, s[48:51], s27 offen offset:2048 sc1
    v_pk_fma_f32 v[124:125], v[124:125], v[248:249], v[240:241] op_sel_hi:[1,0,1]
    v_max_f32 v124, 0, v124
    v_max_f32 v125, 0, v125
    v_pk_mul_f32 v[124:125], v[124:125], v[124:125]
    v_cvt_pk_bf16_f32 v228, v124, v125
    v_pk_fma_f32 v[126:127], v[126:127], v[248:249], v[242:243] op_sel_hi:[1,0,1]
    v_max_f32 v126, 0, v126
    v_max_f32 v127, 0, v127
    v_pk_mul_f32 v[126:127], v[126:127], v[126:127]
    v_cvt_pk_bf16_f32 v229, v126, v127
    buffer_store_dwordx2 v[228:229], v24, s[48:51], s27 offen sc1
    s_nop 7
    s_nop 3
    s_branch L_sec_90_e
L_st_91_s:
    buffer_store_dword v28, off, s[48:51], s85 offset:192 sc1
    s_nop 0
    s_branch L_st_91_e
L_sec_93_s:
    s_nop 7
    s_nop 3
    v_pk_fma_f32 v[72:73], v[72:73], v[244:245], v[188:189] op_sel_hi:[1,0,1]
    s_add_u32 m0, s74, 36864
    v_max_f32 v72, 0, v72
    buffer_load_dwordx4 v32, s[4:7], m0 offen sc1 lds
    v_max_f32 v73, 0, v73
    v_pk_mul_f32 v[72:73], v[72:73], v[72:73]
    v_cvt_pk_bf16_f32 v156, v72, v73
    v_pk_fma_f32 v[74:75], v[74:75], v[244:245], v[190:191] op_sel_hi:[1,0,1]
    v_max_f32 v74, 0, v74
    v_max_f32 v75, 0, v75
    v_pk_mul_f32 v[74:75], v[74:75], v[74:75]
    v_cvt_pk_bf16_f32 v157, v74, v75
    v_pk_fma_f32 v[76:77], v[76:77], v[244:245], v[192:193] op_sel_hi:[1,0,1]
    v_max_f32 v76, 0, v76
    v_max_f32 v77, 0, v77
    v_pk_mul_f32 v[76:77], v[76:77], v[76:77]
    v_cvt_pk_bf16_f32 v158, v76, v77
    v_pk_fma_f32 v[78:79], v[78:79], v[244:245], v[194:195] op_sel_hi:[1,0,1]
    v_max_f32 v78, 0, v78
    v_max_f32_e64 v79, 0, v79
    v_pk_mul_f32 v[78:79], v[78:79], v[78:79]
    v_cvt_pk_bf16_f32 v159, v78, v79
    buffer_store_dwordx4 v[156:159], v23, s[48:51], s26 offen offset:0 sc1
    v_pk_fma_f32 v[80:81], v[80:81], v[244:245], v[196:197] op_sel_hi:[1,0,1]
    v_max_f32 v80, 0, v80
    v_max_f32 v81, 0, v81
    s_add_u32 m0, s74, 40960
    v_pk_mul_f32 v[80:81], v[80:81], v[80:81]
    buffer_load_dwordx4 v32, s[4:7], m0 offen sc1 lds
    v_cvt_pk_bf16_f32 v160, v80, v81
    v_pk_fma_f32 v[82:83], v[82:83], v[244:245], v[198:199] op_sel_hi:[1,0,1]
    v_max_f32 v82, 0, v82
    v_max_f32 v83, 0, v83
    v_pk_mul_f32 v[82:83], v[82:83], v[82:83]
    v_cvt_pk_bf16_f32 v161, v82, v83
    v_pk_fma_f32 v[84:85], v[84:85], v[244:245], v[200:201] op_sel_hi:[1,0,1]
    v_max_f32 v84, 0, v84
    v_max_f32 v85, 0, v85
    v_pk_mul_f32 v[84:85], v[84:85], v[84:85]
    v_cvt_pk_bf16_f32 v162, v84, v85
    v_pk_fma_f32 v[86:87], v[86:87], v[244:245], v[202:203] op_sel_hi:[1,0,1]
    v_max_f32 v86, 0, v86
    v_max_f32 v87, 0, v87
    v_pk_mul_f32 v[86:87], v[86:87], v[86:87]
    v_cvt_pk_bf16_f32 v163, v86, v87
    buffer_store_dwordx4 v[160:163], v23, s[48:51], s26 offen offset:1024 sc1
    v_pk_fma_f32 v[88:89], v[88:89], v[244:245], v[204:205] op_sel_hi:[1,0,1]
    v_max_f32 v88, 0, v88
    v_max_f32 v89, 0, v89
    v_pk_mul_f32 v[88:89], v[88:89], v[88:89]
    v_cvt_pk_bf16_f32 v164, v88, v89
    s_add_u32 m0, s74, 45056
    v_pk_fma_f32 v[90:91], v[90:91], v[244:245], v[206:207] op_sel_hi:[1,0,1]
    buffer_load_dwordx4 v32, s[4:7], m0 offen sc1 lds
    v_max_f32 v90, 0, v90
    v_max_f32 v91, 0, v91
    v_pk_mul_f32 v[90:91], v[90:91], v[90:91]
    v_cvt_pk_bf16_f32 v165, v90, v91
    v_pk_fma_f32 v[92:93], v[92:93], v[244:245], v[208:209] op_sel_hi:[1,0,1]
    v_max_f32 v92, 0, v92
    v_max_f32 v93, 0, v93
    v_pk_mul_f32 v[92:93], v[92:93], v[92:93]
    v_cvt_pk_bf16_f32 v166, v92, v93
    v_pk_fma_f32 v[94:95], v[94:95], v[244:245], v[210:211] op_sel_hi:[1,0,1]
    v_max_f32 v94, 0, v94
    v_max_f32 v95, 0, v95
    v_pk_mul_f32 v[94:95], v[94:95], v[94:95]
    v_cvt_pk_bf16_f32 v167, v94, v95
    buffer_store_dwordx4 v[164:167], v23, s[48:51], s26 offen offset:2048 sc1
    v_pk_fma_f32 v[96:97], v[96:97], v[244:245], v[212:213] op_sel_hi:[1,0,1]
    v_max_f32 v96, 0, v96
    v_max_f32 v97, 0, v97
    v_pk_mul_f32 v[96:97], v[96:97], v[96:97]
    v_cvt_pk_bf16_f32 v168, v96, v97
    v_pk_fma_f32 v[98:99], v[98:99], v[244:245], v[214:215] op_sel_hi:[1,0,1]
    v_max_f32 v98, 0, v98
    v_max_f32 v99, 0, v99
    v_pk_mul_f32 v[98:99], v[98:99], v[98:99]
    v_cvt_pk_bf16_f32 v169, v98, v99
    buffer_store_dwordx2 v[168:169], v24, s[48:51], s26 offen sc1
    s_waitcnt lgkmcnt(0)
    s_nop 0
    v_pk_add_f32 v[52:53], v[52:53], v[136:137]
    v_pk_add_f32 v[54:55], v[54:55], v[138:139]
    v_pk_add_f32 v[56:57], v[56:57], v[140:141]
    v_pk_add_f32 v[58:59], v[58:59], v[142:143]
    v_pk_add_f32 v[60:61], v[60:61], v[144:145]
    v_pk_add_f32 v[62:63], v[62:63], v[146:147]
    v_pk_add_f32 v[64:65], v[64:65], v[148:149]
    v_pk_add_f32 v[66:67], v[66:67], v[150:151]
    v_pk_add_f32 v[68:69], v[68:69], v[152:153]
    v_pk_add_f32 v[70:71], v[70:71], v[154:155]
    s_mov_b64 s[8:9], s[48:49]
    s_add_u32 s48, s48, s56
    s_addc_u32 s49, s49, 0
    s_nop 7
    s_nop 3
    s_branch L_sec_93_e
L_st_94_s:
    buffer_store_dword v28, off, s[8:11], s85 offset:64 sc1
    s_nop 0
    s_branch L_st_94_e
L_st_96_s:
    buffer_store_dwordx4 v[208:211], v220, s[48:51], 0 offen sc1
    s_nop 0
    s_branch L_st_96_e
L_st_97_s:
    buffer_store_dwordx4 v[212:215], v220, s[48:51], 0 offen offset:2048 sc1
    s_nop 0
    s_branch L_st_97_e
L_st_98_s:
    buffer_store_dwordx2 v[216:217], v221, s[48:51], 0 offen sc1
    s_nop 0
    s_branch L_st_98_e
L_st_99_s:
    buffer_store_dword v28, off, s[48:51], s85 offset:128 sc1
    s_nop 0
    s_branch L_st_99_e
.section .rodata,"a"
.p2align 6
.amdhsa_kernel interleave_layers__linear_kernel_hedgehog__dense_activation_squared_relu__prompt_kernel
  .amdhsa_next_free_vgpr 512
  .amdhsa_next_free_sgpr 102
  .amdhsa_accum_offset 256
  .amdhsa_group_segment_fixed_size 0
  .amdhsa_kernarg_size 96
  .amdhsa_user_sgpr_count 2
  .amdhsa_user_sgpr_kernarg_segment_ptr 1
  .amdhsa_system_sgpr_workgroup_id_x 1
.end_amdhsa_kernel
```
